```python
import torch

def _softmax(x, axis=-1):
    return torch.softmax(x, dim=axis)
def _gelu(x):
    return torch.nn.functional.gelu(x, approximate="tanh")
def _silu(x):
    return torch.nn.functional.silu(x)
def _sigmoid(x):
    return torch.sigmoid(x)
def _layernorm(x, axis=-1, eps=1e-5):
    m = x.mean(dim=axis, keepdim=True)
    v = x.var(dim=axis, keepdim=True, unbiased=False)
    return (x - m) / torch.sqrt(v + eps)
def _scatter_add(tgt, idx, src, axis=0):
    return tgt.clone().index_add_(axis, idx, src)
def _segment_sum(src, seg, n):
    out = torch.zeros((n,) + src.shape[1:], dtype=src.dtype)
    return out.index_add_(0, seg, src)
def _pad(x, pw):
    flat = tuple(v for pair in reversed(pw) for v in pair)
    return torch.nn.functional.pad(x, flat)

kernel_name = 'recurrent_scan__linear_attn_block__glu_gated_glu__prompt'

def setup_inputs():

    _w = (lambda a: (lambda t: t.to(torch.bfloat16) if t.is_floating_point() else t)(torch.as_tensor(a)))
    def _A_setup():
        B, S, D = 1, 2048, 576
        return {
            "x": _w((lambda *s: torch.randn(*s, dtype=torch.bfloat16) * 0.05)(B, S, D)),
            "wqkv": _w((lambda *s: torch.randn(*s, dtype=torch.bfloat16) * 0.05)(D, 3 * D)),
            "wo": _w((lambda *s: torch.randn(*s, dtype=torch.bfloat16) * 0.05)(D, D)),
        }
    _A_in = _A_setup()

    def _B_setup():
        B, S, D, F = 1, 2048, 576, 4608
        return {
            "x": _w((lambda *s: torch.randn(*s, dtype=torch.bfloat16) * 0.05)(B, S, D)),
            "w_gate": _w((lambda *s: torch.randn(*s, dtype=torch.bfloat16) * 0.05)(D, F)),
            "w_up": _w((lambda *s: torch.randn(*s, dtype=torch.bfloat16) * 0.05)(D, F)),
            "w_down": _w((lambda *s: torch.randn(*s, dtype=torch.bfloat16) * 0.05)(F, D)),
        }
    _B_in = _B_setup()

    return {
        "A_x": _A_in["x"],
        "A_wqkv": _A_in["wqkv"],
        "A_wo": _A_in["wo"],
        "B_x": _B_in["x"],
        "B_w_gate": _B_in["w_gate"],
        "B_w_up": _B_in["w_up"],
        "B_w_down": _B_in["w_down"],
    }

def reference(A_x, A_wqkv, A_wo, B_x, B_w_gate, B_w_up, B_w_down):
    def _A_ref(x, wqkv, wo):
        B, S, D = x.shape
        H = 32; Dh = D // H
        qkv = (lambda x, *d: x.permute(*d))((x @ wqkv).reshape(B, S, 3, H, Dh), 2, 0, 3, 1, 4)
        q, k, v = qkv[0], qkv[1], qkv[2]
        phi = lambda t: torch.where(t > 0, t + 1, torch.exp(t)) + 1e-6
        pq, pk = phi(q), phi(k)
        kv = torch.einsum("bhsd,bhse->bhde", pk, v)
        z = torch.einsum("bhsd->bhd", pk)
        num = torch.einsum("bhqd,bhde->bhqe", pq, kv)
        den = torch.einsum("bhqd,bhd->bhq", pq, z)[..., None] + 1e-6
        o = num / den
        return (lambda x, *d: x.permute(*d))(o, 0, 2, 1, 3).reshape(B, S, D) @ wo

    def _B_ref(x, w_gate, w_up, w_down):
        g = torch.einsum("bsd,df->bsf", x, w_gate)
        u = torch.einsum("bsd,df->bsf", x, w_up)
        h = _sigmoid(g) * u
        return torch.einsum("bsf,fd->bsd", h, w_down)

    x = A_x
    xn = _layernorm(x, axis=-1)
    s = _A_ref(xn, A_wqkv, A_wo)
    g = _silu(_B_ref(xn, B_w_gate, B_w_up, B_w_down))
    return x + s * g
```

```asm
; @launch grid=(256,1,1) block=(256,1,1) lds=163840
.amdgcn_target "amdgcn-amd-amdhsa--gfx950"
.text
.globl recurrent_scan__linear_attn_block__glu_gated_glu__prompt_kernel
.p2align 8
.type recurrent_scan__linear_attn_block__glu_gated_glu__prompt_kernel,@function
recurrent_scan__linear_attn_block__glu_gated_glu__prompt_kernel:
s_cmp_ge_u32 s2,256
s_cbranch_scc0 L_go
s_endpgm
L_go:
s_load_dwordx4 s[4:7],s[0:1],0
s_load_dwordx4 s[32:35],s[0:1],64
s_load_dwordx2 s[36:37],s[0:1],16
s_load_dwordx4 s[8:11],s[0:1],32
s_load_dwordx4 s[20:23],s[0:1],48
s_add_u32 s3,s2,8
s_bitcmp1_b32 s3,4
s_cbranch_scc1 L_four
s_getpc_b64 s[90:91]
L_pc_5:
s_lshr_b32 s89,s2,3
v_and_b32 v226,63,v0
v_lshrrev_b32 v1,6,v0
s_lshr_b32 s88,s2,4
s_and_b32 s88,s88,14
s_bfe_u32 s98,s2,0x10003
s_or_b32 s88,s88,s98
v_lshl_add_u32 v2,v226,4,s88
v_readfirstlane_b32 s45,v1
v_lshlrev_b32 v2,7,v2
v_min_u32 v2,L_stop_5-L_pc_5,v2
v_cmp_gt_u32 vcc,32,v0
s_nop 1
s_and_saveexec_b64 s[98:99],vcc
s_cbranch_execz L_nowarm_5
global_load_dword v255,v2,s[90:91]
L_nowarm_5:
s_mov_b64 exec,-1
s_and_b32 s43,s89,3
s_lshr_b32 s44,s89,2
s_and_b32 s88,s2,1
s_lshl_b32 s88,s88,3
s_add_u32 s40,s88,s44
s_lshl_b32 s88,s43,1
s_add_u32 s88,s88,s44
s_sub_u32 s90,s88,9
s_cselect_b32 s88,s88,s90
s_lshl_b32 s66,s88,7
s_lshl_b32 s89,s40,2
s_add_u32 s89,s89,s45
s_lshl_b32 s89,s89,5
v_lshrrev_b32 v4,3,v226
v_add_u32 v4,s89,v4
v_mul_u32_u24 v4,1152,v4
v_bfe_u32 v5,v226,4,2
v_lshlrev_b32 v5,1,v5
v_and_b32 v6,7,v226
v_xor_b32 v213,v5,v6
v_lshl_add_u32 v230,v213,4,v4
v_add_u32 v231,8192,v230
v_add_u32 v232,18432,v230
v_add_u32 v233,26624,v230
s_mul_i32 s85,s45,18432
s_add_u32 s85,s85,16384
s_add_u32 s75,s85,73728
v_mov_b32 v253,v0
s_waitcnt lgkmcnt(0)
s_mov_b32 s16,s6
s_mov_b32 s17,s7
s_mov_b32 s6,2359296
s_mov_b32 s7,0x20000
s_add_u32 m0,s85,0
s_nop 0
buffer_load_dwordx4 v230,s[4:7],s66 offen lds
buffer_load_dwordx4 v231,s[4:7],s66 offen offset:1024 lds
s_add_u32 s67,s66,128
s_cmp_eq_u32 s67,1152
s_cselect_b32 s67,0,s67
s_add_u32 m0,s85,2048
s_nop 0
buffer_load_dwordx4 v230,s[4:7],s67 offen lds
buffer_load_dwordx4 v231,s[4:7],s67 offen offset:1024 lds
s_add_u32 s68,s67,128
s_cmp_eq_u32 s68,1152
s_cselect_b32 s68,0,s68
s_add_u32 m0,s85,4096
s_nop 0
buffer_load_dwordx4 v230,s[4:7],s68 offen lds
buffer_load_dwordx4 v231,s[4:7],s68 offen offset:1024 lds
s_add_u32 m0,s75,0
s_nop 0
buffer_load_dwordx4 v232,s[4:7],s66 offen lds
buffer_load_dwordx4 v233,s[4:7],s66 offen offset:1024 lds
s_add_u32 m0,s75,2048
s_nop 0
buffer_load_dwordx4 v232,s[4:7],s67 offen lds
buffer_load_dwordx4 v233,s[4:7],s67 offen offset:1024 lds
s_add_u32 m0,s75,4096
s_nop 0
buffer_load_dwordx4 v232,s[4:7],s68 offen lds
buffer_load_dwordx4 v233,s[4:7],s68 offen offset:1024 lds
s_add_u32 s69,s68,128
s_cmp_eq_u32 s69,1152
s_cselect_b32 s69,0,s69
s_add_u32 s70,s69,128
s_cmp_eq_u32 s70,1152
s_cselect_b32 s70,0,s70
s_add_u32 s71,s70,128
s_cmp_eq_u32 s71,1152
s_cselect_b32 s71,0,s71
s_add_u32 s72,s71,128
s_cmp_eq_u32 s72,1152
s_cselect_b32 s72,0,s72
s_add_u32 s73,s72,128
s_cmp_eq_u32 s73,1152
s_cselect_b32 s73,0,s73
s_add_u32 s74,s73,128
s_cmp_eq_u32 s74,1152
s_cselect_b32 s74,0,s74
s_mov_b32 s24,s34
s_mov_b32 s25,s35
s_mov_b32 s26,67108864
s_mov_b32 s27,0x20000
s_bfe_u32 s42,s2,0x20001
s_lshl_b32 s41,s42,2
s_and_b32 s88,s43,2
s_add_u32 s41,s41,s88
s_lshr_b32 s88,s42,1
s_xor_b32 s88,s88,0
s_add_u32 s41,s41,s88
s_lshr_b32 s3,s40,3
s_and_b32 s3,s3,1
s_xor_b32 s101,s41,1
s_lshr_b32 s46,s45,1
s_and_b32 s47,s45,1
v_mov_b32 v225,1
v_min_u32 v224,1,v253
v_lshlrev_b32 v224,31,v224
v_lshlrev_b32 v212,4,v226
v_mov_b32 v192,0x3f803f80
v_mov_b32 v193,0x3f803f80
v_mov_b32 v194,0x3f803f80
v_mov_b32 v195,0x3f803f80
v_and_b32 v238,15,v226
v_lshrrev_b32 v239,4,v226
v_bfe_u32 v244,v226,1,2
v_lshlrev_b32 v244,1,v244
v_xor_b32 v244,v244,v239
v_lshlrev_b32 v244,4,v244
v_lshl_add_u32 v244,v238,7,v244
s_mov_b32 s88,s85
v_add_u32 v244,s88,v244
v_xor_b32 v245,64,v244
v_lshlrev_b32 v239,3,v239
v_sub_u32 v238,v238,v239
v_mov_b32 v239,0x3f80
v_mov_b32 v242,0x3f800000
v_cmp_eq_u32 vcc,0,v238
v_cmp_eq_u32 s[98:99],1,v238
v_mov_b32 v240,0
v_cndmask_b32 v196,0,v239,vcc
v_cndmask_b32 v196,v196,v242,s[98:99]
v_cmp_eq_u32 vcc,2,v238
v_cmp_eq_u32 s[98:99],3,v238
v_mov_b32 v240,0
v_cndmask_b32 v197,0,v239,vcc
v_cndmask_b32 v197,v197,v242,s[98:99]
v_cmp_eq_u32 vcc,4,v238
v_cmp_eq_u32 s[98:99],5,v238
v_mov_b32 v240,0
v_cndmask_b32 v198,0,v239,vcc
v_cndmask_b32 v198,v198,v242,s[98:99]
v_cmp_eq_u32 vcc,6,v238
v_cmp_eq_u32 s[98:99],7,v238
v_mov_b32 v240,0
v_cndmask_b32 v199,0,v239,vcc
v_cndmask_b32 v199,v199,v242,s[98:99]
v_cmp_eq_u32 vcc,-16,v238
v_cmp_eq_u32 s[98:99],-15,v238
v_mov_b32 v240,0
v_cndmask_b32 v200,0,v239,vcc
v_cndmask_b32 v200,v200,v242,s[98:99]
v_cmp_eq_u32 vcc,-14,v238
v_cmp_eq_u32 s[98:99],-13,v238
v_mov_b32 v240,0
v_cndmask_b32 v201,0,v239,vcc
v_cndmask_b32 v201,v201,v242,s[98:99]
v_cmp_eq_u32 vcc,-12,v238
v_cmp_eq_u32 s[98:99],-11,v238
v_mov_b32 v240,0
v_cndmask_b32 v202,0,v239,vcc
v_cndmask_b32 v202,v202,v242,s[98:99]
v_cmp_eq_u32 vcc,-10,v238
v_cmp_eq_u32 s[98:99],-9,v238
v_mov_b32 v240,0
v_cndmask_b32 v203,0,v239,vcc
v_cndmask_b32 v203,v203,v242,s[98:99]
v_add_u32 v242,s88,v212
s_xor_b32 s89,s45,1
s_mul_i32 s89,s89,18432
s_add_u32 s89,s89,16384
v_add_u32 v243,s89,v212
v_mov_b32 v238,0
v_mov_b32 v239,0
v_mov_b32 v241,0
s_add_u32 m0,s85,6144
s_nop 0
buffer_load_dwordx4 v230,s[4:7],s69 offen lds
s_mul_i32 s48,s66,4608
s_mul_i32 s57,s66,1728
s_mul_i32 s49,s67,4608
s_mul_i32 s58,s67,1728
s_mul_i32 s50,s68,4608
s_mul_i32 s59,s68,1728
s_mul_i32 s51,s69,4608
s_mul_i32 s60,s69,1728
s_mul_i32 s52,s70,4608
s_mul_i32 s61,s70,1728
s_mul_i32 s53,s71,4608
s_mul_i32 s62,s71,1728
s_mul_i32 s54,s72,4608
s_mul_i32 s63,s72,1728
s_mul_i32 s55,s73,4608
s_mul_i32 s64,s73,1728
s_mul_i32 s56,s74,4608
s_mul_i32 s65,s74,1728
s_mov_b32 s12,s10
s_mov_b32 s13,s11
buffer_load_dwordx4 v231,s[4:7],s69 offen offset:1024 lds
s_mov_b32 s28,s22
s_mov_b32 s29,s23
s_mov_b32 s30,2359296
s_mov_b32 s31,0x20000
s_mov_b32 s34,256
s_mov_b32 s35,0x20000
s_lshl_b32 s89,s43,3
s_lshr_b32 s97,0x0d090500,s89
s_and_b32 s97,s97,0xff
s_lshl_b32 s88,s97,7
s_mul_i32 s89,s42,2304
s_add_u32 s88,s88,s89
s_add_u32 s8,s8,s88
s_addc_u32 s9,s9,0
s_sub_u32 s10,5308416,s88
s_mov_b32 s11,0x20000
s_add_u32 s12,s12,s88
s_addc_u32 s13,s13,0
s_sub_u32 s12,s12,1024
s_subb_u32 s13,s13,0
s_sub_u32 s14,5309440,s88
s_mov_b32 s15,0x20000
s_mov_b32 s18,1990656
s_mov_b32 s19,0x20000
s_add_u32 m0,s85,8192
s_nop 0
buffer_load_dwordx4 v230,s[4:7],s70 offen lds
s_lshl_b32 s89,s43,3
s_lshr_b32 s88,0x07050200,s89
s_and_b32 s88,s88,0xff
s_lshl_b32 s88,s88,7
s_mul_i32 s89,s46,4608
s_add_u32 s89,s89,s88
s_add_u32 s36,s36,s89
s_addc_u32 s37,s37,0
s_sub_u32 s36,s36,1024
s_subb_u32 s37,s37,0
s_sub_u32 s38,664576,s89
s_mov_b32 s39,0x20000
s_mul_i32 s89,s42,1327104
s_add_u32 s88,s88,s89
s_add_u32 s20,s20,s88
s_addc_u32 s21,s21,0
s_sub_u32 s20,s20,1024
s_subb_u32 s21,s21,0
s_sub_u32 s22,5309440,s88
s_mov_b32 s23,0x20000
s_lshl_b32 s84,s45,11
v_lshrrev_b32 v237,3,v226
s_lshl_b32 s88,s45,3
v_add_u32 v237,s88,v237
buffer_load_dwordx4 v231,s[4:7],s70 offen offset:1024 lds
v_mul_u32_u24 v237,9216,v237
v_lshl_add_u32 v213,v213,4,v237
v_add_u32 v214,294912,v213
v_lshrrev_b32 v236,2,v226
v_lshrrev_b32 v237,5,v226
v_lshlrev_b32 v237,11,v237
v_and_b32 v235,7,v236
v_lshl_add_u32 v237,v235,7,v237
v_bfe_u32 v235,v226,3,2
s_lshl_b32 s88,s47,1
v_xor_b32 v235,s88,v235
v_lshl_add_u32 v237,v235,5,v237
v_and_b32 v235,3,v226
v_lshl_add_u32 v215,v235,3,v237
v_xor_b32 v216,32,v215
s_sub_u32 s92,0,s47
s_mov_b32 s93,s92
s_lshl_b32 s88,s47,1
s_lshr_b32 s94,0x44444444,s88
s_mov_b32 s95,s94
s_lshl_b32 s88,s40,2
s_add_u32 m0,s85,10240
s_nop 0
buffer_load_dwordx4 v230,s[4:7],s71 offen lds
s_add_u32 s88,s88,s42
s_mul_i32 s96,s88,294912
s_add_u32 s96,s96,16777216
s_lshl_b32 s88,s97,14
s_add_u32 s88,s88,s96
s_lshl_b32 s89,s47,11
s_add_u32 s88,s88,s89
s_lshl_b32 s89,s45,12
s_add_u32 s86,s88,s89
s_xor_b32 s89,s89,4096
s_add_u32 s87,s88,s89
s_mul_i32 s98,s101,72
s_and_b32 s98,s98,-16
v_mov_b32 v252,s98
s_mul_i32 s98,s41,72
s_and_b32 s98,s98,-16
v_lshrrev_b32 v248,4,v226
v_add_u32 v248,0,v248
v_and_b32 v249,7,v248
v_lshlrev_b32 v249,1,v249
buffer_load_dwordx4 v231,s[4:7],s71 offen offset:1024 lds
v_and_b32 v250,15,v226
v_xor_b32 v249,v249,v250
v_mul_u32_u24 v250,52,v249
v_lshrrev_b32 v250,8,v250
v_mul_u32_u24 v251,5,v250
v_sub_u32 v249,v249,v251
v_lshlrev_b32 v249,4,v249
v_add_u32 v251,1,v250
v_mul_u32_u24 v251,1152,v251
v_add_u32 v251,s98,v251
v_cmp_eq_u32 vcc,2,v250
s_nop 1
v_cndmask_b32 v251,v251,v252,vcc
v_add_u32 v249,v249,v251
v_add_u32 v250,1,v250
v_lshrrev_b32 v250,2,v250
v_lshl_or_b32 v249,v250,31,v249
s_lshl_b32 s100,s45,4
v_add_u32 v248,s100,v248
v_mul_u32_u24 v248,3456,v248
v_add_u32 v219,v248,v249
v_lshrrev_b32 v248,4,v226
s_add_u32 m0,s85,12288
s_nop 0
buffer_load_dwordx4 v230,s[4:7],s72 offen lds
v_add_u32 v248,4,v248
v_and_b32 v249,7,v248
v_lshlrev_b32 v249,1,v249
v_and_b32 v250,15,v226
v_xor_b32 v249,v249,v250
v_mul_u32_u24 v250,52,v249
v_lshrrev_b32 v250,8,v250
v_mul_u32_u24 v251,5,v250
v_sub_u32 v249,v249,v251
v_lshlrev_b32 v249,4,v249
v_add_u32 v251,1,v250
v_mul_u32_u24 v251,1152,v251
v_add_u32 v251,s98,v251
v_cmp_eq_u32 vcc,2,v250
s_nop 1
v_cndmask_b32 v251,v251,v252,vcc
v_add_u32 v249,v249,v251
v_add_u32 v250,1,v250
v_lshrrev_b32 v250,2,v250
v_lshl_or_b32 v249,v250,31,v249
s_lshl_b32 s100,s45,4
buffer_load_dwordx4 v231,s[4:7],s72 offen offset:1024 lds
v_add_u32 v248,s100,v248
v_mul_u32_u24 v248,3456,v248
v_add_u32 v220,v248,v249
v_subrev_u32 v220,1024,v220
v_lshrrev_b32 v248,4,v226
v_add_u32 v248,8,v248
v_and_b32 v249,7,v248
v_lshlrev_b32 v249,1,v249
v_and_b32 v250,15,v226
v_xor_b32 v249,v249,v250
v_mul_u32_u24 v250,52,v249
v_lshrrev_b32 v250,8,v250
v_mul_u32_u24 v251,5,v250
v_sub_u32 v249,v249,v251
v_lshlrev_b32 v249,4,v249
v_add_u32 v251,1,v250
v_mul_u32_u24 v251,1152,v251
v_add_u32 v251,s98,v251
v_cmp_eq_u32 vcc,2,v250
s_nop 1
v_cndmask_b32 v251,v251,v252,vcc
v_add_u32 v249,v249,v251
s_add_u32 m0,s85,14336
s_nop 0
buffer_load_dwordx4 v230,s[4:7],s73 offen lds
v_add_u32 v250,1,v250
v_lshrrev_b32 v250,2,v250
v_lshl_or_b32 v249,v250,31,v249
s_lshl_b32 s100,s45,4
v_add_u32 v248,s100,v248
v_mul_u32_u24 v248,3456,v248
v_add_u32 v221,v248,v249
v_subrev_u32 v221,2048,v221
v_lshrrev_b32 v248,4,v226
v_add_u32 v248,12,v248
v_and_b32 v249,7,v248
v_lshlrev_b32 v249,1,v249
v_and_b32 v250,15,v226
v_xor_b32 v249,v249,v250
v_mul_u32_u24 v250,52,v249
v_lshrrev_b32 v250,8,v250
v_mul_u32_u24 v251,5,v250
v_sub_u32 v249,v249,v251
v_lshlrev_b32 v249,4,v249
v_add_u32 v251,1,v250
buffer_load_dwordx4 v231,s[4:7],s73 offen offset:1024 lds
v_mul_u32_u24 v251,1152,v251
v_add_u32 v251,s98,v251
v_cmp_eq_u32 vcc,2,v250
s_nop 1
v_cndmask_b32 v251,v251,v252,vcc
v_add_u32 v249,v249,v251
v_add_u32 v250,1,v250
v_lshrrev_b32 v250,2,v250
v_lshl_or_b32 v249,v250,31,v249
s_lshl_b32 s100,s45,4
v_add_u32 v248,s100,v248
v_mul_u32_u24 v248,3456,v248
v_add_u32 v222,v248,v249
v_subrev_u32 v222,3072,v222
s_and_b32 s98,s41,1
s_lshl_b32 s98,s98,3
s_mul_i32 s99,s47,40
s_and_b32 s100,s101,1
s_lshl_b32 s100,s100,3
s_add_u32 s100,s100,s99
s_add_u32 s99,s99,s98
s_add_u32 s98,s98,32
s_add_u32 m0,s85,16384
s_nop 0
buffer_load_dwordx4 v230,s[4:7],s74 offen lds
v_and_b32 v248,3,v226
v_lshl_add_u32 v248,v248,3,s99
v_add_u32 v248,0,v248
v_bfe_u32 v249,v226,2,3
v_lshlrev_b32 v249,5,v249
v_xor_b32 v248,v248,v249
v_lshrrev_b32 v249,2,v226
v_lshl_add_u32 v218,v249,8,v248
v_and_b32 v248,3,v226
v_lshl_add_u32 v248,v248,3,s99
v_add_u32 v248,80,v248
v_bfe_u32 v249,v226,2,3
v_lshlrev_b32 v249,5,v249
v_xor_b32 v248,v248,v249
v_lshrrev_b32 v249,2,v226
v_lshl_add_u32 v228,v249,8,v248
v_and_b32 v248,3,v226
v_lshl_add_u32 v248,v248,3,s100
v_add_u32 v248,160,v248
v_bfe_u32 v249,v226,2,3
buffer_load_dwordx4 v231,s[4:7],s74 offen offset:1024 lds
v_lshlrev_b32 v249,5,v249
v_xor_b32 v248,v248,v249
v_lshrrev_b32 v249,2,v226
v_lshl_add_u32 v229,v249,8,v248
v_and_b32 v248,3,v226
v_min_u32 v248,2,v248
v_lshrrev_b32 v250,1,v248
v_mul_u32_u24 v248,80,v248
v_add_u32 v248,s98,v248
v_lshlrev_b32 v250,3,v250
v_and_b32 v250,8,v250
v_xor_b32 v248,v248,v250
v_bfe_u32 v249,v226,2,3
v_lshlrev_b32 v249,5,v249
v_xor_b32 v248,v248,v249
v_lshrrev_b32 v249,2,v226
v_lshl_add_u32 v223,v249,8,v248
s_waitcnt vmcnt(22)
ds_read_b128 v[0:3],v244 offset:0
ds_read_b128 v[4:7],v245 offset:0
s_waitcnt vmcnt(20)
ds_read_b128 v[8:11],v244 offset:2048
s_waitcnt lgkmcnt(0)
v_mfma_f32_16x16x32_bf16 v[204:207],v[192:195],v[0:3],0
ds_read_b128 v[12:15],v245 offset:2048
s_add_u32 m0,s75,6144
s_waitcnt vmcnt(18)
ds_read_b128 v[16:19],v244 offset:4096
ds_read_b128 v[20:23],v245 offset:4096
v_mfma_f32_16x16x32_bf16 v[204:207],v[192:195],v[4:7],v[204:207]
buffer_load_dwordx4 v232,s[4:7],s69 offen lds
buffer_load_dwordx4 v233,s[4:7],s69 offen offset:1024 lds
s_add_u32 m0,s75,8192
s_waitcnt vmcnt(8)
ds_read_b128 v[24:27],v244 offset:6144
v_mfma_f32_16x16x32_bf16 v[204:207],v[192:195],v[8:11],v[204:207]
ds_read_b128 v[28:31],v245 offset:6144
ds_read_b128 v[32:35],v244 offset:8192
ds_read_b128 v[36:39],v245 offset:8192
ds_read_b128 v[40:43],v244 offset:10240
ds_read_b128 v[44:47],v245 offset:10240
s_waitcnt lgkmcnt(6)
v_mfma_f32_16x16x32_bf16 v[204:207],v[192:195],v[12:15],v[204:207]
buffer_load_dwordx4 v232,s[4:7],s70 offen lds
buffer_load_dwordx4 v233,s[4:7],s70 offen offset:1024 lds
s_add_u32 m0,s75,10240
s_waitcnt vmcnt(4)
ds_read_b128 v[48:51],v244 offset:12288
v_mfma_f32_16x16x32_bf16 v[204:207],v[192:195],v[16:19],v[204:207]
ds_read_b128 v[52:55],v245 offset:12288
ds_read_b128 v[56:59],v244 offset:14336
ds_read_b128 v[60:63],v245 offset:14336
ds_read_b128 v[120:123],v244 offset:16384
ds_read_b128 v[124:127],v245 offset:16384
v_mfma_f32_16x16x32_bf16 v[204:207],v[192:195],v[20:23],v[204:207]
buffer_load_dwordx4 v232,s[4:7],s71 offen lds
buffer_load_dwordx4 v233,s[4:7],s71 offen offset:1024 lds
s_add_u32 m0,s75,12288
s_waitcnt lgkmcnt(9)
s_sub_u32 s88,s75,s85
v_mfma_f32_16x16x32_bf16 v[204:207],v[192:195],v[24:27],v[204:207]
buffer_load_dwordx4 v232,s[4:7],s72 offen lds
buffer_load_dwordx4 v233,s[4:7],s72 offen offset:1024 lds
s_add_u32 m0,s75,14336
v_add_u32 v244,s88,v244
v_add_u32 v245,s88,v245
v_mfma_f32_16x16x32_bf16 v[204:207],v[192:195],v[28:31],v[204:207]
buffer_load_dwordx4 v232,s[4:7],s73 offen lds
buffer_load_dwordx4 v233,s[4:7],s73 offen offset:1024 lds
s_add_u32 m0,s75,16384
s_lshl_b32 s88,s45,10
s_add_u32 s88,s88,147456
v_mfma_f32_16x16x32_bf16 v[204:207],v[192:195],v[32:35],v[204:207]
buffer_load_dwordx4 v232,s[4:7],s74 offen lds
buffer_load_dwordx4 v233,s[4:7],s74 offen offset:1024 lds
s_waitcnt lgkmcnt(6)
v_mfma_f32_16x16x32_bf16 v[204:207],v[192:195],v[36:39],v[204:207]
v_mfma_f32_16x16x32_bf16 v[204:207],v[192:195],v[40:43],v[204:207]
v_mfma_f32_16x16x32_bf16 v[204:207],v[192:195],v[44:47],v[204:207]
s_waitcnt lgkmcnt(3)
v_mfma_f32_16x16x32_bf16 v[204:207],v[192:195],v[48:51],v[204:207]
v_mfma_f32_16x16x32_bf16 v[204:207],v[192:195],v[52:55],v[204:207]
v_mfma_f32_16x16x32_bf16 v[204:207],v[192:195],v[56:59],v[204:207]
s_waitcnt lgkmcnt(0)
v_mfma_f32_16x16x32_bf16 v[204:207],v[192:195],v[60:63],v[204:207]
v_mfma_f32_16x16x32_bf16 v[204:207],v[192:195],v[120:123],v[204:207]
v_mfma_f32_16x16x32_bf16 v[204:207],v[192:195],v[124:127],v[204:207]
s_nop 7
v_mul_f32 v204,0xbae38e39,v204
v_mul_f32 v205,0xbae38e39,v205
v_mul_f32 v206,0xbae38e39,v206
v_mul_f32 v207,0xbae38e39,v207
s_nop 1
v_mfma_f32_16x16x32_bf16 v[176:179],v[196:199],v[0:3],v[204:207]
v_mfma_f32_16x16x32_bf16 v[180:183],v[200:203],v[0:3],v[204:207]
v_mfma_f32_16x16x32_bf16 v[184:187],v[196:199],v[4:7],v[204:207]
v_mfma_f32_16x16x32_bf16 v[188:191],v[200:203],v[4:7],v[204:207]
s_nop 4
v_cvt_pk_bf16_f32 v246,v176,v177
v_cvt_pk_bf16_f32 v247,v178,v179
v_cvt_pk_bf16_f32 v248,v180,v181
v_cvt_pk_bf16_f32 v249,v182,v183
v_accvgpr_write_b32 a0,v246
s_nop 0
v_mfma_f32_16x16x32_bf16 v[238:241],v[246:249],v[246:249],0
ds_write_b128 v242,v[246:249] offset:0
v_accvgpr_write_b32 a1,v247
v_accvgpr_write_b32 a2,v248
v_accvgpr_write_b32 a3,v249
v_mfma_f32_16x16x32_bf16 v[176:179],v[196:199],v[8:11],v[204:207]
v_cvt_pk_bf16_f32 v250,v184,v185
v_cvt_pk_bf16_f32 v251,v186,v187
v_accvgpr_write_b32 a16,v250
v_accvgpr_write_b32 a17,v251
v_mfma_f32_16x16x32_bf16 v[180:183],v[200:203],v[8:11],v[204:207]
s_add_u32 m0,s84,0
v_cvt_pk_bf16_f32 v252,v188,v189
v_cvt_pk_bf16_f32 v253,v190,v191
ds_write_b128 v242,v[250:253] offset:1024
v_accvgpr_write_b32 a18,v252
v_mfma_f32_16x16x32_bf16 v[238:241],v[250:253],v[250:253],v[238:241]
buffer_load_dwordx4 v213,s[8:11],s48 offen lds
buffer_load_dwordx4 v213,s[12:15],s48 offen offset:1024 lds
s_add_u32 m0,s84,8192
v_accvgpr_write_b32 a19,v253
v_mfma_f32_16x16x32_bf16 v[184:187],v[196:199],v[12:15],v[204:207]
buffer_load_dwordx4 v214,s[8:11],s48 offen lds
buffer_load_dwordx4 v214,s[12:15],s48 offen offset:1024 lds
v_cvt_pk_bf16_f32 v208,v176,v177
v_cvt_pk_bf16_f32 v209,v178,v179
v_accvgpr_write_b32 a32,v208
v_mfma_f32_16x16x32_bf16 v[188:191],v[200:203],v[12:15],v[204:207]
v_cvt_pk_bf16_f32 v210,v180,v181
v_cvt_pk_bf16_f32 v211,v182,v183
ds_write_b128 v242,v[208:211] offset:2048
v_accvgpr_write_b32 a33,v209
v_accvgpr_write_b32 a34,v210
v_mfma_f32_16x16x32_bf16 v[238:241],v[208:211],v[208:211],v[238:241]
v_accvgpr_write_b32 a35,v211
v_mfma_f32_16x16x32_bf16 v[176:179],v[196:199],v[16:19],v[204:207]
v_cvt_pk_bf16_f32 v246,v184,v185
v_cvt_pk_bf16_f32 v247,v186,v187
v_accvgpr_write_b32 a48,v246
v_accvgpr_write_b32 a49,v247
v_mfma_f32_16x16x32_bf16 v[180:183],v[200:203],v[16:19],v[204:207]
v_cvt_pk_bf16_f32 v248,v188,v189
v_cvt_pk_bf16_f32 v249,v190,v191
ds_write_b128 v242,v[246:249] offset:3072
v_accvgpr_write_b32 a50,v248
v_accvgpr_write_b32 a51,v249
v_mfma_f32_16x16x32_bf16 v[238:241],v[246:249],v[246:249],v[238:241]
v_mfma_f32_16x16x32_bf16 v[184:187],v[196:199],v[20:23],v[204:207]
v_cvt_pk_bf16_f32 v250,v176,v177
v_cvt_pk_bf16_f32 v251,v178,v179
v_accvgpr_write_b32 a64,v250
v_accvgpr_write_b32 a65,v251
v_mfma_f32_16x16x32_bf16 v[188:191],v[200:203],v[20:23],v[204:207]
v_cvt_pk_bf16_f32 v252,v180,v181
v_cvt_pk_bf16_f32 v253,v182,v183
ds_write_b128 v242,v[250:253] offset:4096
v_accvgpr_write_b32 a66,v252
v_accvgpr_write_b32 a67,v253
v_mfma_f32_16x16x32_bf16 v[238:241],v[250:253],v[250:253],v[238:241]
v_mfma_f32_16x16x32_bf16 v[176:179],v[196:199],v[24:27],v[204:207]
v_cvt_pk_bf16_f32 v208,v184,v185
v_cvt_pk_bf16_f32 v209,v186,v187
v_accvgpr_write_b32 a80,v208
v_accvgpr_write_b32 a81,v209
v_mfma_f32_16x16x32_bf16 v[180:183],v[200:203],v[24:27],v[204:207]
v_cvt_pk_bf16_f32 v210,v188,v189
v_cvt_pk_bf16_f32 v211,v190,v191
ds_write_b128 v242,v[208:211] offset:5120
v_accvgpr_write_b32 a82,v210
v_accvgpr_write_b32 a83,v211
v_mfma_f32_16x16x32_bf16 v[238:241],v[208:211],v[208:211],v[238:241]
v_mfma_f32_16x16x32_bf16 v[184:187],v[196:199],v[28:31],v[204:207]
v_cvt_pk_bf16_f32 v246,v176,v177
v_cvt_pk_bf16_f32 v247,v178,v179
v_accvgpr_write_b32 a96,v246
v_accvgpr_write_b32 a97,v247
v_mfma_f32_16x16x32_bf16 v[188:191],v[200:203],v[28:31],v[204:207]
v_cvt_pk_bf16_f32 v248,v180,v181
v_cvt_pk_bf16_f32 v249,v182,v183
ds_write_b128 v242,v[246:249] offset:6144
v_accvgpr_write_b32 a98,v248
v_accvgpr_write_b32 a99,v249
v_mfma_f32_16x16x32_bf16 v[238:241],v[246:249],v[246:249],v[238:241]
v_mfma_f32_16x16x32_bf16 v[176:179],v[196:199],v[32:35],v[204:207]
v_cvt_pk_bf16_f32 v250,v184,v185
v_cvt_pk_bf16_f32 v251,v186,v187
v_accvgpr_write_b32 a112,v250
v_accvgpr_write_b32 a113,v251
s_waitcnt lgkmcnt(1)
v_mfma_f32_16x16x32_bf16 v[180:183],v[200:203],v[32:35],v[204:207]
v_cvt_pk_bf16_f32 v252,v188,v189
v_cvt_pk_bf16_f32 v253,v190,v191
ds_write_b128 v242,v[250:253] offset:7168
v_accvgpr_write_b32 a114,v252
v_accvgpr_write_b32 a115,v253
v_mfma_f32_16x16x32_bf16 v[238:241],v[250:253],v[250:253],v[238:241]
s_barrier
ds_read_b128 a[8:11],v243 offset:0
ds_read_b128 a[24:27],v243 offset:1024
ds_read_b128 a[40:43],v243 offset:2048
ds_read_b128 a[56:59],v243 offset:3072
v_mfma_f32_16x16x32_bf16 v[184:187],v[196:199],v[36:39],v[204:207]
v_cvt_pk_bf16_f32 v208,v176,v177
v_cvt_pk_bf16_f32 v209,v178,v179
v_accvgpr_write_b32 a128,v208
v_accvgpr_write_b32 a129,v209
v_mfma_f32_16x16x32_bf16 v[188:191],v[200:203],v[36:39],v[204:207]
ds_read_b128 v[160:163],v244 offset:0
ds_read_b128 v[164:167],v245 offset:0
v_cvt_pk_bf16_f32 v210,v180,v181
v_cvt_pk_bf16_f32 v211,v182,v183
ds_write_b128 v242,v[208:211] offset:8192
s_nop 0
v_mfma_f32_16x16x32_bf16 v[238:241],v[208:211],v[208:211],v[238:241]
v_accvgpr_write_b32 a130,v210
v_accvgpr_write_b32 a131,v211
ds_read_b128 v[168:171],v244 offset:2048
ds_read_b128 v[172:175],v245 offset:2048
v_mfma_f32_16x16x32_bf16 v[176:179],v[196:199],v[40:43],v[204:207]
v_cvt_pk_bf16_f32 v246,v184,v185
v_cvt_pk_bf16_f32 v247,v186,v187
v_accvgpr_write_b32 a144,v246
v_accvgpr_write_b32 a145,v247
v_mfma_f32_16x16x32_bf16 v[180:183],v[200:203],v[40:43],v[204:207]
ds_read_b128 v[64:67],v244 offset:4096
ds_read_b128 v[68:71],v245 offset:4096
v_cvt_pk_bf16_f32 v248,v188,v189
v_cvt_pk_bf16_f32 v249,v190,v191
ds_write_b128 v242,v[246:249] offset:9216
s_nop 0
v_mfma_f32_16x16x32_bf16 v[238:241],v[246:249],v[246:249],v[238:241]
v_accvgpr_write_b32 a146,v248
v_accvgpr_write_b32 a147,v249
s_waitcnt vmcnt(10)
ds_read_b128 v[72:75],v244 offset:6144
ds_read_b128 v[76:79],v245 offset:6144
v_mfma_f32_16x16x32_bf16 v[184:187],v[196:199],v[44:47],v[204:207]
v_cvt_pk_bf16_f32 v250,v176,v177
v_cvt_pk_bf16_f32 v251,v178,v179
ds_read_b128 v[80:83],v244 offset:8192
ds_read_b128 v[84:87],v245 offset:8192
ds_read_b128 v[88:91],v244 offset:10240
v_mfma_f32_16x16x32_bf16 v[188:191],v[200:203],v[44:47],v[204:207]
v_cvt_pk_bf16_f32 v252,v180,v181
v_cvt_pk_bf16_f32 v253,v182,v183
ds_read_b128 v[92:95],v245 offset:10240
ds_write_b128 v242,v[250:253] offset:10240
v_accvgpr_write_b32 a160,v250
v_mfma_f32_16x16x32_bf16 v[238:241],v[250:253],v[250:253],v[238:241]
v_accvgpr_write_b32 a161,v251
v_accvgpr_write_b32 a162,v252
v_accvgpr_write_b32 a163,v253
s_waitcnt vmcnt(4)
ds_read_b128 v[96:99],v244 offset:12288
v_mfma_f32_16x16x32_bf16 v[176:179],v[196:199],v[48:51],v[204:207]
v_cvt_pk_bf16_f32 v208,v184,v185
v_cvt_pk_bf16_f32 v209,v186,v187
ds_read_b128 v[100:103],v245 offset:12288
ds_read_b128 v[104:107],v244 offset:14336
ds_read_b128 v[108:111],v245 offset:14336
v_mfma_f32_16x16x32_bf16 v[180:183],v[200:203],v[48:51],v[204:207]
v_cvt_pk_bf16_f32 v210,v188,v189
v_cvt_pk_bf16_f32 v211,v190,v191
ds_read_b128 v[112:115],v244 offset:16384
ds_read_b128 v[116:119],v245 offset:16384
ds_write_b128 v242,v[208:211] offset:11264
v_mfma_f32_16x16x32_bf16 v[238:241],v[208:211],v[208:211],v[238:241]
s_waitcnt lgkmcnt(15)
v_accvgpr_write_b32 a176,v208
v_accvgpr_write_b32 a177,v209
v_accvgpr_write_b32 a178,v210
v_accvgpr_write_b32 a179,v211
v_mfma_f32_16x16x32_bf16 v[230:233],v[192:195],v[160:163],0
v_cvt_pk_bf16_f32 v246,v176,v177
v_cvt_pk_bf16_f32 v247,v178,v179
v_accvgpr_write_b32 a192,v246
v_accvgpr_write_b32 a193,v247
ds_read_b128 a[72:75],v243 offset:4096
v_mfma_f32_16x16x32_bf16 v[230:233],v[192:195],v[164:167],v[230:233]
v_cvt_pk_bf16_f32 v248,v180,v181
v_cvt_pk_bf16_f32 v249,v182,v183
ds_write_b128 v242,v[246:249] offset:12288
v_accvgpr_write_b32 a194,v248
v_accvgpr_write_b32 a195,v249
v_mfma_f32_16x16x32_bf16 v[230:233],v[192:195],v[168:171],v[230:233]
ds_read_b128 a[88:91],v243 offset:5120
v_add_u32 v244,s88,v212
v_xor_b32 v245,1024,v244
v_mfma_f32_16x16x32_bf16 v[184:187],v[196:199],v[52:55],v[204:207]
s_waitcnt lgkmcnt(3)
s_barrier
s_add_u32 m0,s84,92160
ds_read_b128 a[104:107],v243 offset:6144
ds_read_b128 a[120:123],v243 offset:7168
v_mfma_f32_16x16x32_bf16 v[188:191],v[200:203],v[52:55],v[204:207]
buffer_load_dwordx4 v213,s[8:11],s49 offen lds
ds_read_b128 a[136:139],v243 offset:8192
ds_read_b128 a[152:155],v243 offset:9216
ds_read_b128 a[168:171],v243 offset:10240
ds_read_b128 a[184:187],v243 offset:11264
v_mfma_f32_16x16x32_bf16 v[238:241],v[246:249],v[246:249],v[238:241]
buffer_load_dwordx4 v213,s[12:15],s49 offen offset:1024 lds
s_add_u32 m0,s84,100352
v_mfma_f32_16x16x32_bf16 v[230:233],v[192:195],v[172:175],v[230:233]
v_cvt_pk_bf16_f32 v250,v184,v185
v_cvt_pk_bf16_f32 v251,v186,v187
v_accvgpr_write_b32 a208,v250
v_accvgpr_write_b32 a209,v251
v_mfma_f32_16x16x32_bf16 v[230:233],v[192:195],v[64:67],v[230:233]
v_cvt_pk_bf16_f32 v252,v188,v189
v_cvt_pk_bf16_f32 v253,v190,v191
ds_write_b128 v242,v[250:253] offset:13312
v_accvgpr_write_b32 a210,v252
v_accvgpr_write_b32 a211,v253
v_mfma_f32_16x16x32_bf16 v[230:233],v[192:195],v[68:71],v[230:233]
buffer_load_dwordx4 v214,s[8:11],s49 offen lds
v_mfma_f32_16x16x32_bf16 v[176:179],v[196:199],v[56:59],v[204:207]
v_mfma_f32_16x16x32_bf16 v[180:183],v[200:203],v[56:59],v[204:207]
v_mfma_f32_16x16x32_bf16 v[238:241],v[250:253],v[250:253],v[238:241]
v_mfma_f32_16x16x32_bf16 v[230:233],v[192:195],v[72:75],v[230:233]
s_nop 4
v_cvt_pk_bf16_f32 v208,v176,v177
v_cvt_pk_bf16_f32 v209,v178,v179
buffer_load_dwordx4 v214,s[12:15],s49 offen offset:1024 lds
s_add_u32 m0,s84,110592
v_accvgpr_write_b32 a224,v208
v_mfma_f32_16x16x32_bf16 v[230:233],v[192:195],v[76:79],v[230:233]
v_cvt_pk_bf16_f32 v210,v180,v181
v_cvt_pk_bf16_f32 v211,v182,v183
ds_write_b128 v242,v[208:211] offset:14336
v_accvgpr_write_b32 a225,v209
v_accvgpr_write_b32 a226,v210
v_mfma_f32_16x16x32_bf16 v[230:233],v[192:195],v[80:83],v[230:233]
v_accvgpr_write_b32 a227,v211
v_mfma_f32_16x16x32_bf16 v[184:187],v[196:199],v[60:63],v[204:207]
v_mfma_f32_16x16x32_bf16 v[188:191],v[200:203],v[60:63],v[204:207]
buffer_load_dwordx4 v213,s[8:11],s50 offen lds
v_mfma_f32_16x16x32_bf16 v[238:241],v[208:211],v[208:211],v[238:241]
v_mfma_f32_16x16x32_bf16 v[230:233],v[192:195],v[84:87],v[230:233]
s_nop 3
v_cvt_pk_bf16_f32 v246,v184,v185
v_cvt_pk_bf16_f32 v247,v186,v187
v_accvgpr_write_b32 a240,v246
v_accvgpr_write_b32 a241,v247
v_mfma_f32_16x16x32_bf16 v[230:233],v[192:195],v[88:91],v[230:233]
buffer_load_dwordx4 v213,s[12:15],s50 offen offset:1024 lds
s_add_u32 m0,s84,118784
v_cvt_pk_bf16_f32 v248,v188,v189
v_cvt_pk_bf16_f32 v249,v190,v191
ds_write_b128 v242,v[246:249] offset:15360
v_mfma_f32_16x16x32_bf16 v[230:233],v[192:195],v[92:95],v[230:233]
v_accvgpr_write_b32 a242,v248
v_accvgpr_write_b32 a243,v249
v_mfma_f32_16x16x32_bf16 v[176:179],v[196:199],v[120:123],v[204:207]
v_mfma_f32_16x16x32_bf16 v[180:183],v[200:203],v[120:123],v[204:207]
v_mfma_f32_16x16x32_bf16 v[238:241],v[246:249],v[246:249],v[238:241]
buffer_load_dwordx4 v214,s[8:11],s50 offen lds
v_mfma_f32_16x16x32_bf16 v[230:233],v[192:195],v[96:99],v[230:233]
s_nop 3
v_cvt_pk_bf16_f32 v250,v176,v177
v_cvt_pk_bf16_f32 v251,v178,v179
v_mov_b32 v128,v250
v_mov_b32 v129,v251
v_mfma_f32_16x16x32_bf16 v[230:233],v[192:195],v[100:103],v[230:233]
v_cvt_pk_bf16_f32 v252,v180,v181
v_cvt_pk_bf16_f32 v253,v182,v183
ds_write_b128 v242,v[250:253] offset:16384
v_mov_b32 v130,v252
v_mov_b32 v131,v253
v_mfma_f32_16x16x32_bf16 v[230:233],v[192:195],v[104:107],v[230:233]
v_mfma_f32_16x16x32_bf16 v[184:187],v[196:199],v[124:127],v[204:207]
buffer_load_dwordx4 v214,s[12:15],s50 offen offset:1024 lds
s_add_u32 m0,s84,129024
v_mfma_f32_16x16x32_bf16 v[188:191],v[200:203],v[124:127],v[204:207]
v_mfma_f32_16x16x32_bf16 v[238:241],v[250:253],v[250:253],v[238:241]
v_mfma_f32_16x16x32_bf16 v[230:233],v[192:195],v[108:111],v[230:233]
s_nop 2
v_cvt_pk_bf16_f32 v208,v184,v185
v_cvt_pk_bf16_f32 v209,v186,v187
v_mov_b32 v144,v208
v_mov_b32 v145,v209
v_mfma_f32_16x16x32_bf16 v[230:233],v[192:195],v[112:115],v[230:233]
buffer_load_dwordx4 v213,s[8:11],s51 offen lds
v_cvt_pk_bf16_f32 v210,v188,v189
v_cvt_pk_bf16_f32 v211,v190,v191
ds_write_b128 v242,v[208:211] offset:17408
v_mov_b32 v146,v210
v_mfma_f32_16x16x32_bf16 v[230:233],v[192:195],v[116:119],v[230:233]
s_nop 7
v_mul_f32 v230,0xbae38e39,v230
v_mul_f32 v231,0xbae38e39,v231
v_mul_f32 v232,0xbae38e39,v232
v_mul_f32 v233,0xbae38e39,v233
v_mov_b32 v147,v211
s_nop 0
v_mfma_f32_16x16x32_bf16 v[176:179],v[196:199],v[160:163],v[230:233]
v_mfma_f32_16x16x32_bf16 v[180:183],v[200:203],v[160:163],v[230:233]
buffer_load_dwordx4 v213,s[12:15],s51 offen offset:1024 lds
s_add_u32 m0,s84,137216
v_mfma_f32_16x16x32_bf16 v[238:241],v[208:211],v[208:211],v[238:241]
v_mfma_f32_16x16x32_bf16 v[184:187],v[196:199],v[164:167],v[230:233]
s_waitcnt lgkmcnt(0)
s_barrier
s_nop 0
v_cvt_pk_bf16_f32 v246,v176,v177
v_cvt_pk_bf16_f32 v247,v178,v179
ds_read_b128 a[200:203],v243 offset:12288
v_mfma_f32_16x16x32_bf16 v[188:191],v[200:203],v[164:167],v[230:233]
buffer_load_dwordx4 v214,s[8:11],s51 offen lds
v_cvt_pk_bf16_f32 v248,v180,v181
v_cvt_pk_bf16_f32 v249,v182,v183
ds_read_b128 a[216:219],v243 offset:13312
ds_read_b128 a[232:235],v243 offset:14336
v_mfma_f32_16x16x32_bf16 v[234:237],v[246:249],v[246:249],0
ds_read_b128 a[248:251],v243 offset:15360
ds_read_b128 v[136:139],v243 offset:16384
ds_read_b128 v[152:155],v243 offset:17408
ds_write_b128 v244,v[246:249] offset:0
v_accvgpr_write_b32 a4,v246
v_mfma_f32_16x16x32_bf16 v[176:179],v[196:199],v[168:171],v[230:233]
v_cvt_pk_bf16_f32 v250,v184,v185
v_cvt_pk_bf16_f32 v251,v186,v187
v_accvgpr_write_b32 a5,v247
v_accvgpr_write_b32 a6,v248
v_accvgpr_write_b32 a7,v249
v_mfma_f32_16x16x32_bf16 v[180:183],v[200:203],v[168:171],v[230:233]
buffer_load_dwordx4 v214,s[12:15],s51 offen offset:1024 lds
v_cvt_pk_bf16_f32 v252,v188,v189
v_cvt_pk_bf16_f32 v253,v190,v191
ds_write_b128 v244,v[250:253] offset:4096
v_accvgpr_write_b32 a20,v250
v_mfma_f32_16x16x32_bf16 v[234:237],v[250:253],v[250:253],v[234:237]
v_accvgpr_write_b32 a21,v251
v_accvgpr_write_b32 a22,v252
v_accvgpr_write_b32 a23,v253
v_mfma_f32_16x16x32_bf16 v[184:187],v[196:199],v[172:175],v[230:233]
v_cvt_pk_bf16_f32 v208,v176,v177
v_cvt_pk_bf16_f32 v209,v178,v179
v_accvgpr_write_b32 a36,v208
v_accvgpr_write_b32 a37,v209
v_mfma_f32_16x16x32_bf16 v[188:191],v[200:203],v[172:175],v[230:233]
v_cvt_pk_bf16_f32 v210,v180,v181
v_cvt_pk_bf16_f32 v211,v182,v183
ds_write_b128 v244,v[208:211] offset:8192
v_accvgpr_write_b32 a38,v210
v_accvgpr_write_b32 a39,v211
v_mfma_f32_16x16x32_bf16 v[234:237],v[208:211],v[208:211],v[234:237]
v_cvt_pk_bf16_f32 v246,v184,v185
v_cvt_pk_bf16_f32 v247,v186,v187
v_cvt_pk_bf16_f32 v248,v188,v189
v_cvt_pk_bf16_f32 v249,v190,v191
s_nop 1
v_mfma_f32_16x16x32_bf16 v[234:237],v[246:249],v[246:249],v[234:237]
ds_write_b128 v244,v[246:249] offset:12288
v_accvgpr_write_b32 a52,v246
v_accvgpr_write_b32 a53,v247
v_accvgpr_write_b32 a54,v248
v_accvgpr_write_b32 a55,v249
s_waitcnt vmcnt(12) lgkmcnt(0)
s_barrier
ds_read_b128 a[12:15],v245 offset:0
ds_read_b128 a[28:31],v245 offset:4096
ds_read_b64_tr_b16 v[160:161],v215 offset:0
ds_read_b64_tr_b16 v[162:163],v215 offset:4096
ds_read_b64_tr_b16 v[164:165],v216 offset:0
ds_read_b64_tr_b16 v[166:167],v216 offset:4096
ds_read_b64_tr_b16 v[168:169],v215 offset:1024
ds_read_b64_tr_b16 v[170:171],v215 offset:5120
ds_read_b64_tr_b16 v[172:173],v216 offset:1024
ds_read_b64_tr_b16 v[174:175],v216 offset:5120
s_waitcnt lgkmcnt(0)
v_mfma_f32_16x16x32_bf16 v[0:3],v[160:163],a[0:3],0
s_add_u32 m0,s84,18432
v_add_u32 v218,92160,v218
v_mfma_f32_16x16x32_bf16 v[4:7],v[160:163],a[4:7],0
buffer_load_dwordx4 v213,s[8:11],s52 offen lds
v_add_u32 v228,92160,v228
v_mfma_f32_16x16x32_bf16 v[8:11],v[160:163],a[8:11],0
buffer_load_dwordx4 v213,s[12:15],s52 offen offset:1024 lds
s_add_u32 m0,s84,26624
v_mfma_f32_16x16x32_bf16 v[12:15],v[160:163],a[12:15],0
ds_read_b64_tr_b16 v[176:177],v215 offset:8192
v_add_u32 v229,92160,v229
v_mfma_f32_16x16x32_bf16 v[16:19],v[164:167],a[0:3],0
ds_read_b64_tr_b16 v[178:179],v215 offset:12288
v_add_u32 v223,92160,v223
v_mfma_f32_16x16x32_bf16 v[20:23],v[164:167],a[4:7],0
ds_read_b64_tr_b16 v[180:181],v216 offset:8192
s_mov_b32 vcc_lo,0x22222222
v_mfma_f32_16x16x32_bf16 v[24:27],v[164:167],a[8:11],0
ds_read_b64_tr_b16 v[182:183],v216 offset:12288
s_mov_b32 vcc_hi,0x22222222
v_mfma_f32_16x16x32_bf16 v[28:31],v[164:167],a[12:15],0
buffer_load_dwordx4 v214,s[8:11],s52 offen lds
ds_read_b64_tr_b16 v[184:185],v215 offset:9216
v_mfma_f32_16x16x32_bf16 v[32:35],v[168:171],a[0:3],0
ds_read_b64_tr_b16 v[186:187],v215 offset:13312
v_add_u32 v215,92160,v215
v_mfma_f32_16x16x32_bf16 v[36:39],v[168:171],a[4:7],0
ds_read_b64_tr_b16 v[188:189],v216 offset:9216
v_cndmask_b32 v238,v238,v239,vcc
v_mfma_f32_16x16x32_bf16 v[40:43],v[168:171],a[8:11],0
ds_read_b64_tr_b16 v[190:191],v216 offset:13312
v_add_u32 v216,92160,v216
v_mfma_f32_16x16x32_bf16 v[44:47],v[168:171],a[12:15],0
buffer_load_dwordx4 v214,s[12:15],s52 offen offset:1024 lds
s_add_u32 m0,s84,36864
v_mfma_f32_16x16x32_bf16 v[48:51],v[172:175],a[0:3],0
s_mov_b32 vcc_lo,0x44444444
s_mov_b32 s89,0x3ae38e39
v_mfma_f32_16x16x32_bf16 v[52:55],v[172:175],a[4:7],0
s_mov_b32 vcc_hi,0x44444444
s_lshl_b32 s88,s45,7
v_mfma_f32_16x16x32_bf16 v[56:59],v[172:175],a[8:11],0
v_cndmask_b32 v238,v238,v240,vcc
s_mov_b32 vcc_lo,0x88888888
v_mfma_f32_16x16x32_bf16 v[60:63],v[172:175],a[12:15],0
buffer_load_dwordx4 v213,s[8:11],s53 offen lds
s_mov_b32 vcc_hi,0x88888888
v_mfma_f32_16x16x32_bf16 v[246:249],v[196:199],v[64:67],v[230:233]
v_cndmask_b32 v238,v238,v241,vcc
s_mov_b32 vcc_lo,0x00f0000f
v_mfma_f32_16x16x32_bf16 v[250:253],v[200:203],v[64:67],v[230:233]
s_waitcnt lgkmcnt(0)
s_mov_b32 vcc_hi,0xf0000f00
v_mfma_f32_16x16x32_bf16 v[0:3],v[176:179],a[16:19],v[0:3]
s_waitcnt vmcnt(13)
s_barrier
v_mfma_f32_16x16x32_bf16 v[4:7],v[176:179],a[20:23],v[4:7]
ds_read_b128 a[44:47],v245 offset:8192
v_cvt_pk_bf16_f32 v192,v246,v247
v_mfma_f32_16x16x32_bf16 v[8:11],v[176:179],a[24:27],v[8:11]
buffer_load_dwordx4 v213,s[12:15],s53 offen offset:1024 lds
s_add_u32 m0,s84,45056
v_mfma_f32_16x16x32_bf16 v[12:15],v[176:179],a[28:31],v[12:15]
ds_read_b128 a[60:63],v245 offset:12288
v_cvt_pk_bf16_f32 v193,v248,v249
v_mfma_f32_16x16x32_bf16 v[16:19],v[180:183],a[16:19],v[16:19]
ds_read_b64_tr_b16 v[160:161],v215 offset:0
v_cvt_pk_bf16_f32 v194,v250,v251
v_mfma_f32_16x16x32_bf16 v[20:23],v[180:183],a[20:23],v[20:23]
ds_read_b64_tr_b16 v[162:163],v215 offset:4096
v_cvt_pk_bf16_f32 v195,v252,v253
v_mfma_f32_16x16x32_bf16 v[24:27],v[180:183],a[24:27],v[24:27]
buffer_load_dwordx4 v214,s[8:11],s53 offen lds
ds_read_b64_tr_b16 v[164:165],v216 offset:0
v_mfma_f32_16x16x32_bf16 v[28:31],v[180:183],a[28:31],v[28:31]
ds_read_b64_tr_b16 v[166:167],v216 offset:4096
v_accvgpr_write_b32 a68,v192
v_mfma_f32_16x16x32_bf16 v[32:35],v[184:187],a[16:19],v[32:35]
ds_read_b64_tr_b16 v[168:169],v215 offset:1024
v_accvgpr_write_b32 a69,v193
v_mfma_f32_16x16x32_bf16 v[36:39],v[184:187],a[20:23],v[36:39]
ds_read_b64_tr_b16 v[170:171],v215 offset:5120
v_accvgpr_write_b32 a70,v194
v_mfma_f32_16x16x32_bf16 v[40:43],v[184:187],a[24:27],v[40:43]
buffer_load_dwordx4 v214,s[12:15],s53 offen offset:1024 lds
s_add_u32 m0,s84,55296
v_mfma_f32_16x16x32_bf16 v[44:47],v[184:187],a[28:31],v[44:47]
ds_read_b64_tr_b16 v[172:173],v216 offset:1024
v_accvgpr_write_b32 a71,v195
v_mfma_f32_16x16x32_bf16 v[48:51],v[188:191],a[16:19],v[48:51]
ds_read_b64_tr_b16 v[174:175],v216 offset:5120
v_cndmask_b32 v238,0,v238,vcc
v_mfma_f32_16x16x32_bf16 v[52:55],v[188:191],a[20:23],v[52:55]
ds_write_b128 v244,v[192:195] offset:0
s_mov_b32 vcc_lo,0x22222222
v_mfma_f32_16x16x32_bf16 v[56:59],v[188:191],a[24:27],v[56:59]
s_mov_b32 vcc_hi,0x22222222
s_add_u32 s88,s88,159744
v_mfma_f32_16x16x32_bf16 v[60:63],v[188:191],a[28:31],v[60:63]
buffer_load_dwordx4 v213,s[8:11],s54 offen lds
s_lshl_b32 s91,s40,2
v_mfma_f32_16x16x32_bf16 v[120:123],v[196:199],v[68:71],v[230:233]
s_lshl_b32 s98,s43,1
s_add_u32 s98,s98,s44
v_mfma_f32_16x16x32_bf16 v[124:127],v[200:203],v[68:71],v[230:233]
s_mul_i32 s99,s3,0x2010102
s_add_u32 s99,s99,0x0e0a0601
v_mfma_f32_16x16x32_bf16 v[234:237],v[192:195],v[192:195],v[234:237]
s_waitcnt lgkmcnt(1)
ds_read_b64_tr_b16 v[176:177],v215 offset:8192
v_mfma_f32_16x16x32_bf16 v[0:3],v[160:163],a[32:35],v[0:3]
buffer_load_dwordx4 v213,s[12:15],s54 offen offset:1024 lds
s_add_u32 m0,s84,63488
v_mfma_f32_16x16x32_bf16 v[4:7],v[160:163],a[36:39],v[4:7]
ds_read_b64_tr_b16 v[178:179],v215 offset:12288
v_cvt_pk_bf16_f32 v204,v120,v121
v_mfma_f32_16x16x32_bf16 v[8:11],v[160:163],a[40:43],v[8:11]
ds_read_b64_tr_b16 v[180:181],v216 offset:8192
v_cvt_pk_bf16_f32 v205,v122,v123
v_mfma_f32_16x16x32_bf16 v[12:15],v[160:163],a[44:47],v[12:15]
ds_read_b64_tr_b16 v[182:183],v216 offset:12288
v_cvt_pk_bf16_f32 v206,v124,v125
v_mfma_f32_16x16x32_bf16 v[16:19],v[164:167],a[32:35],v[16:19]
buffer_load_dwordx4 v214,s[8:11],s54 offen lds
ds_read_b64_tr_b16 v[184:185],v215 offset:9216
v_mfma_f32_16x16x32_bf16 v[20:23],v[164:167],a[36:39],v[20:23]
ds_read_b64_tr_b16 v[186:187],v215 offset:13312
v_cvt_pk_bf16_f32 v207,v126,v127
v_mfma_f32_16x16x32_bf16 v[24:27],v[164:167],a[40:43],v[24:27]
ds_read_b64_tr_b16 v[188:189],v216 offset:9216
v_accvgpr_write_b32 a84,v204
v_mfma_f32_16x16x32_bf16 v[28:31],v[164:167],a[44:47],v[28:31]
ds_read_b64_tr_b16 v[190:191],v216 offset:13312
v_accvgpr_write_b32 a85,v205
v_mfma_f32_16x16x32_bf16 v[32:35],v[168:171],a[32:35],v[32:35]
ds_write_b128 v244,v[204:207] offset:4096
v_accvgpr_write_b32 a86,v206
v_mfma_f32_16x16x32_bf16 v[36:39],v[168:171],a[36:39],v[36:39]
buffer_load_dwordx4 v214,s[12:15],s54 offen offset:1024 lds
s_add_u32 m0,s84,73728
v_mfma_f32_16x16x32_bf16 v[40:43],v[168:171],a[40:43],v[40:43]
v_accvgpr_write_b32 a87,v207
s_add_u32 s66,s98,0
v_mfma_f32_16x16x32_bf16 v[44:47],v[168:171],a[44:47],v[44:47]
s_lshl_b32 s100,s84,1
s_add_u32 s67,s98,1
v_mfma_f32_16x16x32_bf16 v[48:51],v[172:175],a[32:35],v[48:51]
s_add_u32 s68,s98,2
s_add_u32 s69,s98,3
v_mfma_f32_16x16x32_bf16 v[52:55],v[172:175],a[36:39],v[52:55]
buffer_load_dwordx4 v213,s[8:11],s55 offen lds
s_add_u32 s70,s98,4
v_mfma_f32_16x16x32_bf16 v[56:59],v[172:175],a[40:43],v[56:59]
s_add_u32 s71,s98,5
s_add_u32 s72,s98,6
v_mfma_f32_16x16x32_bf16 v[60:63],v[172:175],a[44:47],v[60:63]
s_add_u32 s73,s98,7
s_add_u32 s98,s44,s43
v_mfma_f32_16x16x32_bf16 v[246:249],v[196:199],v[72:75],v[230:233]
s_add_u32 s74,s98,0
s_and_b32 s74,s74,3
v_mfma_f32_16x16x32_bf16 v[250:253],v[200:203],v[72:75],v[230:233]
s_lshl_b32 s74,s74,3
s_add_u32 s75,s98,1
v_mfma_f32_16x16x32_bf16 v[234:237],v[204:207],v[204:207],v[234:237]
buffer_load_dwordx4 v213,s[12:15],s55 offen offset:1024 lds
s_add_u32 m0,s84,81920
s_waitcnt lgkmcnt(1)
v_mfma_f32_16x16x32_bf16 v[0:3],v[176:179],a[48:51],v[0:3]
s_waitcnt vmcnt(18) lgkmcnt(0)
s_barrier
v_mfma_f32_16x16x32_bf16 v[4:7],v[176:179],a[52:55],v[4:7]
ds_read_b128 a[76:79],v245 offset:0
v_cvt_pk_bf16_f32 v208,v246,v247
v_mfma_f32_16x16x32_bf16 v[8:11],v[176:179],a[56:59],v[8:11]
ds_read_b128 a[92:95],v245 offset:4096
v_cvt_pk_bf16_f32 v209,v248,v249
v_mfma_f32_16x16x32_bf16 v[12:15],v[176:179],a[60:63],v[12:15]
buffer_load_dwordx4 v214,s[8:11],s55 offen lds
ds_read_b64_tr_b16 v[160:161],v215 offset:18432
v_mfma_f32_16x16x32_bf16 v[16:19],v[180:183],a[48:51],v[16:19]
ds_read_b64_tr_b16 v[162:163],v215 offset:22528
v_cvt_pk_bf16_f32 v210,v250,v251
v_mfma_f32_16x16x32_bf16 v[20:23],v[180:183],a[52:55],v[20:23]
ds_read_b64_tr_b16 v[164:165],v216 offset:18432
v_cvt_pk_bf16_f32 v211,v252,v253
v_mfma_f32_16x16x32_bf16 v[24:27],v[180:183],a[56:59],v[24:27]
ds_read_b64_tr_b16 v[166:167],v216 offset:22528
v_accvgpr_write_b32 a100,v208
v_mfma_f32_16x16x32_bf16 v[28:31],v[180:183],a[60:63],v[28:31]
buffer_load_dwordx4 v214,s[12:15],s55 offen offset:1024 lds
s_add_u32 m0,s84,0
v_mfma_f32_16x16x32_bf16 v[32:35],v[184:187],a[48:51],v[32:35]
ds_read_b64_tr_b16 v[168:169],v215 offset:19456
v_accvgpr_write_b32 a101,v209
v_mfma_f32_16x16x32_bf16 v[36:39],v[184:187],a[52:55],v[36:39]
ds_read_b64_tr_b16 v[170:171],v215 offset:23552
v_accvgpr_write_b32 a102,v210
v_mfma_f32_16x16x32_bf16 v[40:43],v[184:187],a[56:59],v[40:43]
ds_read_b64_tr_b16 v[172:173],v216 offset:19456
v_accvgpr_write_b32 a103,v211
v_mfma_f32_16x16x32_bf16 v[44:47],v[184:187],a[60:63],v[44:47]
buffer_load_dwordx4 v213,s[8:11],s56 offen lds
ds_read_b64_tr_b16 v[174:175],v216 offset:23552
v_mfma_f32_16x16x32_bf16 v[48:51],v[188:191],a[48:51],v[48:51]
ds_write_b128 v244,v[208:211] offset:8192
s_and_b32 s75,s75,3
v_mfma_f32_16x16x32_bf16 v[52:55],v[188:191],a[52:55],v[52:55]
s_lshl_b32 s75,s75,3
s_add_u32 s76,s98,2
v_mfma_f32_16x16x32_bf16 v[56:59],v[188:191],a[56:59],v[56:59]
s_and_b32 s76,s76,3
s_lshl_b32 s76,s76,3
v_mfma_f32_16x16x32_bf16 v[60:63],v[188:191],a[60:63],v[60:63]
s_add_u32 s77,s98,3
s_and_b32 s77,s77,3
v_mfma_f32_16x16x32_bf16 v[120:123],v[196:199],v[76:79],v[230:233]
buffer_load_dwordx4 v213,s[12:15],s56 offen offset:1024 lds
s_add_u32 m0,s84,8192
v_mfma_f32_16x16x32_bf16 v[124:127],v[200:203],v[76:79],v[230:233]
s_lshl_b32 s77,s77,3
s_add_u32 s78,s98,0
v_mfma_f32_16x16x32_bf16 v[234:237],v[208:211],v[208:211],v[234:237]
s_waitcnt lgkmcnt(1)
ds_read_b64_tr_b16 v[176:177],v215 offset:26624
v_mfma_f32_16x16x32_bf16 v[0:3],v[160:163],a[64:67],v[0:3]
ds_read_b64_tr_b16 v[178:179],v215 offset:30720
v_cvt_pk_bf16_f32 v192,v120,v121
v_mfma_f32_16x16x32_bf16 v[4:7],v[160:163],a[68:71],v[4:7]
buffer_load_dwordx4 v214,s[8:11],s56 offen lds
ds_read_b64_tr_b16 v[180:181],v216 offset:26624
v_mfma_f32_16x16x32_bf16 v[8:11],v[160:163],a[72:75],v[8:11]
ds_read_b64_tr_b16 v[182:183],v216 offset:30720
v_cvt_pk_bf16_f32 v193,v122,v123
v_mfma_f32_16x16x32_bf16 v[12:15],v[160:163],a[76:79],v[12:15]
ds_read_b64_tr_b16 v[184:185],v215 offset:27648
v_cvt_pk_bf16_f32 v194,v124,v125
v_mfma_f32_16x16x32_bf16 v[16:19],v[164:167],a[64:67],v[16:19]
ds_read_b64_tr_b16 v[186:187],v215 offset:31744
v_cvt_pk_bf16_f32 v195,v126,v127
v_mfma_f32_16x16x32_bf16 v[20:23],v[164:167],a[68:71],v[20:23]
buffer_load_dwordx4 v214,s[12:15],s56 offen offset:1024 lds
s_add_u32 m0,s100,92160
v_mfma_f32_16x16x32_bf16 v[24:27],v[164:167],a[72:75],v[24:27]
ds_read_b64_tr_b16 v[188:189],v216 offset:27648
v_accvgpr_write_b32 a116,v192
v_mfma_f32_16x16x32_bf16 v[28:31],v[164:167],a[76:79],v[28:31]
ds_read_b64_tr_b16 v[190:191],v216 offset:31744
v_accvgpr_write_b32 a117,v193
v_mfma_f32_16x16x32_bf16 v[32:35],v[168:171],a[64:67],v[32:35]
ds_write_b128 v244,v[192:195] offset:12288
v_accvgpr_write_b32 a118,v194
v_mfma_f32_16x16x32_bf16 v[36:39],v[168:171],a[68:71],v[36:39]
v_accvgpr_write_b32 a119,v195
s_and_b32 s78,s78,3
v_mfma_f32_16x16x32_bf16 v[40:43],v[168:171],a[72:75],v[40:43]
buffer_load_dwordx4 v219,s[16:19],s57 offen lds
s_lshl_b32 s78,s78,3
v_mfma_f32_16x16x32_bf16 v[44:47],v[168:171],a[76:79],v[44:47]
s_lshl_b32 s100,s84,1
s_add_u32 s79,s98,1
v_mfma_f32_16x16x32_bf16 v[48:51],v[172:175],a[64:67],v[48:51]
s_and_b32 s79,s79,3
s_lshl_b32 s79,s79,3
v_mfma_f32_16x16x32_bf16 v[52:55],v[172:175],a[68:71],v[52:55]
s_add_u32 s80,s98,2
s_and_b32 s80,s80,3
v_mfma_f32_16x16x32_bf16 v[56:59],v[172:175],a[72:75],v[56:59]
s_lshl_b32 s80,s80,3
s_add_u32 s81,s98,3
v_mfma_f32_16x16x32_bf16 v[60:63],v[172:175],a[76:79],v[60:63]
s_and_b32 s81,s81,3
s_lshl_b32 s81,s81,3
v_mfma_f32_16x16x32_bf16 v[246:249],v[196:199],v[80:83],v[230:233]
s_add_u32 s82,s98,0
s_and_b32 s82,s82,1
v_mfma_f32_16x16x32_bf16 v[250:253],v[200:203],v[80:83],v[230:233]
s_lshl_b32 s82,s82,3
s_add_u32 s83,s98,1
v_mfma_f32_16x16x32_bf16 v[234:237],v[192:195],v[192:195],v[234:237]
buffer_load_dwordx4 v220,s[16:19],s57 offen offset:1024 lds
s_waitcnt lgkmcnt(1)
v_mfma_f32_16x16x32_bf16 v[0:3],v[176:179],a[80:83],v[0:3]
s_waitcnt vmcnt(22) lgkmcnt(0)
s_barrier
v_mfma_f32_16x16x32_bf16 v[4:7],v[176:179],a[84:87],v[4:7]
ds_read_b128 a[108:111],v245 offset:8192
v_cvt_pk_bf16_f32 v204,v246,v247
v_mfma_f32_16x16x32_bf16 v[8:11],v[176:179],a[88:91],v[8:11]
ds_read_b128 a[124:127],v245 offset:12288
v_cvt_pk_bf16_f32 v205,v248,v249
v_mfma_f32_16x16x32_bf16 v[12:15],v[176:179],a[92:95],v[12:15]
ds_read_b64_tr_b16 v[160:161],v215 offset:36864
v_cvt_pk_bf16_f32 v206,v250,v251
v_mfma_f32_16x16x32_bf16 v[16:19],v[180:183],a[80:83],v[16:19]
ds_read_b64_tr_b16 v[162:163],v215 offset:40960
v_cvt_pk_bf16_f32 v207,v252,v253
v_mfma_f32_16x16x32_bf16 v[20:23],v[180:183],a[84:87],v[20:23]
ds_read_b64_tr_b16 v[164:165],v216 offset:36864
v_accvgpr_write_b32 a132,v204
v_mfma_f32_16x16x32_bf16 v[24:27],v[180:183],a[88:91],v[24:27]
ds_read_b64_tr_b16 v[166:167],v216 offset:40960
v_accvgpr_write_b32 a133,v205
v_mfma_f32_16x16x32_bf16 v[28:31],v[180:183],a[92:95],v[28:31]
buffer_load_dwordx4 v221,s[16:19],s57 offen offset:2048 lds
ds_read_b64_tr_b16 v[168:169],v215 offset:37888
v_mfma_f32_16x16x32_bf16 v[32:35],v[184:187],a[80:83],v[32:35]
ds_read_b64_tr_b16 v[170:171],v215 offset:41984
v_accvgpr_write_b32 a134,v206
v_mfma_f32_16x16x32_bf16 v[36:39],v[184:187],a[84:87],v[36:39]
ds_read_b64_tr_b16 v[172:173],v216 offset:37888
v_accvgpr_write_b32 a135,v207
v_mfma_f32_16x16x32_bf16 v[40:43],v[184:187],a[88:91],v[40:43]
ds_read_b64_tr_b16 v[174:175],v216 offset:41984
s_and_b32 s83,s83,1
v_mfma_f32_16x16x32_bf16 v[44:47],v[184:187],a[92:95],v[44:47]
ds_write_b128 v244,v[204:207] offset:0
s_lshl_b32 s83,s83,3
v_mfma_f32_16x16x32_bf16 v[48:51],v[188:191],a[80:83],v[48:51]
v_bfe_u32 v240,v226,2,2
s_mul_i32 s85,s3,32768
v_mfma_f32_16x16x32_bf16 v[52:55],v[188:191],a[84:87],v[52:55]
s_add_u32 s85,s85,16384
v_mfma_f32_16x16x32_bf16 v[56:59],v[188:191],a[88:91],v[56:59]
v_mfma_f32_16x16x32_bf16 v[60:63],v[188:191],a[92:95],v[60:63]
buffer_load_dwordx4 v222,s[16:19],s57 offen offset:3072 lds
s_add_u32 m0,s100,110592
v_mfma_f32_16x16x32_bf16 v[120:123],v[196:199],v[84:87],v[230:233]
s_lshl_b32 s57,s40,2
v_mfma_f32_16x16x32_bf16 v[124:127],v[200:203],v[84:87],v[230:233]
v_mfma_f32_16x16x32_bf16 v[234:237],v[204:207],v[204:207],v[234:237]
s_waitcnt lgkmcnt(1)
ds_read_b64_tr_b16 v[176:177],v215 offset:45056
v_mfma_f32_16x16x32_bf16 v[0:3],v[160:163],a[96:99],v[0:3]
ds_read_b64_tr_b16 v[178:179],v215 offset:49152
s_nop 0
v_cvt_pk_bf16_f32 v208,v120,v121
v_mfma_f32_16x16x32_bf16 v[4:7],v[160:163],a[100:103],v[4:7]
ds_read_b64_tr_b16 v[180:181],v216 offset:45056
v_cvt_pk_bf16_f32 v209,v122,v123
v_mfma_f32_16x16x32_bf16 v[8:11],v[160:163],a[104:107],v[8:11]
ds_read_b64_tr_b16 v[182:183],v216 offset:49152
v_cvt_pk_bf16_f32 v210,v124,v125
v_mfma_f32_16x16x32_bf16 v[12:15],v[160:163],a[108:111],v[12:15]
ds_read_b64_tr_b16 v[184:185],v215 offset:46080
v_cvt_pk_bf16_f32 v211,v126,v127
v_mfma_f32_16x16x32_bf16 v[16:19],v[164:167],a[96:99],v[16:19]
buffer_load_dwordx4 v219,s[16:19],s58 offen lds
ds_read_b64_tr_b16 v[186:187],v215 offset:50176
v_mfma_f32_16x16x32_bf16 v[20:23],v[164:167],a[100:103],v[20:23]
v_subrev_u32 v215,73728,v215
ds_read_b64_tr_b16 v[188:189],v216 offset:46080
v_mfma_f32_16x16x32_bf16 v[24:27],v[164:167],a[104:107],v[24:27]
ds_read_b64_tr_b16 v[190:191],v216 offset:50176
v_subrev_u32 v216,73728,v216
v_mfma_f32_16x16x32_bf16 v[28:31],v[164:167],a[108:111],v[28:31]
ds_write_b128 v244,v[208:211] offset:4096
v_accvgpr_write_b32 a148,v208
v_mfma_f32_16x16x32_bf16 v[32:35],v[168:171],a[96:99],v[32:35]
v_accvgpr_write_b32 a149,v209
v_accvgpr_write_b32 a150,v210
v_mfma_f32_16x16x32_bf16 v[36:39],v[168:171],a[100:103],v[36:39]
v_accvgpr_write_b32 a151,v211
v_mfma_f32_16x16x32_bf16 v[40:43],v[168:171],a[104:107],v[40:43]
v_mfma_f32_16x16x32_bf16 v[44:47],v[168:171],a[108:111],v[44:47]
s_lshl_b32 s100,s84,1
v_mfma_f32_16x16x32_bf16 v[48:51],v[172:175],a[96:99],v[48:51]
buffer_load_dwordx4 v220,s[16:19],s58 offen offset:1024 lds
v_mfma_f32_16x16x32_bf16 v[52:55],v[172:175],a[100:103],v[52:55]
v_mfma_f32_16x16x32_bf16 v[56:59],v[172:175],a[104:107],v[56:59]
v_mfma_f32_16x16x32_bf16 v[60:63],v[172:175],a[108:111],v[60:63]
v_mfma_f32_16x16x32_bf16 v[246:249],v[196:199],v[88:91],v[230:233]
v_mfma_f32_16x16x32_bf16 v[250:253],v[200:203],v[88:91],v[230:233]
v_mfma_f32_16x16x32_bf16 v[234:237],v[208:211],v[208:211],v[234:237]
s_waitcnt lgkmcnt(1)
v_mfma_f32_16x16x32_bf16 v[0:3],v[176:179],a[112:115],v[0:3]
s_waitcnt vmcnt(22) lgkmcnt(0)
s_barrier
v_mfma_f32_16x16x32_bf16 v[4:7],v[176:179],a[116:119],v[4:7]
buffer_load_dwordx4 v221,s[16:19],s58 offen offset:2048 lds
ds_read_b128 a[140:143],v245 offset:0
v_mfma_f32_16x16x32_bf16 v[8:11],v[176:179],a[120:123],v[8:11]
ds_read_b128 a[156:159],v245 offset:4096
v_cvt_pk_bf16_f32 v192,v246,v247
v_mfma_f32_16x16x32_bf16 v[12:15],v[176:179],a[124:127],v[12:15]
ds_read_b64_tr_b16 v[160:161],v215 offset:0
v_cvt_pk_bf16_f32 v193,v248,v249
v_mfma_f32_16x16x32_bf16 v[16:19],v[180:183],a[112:115],v[16:19]
ds_read_b64_tr_b16 v[162:163],v215 offset:4096
v_cvt_pk_bf16_f32 v194,v250,v251
v_mfma_f32_16x16x32_bf16 v[20:23],v[180:183],a[116:119],v[20:23]
ds_read_b64_tr_b16 v[164:165],v216 offset:0
v_cvt_pk_bf16_f32 v195,v252,v253
v_mfma_f32_16x16x32_bf16 v[24:27],v[180:183],a[120:123],v[24:27]
ds_read_b64_tr_b16 v[166:167],v216 offset:4096
v_accvgpr_write_b32 a164,v192
v_mfma_f32_16x16x32_bf16 v[28:31],v[180:183],a[124:127],v[28:31]
ds_read_b64_tr_b16 v[168:169],v215 offset:1024
v_accvgpr_write_b32 a165,v193
v_mfma_f32_16x16x32_bf16 v[32:35],v[184:187],a[112:115],v[32:35]
ds_read_b64_tr_b16 v[170:171],v215 offset:5120
v_accvgpr_write_b32 a166,v194
v_mfma_f32_16x16x32_bf16 v[36:39],v[184:187],a[116:119],v[36:39]
buffer_load_dwordx4 v222,s[16:19],s58 offen offset:3072 lds
s_add_u32 m0,s100,129024
v_mfma_f32_16x16x32_bf16 v[40:43],v[184:187],a[120:123],v[40:43]
ds_read_b64_tr_b16 v[172:173],v216 offset:1024
v_accvgpr_write_b32 a167,v195
v_mfma_f32_16x16x32_bf16 v[44:47],v[184:187],a[124:127],v[44:47]
ds_read_b64_tr_b16 v[174:175],v216 offset:5120
v_mfma_f32_16x16x32_bf16 v[48:51],v[188:191],a[112:115],v[48:51]
ds_write_b128 v244,v[192:195] offset:8192
v_mfma_f32_16x16x32_bf16 v[52:55],v[188:191],a[116:119],v[52:55]
v_mfma_f32_16x16x32_bf16 v[56:59],v[188:191],a[120:123],v[56:59]
v_mfma_f32_16x16x32_bf16 v[60:63],v[188:191],a[124:127],v[60:63]
v_mfma_f32_16x16x32_bf16 v[120:123],v[196:199],v[92:95],v[230:233]
v_mfma_f32_16x16x32_bf16 v[124:127],v[200:203],v[92:95],v[230:233]
buffer_load_dwordx4 v219,s[16:19],s59 offen lds
v_mfma_f32_16x16x32_bf16 v[234:237],v[192:195],v[192:195],v[234:237]
s_waitcnt lgkmcnt(1)
ds_read_b64_tr_b16 v[176:177],v215 offset:8192
v_mfma_f32_16x16x32_bf16 v[0:3],v[160:163],a[128:131],v[0:3]
ds_read_b64_tr_b16 v[178:179],v215 offset:12288
s_nop 0
v_cvt_pk_bf16_f32 v204,v120,v121
v_mfma_f32_16x16x32_bf16 v[4:7],v[160:163],a[132:135],v[4:7]
ds_read_b64_tr_b16 v[180:181],v216 offset:8192
v_cvt_pk_bf16_f32 v205,v122,v123
v_mfma_f32_16x16x32_bf16 v[8:11],v[160:163],a[136:139],v[8:11]
ds_read_b64_tr_b16 v[182:183],v216 offset:12288
v_cvt_pk_bf16_f32 v206,v124,v125
v_mfma_f32_16x16x32_bf16 v[12:15],v[160:163],a[140:143],v[12:15]
ds_read_b64_tr_b16 v[184:185],v215 offset:9216
v_cvt_pk_bf16_f32 v207,v126,v127
v_mfma_f32_16x16x32_bf16 v[16:19],v[164:167],a[128:131],v[16:19]
ds_read_b64_tr_b16 v[186:187],v215 offset:13312
v_accvgpr_write_b32 a180,v204
v_mfma_f32_16x16x32_bf16 v[20:23],v[164:167],a[132:135],v[20:23]
ds_read_b64_tr_b16 v[188:189],v216 offset:9216
v_accvgpr_write_b32 a181,v205
v_mfma_f32_16x16x32_bf16 v[24:27],v[164:167],a[136:139],v[24:27]
buffer_load_dwordx4 v220,s[16:19],s59 offen offset:1024 lds
ds_read_b64_tr_b16 v[190:191],v216 offset:13312
v_mfma_f32_16x16x32_bf16 v[28:31],v[164:167],a[140:143],v[28:31]
ds_write_b128 v244,v[204:207] offset:12288
v_accvgpr_write_b32 a182,v206
v_mfma_f32_16x16x32_bf16 v[32:35],v[168:171],a[128:131],v[32:35]
v_accvgpr_write_b32 a183,v207
v_mfma_f32_16x16x32_bf16 v[36:39],v[168:171],a[132:135],v[36:39]
v_mfma_f32_16x16x32_bf16 v[40:43],v[168:171],a[136:139],v[40:43]
v_mfma_f32_16x16x32_bf16 v[44:47],v[168:171],a[140:143],v[44:47]
s_lshl_b32 s100,s84,1
v_mfma_f32_16x16x32_bf16 v[48:51],v[172:175],a[128:131],v[48:51]
v_mfma_f32_16x16x32_bf16 v[52:55],v[172:175],a[132:135],v[52:55]
v_mfma_f32_16x16x32_bf16 v[56:59],v[172:175],a[136:139],v[56:59]
buffer_load_dwordx4 v221,s[16:19],s59 offen offset:2048 lds
v_mfma_f32_16x16x32_bf16 v[60:63],v[172:175],a[140:143],v[60:63]
v_mfma_f32_16x16x32_bf16 v[246:249],v[196:199],v[96:99],v[230:233]
v_mfma_f32_16x16x32_bf16 v[250:253],v[200:203],v[96:99],v[230:233]
v_mfma_f32_16x16x32_bf16 v[234:237],v[204:207],v[204:207],v[234:237]
s_waitcnt lgkmcnt(1)
v_mfma_f32_16x16x32_bf16 v[0:3],v[176:179],a[144:147],v[0:3]
s_waitcnt vmcnt(23) lgkmcnt(0)
s_barrier
v_mfma_f32_16x16x32_bf16 v[4:7],v[176:179],a[148:151],v[4:7]
ds_read_b128 a[172:175],v245 offset:8192
v_cvt_pk_bf16_f32 v208,v246,v247
v_mfma_f32_16x16x32_bf16 v[8:11],v[176:179],a[152:155],v[8:11]
ds_read_b128 a[188:191],v245 offset:12288
v_cvt_pk_bf16_f32 v209,v248,v249
v_mfma_f32_16x16x32_bf16 v[12:15],v[176:179],a[156:159],v[12:15]
buffer_load_dwordx4 v222,s[16:19],s59 offen offset:3072 lds
s_add_u32 m0,s100,18432
v_mfma_f32_16x16x32_bf16 v[16:19],v[180:183],a[144:147],v[16:19]
ds_read_b64_tr_b16 v[160:161],v215 offset:18432
v_cvt_pk_bf16_f32 v210,v250,v251
v_mfma_f32_16x16x32_bf16 v[20:23],v[180:183],a[148:151],v[20:23]
ds_read_b64_tr_b16 v[162:163],v215 offset:22528
v_cvt_pk_bf16_f32 v211,v252,v253
v_mfma_f32_16x16x32_bf16 v[24:27],v[180:183],a[152:155],v[24:27]
ds_read_b64_tr_b16 v[164:165],v216 offset:18432
v_accvgpr_write_b32 a196,v208
v_mfma_f32_16x16x32_bf16 v[28:31],v[180:183],a[156:159],v[28:31]
ds_read_b64_tr_b16 v[166:167],v216 offset:22528
v_accvgpr_write_b32 a197,v209
v_mfma_f32_16x16x32_bf16 v[32:35],v[184:187],a[144:147],v[32:35]
ds_read_b64_tr_b16 v[168:169],v215 offset:19456
v_accvgpr_write_b32 a198,v210
v_mfma_f32_16x16x32_bf16 v[36:39],v[184:187],a[148:151],v[36:39]
ds_read_b64_tr_b16 v[170:171],v215 offset:23552
v_accvgpr_write_b32 a199,v211
v_mfma_f32_16x16x32_bf16 v[40:43],v[184:187],a[152:155],v[40:43]
ds_read_b64_tr_b16 v[172:173],v216 offset:19456
v_mfma_f32_16x16x32_bf16 v[44:47],v[184:187],a[156:159],v[44:47]
buffer_load_dwordx4 v219,s[16:19],s60 offen lds
ds_read_b64_tr_b16 v[174:175],v216 offset:23552
v_mfma_f32_16x16x32_bf16 v[48:51],v[188:191],a[144:147],v[48:51]
ds_write_b128 v244,v[208:211] offset:0
v_mfma_f32_16x16x32_bf16 v[52:55],v[188:191],a[148:151],v[52:55]
v_mfma_f32_16x16x32_bf16 v[56:59],v[188:191],a[152:155],v[56:59]
v_mfma_f32_16x16x32_bf16 v[60:63],v[188:191],a[156:159],v[60:63]
v_mfma_f32_16x16x32_bf16 v[120:123],v[196:199],v[100:103],v[230:233]
v_mfma_f32_16x16x32_bf16 v[124:127],v[200:203],v[100:103],v[230:233]
v_mfma_f32_16x16x32_bf16 v[234:237],v[208:211],v[208:211],v[234:237]
s_waitcnt lgkmcnt(1)
ds_read_b64_tr_b16 v[176:177],v215 offset:26624
v_mfma_f32_16x16x32_bf16 v[0:3],v[160:163],a[160:163],v[0:3]
buffer_load_dwordx4 v220,s[16:19],s60 offen offset:1024 lds
ds_read_b64_tr_b16 v[178:179],v215 offset:30720
v_mfma_f32_16x16x32_bf16 v[4:7],v[160:163],a[164:167],v[4:7]
ds_read_b64_tr_b16 v[180:181],v216 offset:26624
v_cvt_pk_bf16_f32 v192,v120,v121
v_mfma_f32_16x16x32_bf16 v[8:11],v[160:163],a[168:171],v[8:11]
ds_read_b64_tr_b16 v[182:183],v216 offset:30720
v_cvt_pk_bf16_f32 v193,v122,v123
v_mfma_f32_16x16x32_bf16 v[12:15],v[160:163],a[172:175],v[12:15]
ds_read_b64_tr_b16 v[184:185],v215 offset:27648
v_cvt_pk_bf16_f32 v194,v124,v125
v_mfma_f32_16x16x32_bf16 v[16:19],v[164:167],a[160:163],v[16:19]
ds_read_b64_tr_b16 v[186:187],v215 offset:31744
v_cvt_pk_bf16_f32 v195,v126,v127
v_mfma_f32_16x16x32_bf16 v[20:23],v[164:167],a[164:167],v[20:23]
ds_read_b64_tr_b16 v[188:189],v216 offset:27648
v_accvgpr_write_b32 a212,v192
v_mfma_f32_16x16x32_bf16 v[24:27],v[164:167],a[168:171],v[24:27]
ds_read_b64_tr_b16 v[190:191],v216 offset:31744
v_accvgpr_write_b32 a213,v193
v_mfma_f32_16x16x32_bf16 v[28:31],v[164:167],a[172:175],v[28:31]
ds_write_b128 v244,v[192:195] offset:4096
v_accvgpr_write_b32 a214,v194
v_mfma_f32_16x16x32_bf16 v[32:35],v[168:171],a[160:163],v[32:35]
buffer_load_dwordx4 v221,s[16:19],s60 offen offset:2048 lds
v_accvgpr_write_b32 a215,v195
v_mfma_f32_16x16x32_bf16 v[36:39],v[168:171],a[164:167],v[36:39]
v_mfma_f32_16x16x32_bf16 v[40:43],v[168:171],a[168:171],v[40:43]
v_mfma_f32_16x16x32_bf16 v[44:47],v[168:171],a[172:175],v[44:47]
s_lshl_b32 s100,s84,1
v_mfma_f32_16x16x32_bf16 v[48:51],v[172:175],a[160:163],v[48:51]
v_mfma_f32_16x16x32_bf16 v[52:55],v[172:175],a[164:167],v[52:55]
v_mfma_f32_16x16x32_bf16 v[56:59],v[172:175],a[168:171],v[56:59]
v_mfma_f32_16x16x32_bf16 v[60:63],v[172:175],a[172:175],v[60:63]
v_mfma_f32_16x16x32_bf16 v[246:249],v[196:199],v[104:107],v[230:233]
buffer_load_dwordx4 v222,s[16:19],s60 offen offset:3072 lds
s_add_u32 m0,s100,36864
v_mfma_f32_16x16x32_bf16 v[250:253],v[200:203],v[104:107],v[230:233]
s_lshl_b32 s60,s101,1
s_add_u32 s60,s60,s47
v_mfma_f32_16x16x32_bf16 v[234:237],v[192:195],v[192:195],v[234:237]
s_waitcnt lgkmcnt(1)
s_lshl_b32 s60,s60,1
v_mfma_f32_16x16x32_bf16 v[0:3],v[176:179],a[176:179],v[0:3]
s_waitcnt vmcnt(24) lgkmcnt(0)
s_barrier
v_mfma_f32_16x16x32_bf16 v[4:7],v[176:179],a[180:183],v[4:7]
ds_read_b128 a[204:207],v245 offset:0
v_cvt_pk_bf16_f32 v204,v246,v247
v_mfma_f32_16x16x32_bf16 v[8:11],v[176:179],a[184:187],v[8:11]
ds_read_b128 a[220:223],v245 offset:4096
v_cvt_pk_bf16_f32 v205,v248,v249
v_mfma_f32_16x16x32_bf16 v[12:15],v[176:179],a[188:191],v[12:15]
ds_read_b64_tr_b16 v[160:161],v215 offset:36864
v_cvt_pk_bf16_f32 v206,v250,v251
v_mfma_f32_16x16x32_bf16 v[16:19],v[180:183],a[176:179],v[16:19]
ds_read_b64_tr_b16 v[162:163],v215 offset:40960
v_cvt_pk_bf16_f32 v207,v252,v253
v_mfma_f32_16x16x32_bf16 v[20:23],v[180:183],a[180:183],v[20:23]
buffer_load_dwordx4 v219,s[16:19],s61 offen lds
ds_read_b64_tr_b16 v[164:165],v216 offset:36864
v_mfma_f32_16x16x32_bf16 v[24:27],v[180:183],a[184:187],v[24:27]
ds_read_b64_tr_b16 v[166:167],v216 offset:40960
v_accvgpr_write_b32 a228,v204
v_mfma_f32_16x16x32_bf16 v[28:31],v[180:183],a[188:191],v[28:31]
ds_read_b64_tr_b16 v[168:169],v215 offset:37888
v_accvgpr_write_b32 a229,v205
v_mfma_f32_16x16x32_bf16 v[32:35],v[184:187],a[176:179],v[32:35]
ds_read_b64_tr_b16 v[170:171],v215 offset:41984
v_accvgpr_write_b32 a230,v206
v_mfma_f32_16x16x32_bf16 v[36:39],v[184:187],a[180:183],v[36:39]
ds_read_b64_tr_b16 v[172:173],v216 offset:37888
v_accvgpr_write_b32 a231,v207
v_mfma_f32_16x16x32_bf16 v[40:43],v[184:187],a[184:187],v[40:43]
ds_read_b64_tr_b16 v[174:175],v216 offset:41984
s_add_u32 s60,s60,s46
v_mfma_f32_16x16x32_bf16 v[44:47],v[184:187],a[188:191],v[44:47]
ds_write_b128 v244,v[204:207] offset:8192
s_lshl_b32 s60,s60,13
v_mfma_f32_16x16x32_bf16 v[48:51],v[188:191],a[176:179],v[48:51]
v_mfma_f32_16x16x32_bf16 v[52:55],v[188:191],a[180:183],v[52:55]
buffer_load_dwordx4 v220,s[16:19],s61 offen offset:1024 lds
v_mfma_f32_16x16x32_bf16 v[56:59],v[188:191],a[184:187],v[56:59]
v_mfma_f32_16x16x32_bf16 v[60:63],v[188:191],a[188:191],v[60:63]
v_mfma_f32_16x16x32_bf16 v[120:123],v[196:199],v[108:111],v[230:233]
v_mfma_f32_16x16x32_bf16 v[124:127],v[200:203],v[108:111],v[230:233]
v_mfma_f32_16x16x32_bf16 v[234:237],v[204:207],v[204:207],v[234:237]
s_waitcnt lgkmcnt(1)
ds_read_b64_tr_b16 v[176:177],v215 offset:45056
v_mfma_f32_16x16x32_bf16 v[0:3],v[160:163],a[192:195],v[0:3]
ds_read_b64_tr_b16 v[178:179],v215 offset:49152
s_nop 1
v_cvt_pk_bf16_f32 v208,v120,v121
v_mfma_f32_16x16x32_bf16 v[4:7],v[160:163],a[196:199],v[4:7]
ds_read_b64_tr_b16 v[180:181],v216 offset:45056
v_cvt_pk_bf16_f32 v209,v122,v123
v_mfma_f32_16x16x32_bf16 v[8:11],v[160:163],a[200:203],v[8:11]
buffer_load_dwordx4 v221,s[16:19],s61 offen offset:2048 lds
ds_read_b64_tr_b16 v[182:183],v216 offset:49152
v_mfma_f32_16x16x32_bf16 v[12:15],v[160:163],a[204:207],v[12:15]
ds_read_b64_tr_b16 v[184:185],v215 offset:46080
v_cvt_pk_bf16_f32 v210,v124,v125
v_mfma_f32_16x16x32_bf16 v[16:19],v[164:167],a[192:195],v[16:19]
ds_read_b64_tr_b16 v[186:187],v215 offset:50176
v_cvt_pk_bf16_f32 v211,v126,v127
v_mfma_f32_16x16x32_bf16 v[20:23],v[164:167],a[196:199],v[20:23]
ds_read_b64_tr_b16 v[188:189],v216 offset:46080
v_accvgpr_write_b32 a244,v208
v_mfma_f32_16x16x32_bf16 v[24:27],v[164:167],a[200:203],v[24:27]
ds_read_b64_tr_b16 v[190:191],v216 offset:50176
v_accvgpr_write_b32 a245,v209
v_mfma_f32_16x16x32_bf16 v[28:31],v[164:167],a[204:207],v[28:31]
ds_write_b128 v244,v[208:211] offset:12288
v_accvgpr_write_b32 a246,v210
v_mfma_f32_16x16x32_bf16 v[32:35],v[168:171],a[192:195],v[32:35]
v_accvgpr_write_b32 a247,v211
v_mfma_f32_16x16x32_bf16 v[36:39],v[168:171],a[196:199],v[36:39]
v_mfma_f32_16x16x32_bf16 v[40:43],v[168:171],a[200:203],v[40:43]
buffer_load_dwordx4 v222,s[16:19],s61 offen offset:3072 lds
s_lshr_b32 s61,s60,3
v_mfma_f32_16x16x32_bf16 v[44:47],v[168:171],a[204:207],v[44:47]
s_lshl_b32 s100,s84,1
s_add_u32 m0,s100,55296
v_mfma_f32_16x16x32_bf16 v[48:51],v[172:175],a[192:195],v[48:51]
s_add_u32 s61,s61,1048576
s_add_u32 s60,s60,131072
v_mfma_f32_16x16x32_bf16 v[52:55],v[172:175],a[196:199],v[52:55]
v_mfma_f32_16x16x32_bf16 v[56:59],v[172:175],a[200:203],v[56:59]
v_mfma_f32_16x16x32_bf16 v[60:63],v[172:175],a[204:207],v[60:63]
v_mfma_f32_16x16x32_bf16 v[246:249],v[196:199],v[112:115],v[230:233]
v_mfma_f32_16x16x32_bf16 v[250:253],v[200:203],v[112:115],v[230:233]
v_mfma_f32_16x16x32_bf16 v[234:237],v[208:211],v[208:211],v[234:237]
s_waitcnt lgkmcnt(1)
v_mfma_f32_16x16x32_bf16 v[0:3],v[176:179],a[208:211],v[0:3]
s_waitcnt vmcnt(24) lgkmcnt(0)
s_barrier
v_mfma_f32_16x16x32_bf16 v[4:7],v[176:179],a[212:215],v[4:7]
buffer_load_dwordx4 v219,s[16:19],s62 offen lds
ds_read_b128 a[236:239],v245 offset:8192
v_mfma_f32_16x16x32_bf16 v[8:11],v[176:179],a[216:219],v[8:11]
ds_read_b128 a[252:255],v245 offset:12288
v_cvt_pk_bf16_f32 v192,v246,v247
v_mfma_f32_16x16x32_bf16 v[12:15],v[176:179],a[220:223],v[12:15]
ds_read_b64_tr_b16 v[160:161],v215 offset:55296
v_cvt_pk_bf16_f32 v193,v248,v249
v_mfma_f32_16x16x32_bf16 v[16:19],v[180:183],a[208:211],v[16:19]
ds_read_b64_tr_b16 v[162:163],v215 offset:59392
v_cvt_pk_bf16_f32 v194,v250,v251
v_mfma_f32_16x16x32_bf16 v[20:23],v[180:183],a[212:215],v[20:23]
ds_read_b64_tr_b16 v[164:165],v216 offset:55296
v_cvt_pk_bf16_f32 v195,v252,v253
v_mfma_f32_16x16x32_bf16 v[24:27],v[180:183],a[216:219],v[24:27]
ds_read_b64_tr_b16 v[166:167],v216 offset:59392
v_mov_b32 v132,v192
v_mfma_f32_16x16x32_bf16 v[28:31],v[180:183],a[220:223],v[28:31]
buffer_load_dwordx4 v220,s[16:19],s62 offen offset:1024 lds
ds_read_b64_tr_b16 v[168:169],v215 offset:56320
v_mfma_f32_16x16x32_bf16 v[32:35],v[184:187],a[208:211],v[32:35]
ds_read_b64_tr_b16 v[170:171],v215 offset:60416
v_add_u32 v215,55296,v215
v_mfma_f32_16x16x32_bf16 v[36:39],v[184:187],a[212:215],v[36:39]
ds_read_b64_tr_b16 v[172:173],v216 offset:56320
v_mov_b32 v133,v193
v_mfma_f32_16x16x32_bf16 v[40:43],v[184:187],a[216:219],v[40:43]
ds_read_b64_tr_b16 v[174:175],v216 offset:60416
v_add_u32 v216,55296,v216
v_mfma_f32_16x16x32_bf16 v[44:47],v[184:187],a[220:223],v[44:47]
ds_write_b128 v244,v[192:195] offset:0
v_mov_b32 v134,v194
v_mfma_f32_16x16x32_bf16 v[48:51],v[188:191],a[208:211],v[48:51]
v_mov_b32 v135,v195
v_mov_b32 v246,v238
v_mfma_f32_16x16x32_bf16 v[52:55],v[188:191],a[212:215],v[52:55]
s_nop 0
v_permlane32_swap_b32 v246,v238
v_add_f32 v238,v246,v238
v_mfma_f32_16x16x32_bf16 v[56:59],v[188:191],a[216:219],v[56:59]
v_mov_b32 v246,v238
v_mov_b32 v248,0x3727c5ac
v_mfma_f32_16x16x32_bf16 v[60:63],v[188:191],a[220:223],v[60:63]
buffer_load_dwordx4 v221,s[16:19],s62 offen offset:2048 lds
v_permlane16_swap_b32 v246,v238
v_mfma_f32_16x16x32_bf16 v[120:123],v[196:199],v[116:119],v[230:233]
v_add_f32 v238,v246,v238
v_fma_f32 v238,v238,s89,v248
v_mfma_f32_16x16x32_bf16 v[124:127],v[200:203],v[116:119],v[230:233]
v_rsq_f32 v238,v238
v_mfma_f32_16x16x32_bf16 v[234:237],v[192:195],v[192:195],v[234:237]
s_waitcnt lgkmcnt(1)
ds_read_b64_tr_b16 v[176:177],v215 offset:8192
v_mfma_f32_16x16x32_bf16 v[0:3],v[160:163],a[224:227],v[0:3]
ds_read_b64_tr_b16 v[178:179],v215 offset:12288
v_cvt_pk_bf16_f32 v204,v120,v121
v_mfma_f32_16x16x32_bf16 v[4:7],v[160:163],a[228:231],v[4:7]
ds_read_b64_tr_b16 v[180:181],v216 offset:8192
v_cvt_pk_bf16_f32 v205,v122,v123
v_mfma_f32_16x16x32_bf16 v[8:11],v[160:163],a[232:235],v[8:11]
ds_read_b64_tr_b16 v[182:183],v216 offset:12288
v_cvt_pk_bf16_f32 v206,v124,v125
v_mfma_f32_16x16x32_bf16 v[12:15],v[160:163],a[236:239],v[12:15]
ds_read_b64_tr_b16 v[184:185],v215 offset:9216
v_cvt_pk_bf16_f32 v207,v126,v127
v_mfma_f32_16x16x32_bf16 v[16:19],v[164:167],a[224:227],v[16:19]
buffer_load_dwordx4 v222,s[16:19],s62 offen offset:3072 lds
ds_read_b64_tr_b16 v[186:187],v215 offset:13312
v_mfma_f32_16x16x32_bf16 v[20:23],v[164:167],a[228:231],v[20:23]
v_subrev_u32 v215,73728,v215
ds_read_b64_tr_b16 v[188:189],v216 offset:9216
v_mfma_f32_16x16x32_bf16 v[24:27],v[164:167],a[232:235],v[24:27]
ds_read_b64_tr_b16 v[190:191],v216 offset:13312
v_subrev_u32 v216,73728,v216
v_mfma_f32_16x16x32_bf16 v[28:31],v[164:167],a[236:239],v[28:31]
ds_write_b128 v244,v[204:207] offset:4096
v_and_b32 v247,15,v226
v_mfma_f32_16x16x32_bf16 v[32:35],v[168:171],a[224:227],v[32:35]
s_lshl_b32 s100,s84,1
s_add_u32 m0,s100,73728
v_mfma_f32_16x16x32_bf16 v[36:39],v[168:171],a[228:231],v[36:39]
v_lshl_add_u32 v247,v247,2,s88
s_or_b32 s88,s41,s45
v_mfma_f32_16x16x32_bf16 v[40:43],v[168:171],a[232:235],v[40:43]
s_min_u32 s88,s88,1
s_lshl_b32 s88,s88,31
v_mfma_f32_16x16x32_bf16 v[44:47],v[168:171],a[236:239],v[44:47]
v_mov_b32 v148,v204
v_mov_b32 v149,v205
v_mfma_f32_16x16x32_bf16 v[48:51],v[172:175],a[224:227],v[48:51]
v_mov_b32 v150,v206
v_mov_b32 v151,v207
v_mfma_f32_16x16x32_bf16 v[52:55],v[172:175],a[228:231],v[52:55]
v_or_b32 v252,s88,v212
v_or_b32 v227,s88,v224
v_mfma_f32_16x16x32_bf16 v[56:59],v[172:175],a[232:235],v[56:59]
s_lshl_b32 s88,s40,12
v_mov_b32 v249,0
v_mfma_f32_16x16x32_bf16 v[60:63],v[172:175],a[236:239],v[60:63]
v_mov_b32 v250,0
v_mov_b32 v251,0
v_mfma_f32_16x16x32_bf16 v[234:237],v[204:207],v[204:207],v[234:237]
s_waitcnt lgkmcnt(1)
s_waitcnt vmcnt(24) lgkmcnt(0)
v_mfma_f32_16x16x32_bf16 v[0:3],v[176:179],a[240:243],v[0:3]
s_barrier
buffer_load_dwordx4 v219,s[16:19],s63 offen lds
v_mfma_f32_16x16x32_bf16 v[4:7],v[176:179],a[244:247],v[4:7]
ds_read_b128 v[140:143],v245 offset:0
v_min_u32 v253,1,v226
v_mfma_f32_16x16x32_bf16 v[8:11],v[176:179],a[248:251],v[8:11]
ds_read_b128 v[156:159],v245 offset:4096
v_cndmask_b32 v234,v234,v235,vcc
v_mfma_f32_16x16x32_bf16 v[12:15],v[176:179],a[252:255],v[12:15]
ds_read_b64_tr_b16 v[160:161],v215 offset:0
s_mov_b32 vcc_lo,0x44444444
v_mfma_f32_16x16x32_bf16 v[16:19],v[180:183],a[240:243],v[16:19]
ds_read_b64_tr_b16 v[162:163],v215 offset:4096
s_mov_b32 vcc_hi,0x44444444
v_mfma_f32_16x16x32_bf16 v[20:23],v[180:183],a[244:247],v[20:23]
buffer_load_dwordx4 v220,s[16:19],s63 offen offset:1024 lds
ds_read_b64_tr_b16 v[164:165],v216 offset:0
v_mfma_f32_16x16x32_bf16 v[24:27],v[180:183],a[248:251],v[24:27]
ds_read_b64_tr_b16 v[166:167],v216 offset:4096
v_cndmask_b32 v234,v234,v236,vcc
v_mfma_f32_16x16x32_bf16 v[28:31],v[180:183],a[252:255],v[28:31]
ds_read_b64_tr_b16 v[168:169],v215 offset:1024
s_mov_b32 vcc_lo,0x88888888
v_mfma_f32_16x16x32_bf16 v[32:35],v[184:187],a[240:243],v[32:35]
ds_read_b64_tr_b16 v[170:171],v215 offset:5120
s_mov_b32 vcc_hi,0x88888888
v_mfma_f32_16x16x32_bf16 v[36:39],v[184:187],a[244:247],v[36:39]
ds_read_b64_tr_b16 v[172:173],v216 offset:1024
v_cndmask_b32 v234,v234,v237,vcc
v_mfma_f32_16x16x32_bf16 v[40:43],v[184:187],a[248:251],v[40:43]
ds_read_b64_tr_b16 v[174:175],v216 offset:5120
s_mov_b32 vcc_lo,0x00f0000f
v_mfma_f32_16x16x32_bf16 v[44:47],v[184:187],a[252:255],v[44:47]
s_mov_b32 vcc_hi,0xf0000f00
ds_write_b32 v247,v238 offset:0
v_mfma_f32_16x16x32_bf16 v[48:51],v[188:191],a[240:243],v[48:51]
v_cndmask_b32 v234,0,v234,vcc
v_mov_b32 v246,v234
v_mfma_f32_16x16x32_bf16 v[52:55],v[188:191],a[244:247],v[52:55]
buffer_load_dwordx4 v221,s[16:19],s63 offen offset:2048 lds
v_permlane32_swap_b32 v246,v234
v_mfma_f32_16x16x32_bf16 v[56:59],v[188:191],a[248:251],v[56:59]
v_add_f32 v234,v246,v234
v_mov_b32 v246,v234
v_mfma_f32_16x16x32_bf16 v[60:63],v[188:191],a[252:255],v[60:63]
s_waitcnt lgkmcnt(1)
ds_read_b64_tr_b16 v[176:177],v215 offset:8192
v_mfma_f32_16x16x32_bf16 v[0:3],v[160:163],v[128:131],v[0:3]
ds_read_b64_tr_b16 v[178:179],v215 offset:12288
v_permlane16_swap_b32 v246,v234
v_mfma_f32_16x16x32_bf16 v[4:7],v[160:163],v[132:135],v[4:7]
ds_read_b64_tr_b16 v[180:181],v216 offset:8192
v_add_f32 v234,v246,v234
v_mfma_f32_16x16x32_bf16 v[8:11],v[160:163],v[136:139],v[8:11]
ds_read_b64_tr_b16 v[182:183],v216 offset:12288
v_fma_f32 v234,v234,s89,v248
v_mfma_f32_16x16x32_bf16 v[12:15],v[160:163],v[140:143],v[12:15]
ds_read_b64_tr_b16 v[184:185],v215 offset:9216
v_mov_b32 v248,0
v_mfma_f32_16x16x32_bf16 v[16:19],v[164:167],v[128:131],v[16:19]
ds_read_b64_tr_b16 v[186:187],v215 offset:13312
s_and_b32 s89,s43,1
v_mfma_f32_16x16x32_bf16 v[20:23],v[164:167],v[132:135],v[20:23]
buffer_store_dwordx4 v[248:251],v252,s[24:27],s88 offen sc1
ds_read_b64_tr_b16 v[188:189],v216 offset:9216
v_mfma_f32_16x16x32_bf16 v[24:27],v[164:167],v[136:139],v[24:27]
buffer_store_dwordx4 v[248:251],v252,s[24:27],s88 offen offset:1024 sc1
ds_read_b64_tr_b16 v[190:191],v216 offset:13312
v_mfma_f32_16x16x32_bf16 v[28:31],v[164:167],v[140:143],v[28:31]
buffer_store_dwordx4 v[248:251],v252,s[24:27],s88 offen offset:2048 sc1
v_add_u32 v215,110592,v215
v_mfma_f32_16x16x32_bf16 v[32:35],v[168:171],v[128:131],v[32:35]
buffer_load_dwordx4 v222,s[16:19],s63 offen offset:3072 lds
s_lshl_b32 s100,s84,1
v_mfma_f32_16x16x32_bf16 v[36:39],v[168:171],v[132:135],v[36:39]
s_add_u32 m0,s100,0
v_and_b32 v248,15,v226
v_mfma_f32_16x16x32_bf16 v[40:43],v[168:171],v[136:139],v[40:43]
s_bitcmp1_b32 s66,0
s_cselect_b32 s100,s99,0x0d090500
v_mfma_f32_16x16x32_bf16 v[44:47],v[168:171],v[140:143],v[44:47]
s_and_b32 s66,s66,6
s_lshl_b32 s66,s66,2
v_mfma_f32_16x16x32_bf16 v[48:51],v[172:175],v[128:131],v[48:51]
s_lshr_b32 s66,s100,s66
v_rsq_f32 v234,v234
v_mfma_f32_16x16x32_bf16 v[52:55],v[172:175],v[132:135],v[52:55]
s_bitcmp1_b32 s67,0
s_cselect_b32 s100,s99,0x0d090500
ds_write_b32 v247,v234 offset:64
v_mfma_f32_16x16x32_bf16 v[56:59],v[172:175],v[136:139],v[56:59]
s_and_b32 s67,s67,6
s_lshl_b32 s67,s67,2
v_mfma_f32_16x16x32_bf16 v[60:63],v[172:175],v[140:143],v[60:63]
s_lshr_b32 s67,s100,s67
s_waitcnt lgkmcnt(1)
v_mfma_f32_16x16x32_bf16 v[0:3],v[176:179],v[144:147],v[0:3]
s_bitcmp1_b32 s68,0
s_cselect_b32 s100,s99,0x0d090500
s_waitcnt vmcnt(23) lgkmcnt(0)
v_mfma_f32_16x16x32_bf16 v[4:7],v[176:179],v[148:151],v[4:7]
s_barrier
buffer_load_dwordx4 v219,s[16:19],s64 offen lds
v_mfma_f32_16x16x32_bf16 v[8:11],v[176:179],v[152:155],v[8:11]
s_and_b32 s68,s68,6
s_lshl_b32 s68,s68,2
v_mfma_f32_16x16x32_bf16 v[12:15],v[176:179],v[156:159],v[12:15]
s_lshr_b32 s68,s100,s68
ds_read_b64_tr_b16 v[160:161],v218 offset:0
v_mfma_f32_16x16x32_bf16 v[16:19],v[180:183],v[144:147],v[16:19]
s_bitcmp1_b32 s69,0
s_cselect_b32 s100,s99,0x0d090500
v_mfma_f32_16x16x32_bf16 v[20:23],v[180:183],v[148:151],v[20:23]
s_and_b32 s69,s69,6
s_lshl_b32 s69,s69,2
v_mfma_f32_16x16x32_bf16 v[24:27],v[180:183],v[152:155],v[24:27]
s_lshr_b32 s69,s100,s69
ds_read_b64_tr_b16 v[162:163],v218 offset:4096
v_mfma_f32_16x16x32_bf16 v[28:31],v[180:183],v[156:159],v[28:31]
s_bitcmp1_b32 s70,0
s_cselect_b32 s100,s99,0x0d090500
v_mfma_f32_16x16x32_bf16 v[32:35],v[184:187],v[144:147],v[32:35]
buffer_load_dwordx4 v220,s[16:19],s64 offen offset:1024 lds
s_and_b32 s70,s70,6
v_mfma_f32_16x16x32_bf16 v[36:39],v[184:187],v[148:151],v[36:39]
s_lshl_b32 s70,s70,2
s_lshr_b32 s70,s100,s70
v_mfma_f32_16x16x32_bf16 v[40:43],v[184:187],v[152:155],v[40:43]
s_bitcmp1_b32 s71,0
s_cselect_b32 s100,s99,0x0d090500
v_mfma_f32_16x16x32_bf16 v[44:47],v[184:187],v[156:159],v[44:47]
s_and_b32 s71,s71,6
s_lshl_b32 s71,s71,2
ds_read_b64_tr_b16 v[164:165],v228 offset:0
ds_read_b64_tr_b16 v[166:167],v228 offset:4096
ds_read_b64_tr_b16 v[168:169],v229 offset:0
ds_read_b64_tr_b16 v[170:171],v229 offset:4096
ds_read_b64_tr_b16 v[172:173],v223 offset:0
ds_read_b64_tr_b16 v[174:175],v223 offset:4096
v_mfma_f32_16x16x32_bf16 v[48:51],v[188:191],v[144:147],v[48:51]
s_lshr_b32 s71,s100,s71
s_lshl_b32 s88,s45,7
v_mfma_f32_16x16x32_bf16 v[52:55],v[188:191],v[148:151],v[52:55]
s_bitcmp1_b32 s72,0
s_cselect_b32 s100,s99,0x0d090500
v_mfma_f32_16x16x32_bf16 v[56:59],v[188:191],v[152:155],v[56:59]
s_and_b32 s72,s72,6
s_lshl_b32 s72,s72,2
v_mfma_f32_16x16x32_bf16 v[60:63],v[188:191],v[156:159],v[60:63]
buffer_load_dwordx4 v221,s[16:19],s64 offen offset:2048 lds
s_lshr_b32 s72,s100,s72
s_waitcnt lgkmcnt(0)
v_mfma_f32_16x16x32_bf16 v[64:67],a[0:3],v[160:163],0
s_bitcmp1_b32 s73,0
s_cselect_b32 s100,s99,0x0d090500
v_mfma_f32_16x16x32_bf16 v[68:71],a[4:7],v[160:163],0
s_and_b32 s73,s73,6
s_lshl_b32 s73,s73,2
v_mfma_f32_16x16x32_bf16 v[72:75],a[8:11],v[160:163],0
s_lshr_b32 s73,s100,s73
s_mul_i32 s99,s3,0x2010102
v_mfma_f32_16x16x32_bf16 v[76:79],a[12:15],v[160:163],0
s_add_u32 s99,s99,0xf0b0702
s_lshr_b32 s74,s99,s74
v_mfma_f32_16x16x32_bf16 v[80:83],a[0:3],v[164:167],0
s_lshr_b32 s75,s99,s75
s_lshr_b32 s76,s99,s76
v_mfma_f32_16x16x32_bf16 v[84:87],a[4:7],v[164:167],0
s_lshr_b32 s77,s99,s77
s_mul_i32 s99,s3,0xfdfdfdfe
v_mfma_f32_16x16x32_bf16 v[88:91],a[8:11],v[164:167],0
s_add_u32 s99,s99,0x100c0803
s_lshr_b32 s78,s99,s78
v_mfma_f32_16x16x32_bf16 v[92:95],a[12:15],v[164:167],0
buffer_load_dwordx4 v222,s[16:19],s64 offen offset:3072 lds
s_lshr_b32 s79,s99,s79
v_mfma_f32_16x16x32_bf16 v[192:195],v[168:171],a[0:3],0
s_lshr_b32 s80,s99,s80
s_lshr_b32 s81,s99,s81
v_mfma_f32_16x16x32_bf16 v[196:199],v[168:171],a[4:7],0
s_mul_i32 s99,s3,0xfffffdfe
s_add_u32 s99,s99,0x1104
ds_read_b64_tr_b16 v[176:177],v218 offset:8192
ds_read_b64_tr_b16 v[178:179],v218 offset:12288
ds_read_b64_tr_b16 v[180:181],v228 offset:8192
ds_read_b64_tr_b16 v[182:183],v228 offset:12288
ds_read_b64_tr_b16 v[184:185],v229 offset:8192
ds_read_b64_tr_b16 v[186:187],v229 offset:12288
ds_read_b64_tr_b16 v[188:189],v223 offset:8192
ds_read_b64_tr_b16 v[190:191],v223 offset:12288
v_mfma_f32_16x16x32_bf16 v[200:203],v[168:171],a[8:11],0
s_lshr_b32 s82,s99,s82
s_lshr_b32 s83,s99,s83
v_mfma_f32_16x16x32_bf16 v[204:207],v[168:171],a[12:15],0
s_add_u32 s88,s88,159744
v_lshl_add_u32 v248,v248,2,s88
v_mfma_f32_16x16x32_bf16 v[112:115],a[0:3],v[172:175],0
s_lshl_b32 s88,s44,1
s_add_u32 s88,s88,s89
v_mfma_f32_16x16x32_bf16 v[116:119],a[4:7],v[172:175],0
s_waitcnt lgkmcnt(0)
ds_read_b64_tr_b16 v[160:161],v218 offset:18432
v_mfma_f32_16x16x32_bf16 v[64:67],a[16:19],v[176:179],v[64:67]
ds_read_b64_tr_b16 v[162:163],v218 offset:22528
s_lshl_b32 s89,s45,4
v_mfma_f32_16x16x32_bf16 v[68:71],a[20:23],v[176:179],v[68:71]
ds_read_b64_tr_b16 v[164:165],v228 offset:18432
s_add_u32 s88,s88,s89
v_mfma_f32_16x16x32_bf16 v[72:75],a[24:27],v[176:179],v[72:75]
ds_read_b64_tr_b16 v[166:167],v228 offset:22528
v_lshl_add_u32 v253,v253,6,s88
v_mfma_f32_16x16x32_bf16 v[76:79],a[28:31],v[176:179],v[76:79]
ds_read_b64_tr_b16 v[168:169],v229 offset:18432
v_lshlrev_b32 v253,7,v253
v_mfma_f32_16x16x32_bf16 v[80:83],a[16:19],v[180:183],v[80:83]
ds_read_b64_tr_b16 v[170:171],v229 offset:22528
v_add_u32 v253,2048,v253
v_mfma_f32_16x16x32_bf16 v[84:87],a[20:23],v[180:183],v[84:87]
ds_read_b64_tr_b16 v[172:173],v223 offset:18432
v_add_u32 v216,110592,v216
v_mfma_f32_16x16x32_bf16 v[88:91],a[24:27],v[180:183],v[88:91]
ds_read_b64_tr_b16 v[174:175],v223 offset:22528
v_xor_b32 v249,128,v248
v_mfma_f32_16x16x32_bf16 v[92:95],a[28:31],v[180:183],v[92:95]
ds_read_b32 v208,v248 offset:0
s_lshl_b32 s88,s45,7
v_mfma_f32_16x16x32_bf16 v[192:195],v[184:187],a[16:19],v[192:195]
ds_read_b32 v209,v248 offset:64
v_lshrrev_b32 v248,4,v226
v_mfma_f32_16x16x32_bf16 v[196:199],v[184:187],a[20:23],v[196:199]
ds_read_b32 v210,v249 offset:0
s_add_u32 s88,s88,159744
v_mfma_f32_16x16x32_bf16 v[200:203],v[184:187],a[24:27],v[200:203]
ds_read_b32 v211,v249 offset:64
v_lshl_add_u32 v248,v248,4,s88
v_mfma_f32_16x16x32_bf16 v[204:207],v[184:187],a[28:31],v[204:207]
ds_read_b128 v[232:235],v248 offset:64
v_cmp_eq_u32 vcc,2,v240
v_mfma_f32_16x16x32_bf16 v[112:115],a[16:19],v[188:191],v[112:115]
v_and_b32 v250,3,v226
v_lshlrev_b32 v250,5,v250
v_mfma_f32_16x16x32_bf16 v[116:119],a[20:23],v[188:191],v[116:119]
s_waitcnt lgkmcnt(5)
ds_read_b64_tr_b16 v[176:177],v218 offset:26624
v_mfma_f32_16x16x32_bf16 v[64:67],a[32:35],v[160:163],v[64:67]
ds_read_b64_tr_b16 v[178:179],v218 offset:30720
v_lshrrev_b32 v244,4,v226
v_mfma_f32_16x16x32_bf16 v[68:71],a[36:39],v[160:163],v[68:71]
ds_read_b64_tr_b16 v[180:181],v228 offset:26624
v_lshl_add_u32 v250,v244,3,v250
v_mfma_f32_16x16x32_bf16 v[72:75],a[40:43],v[160:163],v[72:75]
ds_read_b64_tr_b16 v[182:183],v228 offset:30720
s_waitcnt lgkmcnt(5)
v_mfma_f32_16x16x32_bf16 v[76:79],a[44:47],v[160:163],v[76:79]
ds_read_b64_tr_b16 v[184:185],v229 offset:26624
v_mul_f32 v208,0xbfb8aa3b,v208
v_mfma_f32_16x16x32_bf16 v[80:83],a[32:35],v[164:167],v[80:83]
ds_read_b64_tr_b16 v[186:187],v229 offset:30720
v_mul_f32 v0,v208,v0
v_mfma_f32_16x16x32_bf16 v[84:87],a[36:39],v[164:167],v[84:87]
ds_read_b64_tr_b16 v[188:189],v223 offset:26624
v_mul_f32 v1,v208,v1
v_mfma_f32_16x16x32_bf16 v[88:91],a[40:43],v[164:167],v[88:91]
s_lshl_b32 s100,s84,1
s_add_u32 m0,s100,92160
v_mfma_f32_16x16x32_bf16 v[92:95],a[44:47],v[164:167],v[92:95]
s_mul_i32 s98,s3,256
s_add_u32 s98,s98,128
s_ashr_i32 s99,s98,31
v_mfma_f32_16x16x32_bf16 v[192:195],v[168:171],a[32:35],v[192:195]
s_add_u32 s8,s8,s98
s_addc_u32 s9,s9,s99
s_sub_u32 s10,s10,s98
v_mfma_f32_16x16x32_bf16 v[196:199],v[168:171],a[36:39],v[196:199]
s_add_u32 s12,s12,s98
s_addc_u32 s13,s13,s99
s_sub_u32 s14,s14,s98
ds_read_b64_tr_b16 v[190:191],v223 offset:30720
v_mfma_f32_16x16x32_bf16 v[200:203],v[168:171],a[40:43],v[200:203]
v_exp_f32 v0,v0
v_mfma_f32_16x16x32_bf16 v[204:207],v[168:171],a[44:47],v[204:207]
v_exp_f32 v1,v1
v_mfma_f32_16x16x32_bf16 v[112:115],a[32:35],v[172:175],v[112:115]
v_mul_f32 v2,v208,v2
v_mul_f32 v3,v208,v3
v_mfma_f32_16x16x32_bf16 v[116:119],a[36:39],v[172:175],v[116:119]
s_getpc_b64 s[0:1]
L_cp1_5:
v_min_u32 v254,L_stop_5-L_cp1_5,v253
global_load_dword v255,v254,s[0:1]
s_waitcnt lgkmcnt(0)
v_mfma_f32_16x16x32_bf16 v[64:67],a[48:51],v[176:179],v[64:67]
s_waitcnt vmcnt(20)
s_barrier
v_mfma_f32_16x16x32_bf16 v[68:71],a[52:55],v[176:179],v[68:71]
buffer_load_dwordx4 v219,s[16:19],s65 offen lds
ds_read_b64_tr_b16 v[160:161],v218 offset:36864
v_mfma_f32_16x16x32_bf16 v[72:75],a[56:59],v[176:179],v[72:75]
ds_read_b64_tr_b16 v[162:163],v218 offset:40960
v_mul_f32 v209,0xbfb8aa3b,v209
v_mfma_f32_16x16x32_bf16 v[76:79],a[60:63],v[176:179],v[76:79]
ds_read_b64_tr_b16 v[164:165],v228 offset:36864
v_add_f32 v0,1.0,v0
v_mfma_f32_16x16x32_bf16 v[80:83],a[48:51],v[180:183],v[80:83]
ds_read_b64_tr_b16 v[166:167],v228 offset:40960
v_add_f32 v1,1.0,v1
v_mfma_f32_16x16x32_bf16 v[84:87],a[52:55],v[180:183],v[84:87]
ds_read_b64_tr_b16 v[168:169],v229 offset:36864
v_mul_f32 v4,v209,v4
v_mfma_f32_16x16x32_bf16 v[88:91],a[56:59],v[180:183],v[88:91]
buffer_load_dwordx4 v220,s[16:19],s65 offen offset:1024 lds
ds_read_b64_tr_b16 v[170:171],v229 offset:40960
v_mfma_f32_16x16x32_bf16 v[92:95],a[60:63],v[180:183],v[92:95]
ds_read_b64_tr_b16 v[172:173],v223 offset:36864
v_mul_f32 v5,v209,v5
v_mfma_f32_16x16x32_bf16 v[192:195],v[184:187],a[48:51],v[192:195]
ds_read_b64_tr_b16 v[174:175],v223 offset:40960
v_mul_f32 v6,v209,v6
v_mfma_f32_16x16x32_bf16 v[196:199],v[184:187],a[52:55],v[196:199]
v_exp_f32 v2,v2
v_mfma_f32_16x16x32_bf16 v[200:203],v[184:187],a[56:59],v[200:203]
v_exp_f32 v3,v3
v_mfma_f32_16x16x32_bf16 v[204:207],v[184:187],a[60:63],v[204:207]
v_rcp_f32 v0,v0
v_mfma_f32_16x16x32_bf16 v[112:115],a[48:51],v[188:191],v[112:115]
v_rcp_f32 v1,v1
v_mfma_f32_16x16x32_bf16 v[116:119],a[52:55],v[188:191],v[116:119]
s_waitcnt lgkmcnt(0)
ds_read_b64_tr_b16 v[176:177],v218 offset:45056
v_mfma_f32_16x16x32_bf16 v[64:67],a[64:67],v[160:163],v[64:67]
buffer_load_dwordx4 v221,s[16:19],s65 offen offset:2048 lds
ds_read_b64_tr_b16 v[178:179],v218 offset:49152
v_mfma_f32_16x16x32_bf16 v[68:71],a[68:71],v[160:163],v[68:71]
v_subrev_u32 v218,73728,v218
ds_read_b64_tr_b16 v[180:181],v228 offset:45056
v_mfma_f32_16x16x32_bf16 v[72:75],a[72:75],v[160:163],v[72:75]
ds_read_b64_tr_b16 v[182:183],v228 offset:49152
v_subrev_u32 v228,73728,v228
v_mfma_f32_16x16x32_bf16 v[76:79],a[76:79],v[160:163],v[76:79]
ds_read_b64_tr_b16 v[184:185],v229 offset:45056
v_add_f32 v2,1.0,v2
v_mfma_f32_16x16x32_bf16 v[80:83],a[64:67],v[164:167],v[80:83]
ds_read_b64_tr_b16 v[186:187],v229 offset:49152
v_subrev_u32 v229,73728,v229
v_mfma_f32_16x16x32_bf16 v[84:87],a[68:71],v[164:167],v[84:87]
ds_read_b64_tr_b16 v[188:189],v223 offset:45056
v_add_f32 v3,1.0,v3
v_mfma_f32_16x16x32_bf16 v[88:91],a[72:75],v[164:167],v[88:91]
ds_read_b64_tr_b16 v[190:191],v223 offset:49152
v_subrev_u32 v223,73728,v223
v_mfma_f32_16x16x32_bf16 v[92:95],a[76:79],v[164:167],v[92:95]
v_rcp_f32 v2,v2
v_mfma_f32_16x16x32_bf16 v[192:195],v[168:171],a[64:67],v[192:195]
buffer_load_dwordx4 v222,s[16:19],s65 offen offset:3072 lds
s_add_u32 m0,s84,110592
v_mfma_f32_16x16x32_bf16 v[196:199],v[168:171],a[68:71],v[196:199]
v_rcp_f32 v3,v3
v_mfma_f32_16x16x32_bf16 v[200:203],v[168:171],a[72:75],v[200:203]
v_exp_f32 v4,v4
v_mfma_f32_16x16x32_bf16 v[204:207],v[168:171],a[76:79],v[204:207]
v_exp_f32 v5,v5
v_mfma_f32_16x16x32_bf16 v[112:115],a[64:67],v[172:175],v[112:115]
v_exp_f32 v6,v6
v_mfma_f32_16x16x32_bf16 v[116:119],a[68:71],v[172:175],v[116:119]
s_waitcnt lgkmcnt(0)
ds_read_b64_tr_b16 v[160:161],v218 offset:0
v_mfma_f32_16x16x32_bf16 v[64:67],a[80:83],v[176:179],v[64:67]
ds_read_b64_tr_b16 v[162:163],v218 offset:4096
v_mul_f32 v7,v209,v7
v_mfma_f32_16x16x32_bf16 v[68:71],a[84:87],v[176:179],v[68:71]
ds_read_b64_tr_b16 v[164:165],v228 offset:0
v_mul_f32 v210,0xbfb8aa3b,v210
v_mfma_f32_16x16x32_bf16 v[72:75],a[88:91],v[176:179],v[72:75]
buffer_load_dwordx4 v213,s[8:11],s48 offen lds
ds_read_b64_tr_b16 v[166:167],v228 offset:4096
v_mfma_f32_16x16x32_bf16 v[76:79],a[92:95],v[176:179],v[76:79]
ds_read_b64_tr_b16 v[168:169],v229 offset:0
v_mul_f32 v0,v0,v32
v_mfma_f32_16x16x32_bf16 v[80:83],a[80:83],v[180:183],v[80:83]
ds_read_b64_tr_b16 v[170:171],v229 offset:4096
v_mul_f32 v1,v1,v33
v_mfma_f32_16x16x32_bf16 v[84:87],a[84:87],v[180:183],v[84:87]
ds_read_b64_tr_b16 v[172:173],v223 offset:0
v_mul_f32 v2,v2,v34
v_mfma_f32_16x16x32_bf16 v[88:91],a[88:91],v[180:183],v[88:91]
buffer_load_dwordx4 v213,s[12:15],s48 offen offset:1024 lds
s_add_u32 m0,s84,118784
v_mfma_f32_16x16x32_bf16 v[92:95],a[92:95],v[180:183],v[92:95]
ds_read_b64_tr_b16 v[174:175],v223 offset:4096
s_waitcnt vmcnt(12)
v_mfma_f32_16x16x32_bf16 v[192:195],v[184:187],a[80:83],v[192:195]
buffer_store_dword v225,v227,s[32:35],s91 offen sc1
v_mul_f32 v3,v3,v35
v_mfma_f32_16x16x32_bf16 v[196:199],v[184:187],a[84:87],v[196:199]
v_exp_f32 v7,v7
v_mfma_f32_16x16x32_bf16 v[200:203],v[184:187],a[88:91],v[200:203]
v_cvt_pk_bf16_f32 v32,v0,v1
v_cvt_pk_bf16_f32 v33,v2,v3
v_mfma_f32_16x16x32_bf16 v[204:207],v[184:187],a[92:95],v[204:207]
buffer_load_dwordx4 v214,s[8:11],s48 offen lds
v_add_f32 v4,1.0,v4
v_mfma_f32_16x16x32_bf16 v[112:115],a[80:83],v[188:191],v[112:115]
v_rcp_f32 v4,v4
v_mfma_f32_16x16x32_bf16 v[116:119],a[84:87],v[188:191],v[116:119]
s_waitcnt lgkmcnt(0)
ds_read_b64_tr_b16 v[176:177],v218 offset:8192
v_mfma_f32_16x16x32_bf16 v[64:67],a[96:99],v[160:163],v[64:67]
ds_read_b64_tr_b16 v[178:179],v218 offset:12288
v_add_f32 v5,1.0,v5
v_mfma_f32_16x16x32_bf16 v[68:71],a[100:103],v[160:163],v[68:71]
buffer_load_dwordx4 v214,s[12:15],s48 offen offset:1024 lds
ds_read_b64_tr_b16 v[180:181],v228 offset:8192
v_mfma_f32_16x16x32_bf16 v[72:75],a[104:107],v[160:163],v[72:75]
ds_read_b64_tr_b16 v[182:183],v228 offset:12288
v_add_f32 v6,1.0,v6
v_mfma_f32_16x16x32_bf16 v[76:79],a[108:111],v[160:163],v[76:79]
ds_read_b64_tr_b16 v[184:185],v229 offset:8192
v_add_f32 v7,1.0,v7
v_mfma_f32_16x16x32_bf16 v[80:83],a[96:99],v[164:167],v[80:83]
ds_read_b64_tr_b16 v[186:187],v229 offset:12288
v_mul_f32 v8,v210,v8
v_mfma_f32_16x16x32_bf16 v[84:87],a[100:103],v[164:167],v[84:87]
ds_read_b64_tr_b16 v[188:189],v223 offset:8192
v_mul_f32 v9,v210,v9
v_mfma_f32_16x16x32_bf16 v[88:91],a[104:107],v[164:167],v[88:91]
s_add_u32 m0,s84,129024
ds_read_b64_tr_b16 v[190:191],v223 offset:12288
v_mfma_f32_16x16x32_bf16 v[92:95],a[108:111],v[164:167],v[92:95]
v_rcp_f32 v5,v5
v_mfma_f32_16x16x32_bf16 v[192:195],v[168:171],a[96:99],v[192:195]
v_rcp_f32 v6,v6
v_mfma_f32_16x16x32_bf16 v[196:199],v[168:171],a[100:103],v[196:199]
v_rcp_f32 v7,v7
v_mfma_f32_16x16x32_bf16 v[200:203],v[168:171],a[104:107],v[200:203]
v_exp_f32 v8,v8
v_mfma_f32_16x16x32_bf16 v[204:207],v[168:171],a[108:111],v[204:207]
v_exp_f32 v9,v9
v_mfma_f32_16x16x32_bf16 v[112:115],a[96:99],v[172:175],v[112:115]
v_mul_f32 v10,v210,v10
v_mul_f32 v11,v210,v11
v_mfma_f32_16x16x32_bf16 v[116:119],a[100:103],v[172:175],v[116:119]
s_waitcnt lgkmcnt(0)
v_mul_f32 v211,0xbfb8aa3b,v211
v_mfma_f32_16x16x32_bf16 v[64:67],a[112:115],v[176:179],v[64:67]
s_barrier
v_mfma_f32_16x16x32_bf16 v[68:71],a[116:119],v[176:179],v[68:71]
buffer_load_dwordx4 v213,s[8:11],s49 offen lds
ds_read_b64_tr_b16 v[160:161],v218 offset:18432
v_mfma_f32_16x16x32_bf16 v[72:75],a[120:123],v[176:179],v[72:75]
buffer_load_dwordx4 v213,s[12:15],s49 offen offset:1024 lds
s_add_u32 m0,s84,137216
v_mfma_f32_16x16x32_bf16 v[76:79],a[124:127],v[176:179],v[76:79]
ds_read_b64_tr_b16 v[162:163],v218 offset:22528
v_mul_f32 v4,v4,v36
v_mfma_f32_16x16x32_bf16 v[80:83],a[112:115],v[180:183],v[80:83]
ds_read_b64_tr_b16 v[164:165],v228 offset:18432
v_mul_f32 v5,v5,v37
v_mfma_f32_16x16x32_bf16 v[84:87],a[116:119],v[180:183],v[84:87]
ds_read_b64_tr_b16 v[166:167],v228 offset:22528
v_mul_f32 v6,v6,v38
v_mfma_f32_16x16x32_bf16 v[88:91],a[120:123],v[180:183],v[88:91]
ds_read_b64_tr_b16 v[168:169],v229 offset:18432
v_mul_f32 v7,v7,v39
v_mfma_f32_16x16x32_bf16 v[92:95],a[124:127],v[180:183],v[92:95]
buffer_load_dwordx4 v214,s[8:11],s49 offen lds
ds_read_b64_tr_b16 v[170:171],v229 offset:22528
v_mfma_f32_16x16x32_bf16 v[192:195],v[184:187],a[112:115],v[192:195]
ds_read_b64_tr_b16 v[172:173],v223 offset:18432
v_cvt_pk_bf16_f32 v36,v4,v5
v_mfma_f32_16x16x32_bf16 v[196:199],v[184:187],a[116:119],v[196:199]
ds_read_b64_tr_b16 v[174:175],v223 offset:22528
v_cvt_pk_bf16_f32 v37,v6,v7
v_mfma_f32_16x16x32_bf16 v[200:203],v[184:187],a[120:123],v[200:203]
v_exp_f32 v10,v10
v_mfma_f32_16x16x32_bf16 v[204:207],v[184:187],a[124:127],v[204:207]
buffer_load_dwordx4 v214,s[12:15],s49 offen offset:1024 lds
s_add_u32 m0,s84,18432
v_mfma_f32_16x16x32_bf16 v[112:115],a[112:115],v[188:191],v[112:115]
v_exp_f32 v11,v11
v_mfma_f32_16x16x32_bf16 v[116:119],a[116:119],v[188:191],v[116:119]
s_waitcnt lgkmcnt(0)
ds_read_b64_tr_b16 v[176:177],v218 offset:26624
v_mfma_f32_16x16x32_bf16 v[64:67],a[128:131],v[160:163],v[64:67]
ds_read_b64_tr_b16 v[178:179],v218 offset:30720
v_add_f32 v8,1.0,v8
v_mfma_f32_16x16x32_bf16 v[68:71],a[132:135],v[160:163],v[68:71]
buffer_load_dwordx4 v213,s[8:11],s50 offen lds
ds_read_b64_tr_b16 v[180:181],v228 offset:26624
v_mfma_f32_16x16x32_bf16 v[72:75],a[136:139],v[160:163],v[72:75]
ds_read_b64_tr_b16 v[182:183],v228 offset:30720
v_add_f32 v9,1.0,v9
v_mfma_f32_16x16x32_bf16 v[76:79],a[140:143],v[160:163],v[76:79]
ds_read_b64_tr_b16 v[184:185],v229 offset:26624
v_add_f32 v10,1.0,v10
v_mfma_f32_16x16x32_bf16 v[80:83],a[128:131],v[164:167],v[80:83]
ds_read_b64_tr_b16 v[186:187],v229 offset:30720
v_add_f32 v11,1.0,v11
v_mfma_f32_16x16x32_bf16 v[84:87],a[132:135],v[164:167],v[84:87]
ds_read_b64_tr_b16 v[188:189],v223 offset:26624
v_mul_f32 v12,v211,v12
v_mfma_f32_16x16x32_bf16 v[88:91],a[136:139],v[164:167],v[88:91]
buffer_load_dwordx4 v213,s[12:15],s50 offen offset:1024 lds
s_add_u32 m0,s84,26624
v_mfma_f32_16x16x32_bf16 v[92:95],a[140:143],v[164:167],v[92:95]
ds_read_b64_tr_b16 v[190:191],v223 offset:30720
v_mul_f32 v13,v211,v13
v_mfma_f32_16x16x32_bf16 v[192:195],v[168:171],a[128:131],v[192:195]
v_rcp_f32 v8,v8
v_mfma_f32_16x16x32_bf16 v[196:199],v[168:171],a[132:135],v[196:199]
v_rcp_f32 v9,v9
v_mfma_f32_16x16x32_bf16 v[200:203],v[168:171],a[136:139],v[200:203]
buffer_load_dwordx4 v214,s[8:11],s50 offen lds
v_mul_f32 v14,v211,v14
v_mfma_f32_16x16x32_bf16 v[204:207],v[168:171],a[140:143],v[204:207]
v_rcp_f32 v10,v10
v_mfma_f32_16x16x32_bf16 v[112:115],a[128:131],v[172:175],v[112:115]
v_rcp_f32 v11,v11
v_mfma_f32_16x16x32_bf16 v[116:119],a[132:135],v[172:175],v[116:119]
s_waitcnt lgkmcnt(0)
ds_read_b64_tr_b16 v[160:161],v218 offset:36864
v_mfma_f32_16x16x32_bf16 v[64:67],a[144:147],v[176:179],v[64:67]
buffer_load_dwordx4 v214,s[12:15],s50 offen offset:1024 lds
ds_read_b64_tr_b16 v[162:163],v218 offset:40960
v_mfma_f32_16x16x32_bf16 v[68:71],a[148:151],v[176:179],v[68:71]
ds_read_b64_tr_b16 v[164:165],v228 offset:36864
v_mul_f32 v15,v211,v15
v_mfma_f32_16x16x32_bf16 v[72:75],a[152:155],v[176:179],v[72:75]
ds_read_b64_tr_b16 v[166:167],v228 offset:40960
v_mul_f32 v16,v208,v16
v_mfma_f32_16x16x32_bf16 v[76:79],a[156:159],v[176:179],v[76:79]
ds_read_b64_tr_b16 v[168:169],v229 offset:36864
v_mul_f32 v17,v208,v17
v_mfma_f32_16x16x32_bf16 v[80:83],a[144:147],v[180:183],v[80:83]
ds_read_b64_tr_b16 v[170:171],v229 offset:40960
v_mul_f32 v18,v208,v18
v_mfma_f32_16x16x32_bf16 v[84:87],a[148:151],v[180:183],v[84:87]
ds_read_b64_tr_b16 v[172:173],v223 offset:36864
v_mul_f32 v19,v208,v19
v_mfma_f32_16x16x32_bf16 v[88:91],a[152:155],v[180:183],v[88:91]
ds_read_b64_tr_b16 v[174:175],v223 offset:40960
v_mul_f32 v8,v8,v40
v_mfma_f32_16x16x32_bf16 v[92:95],a[156:159],v[180:183],v[92:95]
v_exp_f32 v12,v12
v_mfma_f32_16x16x32_bf16 v[192:195],v[184:187],a[144:147],v[192:195]
v_exp_f32 v13,v13
v_mfma_f32_16x16x32_bf16 v[196:199],v[184:187],a[148:151],v[196:199]
v_exp_f32 v14,v14
v_mfma_f32_16x16x32_bf16 v[200:203],v[184:187],a[152:155],v[200:203]
v_exp_f32 v15,v15
v_mfma_f32_16x16x32_bf16 v[204:207],v[184:187],a[156:159],v[204:207]
v_exp_f32 v16,v16
v_mfma_f32_16x16x32_bf16 v[112:115],a[144:147],v[188:191],v[112:115]
v_exp_f32 v17,v17
v_mfma_f32_16x16x32_bf16 v[116:119],a[148:151],v[188:191],v[116:119]
s_waitcnt lgkmcnt(0)
ds_read_b64_tr_b16 v[176:177],v218 offset:45056
v_mfma_f32_16x16x32_bf16 v[64:67],a[160:163],v[160:163],v[64:67]
ds_read_b64_tr_b16 v[178:179],v218 offset:49152
v_mul_f32 v9,v9,v41
v_mfma_f32_16x16x32_bf16 v[68:71],a[164:167],v[160:163],v[68:71]
ds_read_b64_tr_b16 v[180:181],v228 offset:45056
v_mul_f32 v10,v10,v42
v_mfma_f32_16x16x32_bf16 v[72:75],a[168:171],v[160:163],v[72:75]
ds_read_b64_tr_b16 v[182:183],v228 offset:49152
v_mul_f32 v11,v11,v43
v_mfma_f32_16x16x32_bf16 v[76:79],a[172:175],v[160:163],v[76:79]
ds_read_b64_tr_b16 v[184:185],v229 offset:45056
v_cvt_pk_bf16_f32 v40,v8,v9
v_mfma_f32_16x16x32_bf16 v[80:83],a[160:163],v[164:167],v[80:83]
ds_read_b64_tr_b16 v[186:187],v229 offset:49152
v_cvt_pk_bf16_f32 v41,v10,v11
v_mfma_f32_16x16x32_bf16 v[84:87],a[164:167],v[164:167],v[84:87]
ds_read_b64_tr_b16 v[188:189],v223 offset:45056
v_add_f32 v12,1.0,v12
v_mfma_f32_16x16x32_bf16 v[88:91],a[168:171],v[164:167],v[88:91]
s_add_u32 m0,s84,36864
ds_read_b64_tr_b16 v[190:191],v223 offset:49152
v_mfma_f32_16x16x32_bf16 v[92:95],a[172:175],v[164:167],v[92:95]
v_exp_f32 v18,v18
v_mfma_f32_16x16x32_bf16 v[192:195],v[168:171],a[160:163],v[192:195]
v_exp_f32 v19,v19
v_mfma_f32_16x16x32_bf16 v[196:199],v[168:171],a[164:167],v[196:199]
v_rcp_f32 v12,v12
v_mfma_f32_16x16x32_bf16 v[200:203],v[168:171],a[168:171],v[200:203]
v_add_f32 v13,1.0,v13
v_add_f32 v14,1.0,v14
v_mfma_f32_16x16x32_bf16 v[204:207],v[168:171],a[172:175],v[204:207]
v_rcp_f32 v13,v13
v_mfma_f32_16x16x32_bf16 v[112:115],a[160:163],v[172:175],v[112:115]
v_rcp_f32 v14,v14
v_mfma_f32_16x16x32_bf16 v[116:119],a[164:167],v[172:175],v[116:119]
s_waitcnt lgkmcnt(0)
v_add_f32 v15,1.0,v15
v_mfma_f32_16x16x32_bf16 v[64:67],a[176:179],v[176:179],v[64:67]
s_waitcnt vmcnt(18)
s_barrier
v_mfma_f32_16x16x32_bf16 v[68:71],a[180:183],v[176:179],v[68:71]
buffer_load_dwordx4 v213,s[8:11],s51 offen lds
ds_read_b64_tr_b16 v[160:161],v218 offset:55296
v_mfma_f32_16x16x32_bf16 v[72:75],a[184:187],v[176:179],v[72:75]
buffer_load_dwordx4 v213,s[12:15],s51 offen offset:1024 lds
s_add_u32 m0,s84,45056
v_mfma_f32_16x16x32_bf16 v[76:79],a[188:191],v[176:179],v[76:79]
ds_read_b64_tr_b16 v[162:163],v218 offset:59392
v_add_u32 v218,55296,v218
v_mfma_f32_16x16x32_bf16 v[80:83],a[176:179],v[180:183],v[80:83]
ds_read_b64_tr_b16 v[164:165],v228 offset:55296
v_add_f32 v16,1.0,v16
v_mfma_f32_16x16x32_bf16 v[84:87],a[180:183],v[180:183],v[84:87]
ds_read_b64_tr_b16 v[166:167],v228 offset:59392
v_add_u32 v228,55296,v228
v_mfma_f32_16x16x32_bf16 v[88:91],a[184:187],v[180:183],v[88:91]
ds_read_b64_tr_b16 v[168:169],v229 offset:55296
v_add_f32 v17,1.0,v17
v_mfma_f32_16x16x32_bf16 v[92:95],a[188:191],v[180:183],v[92:95]
buffer_load_dwordx4 v214,s[8:11],s51 offen lds
ds_read_b64_tr_b16 v[170:171],v229 offset:59392
v_mfma_f32_16x16x32_bf16 v[192:195],v[184:187],a[176:179],v[192:195]
v_add_u32 v229,55296,v229
ds_read_b64_tr_b16 v[172:173],v223 offset:55296
v_mfma_f32_16x16x32_bf16 v[196:199],v[184:187],a[180:183],v[196:199]
ds_read_b64_tr_b16 v[174:175],v223 offset:59392
v_add_u32 v223,55296,v223
v_mfma_f32_16x16x32_bf16 v[200:203],v[184:187],a[184:187],v[200:203]
v_rcp_f32 v15,v15
v_mfma_f32_16x16x32_bf16 v[204:207],v[184:187],a[188:191],v[204:207]
buffer_load_dwordx4 v214,s[12:15],s51 offen offset:1024 lds
s_add_u32 m0,s84,55296
v_mfma_f32_16x16x32_bf16 v[112:115],a[176:179],v[188:191],v[112:115]
v_rcp_f32 v16,v16
v_mfma_f32_16x16x32_bf16 v[116:119],a[180:183],v[188:191],v[116:119]
s_waitcnt lgkmcnt(0)
ds_read_b64_tr_b16 v[176:177],v218 offset:8192
v_mfma_f32_16x16x32_bf16 v[64:67],a[192:195],v[160:163],v[64:67]
ds_read_b64_tr_b16 v[178:179],v218 offset:12288
v_subrev_u32 v218,73728,v218
v_mfma_f32_16x16x32_bf16 v[68:71],a[196:199],v[160:163],v[68:71]
buffer_load_dwordx4 v213,s[8:11],s52 offen lds
ds_read_b64_tr_b16 v[180:181],v228 offset:8192
v_mfma_f32_16x16x32_bf16 v[72:75],a[200:203],v[160:163],v[72:75]
ds_read_b64_tr_b16 v[182:183],v228 offset:12288
v_subrev_u32 v228,73728,v228
v_mfma_f32_16x16x32_bf16 v[76:79],a[204:207],v[160:163],v[76:79]
ds_read_b64_tr_b16 v[184:185],v229 offset:8192
v_add_f32 v18,1.0,v18
v_mfma_f32_16x16x32_bf16 v[80:83],a[192:195],v[164:167],v[80:83]
ds_read_b64_tr_b16 v[186:187],v229 offset:12288
v_subrev_u32 v229,73728,v229
v_mfma_f32_16x16x32_bf16 v[84:87],a[196:199],v[164:167],v[84:87]
ds_read_b64_tr_b16 v[188:189],v223 offset:8192
v_add_f32 v19,1.0,v19
v_mfma_f32_16x16x32_bf16 v[88:91],a[200:203],v[164:167],v[88:91]
buffer_load_dwordx4 v213,s[12:15],s52 offen offset:1024 lds
s_add_u32 m0,s84,63488
v_mfma_f32_16x16x32_bf16 v[92:95],a[204:207],v[164:167],v[92:95]
ds_read_b64_tr_b16 v[190:191],v223 offset:12288
v_subrev_u32 v223,73728,v223
v_mfma_f32_16x16x32_bf16 v[192:195],v[168:171],a[192:195],v[192:195]
v_rcp_f32 v17,v17
v_mfma_f32_16x16x32_bf16 v[196:199],v[168:171],a[196:199],v[196:199]
v_rcp_f32 v18,v18
v_mfma_f32_16x16x32_bf16 v[200:203],v[168:171],a[200:203],v[200:203]
buffer_load_dwordx4 v214,s[8:11],s52 offen lds
v_mul_f32 v20,v209,v20
v_mfma_f32_16x16x32_bf16 v[204:207],v[168:171],a[204:207],v[204:207]
v_rcp_f32 v19,v19
v_mfma_f32_16x16x32_bf16 v[112:115],a[192:195],v[172:175],v[112:115]
v_exp_f32 v20,v20
v_mfma_f32_16x16x32_bf16 v[116:119],a[196:199],v[172:175],v[116:119]
s_waitcnt lgkmcnt(0)
ds_read_b64_tr_b16 v[160:161],v218 offset:0
v_mfma_f32_16x16x32_bf16 v[64:67],a[208:211],v[176:179],v[64:67]
buffer_load_dwordx4 v214,s[12:15],s52 offen offset:1024 lds
ds_read_b64_tr_b16 v[162:163],v218 offset:4096
v_mfma_f32_16x16x32_bf16 v[68:71],a[212:215],v[176:179],v[68:71]
ds_read_b64_tr_b16 v[164:165],v228 offset:0
v_mul_f32 v21,v209,v21
v_mfma_f32_16x16x32_bf16 v[72:75],a[216:219],v[176:179],v[72:75]
ds_read_b64_tr_b16 v[166:167],v228 offset:4096
v_mul_f32 v22,v209,v22
v_mfma_f32_16x16x32_bf16 v[76:79],a[220:223],v[176:179],v[76:79]
ds_read_b64_tr_b16 v[168:169],v229 offset:0
v_mul_f32 v23,v209,v23
v_mfma_f32_16x16x32_bf16 v[80:83],a[208:211],v[180:183],v[80:83]
ds_read_b64_tr_b16 v[170:171],v229 offset:4096
v_mul_f32 v12,v12,v44
v_mfma_f32_16x16x32_bf16 v[84:87],a[212:215],v[180:183],v[84:87]
ds_read_b64_tr_b16 v[172:173],v223 offset:0
v_mul_f32 v13,v13,v45
v_mfma_f32_16x16x32_bf16 v[88:91],a[216:219],v[180:183],v[88:91]
ds_read_b64_tr_b16 v[174:175],v223 offset:4096
v_mul_f32 v14,v14,v46
v_mfma_f32_16x16x32_bf16 v[92:95],a[220:223],v[180:183],v[92:95]
v_exp_f32 v21,v21
v_mfma_f32_16x16x32_bf16 v[192:195],v[184:187],a[208:211],v[192:195]
v_exp_f32 v22,v22
v_mfma_f32_16x16x32_bf16 v[196:199],v[184:187],a[212:215],v[196:199]
v_exp_f32 v23,v23
v_mfma_f32_16x16x32_bf16 v[200:203],v[184:187],a[216:219],v[200:203]
v_mul_f32 v15,v15,v47
v_cvt_pk_bf16_f32 v44,v12,v13
v_mfma_f32_16x16x32_bf16 v[204:207],v[184:187],a[220:223],v[204:207]
v_cvt_pk_bf16_f32 v45,v14,v15
v_mul_f32 v16,v16,v48
v_mfma_f32_16x16x32_bf16 v[112:115],a[208:211],v[188:191],v[112:115]
v_mul_f32 v17,v17,v49
v_mul_f32 v18,v18,v50
v_mfma_f32_16x16x32_bf16 v[116:119],a[212:215],v[188:191],v[116:119]
s_waitcnt lgkmcnt(0)
ds_read_b64_tr_b16 v[176:177],v218 offset:8192
v_mfma_f32_16x16x32_bf16 v[64:67],a[224:227],v[160:163],v[64:67]
ds_read_b64_tr_b16 v[178:179],v218 offset:12288
v_add_u32 v218,92160,v218
v_mfma_f32_16x16x32_bf16 v[68:71],a[228:231],v[160:163],v[68:71]
ds_read_b64_tr_b16 v[180:181],v228 offset:8192
v_mul_f32 v19,v19,v51
v_mfma_f32_16x16x32_bf16 v[72:75],a[232:235],v[160:163],v[72:75]
ds_read_b64_tr_b16 v[182:183],v228 offset:12288
v_add_u32 v228,92160,v228
v_mfma_f32_16x16x32_bf16 v[76:79],a[236:239],v[160:163],v[76:79]
ds_read_b64_tr_b16 v[184:185],v229 offset:8192
v_cvt_pk_bf16_f32 v34,v16,v17
v_mfma_f32_16x16x32_bf16 v[80:83],a[224:227],v[164:167],v[80:83]
ds_read_b64_tr_b16 v[186:187],v229 offset:12288
v_add_u32 v229,92160,v229
v_mfma_f32_16x16x32_bf16 v[84:87],a[228:231],v[164:167],v[84:87]
ds_read_b64_tr_b16 v[188:189],v223 offset:8192
v_cvt_pk_bf16_f32 v35,v18,v19
v_mfma_f32_16x16x32_bf16 v[88:91],a[232:235],v[164:167],v[88:91]
buffer_store_dwordx4 v[32:35],v212,s[24:27],s86 offen sc1
s_add_u32 m0,s84,73728
v_mfma_f32_16x16x32_bf16 v[92:95],a[236:239],v[164:167],v[92:95]
ds_read_b64_tr_b16 v[190:191],v223 offset:12288
v_add_u32 v223,92160,v223
v_mfma_f32_16x16x32_bf16 v[192:195],v[168:171],a[224:227],v[192:195]
v_add_f32 v20,1.0,v20
v_add_f32 v21,1.0,v21
v_mfma_f32_16x16x32_bf16 v[196:199],v[168:171],a[228:231],v[196:199]
v_rcp_f32 v20,v20
v_mfma_f32_16x16x32_bf16 v[200:203],v[168:171],a[232:235],v[200:203]
v_rcp_f32 v21,v21
v_mfma_f32_16x16x32_bf16 v[204:207],v[168:171],a[236:239],v[204:207]
v_add_f32 v22,1.0,v22
v_add_f32 v23,1.0,v23
v_mfma_f32_16x16x32_bf16 v[112:115],a[224:227],v[172:175],v[112:115]
v_rcp_f32 v22,v22
v_mfma_f32_16x16x32_bf16 v[116:119],a[228:231],v[172:175],v[116:119]
s_waitcnt lgkmcnt(0)
v_mul_f32 v24,v210,v24
v_mfma_f32_16x16x32_bf16 v[64:67],a[240:243],v[176:179],v[64:67]
s_waitcnt vmcnt(17)
s_barrier
v_mfma_f32_16x16x32_bf16 v[68:71],a[244:247],v[176:179],v[68:71]
buffer_load_dwordx4 v213,s[8:11],s53 offen lds
ds_read_b64_tr_b16 v[160:161],v218 offset:0
v_mfma_f32_16x16x32_bf16 v[72:75],a[248:251],v[176:179],v[72:75]
ds_read_b64_tr_b16 v[162:163],v218 offset:4096
v_mul_f32 v25,v210,v25
v_mfma_f32_16x16x32_bf16 v[76:79],a[252:255],v[176:179],v[76:79]
ds_read_b64_tr_b16 v[164:165],v228 offset:0
v_mul_f32 v26,v210,v26
v_mfma_f32_16x16x32_bf16 v[80:83],a[240:243],v[180:183],v[80:83]
ds_read_b64_tr_b16 v[166:167],v228 offset:4096
v_mul_f32 v27,v210,v27
v_mfma_f32_16x16x32_bf16 v[84:87],a[244:247],v[180:183],v[84:87]
buffer_load_dwordx4 v213,s[12:15],s53 offen offset:1024 lds
s_add_u32 m0,s84,81920
v_mfma_f32_16x16x32_bf16 v[88:91],a[248:251],v[180:183],v[88:91]
ds_read_b64_tr_b16 v[168:169],v229 offset:0
v_mul_f32 v20,v20,v52
v_mfma_f32_16x16x32_bf16 v[92:95],a[252:255],v[180:183],v[92:95]
ds_read_b64_tr_b16 v[170:171],v229 offset:4096
v_mul_f32 v21,v21,v53
v_mfma_f32_16x16x32_bf16 v[192:195],v[184:187],a[240:243],v[192:195]
ds_read_b64_tr_b16 v[172:173],v223 offset:0
v_mul_f32 v22,v22,v54
v_mfma_f32_16x16x32_bf16 v[196:199],v[184:187],a[244:247],v[196:199]
buffer_load_dwordx4 v214,s[8:11],s53 offen lds
ds_read_b64_tr_b16 v[174:175],v223 offset:4096
v_mfma_f32_16x16x32_bf16 v[200:203],v[184:187],a[248:251],v[200:203]
v_rcp_f32 v23,v23
v_mfma_f32_16x16x32_bf16 v[204:207],v[184:187],a[252:255],v[204:207]
v_exp_f32 v24,v24
v_mfma_f32_16x16x32_bf16 v[112:115],a[240:243],v[188:191],v[112:115]
v_exp_f32 v25,v25
v_mfma_f32_16x16x32_bf16 v[116:119],a[244:247],v[188:191],v[116:119]
s_waitcnt lgkmcnt(0)
ds_read_b64_tr_b16 v[176:177],v218 offset:8192
v_mfma_f32_16x16x32_bf16 v[64:67],v[128:131],v[160:163],v[64:67]
buffer_load_dwordx4 v214,s[12:15],s53 offen offset:1024 lds
s_add_u32 m0,s84,0
v_mfma_f32_16x16x32_bf16 v[68:71],v[132:135],v[160:163],v[68:71]
ds_read_b64_tr_b16 v[178:179],v218 offset:12288
v_mul_f32 v23,v23,v55
v_mfma_f32_16x16x32_bf16 v[72:75],v[136:139],v[160:163],v[72:75]
ds_read_b64_tr_b16 v[180:181],v228 offset:8192
v_exp_f32 v26,v26
v_mfma_f32_16x16x32_bf16 v[76:79],v[140:143],v[160:163],v[76:79]
ds_read_b64_tr_b16 v[182:183],v228 offset:12288
v_exp_f32 v27,v27
v_mfma_f32_16x16x32_bf16 v[80:83],v[128:131],v[164:167],v[80:83]
buffer_load_dwordx4 v213,s[8:11],s54 offen lds
ds_read_b64_tr_b16 v[184:185],v229 offset:8192
v_mfma_f32_16x16x32_bf16 v[84:87],v[132:135],v[164:167],v[84:87]
ds_read_b64_tr_b16 v[186:187],v229 offset:12288
v_cvt_pk_bf16_f32 v38,v20,v21
v_mfma_f32_16x16x32_bf16 v[88:91],v[136:139],v[164:167],v[88:91]
ds_read_b64_tr_b16 v[188:189],v223 offset:8192
v_cvt_pk_bf16_f32 v39,v22,v23
v_mfma_f32_16x16x32_bf16 v[92:95],v[140:143],v[164:167],v[92:95]
ds_read_b64_tr_b16 v[190:191],v223 offset:12288
v_add_f32 v24,1.0,v24
v_add_f32 v25,1.0,v25
v_mfma_f32_16x16x32_bf16 v[192:195],v[168:171],v[128:131],v[192:195]
buffer_store_dwordx4 v[36:39],v212,s[24:27],s86 offen offset:1024 sc1
v_rcp_f32 v24,v24
v_mfma_f32_16x16x32_bf16 v[196:199],v[168:171],v[132:135],v[196:199]
v_rcp_f32 v25,v25
v_mfma_f32_16x16x32_bf16 v[200:203],v[168:171],v[136:139],v[200:203]
v_add_f32 v26,1.0,v26
v_add_f32 v27,1.0,v27
v_mfma_f32_16x16x32_bf16 v[204:207],v[168:171],v[140:143],v[204:207]
v_rcp_f32 v26,v26
v_mfma_f32_16x16x32_bf16 v[112:115],v[128:131],v[172:175],v[112:115]
v_rcp_f32 v27,v27
v_mfma_f32_16x16x32_bf16 v[116:119],v[132:135],v[172:175],v[116:119]
s_waitcnt lgkmcnt(0)
ds_read_b64_tr_b16 v[160:161],v215 offset:0
v_mfma_f32_16x16x32_bf16 v[64:67],v[144:147],v[176:179],v[64:67]
ds_read_b64_tr_b16 v[162:163],v215 offset:4096
v_mul_f32 v28,v211,v28
v_mfma_f32_16x16x32_bf16 v[68:71],v[148:151],v[176:179],v[68:71]
ds_read_b64_tr_b16 v[164:165],v216 offset:0
v_mul_f32 v29,v211,v29
v_mfma_f32_16x16x32_bf16 v[72:75],v[152:155],v[176:179],v[72:75]
ds_read_b64_tr_b16 v[166:167],v216 offset:4096
v_mul_f32 v30,v211,v30
v_mfma_f32_16x16x32_bf16 v[76:79],v[156:159],v[176:179],v[76:79]
ds_read_b64_tr_b16 v[168:169],v215 offset:1024
v_mul_f32 v31,v211,v31
v_mfma_f32_16x16x32_bf16 v[80:83],v[144:147],v[180:183],v[80:83]
ds_read_b64_tr_b16 v[170:171],v215 offset:5120
v_exp_f32 v28,v28
v_mfma_f32_16x16x32_bf16 v[84:87],v[148:151],v[180:183],v[84:87]
buffer_load_dwordx4 v213,s[12:15],s54 offen offset:1024 lds
s_add_u32 m0,s84,8192
v_mfma_f32_16x16x32_bf16 v[88:91],v[152:155],v[180:183],v[88:91]
ds_read_b64_tr_b16 v[172:173],v216 offset:1024
v_mul_f32 v24,v24,v56
v_mfma_f32_16x16x32_bf16 v[92:95],v[156:159],v[180:183],v[92:95]
ds_read_b64_tr_b16 v[174:175],v216 offset:5120
v_mul_f32 v25,v25,v57
v_mfma_f32_16x16x32_bf16 v[192:195],v[184:187],v[144:147],v[192:195]
v_exp_f32 v29,v29
v_mfma_f32_16x16x32_bf16 v[196:199],v[184:187],v[148:151],v[196:199]
buffer_load_dwordx4 v214,s[8:11],s54 offen lds
v_exp_f32 v30,v30
v_mfma_f32_16x16x32_bf16 v[200:203],v[184:187],v[152:155],v[200:203]
v_exp_f32 v31,v31
v_mul_f32 v26,v26,v58
v_mfma_f32_16x16x32_bf16 v[204:207],v[184:187],v[156:159],v[204:207]
v_mul_f32 v27,v27,v59
v_cvt_pk_bf16_f32 v42,v24,v25
v_mfma_f32_16x16x32_bf16 v[112:115],v[144:147],v[188:191],v[112:115]
v_cvt_pk_bf16_f32 v43,v26,v27
v_add_f32 v28,1.0,v28
v_add_f32 v29,1.0,v29
v_mfma_f32_16x16x32_bf16 v[116:119],v[148:151],v[188:191],v[116:119]
buffer_store_dwordx4 v[40:43],v212,s[24:27],s87 offen sc1
s_waitcnt lgkmcnt(0)
v_mfma_f32_16x16x32_bf16 v[0:3],v[160:163],a[0:3],0
ds_read_b64_tr_b16 v[176:177],v215 offset:8192
v_add_f32 v30,1.0,v30
v_mfma_f32_16x16x32_bf16 v[4:7],v[160:163],a[4:7],0
ds_read_b64_tr_b16 v[178:179],v215 offset:12288
v_add_f32 v31,1.0,v31
v_mfma_f32_16x16x32_bf16 v[8:11],v[160:163],a[8:11],0
ds_read_b64_tr_b16 v[180:181],v216 offset:8192
s_lshl_b32 s100,s45,3
v_mfma_f32_16x16x32_bf16 v[12:15],v[160:163],a[12:15],0
ds_read_b64_tr_b16 v[182:183],v216 offset:12288
v_rcp_f32 v28,v28
v_mfma_f32_16x16x32_bf16 v[16:19],v[164:167],a[0:3],0
ds_read_b64_tr_b16 v[184:185],v215 offset:9216
v_mul_f32 v28,v28,v60
v_mfma_f32_16x16x32_bf16 v[20:23],v[164:167],a[4:7],0
ds_read_b64_tr_b16 v[186:187],v215 offset:13312
v_rcp_f32 v29,v29
v_rcp_f32 v30,v30
v_rcp_f32 v31,v31
v_mfma_f32_16x16x32_bf16 v[24:27],v[164:167],a[8:11],0
ds_read_b64_tr_b16 v[188:189],v216 offset:9216
v_mul_f32 v29,v29,v61
v_mul_f32 v30,v30,v62
v_mul_f32 v31,v31,v63
v_cvt_pk_bf16_f32 v46,v28,v29
v_cvt_pk_bf16_f32 v47,v30,v31
v_mfma_f32_16x16x32_bf16 v[28:31],v[164:167],a[12:15],0
ds_read_b64_tr_b16 v[190:191],v216 offset:13312
s_lshl_b32 s89,s45,9
v_mfma_f32_16x16x32_bf16 v[32:35],v[168:171],a[0:3],0
ds_read_b128 v[228:231],v248 offset:0
s_add_u32 s89,s89,160256
v_mfma_f32_16x16x32_bf16 v[36:39],v[168:171],a[4:7],0
buffer_store_dwordx4 v[44:47],v212,s[24:27],s87 offen offset:1024 sc1
v_add_u32 v250,s89,v250
v_mfma_f32_16x16x32_bf16 v[40:43],v[168:171],a[8:11],0
v_lshlrev_b32 v244,3,v226
v_add_u32 v244,162304,v244
v_mfma_f32_16x16x32_bf16 v[44:47],v[168:171],a[12:15],0
v_cndmask_b32 v250,v244,v250,vcc
s_mul_i32 s88,s45,3072
v_mfma_f32_16x16x32_bf16 v[48:51],v[172:175],a[0:3],0
s_add_u32 s88,s88,147456
v_add_u32 v236,s88,v212
v_mfma_f32_16x16x32_bf16 v[52:55],v[172:175],a[4:7],0
s_xor_b32 s91,s45,2
s_mul_i32 s91,s91,3072
v_mfma_f32_16x16x32_bf16 v[56:59],v[172:175],a[8:11],0
s_waitcnt lgkmcnt(0)
v_mul_f32 v112,v228,v112
v_mfma_f32_16x16x32_bf16 v[60:63],v[172:175],a[12:15],0
v_mul_f32 v113,v229,v113
v_mfma_f32_16x16x32_bf16 v[0:3],v[176:179],a[16:19],v[0:3]
s_waitcnt vmcnt(19)
s_barrier
v_mfma_f32_16x16x32_bf16 v[4:7],v[176:179],a[20:23],v[4:7]
ds_read_b64_tr_b16 v[160:161],v215 offset:18432
v_mul_f32 v114,v230,v114
v_mfma_f32_16x16x32_bf16 v[8:11],v[176:179],a[24:27],v[8:11]
ds_read_b64_tr_b16 v[162:163],v215 offset:22528
v_mul_f32 v115,v231,v115
v_mfma_f32_16x16x32_bf16 v[12:15],v[176:179],a[28:31],v[12:15]
ds_read_b64_tr_b16 v[164:165],v216 offset:18432
v_mul_f32 v240,0x3fb8aa3b,v112
v_mfma_f32_16x16x32_bf16 v[16:19],v[180:183],a[16:19],v[16:19]
buffer_load_dwordx4 v214,s[12:15],s54 offen offset:1024 lds
s_add_u32 m0,s84,92160
v_mfma_f32_16x16x32_bf16 v[20:23],v[180:183],a[20:23],v[20:23]
ds_read_b64_tr_b16 v[166:167],v216 offset:22528
v_mul_f32 v241,0x3fb8aa3b,v113
v_mfma_f32_16x16x32_bf16 v[24:27],v[180:183],a[24:27],v[24:27]
ds_read_b64_tr_b16 v[168:169],v215 offset:19456
v_mul_f32 v242,0x3fb8aa3b,v114
v_mfma_f32_16x16x32_bf16 v[28:31],v[180:183],a[28:31],v[28:31]
ds_read_b64_tr_b16 v[170:171],v215 offset:23552
v_mul_f32 v243,0x3fb8aa3b,v115
v_mfma_f32_16x16x32_bf16 v[32:35],v[184:187],a[16:19],v[32:35]
buffer_load_dwordx4 v213,s[8:11],s55 offen lds
ds_read_b64_tr_b16 v[172:173],v216 offset:19456
v_mfma_f32_16x16x32_bf16 v[36:39],v[184:187],a[20:23],v[36:39]
ds_read_b64_tr_b16 v[174:175],v216 offset:23552
v_cvt_pk_bf16_f32 v96,v112,v113
v_mfma_f32_16x16x32_bf16 v[40:43],v[184:187],a[24:27],v[40:43]
v_exp_f32 v240,v240 clamp
v_mfma_f32_16x16x32_bf16 v[44:47],v[184:187],a[28:31],v[44:47]
v_exp_f32 v241,v241 clamp
v_mfma_f32_16x16x32_bf16 v[48:51],v[188:191],a[16:19],v[48:51]
v_exp_f32 v242,v242 clamp
v_mfma_f32_16x16x32_bf16 v[52:55],v[188:191],a[20:23],v[52:55]
buffer_load_dwordx4 v213,s[12:15],s55 offen offset:1024 lds
s_add_u32 m0,s84,100352
v_mfma_f32_16x16x32_bf16 v[56:59],v[188:191],a[24:27],v[56:59]
v_exp_f32 v243,v243 clamp
v_mfma_f32_16x16x32_bf16 v[60:63],v[188:191],a[28:31],v[60:63]
s_waitcnt lgkmcnt(0)
ds_read_b64_tr_b16 v[176:177],v215 offset:26624
v_mfma_f32_16x16x32_bf16 v[0:3],v[160:163],a[32:35],v[0:3]
ds_read_b64_tr_b16 v[178:179],v215 offset:30720
v_cvt_pk_bf16_f32 v97,v114,v115
v_mfma_f32_16x16x32_bf16 v[4:7],v[160:163],a[36:39],v[4:7]
buffer_load_dwordx4 v214,s[8:11],s55 offen lds
ds_read_b64_tr_b16 v[180:181],v216 offset:26624
v_mfma_f32_16x16x32_bf16 v[8:11],v[160:163],a[40:43],v[8:11]
ds_read_b64_tr_b16 v[182:183],v216 offset:30720
v_max_f32 v112,0,v112
v_mfma_f32_16x16x32_bf16 v[12:15],v[160:163],a[44:47],v[12:15]
ds_read_b64_tr_b16 v[184:185],v215 offset:27648
v_add_f32 v112,0x358637bd,v112
v_mfma_f32_16x16x32_bf16 v[16:19],v[164:167],a[32:35],v[16:19]
ds_read_b64_tr_b16 v[186:187],v215 offset:31744
v_subrev_u32 v215,92160,v215
v_mfma_f32_16x16x32_bf16 v[20:23],v[164:167],a[36:39],v[20:23]
buffer_load_dwordx4 v214,s[12:15],s55 offen offset:1024 lds
s_add_u32 m0,s84,110592
v_mfma_f32_16x16x32_bf16 v[24:27],v[164:167],a[40:43],v[24:27]
ds_read_b64_tr_b16 v[188:189],v216 offset:27648
v_add_f32 v112,v112,v240
v_mfma_f32_16x16x32_bf16 v[28:31],v[164:167],a[44:47],v[28:31]
ds_read_b64_tr_b16 v[190:191],v216 offset:31744
v_subrev_u32 v216,92160,v216
v_mfma_f32_16x16x32_bf16 v[32:35],v[168:171],a[32:35],v[32:35]
v_max_f32 v113,0,v113
v_add_f32 v113,0x358637bd,v113
v_mfma_f32_16x16x32_bf16 v[36:39],v[168:171],a[36:39],v[36:39]
v_add_f32 v113,v113,v241
v_max_f32 v114,0,v114
v_mfma_f32_16x16x32_bf16 v[40:43],v[168:171],a[40:43],v[40:43]
buffer_load_dwordx4 v213,s[8:11],s56 offen lds
v_add_f32 v114,0x358637bd,v114
v_mfma_f32_16x16x32_bf16 v[44:47],v[168:171],a[44:47],v[44:47]
v_add_f32 v114,v114,v242
v_max_f32 v115,0,v115
v_mfma_f32_16x16x32_bf16 v[48:51],v[172:175],a[32:35],v[48:51]
v_add_f32 v115,0x358637bd,v115
v_add_f32 v115,v115,v243
v_mfma_f32_16x16x32_bf16 v[52:55],v[172:175],a[36:39],v[52:55]
v_mul_f32 v116,v232,v116
v_mul_f32 v117,v233,v117
v_mfma_f32_16x16x32_bf16 v[56:59],v[172:175],a[40:43],v[56:59]
buffer_load_dwordx4 v213,s[12:15],s56 offen offset:1024 lds
s_add_u32 m0,s84,118784
v_mfma_f32_16x16x32_bf16 v[60:63],v[172:175],a[44:47],v[60:63]
s_waitcnt lgkmcnt(0)
ds_read_b64_tr_b16 v[160:161],v215 offset:0
v_mfma_f32_16x16x32_bf16 v[0:3],v[176:179],a[48:51],v[0:3]
ds_read_b64_tr_b16 v[162:163],v215 offset:4096
v_mul_f32 v118,v234,v118
v_mfma_f32_16x16x32_bf16 v[4:7],v[176:179],a[52:55],v[4:7]
ds_read_b64_tr_b16 v[164:165],v216 offset:0
v_mul_f32 v119,v235,v119
v_mfma_f32_16x16x32_bf16 v[8:11],v[176:179],a[56:59],v[8:11]
s_getpc_b64 s[0:1]
L_cp2_5:
v_min_u32 v254,L_stop_5-L_cp2_5,v253
global_load_dword v255,v254,s[0:1]
v_mfma_f32_16x16x32_bf16 v[12:15],v[176:179],a[60:63],v[12:15]
ds_read_b64_tr_b16 v[166:167],v216 offset:4096
v_mul_f32 v240,0x3fb8aa3b,v116
v_mfma_f32_16x16x32_bf16 v[16:19],v[180:183],a[48:51],v[16:19]
ds_read_b64_tr_b16 v[168:169],v215 offset:1024
v_mul_f32 v241,0x3fb8aa3b,v117
v_mfma_f32_16x16x32_bf16 v[20:23],v[180:183],a[52:55],v[20:23]
buffer_load_dwordx4 v214,s[8:11],s56 offen lds
ds_read_b64_tr_b16 v[170:171],v215 offset:5120
v_mfma_f32_16x16x32_bf16 v[24:27],v[180:183],a[56:59],v[24:27]
ds_read_b64_tr_b16 v[172:173],v216 offset:1024
v_mul_f32 v242,0x3fb8aa3b,v118
v_mfma_f32_16x16x32_bf16 v[28:31],v[180:183],a[60:63],v[28:31]
ds_read_b64_tr_b16 v[174:175],v216 offset:5120
v_mul_f32 v243,0x3fb8aa3b,v119
v_mfma_f32_16x16x32_bf16 v[32:35],v[184:187],a[48:51],v[32:35]
v_exp_f32 v240,v240 clamp
v_mfma_f32_16x16x32_bf16 v[36:39],v[184:187],a[52:55],v[36:39]
buffer_load_dwordx4 v214,s[12:15],s56 offen offset:1024 lds
v_cvt_pk_bf16_f32 v112,v112,v113
v_mfma_f32_16x16x32_bf16 v[40:43],v[184:187],a[56:59],v[40:43]
v_exp_f32 v241,v241 clamp
v_mfma_f32_16x16x32_bf16 v[44:47],v[184:187],a[60:63],v[44:47]
v_exp_f32 v242,v242 clamp
v_mfma_f32_16x16x32_bf16 v[48:51],v[188:191],a[48:51],v[48:51]
v_exp_f32 v243,v243 clamp
v_mfma_f32_16x16x32_bf16 v[52:55],v[188:191],a[52:55],v[52:55]
v_cvt_pk_bf16_f32 v113,v114,v115
v_cvt_pk_bf16_f32 v98,v116,v117
v_mfma_f32_16x16x32_bf16 v[56:59],v[188:191],a[56:59],v[56:59]
v_cvt_pk_bf16_f32 v99,v118,v119
v_max_f32 v116,0,v116
v_mfma_f32_16x16x32_bf16 v[60:63],v[188:191],a[60:63],v[60:63]
s_waitcnt lgkmcnt(0)
ds_read_b64_tr_b16 v[176:177],v215 offset:8192
v_mfma_f32_16x16x32_bf16 v[0:3],v[160:163],a[64:67],v[0:3]
ds_read_b64_tr_b16 v[178:179],v215 offset:12288
v_add_f32 v116,0x358637bd,v116
v_mfma_f32_16x16x32_bf16 v[4:7],v[160:163],a[68:71],v[4:7]
ds_read_b64_tr_b16 v[180:181],v216 offset:8192
v_add_f32 v116,v116,v240
v_mfma_f32_16x16x32_bf16 v[8:11],v[160:163],a[72:75],v[8:11]
ds_read_b64_tr_b16 v[182:183],v216 offset:12288
v_max_f32 v117,0,v117
v_mfma_f32_16x16x32_bf16 v[12:15],v[160:163],a[76:79],v[12:15]
ds_read_b64_tr_b16 v[184:185],v215 offset:9216
v_add_f32 v117,0x358637bd,v117
v_mfma_f32_16x16x32_bf16 v[16:19],v[164:167],a[64:67],v[16:19]
ds_read_b64_tr_b16 v[186:187],v215 offset:13312
v_add_f32 v117,v117,v241
v_mfma_f32_16x16x32_bf16 v[20:23],v[164:167],a[68:71],v[20:23]
ds_read_b64_tr_b16 v[188:189],v216 offset:9216
v_max_f32 v118,0,v118
v_mfma_f32_16x16x32_bf16 v[24:27],v[164:167],a[72:75],v[24:27]
ds_read_b64_tr_b16 v[190:191],v216 offset:13312
v_add_f32 v118,0x358637bd,v118
v_mfma_f32_16x16x32_bf16 v[28:31],v[164:167],a[76:79],v[28:31]
v_add_f32 v118,v118,v242
v_max_f32 v119,0,v119
v_mfma_f32_16x16x32_bf16 v[32:35],v[168:171],a[64:67],v[32:35]
s_add_u32 m0,s84,129024
v_add_f32 v119,0x358637bd,v119
v_mfma_f32_16x16x32_bf16 v[36:39],v[168:171],a[68:71],v[36:39]
s_add_u32 s8,s8,128
s_addc_u32 s9,s9,0
s_sub_u32 s10,s10,128
v_mfma_f32_16x16x32_bf16 v[40:43],v[168:171],a[72:75],v[40:43]
s_add_u32 s12,s12,128
s_addc_u32 s13,s13,0
s_sub_u32 s14,s14,128
v_mfma_f32_16x16x32_bf16 v[44:47],v[168:171],a[76:79],v[44:47]
v_add_f32 v119,v119,v243
v_cvt_pk_bf16_f32 v114,v116,v117
v_mfma_f32_16x16x32_bf16 v[48:51],v[172:175],a[64:67],v[48:51]
v_cvt_pk_bf16_f32 v115,v118,v119
ds_write_b128 v236,v[112:115] offset:0
v_mfma_f32_16x16x32_bf16 v[52:55],v[172:175],a[68:71],v[52:55]
ds_write_b128 v236,v[96:99] offset:1024
s_add_u32 s91,s91,147456
v_mfma_f32_16x16x32_bf16 v[56:59],v[172:175],a[72:75],v[56:59]
ds_write_b64 v250,v[112:113] offset:0
s_lshl_b32 s16,s41,1
v_mfma_f32_16x16x32_bf16 v[60:63],v[172:175],a[76:79],v[60:63]
s_waitcnt lgkmcnt(3)
ds_write_b64 v250,v[114:115] offset:128
v_mfma_f32_16x16x32_bf16 v[0:3],v[176:179],a[80:83],v[0:3]
s_waitcnt vmcnt(21)
s_barrier
v_mfma_f32_16x16x32_bf16 v[4:7],v[176:179],a[84:87],v[4:7]
buffer_load_dwordx4 v213,s[8:11],s48 offen lds
ds_read_b64_tr_b16 v[160:161],v215 offset:18432
v_mfma_f32_16x16x32_bf16 v[8:11],v[176:179],a[88:91],v[8:11]
buffer_load_dwordx4 v213,s[12:15],s48 offen offset:1024 lds
s_add_u32 m0,s84,137216
v_mfma_f32_16x16x32_bf16 v[12:15],v[176:179],a[92:95],v[12:15]
ds_read_b64_tr_b16 v[162:163],v215 offset:22528
s_add_u32 s16,s16,s47
v_mfma_f32_16x16x32_bf16 v[16:19],v[180:183],a[80:83],v[16:19]
ds_read_b64_tr_b16 v[164:165],v216 offset:18432
s_lshl_b32 s16,s16,4
v_mfma_f32_16x16x32_bf16 v[20:23],v[180:183],a[84:87],v[20:23]
ds_read_b64_tr_b16 v[166:167],v216 offset:22528
s_add_u32 s16,s16,s40
v_mfma_f32_16x16x32_bf16 v[24:27],v[180:183],a[88:91],v[24:27]
ds_read_b64_tr_b16 v[168:169],v215 offset:19456
s_lshl_b32 s16,s16,10
v_mfma_f32_16x16x32_bf16 v[28:31],v[180:183],a[92:95],v[28:31]
buffer_load_dwordx4 v214,s[8:11],s48 offen lds
ds_read_b64_tr_b16 v[170:171],v215 offset:23552
v_mfma_f32_16x16x32_bf16 v[32:35],v[184:187],a[80:83],v[32:35]
ds_read_b64_tr_b16 v[172:173],v216 offset:19456
s_add_u32 s16,s16,131072
v_mfma_f32_16x16x32_bf16 v[36:39],v[184:187],a[84:87],v[36:39]
ds_read_b64_tr_b16 v[174:175],v216 offset:23552
s_lshl_b32 s17,s46,31
v_mfma_f32_16x16x32_bf16 v[40:43],v[184:187],a[88:91],v[40:43]
s_xor_b32 s89,s45,1
s_mul_i32 s89,s89,3072
v_mfma_f32_16x16x32_bf16 v[44:47],v[184:187],a[92:95],v[44:47]
buffer_load_dwordx4 v214,s[12:15],s48 offen offset:1024 lds
s_add_u32 m0,s84,18432
v_mfma_f32_16x16x32_bf16 v[48:51],v[188:191],a[80:83],v[48:51]
s_add_u32 s89,s89,147456
v_add_u32 v237,s89,v212
v_mfma_f32_16x16x32_bf16 v[52:55],v[188:191],a[84:87],v[52:55]
v_lshrrev_b32 v227,3,v226
v_add_u32 v227,s100,v227
v_mfma_f32_16x16x32_bf16 v[56:59],v[188:191],a[88:91],v[56:59]
v_mul_u32_u24 v227,1152,v227
v_bfe_u32 v247,v226,4,2
v_mfma_f32_16x16x32_bf16 v[60:63],v[188:191],a[92:95],v[60:63]
buffer_load_dwordx4 v213,s[8:11],s49 offen lds
s_waitcnt lgkmcnt(0)
v_mfma_f32_16x16x32_bf16 v[0:3],v[160:163],a[96:99],v[0:3]
ds_read_b64_tr_b16 v[176:177],v215 offset:26624
v_lshlrev_b32 v247,1,v247
v_mfma_f32_16x16x32_bf16 v[4:7],v[160:163],a[100:103],v[4:7]
ds_read_b64_tr_b16 v[178:179],v215 offset:30720
v_and_b32 v219,7,v226
v_mfma_f32_16x16x32_bf16 v[8:11],v[160:163],a[104:107],v[8:11]
ds_read_b64_tr_b16 v[180:181],v216 offset:26624
v_xor_b32 v247,v247,v219
v_mfma_f32_16x16x32_bf16 v[12:15],v[160:163],a[108:111],v[12:15]
ds_read_b64_tr_b16 v[182:183],v216 offset:30720
v_lshl_add_u32 v227,v247,4,v227
v_mfma_f32_16x16x32_bf16 v[16:19],v[164:167],a[96:99],v[16:19]
buffer_load_dwordx4 v213,s[12:15],s49 offen offset:1024 lds
s_add_u32 m0,s84,26624
v_mfma_f32_16x16x32_bf16 v[20:23],v[164:167],a[100:103],v[20:23]
ds_read_b64_tr_b16 v[184:185],v215 offset:27648
v_add_u32 v219,1024,v227
v_mfma_f32_16x16x32_bf16 v[24:27],v[164:167],a[104:107],v[24:27]
ds_read_b64_tr_b16 v[186:187],v215 offset:31744
v_add_u32 v220,128,v227
v_mfma_f32_16x16x32_bf16 v[28:31],v[164:167],a[108:111],v[28:31]
ds_read_b64_tr_b16 v[188:189],v216 offset:27648
v_add_u32 v221,37888,v227
v_mfma_f32_16x16x32_bf16 v[32:35],v[168:171],a[96:99],v[32:35]
buffer_load_dwordx4 v214,s[8:11],s49 offen lds
ds_read_b64_tr_b16 v[190:191],v216 offset:31744
v_mfma_f32_16x16x32_bf16 v[36:39],v[168:171],a[100:103],v[36:39]
v_add_u32 v222,36992,v227
s_add_u32 s86,s86,s85
v_mfma_f32_16x16x32_bf16 v[40:43],v[168:171],a[104:107],v[40:43]
s_mov_b32 s19,0x358637bd
v_xor_b32 v249,128,v248
v_mfma_f32_16x16x32_bf16 v[44:47],v[168:171],a[108:111],v[44:47]
v_fma_f32 v64,v228,v64,s19
v_mul_f32 v80,v228,v80
v_mfma_f32_16x16x32_bf16 v[48:51],v[172:175],a[96:99],v[48:51]
buffer_load_dwordx4 v214,s[12:15],s49 offen offset:1024 lds
v_fma_f32 v65,v229,v65,s19
v_mfma_f32_16x16x32_bf16 v[52:55],v[172:175],a[100:103],v[52:55]
v_mul_f32 v81,v229,v81
v_fma_f32 v66,v230,v66,s19
v_mfma_f32_16x16x32_bf16 v[56:59],v[172:175],a[104:107],v[56:59]
v_mul_f32 v82,v230,v82
v_fma_f32 v67,v231,v67,s19
v_mfma_f32_16x16x32_bf16 v[60:63],v[172:175],a[108:111],v[60:63]
s_waitcnt lgkmcnt(0)
ds_read_b64_tr_b16 v[160:161],v215 offset:36864
v_mfma_f32_16x16x32_bf16 v[0:3],v[176:179],a[112:115],v[0:3]
ds_read_b64_tr_b16 v[162:163],v215 offset:40960
v_mul_f32 v83,v231,v83
v_mfma_f32_16x16x32_bf16 v[4:7],v[176:179],a[116:119],v[4:7]
ds_read_b64_tr_b16 v[164:165],v216 offset:36864
v_fma_f32 v68,v232,v68,s19
v_mfma_f32_16x16x32_bf16 v[8:11],v[176:179],a[120:123],v[8:11]
ds_read_b64_tr_b16 v[166:167],v216 offset:40960
v_mul_f32 v84,v232,v84
v_mfma_f32_16x16x32_bf16 v[12:15],v[176:179],a[124:127],v[12:15]
ds_read_b64_tr_b16 v[168:169],v215 offset:37888
v_fma_f32 v69,v233,v69,s19
v_mfma_f32_16x16x32_bf16 v[16:19],v[180:183],a[112:115],v[16:19]
ds_read_b64_tr_b16 v[170:171],v215 offset:41984
v_mul_f32 v85,v233,v85
v_mfma_f32_16x16x32_bf16 v[20:23],v[180:183],a[116:119],v[20:23]
ds_read_b64_tr_b16 v[172:173],v216 offset:37888
v_fma_f32 v70,v234,v70,s19
v_mfma_f32_16x16x32_bf16 v[24:27],v[180:183],a[120:123],v[24:27]
ds_read_b64_tr_b16 v[174:175],v216 offset:41984
v_mul_f32 v86,v234,v86
v_mfma_f32_16x16x32_bf16 v[28:31],v[180:183],a[124:127],v[28:31]
ds_read_b128 v[228:231],v249 offset:0
v_fma_f32 v71,v235,v71,s19
v_mfma_f32_16x16x32_bf16 v[32:35],v[184:187],a[112:115],v[32:35]
v_mul_f32 v87,v235,v87
ds_read_b128 v[232:235],v249 offset:64
v_mfma_f32_16x16x32_bf16 v[36:39],v[184:187],a[116:119],v[36:39]
v_mul_f32 v240,0x3fb8aa3b,v64
v_mul_f32 v241,0x3fb8aa3b,v65
v_mfma_f32_16x16x32_bf16 v[40:43],v[184:187],a[120:123],v[40:43]
v_exp_f32 v240,v240 clamp
v_mfma_f32_16x16x32_bf16 v[44:47],v[184:187],a[124:127],v[44:47]
v_exp_f32 v241,v241 clamp
v_mfma_f32_16x16x32_bf16 v[48:51],v[188:191],a[112:115],v[48:51]
v_mul_f32 v242,0x3fb8aa3b,v66
v_mul_f32 v243,0x3fb8aa3b,v67
v_mfma_f32_16x16x32_bf16 v[52:55],v[188:191],a[116:119],v[52:55]
v_exp_f32 v242,v242 clamp
v_mfma_f32_16x16x32_bf16 v[56:59],v[188:191],a[120:123],v[56:59]
v_exp_f32 v243,v243 clamp
v_mfma_f32_16x16x32_bf16 v[60:63],v[188:191],a[124:127],v[60:63]
s_waitcnt lgkmcnt(2)
ds_read_b64_tr_b16 v[176:177],v215 offset:45056
v_mfma_f32_16x16x32_bf16 v[0:3],v[160:163],a[128:131],v[0:3]
ds_read_b64_tr_b16 v[178:179],v215 offset:49152
v_max_f32 v64,s19,v64
v_mfma_f32_16x16x32_bf16 v[4:7],v[160:163],a[132:135],v[4:7]
ds_read_b64_tr_b16 v[180:181],v216 offset:45056
v_add_f32 v64,v64,v240
v_mfma_f32_16x16x32_bf16 v[8:11],v[160:163],a[136:139],v[8:11]
ds_read_b64_tr_b16 v[182:183],v216 offset:49152
v_max_f32 v65,s19,v65
v_mfma_f32_16x16x32_bf16 v[12:15],v[160:163],a[140:143],v[12:15]
ds_read_b64_tr_b16 v[184:185],v215 offset:46080
v_add_f32 v65,v65,v241
v_mfma_f32_16x16x32_bf16 v[16:19],v[164:167],a[128:131],v[16:19]
ds_read_b64_tr_b16 v[186:187],v215 offset:50176
v_max_f32 v66,s19,v66
v_mfma_f32_16x16x32_bf16 v[20:23],v[164:167],a[132:135],v[20:23]
ds_read_b64_tr_b16 v[188:189],v216 offset:46080
v_add_f32 v66,v66,v242
v_mfma_f32_16x16x32_bf16 v[24:27],v[164:167],a[136:139],v[24:27]
ds_read_b64_tr_b16 v[190:191],v216 offset:50176
v_max_f32 v67,s19,v67
v_mfma_f32_16x16x32_bf16 v[28:31],v[164:167],a[140:143],v[28:31]
v_add_f32 v67,v67,v243
v_mul_f32 v240,0x3fb8aa3b,v68
v_mfma_f32_16x16x32_bf16 v[32:35],v[168:171],a[128:131],v[32:35]
s_add_u32 m0,s84,36864
v_mul_f32 v241,0x3fb8aa3b,v69
v_mfma_f32_16x16x32_bf16 v[36:39],v[168:171],a[132:135],v[36:39]
v_exp_f32 v240,v240 clamp
v_mfma_f32_16x16x32_bf16 v[40:43],v[168:171],a[136:139],v[40:43]
v_exp_f32 v241,v241 clamp
v_mfma_f32_16x16x32_bf16 v[44:47],v[168:171],a[140:143],v[44:47]
v_mul_f32 v242,0x3fb8aa3b,v70
v_mul_f32 v243,0x3fb8aa3b,v71
v_mfma_f32_16x16x32_bf16 v[48:51],v[172:175],a[128:131],v[48:51]
v_exp_f32 v242,v242 clamp
v_mfma_f32_16x16x32_bf16 v[52:55],v[172:175],a[132:135],v[52:55]
v_exp_f32 v243,v243 clamp
v_mfma_f32_16x16x32_bf16 v[56:59],v[172:175],a[136:139],v[56:59]
v_cvt_pk_bf16_f32 v64,v64,v65
v_cvt_pk_bf16_f32 v65,v66,v67
v_mfma_f32_16x16x32_bf16 v[60:63],v[172:175],a[140:143],v[60:63]
s_waitcnt lgkmcnt(0)
v_cvt_pk_bf16_f32 v80,v80,v81
v_mfma_f32_16x16x32_bf16 v[0:3],v[176:179],a[144:147],v[0:3]
s_waitcnt vmcnt(17)
s_barrier
v_mfma_f32_16x16x32_bf16 v[4:7],v[176:179],a[148:151],v[4:7]
buffer_load_dwordx4 v213,s[8:11],s50 offen lds
ds_read_b128 v[120:123],v237 offset:0
v_mfma_f32_16x16x32_bf16 v[8:11],v[176:179],a[152:155],v[8:11]
buffer_load_dwordx4 v213,s[12:15],s50 offen offset:1024 lds
s_add_u32 m0,s84,45056
v_mfma_f32_16x16x32_bf16 v[12:15],v[176:179],a[156:159],v[12:15]
ds_read_b128 v[100:103],v237 offset:1024
v_cvt_pk_bf16_f32 v81,v82,v83
v_mfma_f32_16x16x32_bf16 v[16:19],v[180:183],a[144:147],v[16:19]
ds_read_b64_tr_b16 v[160:161],v215 offset:55296
v_max_f32 v68,s19,v68
v_mfma_f32_16x16x32_bf16 v[20:23],v[180:183],a[148:151],v[20:23]
ds_read_b64_tr_b16 v[162:163],v215 offset:59392
v_add_f32 v68,v68,v240
v_mfma_f32_16x16x32_bf16 v[24:27],v[180:183],a[152:155],v[24:27]
ds_read_b64_tr_b16 v[164:165],v216 offset:55296
v_max_f32 v69,s19,v69
v_mfma_f32_16x16x32_bf16 v[28:31],v[180:183],a[156:159],v[28:31]
buffer_load_dwordx4 v214,s[8:11],s50 offen lds
ds_read_b64_tr_b16 v[166:167],v216 offset:59392
v_mfma_f32_16x16x32_bf16 v[32:35],v[184:187],a[144:147],v[32:35]
ds_read_b64_tr_b16 v[168:169],v215 offset:56320
v_add_f32 v69,v69,v241
v_mfma_f32_16x16x32_bf16 v[36:39],v[184:187],a[148:151],v[36:39]
ds_read_b64_tr_b16 v[170:171],v215 offset:60416
v_add_u32 v215,55296,v215
v_mfma_f32_16x16x32_bf16 v[40:43],v[184:187],a[152:155],v[40:43]
ds_read_b64_tr_b16 v[172:173],v216 offset:56320
v_max_f32 v70,s19,v70
v_mfma_f32_16x16x32_bf16 v[44:47],v[184:187],a[156:159],v[44:47]
buffer_load_dwordx4 v214,s[12:15],s50 offen offset:1024 lds
s_add_u32 m0,s84,55296
ds_read_b64_tr_b16 v[174:175],v216 offset:60416
v_mfma_f32_16x16x32_bf16 v[48:51],v[188:191],a[144:147],v[48:51]
v_add_u32 v216,55296,v216
v_add_f32 v70,v70,v242
v_mfma_f32_16x16x32_bf16 v[52:55],v[188:191],a[148:151],v[52:55]
v_max_f32 v71,s19,v71
v_add_f32 v71,v71,v243
v_mfma_f32_16x16x32_bf16 v[56:59],v[188:191],a[152:155],v[56:59]
v_cvt_pk_bf16_f32 v66,v68,v69
v_cvt_pk_bf16_f32 v67,v70,v71
v_mfma_f32_16x16x32_bf16 v[60:63],v[188:191],a[156:159],v[60:63]
buffer_load_dwordx4 v213,s[8:11],s51 offen lds
s_waitcnt lgkmcnt(0)
v_mfma_f32_16x16x32_bf16 v[0:3],v[160:163],a[160:163],v[0:3]
ds_read_b64_tr_b16 v[176:177],v215 offset:8192
v_cvt_pk_bf16_f32 v82,v84,v85
v_mfma_f32_16x16x32_bf16 v[4:7],v[160:163],a[164:167],v[4:7]
ds_read_b64_tr_b16 v[178:179],v215 offset:12288
v_cvt_pk_bf16_f32 v83,v86,v87
v_mfma_f32_16x16x32_bf16 v[8:11],v[160:163],a[168:171],v[8:11]
ds_read_b64_tr_b16 v[180:181],v216 offset:8192
v_mov_b32 v238,0x3f803f80
v_mfma_f32_16x16x32_bf16 v[12:15],v[160:163],a[172:175],v[12:15]
ds_read_b64_tr_b16 v[182:183],v216 offset:12288
v_mfma_f32_16x16x32_bf16 v[16:19],v[164:167],a[160:163],v[16:19]
buffer_load_dwordx4 v213,s[12:15],s51 offen offset:1024 lds
s_add_u32 m0,s84,63488
v_mfma_f32_16x16x32_bf16 v[20:23],v[164:167],a[164:167],v[20:23]
ds_read_b64_tr_b16 v[184:185],v215 offset:9216
v_fma_f32 v72,v228,v72,s19
v_mfma_f32_16x16x32_bf16 v[24:27],v[164:167],a[168:171],v[24:27]
ds_read_b64_tr_b16 v[186:187],v215 offset:13312
v_subrev_u32 v215,73728,v215
v_mfma_f32_16x16x32_bf16 v[28:31],v[164:167],a[172:175],v[28:31]
ds_read_b64_tr_b16 v[188:189],v216 offset:9216
v_mul_f32 v88,v228,v88
v_mfma_f32_16x16x32_bf16 v[32:35],v[168:171],a[160:163],v[32:35]
buffer_load_dwordx4 v214,s[8:11],s51 offen lds
ds_read_b64_tr_b16 v[190:191],v216 offset:13312
v_mfma_f32_16x16x32_bf16 v[36:39],v[168:171],a[164:167],v[36:39]
v_subrev_u32 v216,73728,v216
v_fma_f32 v73,v229,v73,s19
v_mfma_f32_16x16x32_bf16 v[40:43],v[168:171],a[168:171],v[40:43]
v_mul_f32 v89,v229,v89
v_fma_f32 v74,v230,v74,s19
v_mfma_f32_16x16x32_bf16 v[44:47],v[168:171],a[172:175],v[44:47]
v_mul_f32 v90,v230,v90
v_fma_f32 v75,v231,v75,s19
v_mfma_f32_16x16x32_bf16 v[48:51],v[172:175],a[160:163],v[48:51]
buffer_load_dwordx4 v214,s[12:15],s51 offen offset:1024 lds
v_mul_f32 v91,v231,v91
v_mfma_f32_16x16x32_bf16 v[52:55],v[172:175],a[164:167],v[52:55]
v_cndmask_b32 v96,v96,v238,s[94:95]
v_mfma_f32_16x16x32_bf16 v[56:59],v[172:175],a[168:171],v[56:59]
v_cndmask_b32 v97,v97,v238,s[94:95]
v_cndmask_b32 v98,v98,v238,s[94:95]
v_mfma_f32_16x16x32_bf16 v[60:63],v[172:175],a[172:175],v[60:63]
s_waitcnt lgkmcnt(0)
ds_read_b64_tr_b16 v[160:161],v215 offset:0
v_mfma_f32_16x16x32_bf16 v[0:3],v[176:179],a[176:179],v[0:3]
ds_read_b64_tr_b16 v[162:163],v215 offset:4096
v_cndmask_b32 v99,v99,v238,s[94:95]
v_mfma_f32_16x16x32_bf16 v[4:7],v[176:179],a[180:183],v[4:7]
ds_read_b64_tr_b16 v[164:165],v216 offset:0
v_mul_f32 v240,0x3fb8aa3b,v72
v_mfma_f32_16x16x32_bf16 v[8:11],v[176:179],a[184:187],v[8:11]
ds_read_b64_tr_b16 v[166:167],v216 offset:4096
v_mul_f32 v241,0x3fb8aa3b,v73
v_mfma_f32_16x16x32_bf16 v[12:15],v[176:179],a[188:191],v[12:15]
ds_read_b64_tr_b16 v[168:169],v215 offset:1024
v_mul_f32 v242,0x3fb8aa3b,v74
v_mfma_f32_16x16x32_bf16 v[16:19],v[180:183],a[176:179],v[16:19]
ds_read_b64_tr_b16 v[170:171],v215 offset:5120
v_mul_f32 v243,0x3fb8aa3b,v75
v_mfma_f32_16x16x32_bf16 v[20:23],v[180:183],a[180:183],v[20:23]
ds_read_b64_tr_b16 v[172:173],v216 offset:1024
v_mfma_f32_16x16x32_bf16 v[24:27],v[180:183],a[184:187],v[24:27]
ds_read_b64_tr_b16 v[174:175],v216 offset:5120
v_fma_f32 v76,v232,v76,s19
v_mfma_f32_16x16x32_bf16 v[28:31],v[180:183],a[188:191],v[28:31]
v_exp_f32 v240,v240 clamp
v_mfma_f32_16x16x32_bf16 v[32:35],v[184:187],a[176:179],v[32:35]
v_exp_f32 v241,v241 clamp
v_mfma_f32_16x16x32_bf16 v[36:39],v[184:187],a[180:183],v[36:39]
v_exp_f32 v242,v242 clamp
v_mfma_f32_16x16x32_bf16 v[40:43],v[184:187],a[184:187],v[40:43]
v_exp_f32 v243,v243 clamp
v_mfma_f32_16x16x32_bf16 v[44:47],v[184:187],a[188:191],v[44:47]
v_mul_f32 v92,v232,v92
v_fma_f32 v77,v233,v77,s19
v_mfma_f32_16x16x32_bf16 v[48:51],v[188:191],a[176:179],v[48:51]
v_mul_f32 v93,v233,v93
v_fma_f32 v78,v234,v78,s19
v_mfma_f32_16x16x32_bf16 v[52:55],v[188:191],a[180:183],v[52:55]
v_mul_f32 v94,v234,v94
v_fma_f32 v79,v235,v79,s19
v_mfma_f32_16x16x32_bf16 v[56:59],v[188:191],a[184:187],v[56:59]
v_mul_f32 v95,v235,v95
v_max_f32 v72,s19,v72
v_mfma_f32_16x16x32_bf16 v[60:63],v[188:191],a[188:191],v[60:63]
s_waitcnt lgkmcnt(0)
ds_read_b64_tr_b16 v[176:177],v215 offset:8192
v_mfma_f32_16x16x32_bf16 v[0:3],v[160:163],a[192:195],v[0:3]
ds_read_b64_tr_b16 v[178:179],v215 offset:12288
v_add_f32 v72,v72,v240
v_mfma_f32_16x16x32_bf16 v[4:7],v[160:163],a[196:199],v[4:7]
ds_read_b64_tr_b16 v[180:181],v216 offset:8192
v_max_f32 v73,s19,v73
v_mfma_f32_16x16x32_bf16 v[8:11],v[160:163],a[200:203],v[8:11]
ds_read_b64_tr_b16 v[182:183],v216 offset:12288
v_add_f32 v73,v73,v241
v_mfma_f32_16x16x32_bf16 v[12:15],v[160:163],a[204:207],v[12:15]
ds_read_b64_tr_b16 v[184:185],v215 offset:9216
v_max_f32 v74,s19,v74
v_mfma_f32_16x16x32_bf16 v[16:19],v[164:167],a[192:195],v[16:19]
ds_read_b64_tr_b16 v[186:187],v215 offset:13312
v_add_u32 v215,92160,v215
v_mfma_f32_16x16x32_bf16 v[20:23],v[164:167],a[196:199],v[20:23]
ds_read_b64_tr_b16 v[188:189],v216 offset:9216
v_add_f32 v74,v74,v242
v_mfma_f32_16x16x32_bf16 v[24:27],v[164:167],a[200:203],v[24:27]
ds_read_b64_tr_b16 v[190:191],v216 offset:13312
v_add_u32 v216,92160,v216
v_mfma_f32_16x16x32_bf16 v[28:31],v[164:167],a[204:207],v[28:31]
v_max_f32 v75,s19,v75
v_add_f32 v75,v75,v243
v_mfma_f32_16x16x32_bf16 v[32:35],v[168:171],a[192:195],v[32:35]
s_add_u32 m0,s84,73728
v_mul_f32 v240,0x3fb8aa3b,v76
v_mfma_f32_16x16x32_bf16 v[36:39],v[168:171],a[196:199],v[36:39]
v_exp_f32 v240,v240 clamp
v_mfma_f32_16x16x32_bf16 v[40:43],v[168:171],a[200:203],v[40:43]
v_mul_f32 v241,0x3fb8aa3b,v77
v_mul_f32 v242,0x3fb8aa3b,v78
v_mfma_f32_16x16x32_bf16 v[44:47],v[168:171],a[204:207],v[44:47]
v_exp_f32 v241,v241 clamp
v_mfma_f32_16x16x32_bf16 v[48:51],v[172:175],a[192:195],v[48:51]
v_exp_f32 v242,v242 clamp
v_mfma_f32_16x16x32_bf16 v[52:55],v[172:175],a[196:199],v[52:55]
v_mul_f32 v243,0x3fb8aa3b,v79
v_cndmask_b32 v100,v100,v238,s[94:95]
v_mfma_f32_16x16x32_bf16 v[56:59],v[172:175],a[200:203],v[56:59]
v_exp_f32 v243,v243 clamp
v_mfma_f32_16x16x32_bf16 v[60:63],v[172:175],a[204:207],v[60:63]
s_waitcnt lgkmcnt(0)
v_cndmask_b32 v101,v101,v238,s[94:95]
v_mfma_f32_16x16x32_bf16 v[0:3],v[176:179],a[208:211],v[0:3]
s_waitcnt vmcnt(16)
s_barrier
v_mfma_f32_16x16x32_bf16 v[4:7],v[176:179],a[212:215],v[4:7]
buffer_load_dwordx4 v213,s[8:11],s52 offen lds
ds_read_b64_tr_b16 v[160:161],v215 offset:0
v_mfma_f32_16x16x32_bf16 v[8:11],v[176:179],a[216:219],v[8:11]
buffer_load_dwordx4 v213,s[12:15],s52 offen offset:1024 lds
s_add_u32 m0,s84,81920
v_mfma_f32_16x16x32_bf16 v[12:15],v[176:179],a[220:223],v[12:15]
ds_read_b64_tr_b16 v[162:163],v215 offset:4096
v_cndmask_b32 v102,v102,v238,s[94:95]
v_mfma_f32_16x16x32_bf16 v[16:19],v[180:183],a[208:211],v[16:19]
ds_read_b64_tr_b16 v[164:165],v216 offset:0
v_cndmask_b32 v103,v103,v238,s[94:95]
v_mfma_f32_16x16x32_bf16 v[20:23],v[180:183],a[212:215],v[20:23]
ds_read_b64_tr_b16 v[166:167],v216 offset:4096
s_add_u32 s87,s87,s85
v_mfma_f32_16x16x32_bf16 v[24:27],v[180:183],a[216:219],v[24:27]
ds_read_b64_tr_b16 v[168:169],v215 offset:1024
v_cvt_pk_bf16_f32 v72,v72,v73
v_mfma_f32_16x16x32_bf16 v[28:31],v[180:183],a[220:223],v[28:31]
buffer_load_dwordx4 v214,s[8:11],s52 offen lds
ds_read_b64_tr_b16 v[170:171],v215 offset:5120
v_mfma_f32_16x16x32_bf16 v[32:35],v[184:187],a[208:211],v[32:35]
ds_read_b64_tr_b16 v[172:173],v216 offset:1024
v_cvt_pk_bf16_f32 v73,v74,v75
v_mfma_f32_16x16x32_bf16 v[36:39],v[184:187],a[212:215],v[36:39]
ds_read_b64_tr_b16 v[174:175],v216 offset:5120
v_cvt_pk_bf16_f32 v88,v88,v89
v_mfma_f32_16x16x32_bf16 v[40:43],v[184:187],a[216:219],v[40:43]
v_cvt_pk_bf16_f32 v89,v90,v91
v_max_f32 v76,s19,v76
v_mfma_f32_16x16x32_bf16 v[44:47],v[184:187],a[220:223],v[44:47]
buffer_load_dwordx4 v214,s[12:15],s52 offen offset:1024 lds
s_add_u32 m0,s84,0
v_mfma_f32_16x16x32_bf16 v[48:51],v[188:191],a[208:211],v[48:51]
v_add_f32 v76,v76,v240
v_max_f32 v77,s19,v77
v_mfma_f32_16x16x32_bf16 v[52:55],v[188:191],a[212:215],v[52:55]
v_add_f32 v77,v77,v241
v_max_f32 v78,s19,v78
v_mfma_f32_16x16x32_bf16 v[56:59],v[188:191],a[216:219],v[56:59]
v_add_f32 v78,v78,v242
v_max_f32 v79,s19,v79
v_mfma_f32_16x16x32_bf16 v[60:63],v[188:191],a[220:223],v[60:63]
buffer_load_dwordx4 v213,s[8:11],s53 offen lds
s_waitcnt lgkmcnt(0)
v_mfma_f32_16x16x32_bf16 v[0:3],v[160:163],a[224:227],v[0:3]
ds_read_b64_tr_b16 v[176:177],v215 offset:8192
v_add_f32 v79,v79,v243
v_mfma_f32_16x16x32_bf16 v[4:7],v[160:163],a[228:231],v[4:7]
ds_read_b64_tr_b16 v[178:179],v215 offset:12288
v_cvt_pk_bf16_f32 v74,v76,v77
v_mfma_f32_16x16x32_bf16 v[8:11],v[160:163],a[232:235],v[8:11]
ds_read_b64_tr_b16 v[180:181],v216 offset:8192
v_cvt_pk_bf16_f32 v75,v78,v79
v_mfma_f32_16x16x32_bf16 v[12:15],v[160:163],a[236:239],v[12:15]
ds_read_b64_tr_b16 v[182:183],v216 offset:12288
v_cvt_pk_bf16_f32 v90,v92,v93
v_mfma_f32_16x16x32_bf16 v[16:19],v[164:167],a[224:227],v[16:19]
buffer_load_dwordx4 v213,s[12:15],s53 offen offset:1024 lds
s_add_u32 m0,s84,8192
v_mfma_f32_16x16x32_bf16 v[20:23],v[164:167],a[228:231],v[20:23]
ds_read_b64_tr_b16 v[184:185],v215 offset:9216
v_cvt_pk_bf16_f32 v91,v94,v95
v_mfma_f32_16x16x32_bf16 v[24:27],v[164:167],a[232:235],v[24:27]
ds_read_b64_tr_b16 v[186:187],v215 offset:13312
s_mul_i32 s89,s45,3072
v_mfma_f32_16x16x32_bf16 v[28:31],v[164:167],a[236:239],v[28:31]
ds_read_b64_tr_b16 v[188:189],v216 offset:9216
s_add_u32 s89,s89,147456
v_mfma_f32_16x16x32_bf16 v[32:35],v[168:171],a[224:227],v[32:35]
buffer_load_dwordx4 v214,s[8:11],s53 offen lds
ds_read_b64_tr_b16 v[190:191],v216 offset:13312
v_mfma_f32_16x16x32_bf16 v[36:39],v[168:171],a[228:231],v[36:39]
v_add_u32 v245,s89,v212
v_add_u32 v246,s91,v212
v_mfma_f32_16x16x32_bf16 v[40:43],v[168:171],a[232:235],v[40:43]
s_mul_i32 s64,s45,3072
s_add_u32 s64,s64,147456
v_mfma_f32_16x16x32_bf16 v[44:47],v[168:171],a[236:239],v[44:47]
v_mul_f32 v244,0xbf317218,v208
v_fma_f32 v192,v244,v192,s19
v_mfma_f32_16x16x32_bf16 v[48:51],v[172:175],a[224:227],v[48:51]
buffer_load_dwordx4 v214,s[12:15],s53 offen offset:1024 lds
v_mul_f32 v249,0x3fb8aa3b,v192
v_mfma_f32_16x16x32_bf16 v[52:55],v[172:175],a[228:231],v[52:55]
v_exp_f32 v249,v249 clamp
v_mfma_f32_16x16x32_bf16 v[56:59],v[172:175],a[232:235],v[56:59]
v_max_f32 v192,s19,v192
v_add_f32 v192,v192,v249
v_mfma_f32_16x16x32_bf16 v[60:63],v[172:175],a[236:239],v[60:63]
s_waitcnt lgkmcnt(0)
ds_read_b64_tr_b16 v[160:161],v215 offset:18432
v_mfma_f32_16x16x32_bf16 v[0:3],v[176:179],a[240:243],v[0:3]
ds_read_b64_tr_b16 v[162:163],v215 offset:22528
v_fma_f32 v194,v244,v194,s19
v_mfma_f32_16x16x32_bf16 v[4:7],v[176:179],a[244:247],v[4:7]
ds_read_b64_tr_b16 v[164:165],v216 offset:18432
v_mul_f32 v249,0x3fb8aa3b,v194
v_mfma_f32_16x16x32_bf16 v[8:11],v[176:179],a[248:251],v[8:11]
ds_read_b64_tr_b16 v[166:167],v216 offset:22528
v_fma_f32 v193,v244,v193,s19
v_mfma_f32_16x16x32_bf16 v[12:15],v[176:179],a[252:255],v[12:15]
ds_read_b64_tr_b16 v[168:169],v215 offset:19456
v_max_f32 v194,s19,v194
v_mfma_f32_16x16x32_bf16 v[16:19],v[180:183],a[240:243],v[16:19]
ds_read_b64_tr_b16 v[170:171],v215 offset:23552
v_fma_f32 v195,v244,v195,s19
v_mfma_f32_16x16x32_bf16 v[20:23],v[180:183],a[244:247],v[20:23]
ds_read_b64_tr_b16 v[172:173],v216 offset:19456
v_mul_f32 v244,0xbf317218,v209
v_mfma_f32_16x16x32_bf16 v[24:27],v[180:183],a[248:251],v[24:27]
ds_read_b64_tr_b16 v[174:175],v216 offset:23552
v_fma_f32 v196,v244,v196,s19
v_mfma_f32_16x16x32_bf16 v[28:31],v[180:183],a[252:255],v[28:31]
v_exp_f32 v249,v249 clamp
v_mfma_f32_16x16x32_bf16 v[32:35],v[184:187],a[240:243],v[32:35]
v_add_f32 v194,v194,v249
v_mul_f32 v249,0x3fb8aa3b,v196
v_mfma_f32_16x16x32_bf16 v[36:39],v[184:187],a[244:247],v[36:39]
v_exp_f32 v249,v249 clamp
v_mfma_f32_16x16x32_bf16 v[40:43],v[184:187],a[248:251],v[40:43]
v_max_f32 v196,s19,v196
v_add_f32 v196,v196,v249
v_mfma_f32_16x16x32_bf16 v[44:47],v[184:187],a[252:255],v[44:47]
v_fma_f32 v198,v244,v198,s19
v_mul_f32 v249,0x3fb8aa3b,v198
v_mfma_f32_16x16x32_bf16 v[48:51],v[188:191],a[240:243],v[48:51]
v_exp_f32 v249,v249 clamp
v_mfma_f32_16x16x32_bf16 v[52:55],v[188:191],a[244:247],v[52:55]
v_fma_f32 v197,v244,v197,s19
v_max_f32 v198,s19,v198
v_mfma_f32_16x16x32_bf16 v[56:59],v[188:191],a[248:251],v[56:59]
v_add_f32 v198,v198,v249
v_fma_f32 v199,v244,v199,s19
v_mfma_f32_16x16x32_bf16 v[60:63],v[188:191],a[252:255],v[60:63]
v_mul_f32 v244,0xbf317218,v210
v_fma_f32 v200,v244,v200,s19
v_mfma_f32_16x16x32_bf16 v[228:231],v[64:67],v[80:83],0
v_mul_f32 v249,0x3fb8aa3b,v200
v_mul_f32 v250,0x3fb8aa3b,v193
v_mfma_f32_16x16x32_bf16 v[232:235],v[64:67],v[96:99],0
v_exp_f32 v249,v249 clamp
v_mfma_f32_16x16x32_bf16 v[236:239],v[112:115],v[80:83],0
v_exp_f32 v250,v250 clamp
v_mfma_f32_16x16x32_bf16 v[240:243],v[112:115],v[96:99],0
v_max_f32 v200,s19,v200
v_add_f32 v200,v200,v249
v_mfma_f32_16x16x32_bf16 v[228:231],v[72:75],v[88:91],v[228:231]
v_fma_f32 v202,v244,v202,s19
v_mul_f32 v249,0x3fb8aa3b,v202
v_mfma_f32_16x16x32_bf16 v[232:235],v[72:75],v[100:103],v[232:235]
v_exp_f32 v249,v249 clamp
v_mfma_f32_16x16x32_bf16 v[236:239],v[120:123],v[88:91],v[236:239]
v_max_f32 v193,s19,v193
v_add_f32 v193,v193,v250
v_mfma_f32_16x16x32_bf16 v[240:243],v[120:123],v[100:103],v[240:243]
s_waitcnt lgkmcnt(0)
ds_read_b64_tr_b16 v[176:177],v215 offset:26624
v_mfma_f32_16x16x32_bf16 v[0:3],v[160:163],v[128:131],v[0:3]
ds_read_b64_tr_b16 v[178:179],v215 offset:30720
v_mul_f32 v250,0x3fb8aa3b,v195
v_mfma_f32_16x16x32_bf16 v[4:7],v[160:163],v[132:135],v[4:7]
ds_read_b64_tr_b16 v[180:181],v216 offset:26624
v_cndmask_b32 v236,v236,v238,s[92:93]
v_mfma_f32_16x16x32_bf16 v[8:11],v[160:163],v[136:139],v[8:11]
ds_read_b64_tr_b16 v[182:183],v216 offset:30720
v_cndmask_b32 v237,v237,v239,s[92:93]
v_mfma_f32_16x16x32_bf16 v[12:15],v[160:163],v[140:143],v[12:15]
ds_read_b64_tr_b16 v[184:185],v215 offset:27648
v_cndmask_b32 v238,v240,v242,s[92:93]
v_mfma_f32_16x16x32_bf16 v[16:19],v[164:167],v[128:131],v[16:19]
ds_read_b64_tr_b16 v[186:187],v215 offset:31744
v_cndmask_b32 v239,v241,v243,s[92:93]
v_mfma_f32_16x16x32_bf16 v[20:23],v[164:167],v[132:135],v[20:23]
ds_read_b64_tr_b16 v[188:189],v216 offset:27648
v_fma_f32 v201,v244,v201,s19
v_mfma_f32_16x16x32_bf16 v[24:27],v[164:167],v[136:139],v[24:27]
ds_read_b64_tr_b16 v[190:191],v216 offset:31744
v_max_f32 v202,s19,v202
v_mfma_f32_16x16x32_bf16 v[28:31],v[164:167],v[140:143],v[28:31]
ds_write_b128 v245,v[228:231] offset:0
v_add_f32 v202,v202,v249
v_mfma_f32_16x16x32_bf16 v[32:35],v[168:171],v[128:131],v[32:35]
s_add_u32 m0,s84,92160
ds_write_b128 v245,v[232:235] offset:1024
v_mfma_f32_16x16x32_bf16 v[36:39],v[168:171],v[132:135],v[36:39]
ds_write_b128 v245,v[236:239] offset:2048
v_or_b32 v245,s17,v212
v_mfma_f32_16x16x32_bf16 v[40:43],v[168:171],v[136:139],v[40:43]
v_exp_f32 v250,v250 clamp
v_mfma_f32_16x16x32_bf16 v[44:47],v[168:171],v[140:143],v[44:47]
v_fma_f32 v203,v244,v203,s19
v_mul_f32 v244,0xbf317218,v211
v_mfma_f32_16x16x32_bf16 v[48:51],v[172:175],v[128:131],v[48:51]
v_fma_f32 v204,v244,v204,s19
v_mul_f32 v249,0x3fb8aa3b,v204
v_mfma_f32_16x16x32_bf16 v[52:55],v[172:175],v[132:135],v[52:55]
v_exp_f32 v249,v249 clamp
v_mfma_f32_16x16x32_bf16 v[56:59],v[172:175],v[136:139],v[56:59]
v_max_f32 v195,s19,v195
v_add_f32 v195,v195,v250
v_mfma_f32_16x16x32_bf16 v[60:63],v[172:175],v[140:143],v[60:63]
s_waitcnt lgkmcnt(3)
v_mul_f32 v250,0x3fb8aa3b,v197
v_mfma_f32_16x16x32_bf16 v[0:3],v[176:179],v[144:147],v[0:3]
s_waitcnt vmcnt(16) lgkmcnt(0)
s_barrier
v_mfma_f32_16x16x32_bf16 v[4:7],v[176:179],v[148:151],v[4:7]
buffer_load_dwordx4 v213,s[8:11],s54 offen lds
ds_read_b64_tr_b16 v[160:161],v215 offset:36864
v_mfma_f32_16x16x32_bf16 v[8:11],v[176:179],v[152:155],v[8:11]
buffer_load_dwordx4 v213,s[12:15],s54 offen offset:1024 lds
s_add_u32 m0,s84,100352
v_mfma_f32_16x16x32_bf16 v[12:15],v[176:179],v[156:159],v[12:15]
ds_read_b64_tr_b16 v[162:163],v215 offset:40960
v_mul_f32 v0,v208,v0
v_mfma_f32_16x16x32_bf16 v[16:19],v[180:183],v[144:147],v[16:19]
ds_read_b64_tr_b16 v[164:165],v216 offset:36864
v_mul_f32 v1,v208,v1
v_mfma_f32_16x16x32_bf16 v[20:23],v[180:183],v[148:151],v[20:23]
ds_read_b64_tr_b16 v[166:167],v216 offset:40960
v_mul_f32 v2,v208,v2
v_mfma_f32_16x16x32_bf16 v[24:27],v[180:183],v[152:155],v[24:27]
ds_read_b64_tr_b16 v[168:169],v215 offset:37888
v_mul_f32 v3,v208,v3
v_mfma_f32_16x16x32_bf16 v[28:31],v[180:183],v[156:159],v[28:31]
buffer_load_dwordx4 v214,s[8:11],s54 offen lds
ds_read_b64_tr_b16 v[170:171],v215 offset:41984
v_mfma_f32_16x16x32_bf16 v[32:35],v[184:187],v[144:147],v[32:35]
ds_read_b64_tr_b16 v[172:173],v216 offset:37888
v_mul_f32 v16,v208,v16
v_mfma_f32_16x16x32_bf16 v[36:39],v[184:187],v[148:151],v[36:39]
ds_read_b64_tr_b16 v[174:175],v216 offset:41984
v_mul_f32 v17,v208,v17
v_mfma_f32_16x16x32_bf16 v[40:43],v[184:187],v[152:155],v[40:43]
ds_read_b128 v[240:243],v246 offset:0
v_mul_f32 v18,v208,v18
v_mfma_f32_16x16x32_bf16 v[44:47],v[184:187],v[156:159],v[44:47]
buffer_load_dwordx4 v214,s[12:15],s54 offen offset:1024 lds
s_add_u32 m0,s84,110592
v_mfma_f32_16x16x32_bf16 v[48:51],v[188:191],v[144:147],v[48:51]
v_exp_f32 v0,v0
v_mfma_f32_16x16x32_bf16 v[52:55],v[188:191],v[148:151],v[52:55]
v_exp_f32 v1,v1
v_mfma_f32_16x16x32_bf16 v[56:59],v[188:191],v[152:155],v[56:59]
v_exp_f32 v2,v2
v_mfma_f32_16x16x32_bf16 v[60:63],v[188:191],v[156:159],v[60:63]
buffer_load_dwordx4 v213,s[8:11],s55 offen lds
s_waitcnt lgkmcnt(1)
v_mfma_f32_16x16x32_bf16 v[64:67],v[160:163],a[0:3],0
ds_read_b64_tr_b16 v[176:177],v215 offset:45056
s_waitcnt lgkmcnt(1)
v_mfma_f32_16x16x32_bf16 v[68:71],v[160:163],a[4:7],0
ds_read_b64_tr_b16 v[178:179],v215 offset:49152
v_and_b32 v227,15,v226
v_mfma_f32_16x16x32_bf16 v[72:75],v[160:163],a[8:11],0
ds_read_b64_tr_b16 v[180:181],v216 offset:45056
v_mul_u32_u24 v227,4,v227
v_mfma_f32_16x16x32_bf16 v[76:79],v[160:163],a[12:15],0
ds_read_b64_tr_b16 v[182:183],v216 offset:49152
v_add_f32 v228,v228,v240
v_mfma_f32_16x16x32_bf16 v[80:83],v[164:167],a[0:3],0
buffer_load_dwordx4 v213,s[12:15],s55 offen offset:1024 lds
s_add_u32 m0,s84,118784
v_mfma_f32_16x16x32_bf16 v[84:87],v[164:167],a[4:7],0
ds_read_b64_tr_b16 v[184:185],v215 offset:46080
v_add_f32 v229,v229,v241
v_mfma_f32_16x16x32_bf16 v[88:91],v[164:167],a[8:11],0
ds_read_b64_tr_b16 v[186:187],v215 offset:50176
v_subrev_u32 v215,73728,v215
v_mfma_f32_16x16x32_bf16 v[92:95],v[164:167],a[12:15],0
ds_read_b64_tr_b16 v[188:189],v216 offset:46080
v_add_f32 v230,v230,v242
v_mfma_f32_16x16x32_bf16 v[96:99],v[168:171],a[0:3],0
buffer_load_dwordx4 v214,s[8:11],s55 offen lds
ds_read_b64_tr_b16 v[190:191],v216 offset:50176
v_mfma_f32_16x16x32_bf16 v[100:103],v[168:171],a[4:7],0
v_subrev_u32 v216,73728,v216
v_add_f32 v231,v231,v243
v_mfma_f32_16x16x32_bf16 v[104:107],v[168:171],a[8:11],0
ds_read_b128 v[240:243],v246 offset:1024
v_cvt_pk_bf16_f32 v228,v228,v229
v_mfma_f32_16x16x32_bf16 v[108:111],v[168:171],a[12:15],0
v_cvt_pk_bf16_f32 v229,v230,v231
v_mul_f32 v19,v208,v19
v_mfma_f32_16x16x32_bf16 v[112:115],v[172:175],a[0:3],0
buffer_load_dwordx4 v214,s[12:15],s55 offen offset:1024 lds
v_add_f32 v0,1.0,v0
v_mfma_f32_16x16x32_bf16 v[116:119],v[172:175],a[4:7],0
v_exp_f32 v3,v3
v_mfma_f32_16x16x32_bf16 v[120:123],v[172:175],a[8:11],0
v_exp_f32 v16,v16
v_mfma_f32_16x16x32_bf16 v[124:127],v[172:175],a[12:15],0
s_waitcnt lgkmcnt(1)
ds_read_b64_tr_b16 v[160:161],v215 offset:0
v_mfma_f32_16x16x32_bf16 v[64:67],v[176:179],a[16:19],v[64:67]
ds_read_b64_tr_b16 v[162:163],v215 offset:4096
s_waitcnt lgkmcnt(2)
v_mfma_f32_16x16x32_bf16 v[68:71],v[176:179],a[20:23],v[68:71]
ds_read_b64_tr_b16 v[164:165],v216 offset:0
v_add_f32 v232,v232,v240
v_mfma_f32_16x16x32_bf16 v[72:75],v[176:179],a[24:27],v[72:75]
ds_read_b64_tr_b16 v[166:167],v216 offset:4096
v_add_f32 v233,v233,v241
v_mfma_f32_16x16x32_bf16 v[76:79],v[176:179],a[28:31],v[76:79]
ds_read_b64_tr_b16 v[168:169],v215 offset:1024
v_add_f32 v234,v234,v242
v_mfma_f32_16x16x32_bf16 v[80:83],v[180:183],a[16:19],v[80:83]
ds_read_b64_tr_b16 v[170:171],v215 offset:5120
v_add_f32 v235,v235,v243
v_mfma_f32_16x16x32_bf16 v[84:87],v[180:183],a[20:23],v[84:87]
ds_read_b64_tr_b16 v[172:173],v216 offset:1024
v_cvt_pk_bf16_f32 v230,v232,v233
v_mfma_f32_16x16x32_bf16 v[88:91],v[180:183],a[24:27],v[88:91]
ds_read_b64_tr_b16 v[174:175],v216 offset:5120
v_cvt_pk_bf16_f32 v231,v234,v235
v_mfma_f32_16x16x32_bf16 v[92:95],v[180:183],a[28:31],v[92:95]
buffer_store_dwordx4 v[228:231],v245,s[24:27],s16 offen sc1
ds_read_b128 v[240:243],v246 offset:2048
v_mfma_f32_16x16x32_bf16 v[96:99],v[184:187],a[16:19],v[96:99]
v_lshrrev_b32 v246,4,v226
v_min_u32 v246,1,v246
v_mfma_f32_16x16x32_bf16 v[100:103],v[184:187],a[20:23],v[100:103]
v_lshlrev_b32 v246,31,v246
v_lshl_or_b32 v246,v226,3,v246
v_mfma_f32_16x16x32_bf16 v[104:107],v[184:187],a[24:27],v[104:107]
v_or_b32 v246,s17,v246
s_lshr_b32 s17,s16,3
v_mfma_f32_16x16x32_bf16 v[108:111],v[184:187],a[28:31],v[108:111]
s_add_u32 s17,s17,1032192
v_add_f32 v1,1.0,v1
v_mfma_f32_16x16x32_bf16 v[112:115],v[188:191],a[16:19],v[112:115]
v_exp_f32 v17,v17
v_mfma_f32_16x16x32_bf16 v[116:119],v[188:191],a[20:23],v[116:119]
s_waitcnt lgkmcnt(0)
v_add_f32 v236,v236,v240
v_mfma_f32_16x16x32_bf16 v[120:123],v[188:191],a[24:27],v[120:123]
v_add_f32 v237,v237,v241
v_add_f32 v238,v238,v242
v_mfma_f32_16x16x32_bf16 v[124:127],v[188:191],a[28:31],v[124:127]
ds_read_b64_tr_b16 v[176:177],v215 offset:8192
v_mfma_f32_16x16x32_bf16 v[64:67],v[160:163],a[32:35],v[64:67]
ds_read_b64_tr_b16 v[178:179],v215 offset:12288
buffer_load_dword v247,v227,s[32:35],0 offen sc1
v_mfma_f32_16x16x32_bf16 v[68:71],v[160:163],a[36:39],v[68:71]
ds_read_b64_tr_b16 v[180:181],v216 offset:8192
v_add_f32 v239,v239,v243
v_mfma_f32_16x16x32_bf16 v[72:75],v[160:163],a[40:43],v[72:75]
ds_read_b64_tr_b16 v[182:183],v216 offset:12288
v_cvt_pk_bf16_f32 v232,v236,v237
v_mfma_f32_16x16x32_bf16 v[76:79],v[160:163],a[44:47],v[76:79]
ds_read_b64_tr_b16 v[184:185],v215 offset:9216
v_cvt_pk_bf16_f32 v233,v238,v239
v_mfma_f32_16x16x32_bf16 v[80:83],v[164:167],a[32:35],v[80:83]
buffer_store_dwordx2 v[232:233],v246,s[24:27],s17 offen sc1
ds_read_b64_tr_b16 v[186:187],v215 offset:13312
v_mfma_f32_16x16x32_bf16 v[84:87],v[164:167],a[36:39],v[84:87]
ds_read_b64_tr_b16 v[188:189],v216 offset:9216
v_add_f32 v2,1.0,v2
v_mfma_f32_16x16x32_bf16 v[88:91],v[164:167],a[40:43],v[88:91]
ds_read_b64_tr_b16 v[190:191],v216 offset:13312
v_add_f32 v3,1.0,v3
v_mfma_f32_16x16x32_bf16 v[92:95],v[164:167],a[44:47],v[92:95]
v_exp_f32 v18,v18
v_mfma_f32_16x16x32_bf16 v[96:99],v[168:171],a[32:35],v[96:99]
s_add_u32 m0,s84,129024
v_exp_f32 v19,v19
v_mfma_f32_16x16x32_bf16 v[100:103],v[168:171],a[36:39],v[100:103]
s_mul_i32 s98,s3,-512
s_add_u32 s98,s98,128
s_ashr_i32 s99,s98,31
v_mfma_f32_16x16x32_bf16 v[104:107],v[168:171],a[40:43],v[104:107]
v_rcp_f32 v0,v0
v_add_f32 v16,1.0,v16
v_mfma_f32_16x16x32_bf16 v[108:111],v[168:171],a[44:47],v[108:111]
v_rcp_f32 v1,v1
v_add_f32 v17,1.0,v17
v_mfma_f32_16x16x32_bf16 v[112:115],v[172:175],a[32:35],v[112:115]
v_rcp_f32 v2,v2
v_add_f32 v18,1.0,v18
v_mfma_f32_16x16x32_bf16 v[116:119],v[172:175],a[36:39],v[116:119]
v_rcp_f32 v3,v3
v_add_f32 v19,1.0,v19
v_mfma_f32_16x16x32_bf16 v[120:123],v[172:175],a[40:43],v[120:123]
v_rcp_f32 v16,v16
v_mul_f32 v0,v0,v32
v_mfma_f32_16x16x32_bf16 v[124:127],v[172:175],a[44:47],v[124:127]
s_getpc_b64 s[0:1]
L_cp3_5:
v_min_u32 v254,L_stop_5-L_cp3_5,v253
global_load_dword v255,v254,s[0:1]
s_waitcnt lgkmcnt(0)
v_mfma_f32_16x16x32_bf16 v[64:67],v[176:179],a[48:51],v[64:67]
s_waitcnt vmcnt(20)
s_barrier
buffer_load_dwordx4 v213,s[8:11],s56 offen lds
v_mfma_f32_16x16x32_bf16 v[68:71],v[176:179],a[52:55],v[68:71]
ds_read_b64_tr_b16 v[160:161],v215 offset:18432
v_rcp_f32 v17,v17
v_mfma_f32_16x16x32_bf16 v[72:75],v[176:179],a[56:59],v[72:75]
buffer_load_dwordx4 v213,s[12:15],s56 offen offset:1024 lds
s_add_u32 m0,s84,137216
ds_read_b64_tr_b16 v[162:163],v215 offset:22528
v_mfma_f32_16x16x32_bf16 v[76:79],v[176:179],a[60:63],v[76:79]
ds_read_b64_tr_b16 v[164:165],v216 offset:18432
v_rcp_f32 v18,v18
v_mfma_f32_16x16x32_bf16 v[80:83],v[180:183],a[48:51],v[80:83]
ds_read_b64_tr_b16 v[166:167],v216 offset:22528
v_rcp_f32 v19,v19
v_mfma_f32_16x16x32_bf16 v[84:87],v[180:183],a[52:55],v[84:87]
ds_read_b64_tr_b16 v[168:169],v215 offset:19456
v_mul_f32 v1,v1,v33
v_mul_f32 v2,v2,v34
v_mfma_f32_16x16x32_bf16 v[88:91],v[180:183],a[56:59],v[88:91]
buffer_load_dwordx4 v214,s[8:11],s56 offen lds
ds_read_b64_tr_b16 v[170:171],v215 offset:23552
v_mul_f32 v3,v3,v35
v_mfma_f32_16x16x32_bf16 v[92:95],v[180:183],a[60:63],v[92:95]
s_add_u32 s8,s8,s98
s_addc_u32 s9,s9,s99
s_sub_u32 s10,s10,s98
v_mfma_f32_16x16x32_bf16 v[96:99],v[184:187],a[48:51],v[96:99]
ds_read_b64_tr_b16 v[172:173],v216 offset:19456
v_mul_f32 v16,v16,v48
v_mul_f32 v17,v17,v49
v_mfma_f32_16x16x32_bf16 v[100:103],v[184:187],a[52:55],v[100:103]
ds_read_b64_tr_b16 v[174:175],v216 offset:23552
v_mul_f32 v18,v18,v50
v_mul_f32 v19,v19,v51
v_mfma_f32_16x16x32_bf16 v[104:107],v[184:187],a[56:59],v[104:107]
buffer_load_dwordx4 v214,s[12:15],s56 offen offset:1024 lds
s_add_u32 m0,s84,18432
v_cvt_pk_bf16_f32 v32,v0,v1
v_mfma_f32_16x16x32_bf16 v[108:111],v[184:187],a[60:63],v[108:111]
s_add_u32 s12,s12,s98
s_addc_u32 s13,s13,s99
s_sub_u32 s14,s14,s98
v_mfma_f32_16x16x32_bf16 v[112:115],v[188:191],a[48:51],v[112:115]
v_cvt_pk_bf16_f32 v33,v2,v3
v_cvt_pk_bf16_f32 v34,v16,v17
v_cvt_pk_bf16_f32 v35,v18,v19
v_mfma_f32_16x16x32_bf16 v[116:119],v[188:191],a[52:55],v[116:119]
buffer_store_dwordx4 v[32:35],v212,s[24:27],s86 offen sc1
v_mul_f32 v4,v209,v4
v_mul_f32 v5,v209,v5
v_mfma_f32_16x16x32_bf16 v[120:123],v[188:191],a[56:59],v[120:123]
v_exp_f32 v4,v4
v_mul_f32 v6,v209,v6
v_mfma_f32_16x16x32_bf16 v[124:127],v[188:191],a[60:63],v[124:127]
s_waitcnt lgkmcnt(0)
ds_read_b64_tr_b16 v[176:177],v215 offset:26624
v_mul_f32 v7,v209,v7
v_mfma_f32_16x16x32_bf16 v[64:67],v[160:163],a[64:67],v[64:67]
ds_read_b64_tr_b16 v[178:179],v215 offset:30720
v_exp_f32 v5,v5
v_mfma_f32_16x16x32_bf16 v[68:71],v[160:163],a[68:71],v[68:71]
ds_read_b64_tr_b16 v[180:181],v216 offset:26624
v_exp_f32 v6,v6
v_mfma_f32_16x16x32_bf16 v[72:75],v[160:163],a[72:75],v[72:75]
ds_read_b64_tr_b16 v[182:183],v216 offset:30720
v_exp_f32 v7,v7
v_mfma_f32_16x16x32_bf16 v[76:79],v[160:163],a[76:79],v[76:79]
ds_read_b64_tr_b16 v[184:185],v215 offset:27648
v_mul_f32 v20,v209,v20
v_mul_f32 v21,v209,v21
v_mfma_f32_16x16x32_bf16 v[80:83],v[164:167],a[64:67],v[80:83]
ds_read_b64_tr_b16 v[186:187],v215 offset:31744
v_exp_f32 v20,v20
v_mfma_f32_16x16x32_bf16 v[84:87],v[164:167],a[68:71],v[84:87]
ds_read_b64_tr_b16 v[188:189],v216 offset:27648
v_mul_f32 v22,v209,v22
v_mfma_f32_16x16x32_bf16 v[88:91],v[164:167],a[72:75],v[88:91]
ds_read_b64_tr_b16 v[190:191],v216 offset:31744
v_mul_f32 v23,v209,v23
v_mfma_f32_16x16x32_bf16 v[92:95],v[164:167],a[76:79],v[92:95]
v_exp_f32 v21,v21
v_mfma_f32_16x16x32_bf16 v[96:99],v[168:171],a[64:67],v[96:99]
buffer_load_dwordx4 v213,s[8:11],s48 offen lds
v_add_f32 v4,1.0,v4
v_mfma_f32_16x16x32_bf16 v[100:103],v[168:171],a[68:71],v[100:103]
v_exp_f32 v22,v22
v_mfma_f32_16x16x32_bf16 v[104:107],v[168:171],a[72:75],v[104:107]
v_exp_f32 v23,v23
v_mfma_f32_16x16x32_bf16 v[108:111],v[168:171],a[76:79],v[108:111]
v_rcp_f32 v4,v4
v_mfma_f32_16x16x32_bf16 v[112:115],v[172:175],a[64:67],v[112:115]
buffer_load_dwordx4 v213,s[12:15],s48 offen offset:1024 lds
s_add_u32 m0,s84,26624
v_mfma_f32_16x16x32_bf16 v[116:119],v[172:175],a[68:71],v[116:119]
v_add_f32 v5,1.0,v5
v_add_f32 v6,1.0,v6
v_mfma_f32_16x16x32_bf16 v[120:123],v[172:175],a[72:75],v[120:123]
v_rcp_f32 v5,v5
v_mfma_f32_16x16x32_bf16 v[124:127],v[172:175],a[76:79],v[124:127]
s_waitcnt lgkmcnt(0)
ds_read_b64_tr_b16 v[160:161],v215 offset:36864
v_mfma_f32_16x16x32_bf16 v[64:67],v[176:179],a[80:83],v[64:67]
buffer_load_dwordx4 v214,s[8:11],s48 offen lds
ds_read_b64_tr_b16 v[162:163],v215 offset:40960
v_mfma_f32_16x16x32_bf16 v[68:71],v[176:179],a[84:87],v[68:71]
ds_read_b64_tr_b16 v[164:165],v216 offset:36864
v_add_f32 v7,1.0,v7
v_mfma_f32_16x16x32_bf16 v[72:75],v[176:179],a[88:91],v[72:75]
ds_read_b64_tr_b16 v[166:167],v216 offset:40960
v_add_f32 v20,1.0,v20
v_mfma_f32_16x16x32_bf16 v[76:79],v[176:179],a[92:95],v[76:79]
ds_read_b64_tr_b16 v[168:169],v215 offset:37888
v_add_f32 v21,1.0,v21
v_mfma_f32_16x16x32_bf16 v[80:83],v[180:183],a[80:83],v[80:83]
ds_read_b64_tr_b16 v[170:171],v215 offset:41984
v_add_f32 v22,1.0,v22
v_mfma_f32_16x16x32_bf16 v[84:87],v[180:183],a[84:87],v[84:87]
buffer_load_dwordx4 v214,s[12:15],s48 offen offset:1024 lds
ds_read_b64_tr_b16 v[172:173],v216 offset:37888
v_mfma_f32_16x16x32_bf16 v[88:91],v[180:183],a[88:91],v[88:91]
ds_read_b64_tr_b16 v[174:175],v216 offset:41984
v_add_f32 v23,1.0,v23
v_mfma_f32_16x16x32_bf16 v[92:95],v[180:183],a[92:95],v[92:95]
v_rcp_f32 v6,v6
v_mfma_f32_16x16x32_bf16 v[96:99],v[184:187],a[80:83],v[96:99]
v_rcp_f32 v7,v7
v_mfma_f32_16x16x32_bf16 v[100:103],v[184:187],a[84:87],v[100:103]
v_rcp_f32 v20,v20
v_mfma_f32_16x16x32_bf16 v[104:107],v[184:187],a[88:91],v[104:107]
v_rcp_f32 v21,v21
v_mfma_f32_16x16x32_bf16 v[108:111],v[184:187],a[92:95],v[108:111]
s_waitcnt vmcnt(11)
v_mul_f32 v4,v4,v36
v_mfma_f32_16x16x32_bf16 v[112:115],v[188:191],a[80:83],v[112:115]
v_cmp_ne_u32 vcc,1,v247
s_cbranch_vccnz L_slow_clr_5
L_back_clr_5:
v_mfma_f32_16x16x32_bf16 v[116:119],v[188:191],a[84:87],v[116:119]
v_rcp_f32 v22,v22
v_mfma_f32_16x16x32_bf16 v[120:123],v[188:191],a[88:91],v[120:123]
v_rcp_f32 v23,v23
v_mfma_f32_16x16x32_bf16 v[124:127],v[188:191],a[92:95],v[124:127]
s_waitcnt lgkmcnt(0)
ds_read_b64_tr_b16 v[176:177],v215 offset:45056
v_mfma_f32_16x16x32_bf16 v[64:67],v[160:163],a[96:99],v[64:67]
ds_read_b64_tr_b16 v[178:179],v215 offset:49152
v_mul_f32 v5,v5,v37
v_mfma_f32_16x16x32_bf16 v[68:71],v[160:163],a[100:103],v[68:71]
ds_read_b64_tr_b16 v[180:181],v216 offset:45056
v_mul_f32 v6,v6,v38
v_mfma_f32_16x16x32_bf16 v[72:75],v[160:163],a[104:107],v[72:75]
ds_read_b64_tr_b16 v[182:183],v216 offset:49152
v_mul_f32 v7,v7,v39
v_mfma_f32_16x16x32_bf16 v[76:79],v[160:163],a[108:111],v[76:79]
ds_read_b64_tr_b16 v[184:185],v215 offset:46080
v_mul_f32 v20,v20,v52
v_mfma_f32_16x16x32_bf16 v[80:83],v[164:167],a[96:99],v[80:83]
ds_read_b64_tr_b16 v[186:187],v215 offset:50176
v_mul_f32 v21,v21,v53
v_mfma_f32_16x16x32_bf16 v[84:87],v[164:167],a[100:103],v[84:87]
ds_read_b64_tr_b16 v[188:189],v216 offset:46080
v_mul_f32 v22,v22,v54
v_mfma_f32_16x16x32_bf16 v[88:91],v[164:167],a[104:107],v[88:91]
ds_read_b64_tr_b16 v[190:191],v216 offset:50176
v_mul_f32 v23,v23,v55
v_mfma_f32_16x16x32_bf16 v[92:95],v[164:167],a[108:111],v[92:95]
v_cvt_pk_bf16_f32 v36,v4,v5
v_cvt_pk_bf16_f32 v37,v6,v7
v_mfma_f32_16x16x32_bf16 v[96:99],v[168:171],a[96:99],v[96:99]
s_add_u32 m0,s84,36864
v_cvt_pk_bf16_f32 v38,v20,v21
v_mfma_f32_16x16x32_bf16 v[100:103],v[168:171],a[100:103],v[100:103]
v_cvt_pk_bf16_f32 v39,v22,v23
buffer_store_dwordx4 v[36:39],v212,s[24:27],s86 offen offset:1024 sc1
v_mul_f32 v8,v210,v8
v_mfma_f32_16x16x32_bf16 v[104:107],v[168:171],a[104:107],v[104:107]
v_exp_f32 v8,v8
v_mul_f32 v9,v210,v9
v_mfma_f32_16x16x32_bf16 v[108:111],v[168:171],a[108:111],v[108:111]
v_exp_f32 v9,v9
v_mul_f32 v10,v210,v10
v_mfma_f32_16x16x32_bf16 v[112:115],v[172:175],a[96:99],v[112:115]
v_exp_f32 v10,v10
v_mul_f32 v11,v210,v11
v_mfma_f32_16x16x32_bf16 v[116:119],v[172:175],a[100:103],v[116:119]
v_exp_f32 v11,v11
v_mul_f32 v24,v210,v24
v_mfma_f32_16x16x32_bf16 v[120:123],v[172:175],a[104:107],v[120:123]
v_exp_f32 v24,v24
v_mul_f32 v25,v210,v25
v_mfma_f32_16x16x32_bf16 v[124:127],v[172:175],a[108:111],v[124:127]
s_waitcnt lgkmcnt(0)
v_exp_f32 v25,v25
v_mfma_f32_16x16x32_bf16 v[64:67],v[176:179],a[112:115],v[64:67]
s_barrier
buffer_load_dwordx4 v213,s[8:11],s49 offen lds
v_mfma_f32_16x16x32_bf16 v[68:71],v[176:179],a[116:119],v[68:71]
ds_read_b64_tr_b16 v[160:161],v215 offset:55296
v_mul_f32 v26,v210,v26
v_mul_f32 v27,v210,v27
v_mfma_f32_16x16x32_bf16 v[72:75],v[176:179],a[120:123],v[72:75]
ds_read_b64_tr_b16 v[162:163],v215 offset:59392
v_exp_f32 v26,v26
v_mfma_f32_16x16x32_bf16 v[76:79],v[176:179],a[124:127],v[76:79]
ds_read_b64_tr_b16 v[164:165],v216 offset:55296
v_exp_f32 v27,v27
v_mfma_f32_16x16x32_bf16 v[80:83],v[180:183],a[112:115],v[80:83]
buffer_load_dwordx4 v213,s[12:15],s49 offen offset:1024 lds
s_add_u32 m0,s84,45056
ds_read_b64_tr_b16 v[166:167],v216 offset:59392
v_mfma_f32_16x16x32_bf16 v[84:87],v[180:183],a[116:119],v[84:87]
ds_read_b64_tr_b16 v[168:169],v215 offset:56320
v_add_f32 v8,1.0,v8
v_add_f32 v9,1.0,v9
v_mfma_f32_16x16x32_bf16 v[88:91],v[180:183],a[120:123],v[88:91]
ds_read_b64_tr_b16 v[170:171],v215 offset:60416
v_add_u32 v215,55296,v215
v_add_f32 v10,1.0,v10
v_mfma_f32_16x16x32_bf16 v[92:95],v[180:183],a[124:127],v[92:95]
ds_read_b64_tr_b16 v[172:173],v216 offset:56320
v_rcp_f32 v8,v8
v_mfma_f32_16x16x32_bf16 v[96:99],v[184:187],a[112:115],v[96:99]
buffer_load_dwordx4 v214,s[8:11],s49 offen lds
ds_read_b64_tr_b16 v[174:175],v216 offset:60416
v_add_u32 v216,55296,v216
v_mfma_f32_16x16x32_bf16 v[100:103],v[184:187],a[116:119],v[100:103]
v_rcp_f32 v9,v9
v_add_f32 v11,1.0,v11
v_mfma_f32_16x16x32_bf16 v[104:107],v[184:187],a[120:123],v[104:107]
v_rcp_f32 v10,v10
v_mfma_f32_16x16x32_bf16 v[108:111],v[184:187],a[124:127],v[108:111]
v_rcp_f32 v11,v11
v_add_f32 v24,1.0,v24
v_mfma_f32_16x16x32_bf16 v[112:115],v[188:191],a[112:115],v[112:115]
buffer_load_dwordx4 v214,s[12:15],s49 offen offset:1024 lds
s_add_u32 m0,s84,55296
v_add_f32 v25,1.0,v25
v_mfma_f32_16x16x32_bf16 v[116:119],v[188:191],a[116:119],v[116:119]
v_rcp_f32 v24,v24
v_add_f32 v26,1.0,v26
v_mfma_f32_16x16x32_bf16 v[120:123],v[188:191],a[120:123],v[120:123]
v_rcp_f32 v25,v25
v_mfma_f32_16x16x32_bf16 v[124:127],v[188:191],a[124:127],v[124:127]
s_waitcnt lgkmcnt(0)
ds_read_b64_tr_b16 v[176:177],v215 offset:8192
v_mfma_f32_16x16x32_bf16 v[64:67],v[160:163],a[128:131],v[64:67]
buffer_load_dwordx4 v213,s[8:11],s50 offen lds
ds_read_b64_tr_b16 v[178:179],v215 offset:12288
v_mfma_f32_16x16x32_bf16 v[68:71],v[160:163],a[132:135],v[68:71]
ds_read_b64_tr_b16 v[180:181],v216 offset:8192
v_add_f32 v27,1.0,v27
v_mfma_f32_16x16x32_bf16 v[72:75],v[160:163],a[136:139],v[72:75]
ds_read_b64_tr_b16 v[182:183],v216 offset:12288
v_mul_f32 v8,v8,v40
v_mfma_f32_16x16x32_bf16 v[76:79],v[160:163],a[140:143],v[76:79]
ds_read_b64_tr_b16 v[184:185],v215 offset:9216
v_mul_f32 v9,v9,v41
v_mfma_f32_16x16x32_bf16 v[80:83],v[164:167],a[128:131],v[80:83]
buffer_load_dwordx4 v213,s[12:15],s50 offen offset:1024 lds
s_add_u32 m0,s84,63488
v_mfma_f32_16x16x32_bf16 v[84:87],v[164:167],a[132:135],v[84:87]
ds_read_b64_tr_b16 v[186:187],v215 offset:13312
v_subrev_u32 v215,73728,v215
v_mfma_f32_16x16x32_bf16 v[88:91],v[164:167],a[136:139],v[88:91]
ds_read_b64_tr_b16 v[188:189],v216 offset:9216
v_mul_f32 v10,v10,v42
v_mfma_f32_16x16x32_bf16 v[92:95],v[164:167],a[140:143],v[92:95]
ds_read_b64_tr_b16 v[190:191],v216 offset:13312
v_subrev_u32 v216,73728,v216
v_mfma_f32_16x16x32_bf16 v[96:99],v[168:171],a[128:131],v[96:99]
s_lshl_b32 s18,s41,5
s_add_u32 s18,s18,21
v_mfma_f32_16x16x32_bf16 v[100:103],v[168:171],a[132:135],v[100:103]
s_lshl_b32 s18,s18,5
s_add_u32 s18,s18,s40
s_lshl_b32 s18,s18,2
v_mfma_f32_16x16x32_bf16 v[104:107],v[168:171],a[136:139],v[104:107]
buffer_load_dwordx4 v214,s[8:11],s50 offen lds
v_rcp_f32 v26,v26
v_mfma_f32_16x16x32_bf16 v[108:111],v[168:171],a[140:143],v[108:111]
v_rcp_f32 v27,v27
v_mul_f32 v11,v11,v43
v_mfma_f32_16x16x32_bf16 v[112:115],v[172:175],a[128:131],v[112:115]
v_mul_f32 v24,v24,v56
v_mul_f32 v25,v25,v57
v_mul_f32 v26,v26,v58
v_mfma_f32_16x16x32_bf16 v[116:119],v[172:175],a[132:135],v[116:119]
buffer_load_dwordx4 v214,s[12:15],s50 offen offset:1024 lds
v_mul_f32 v27,v27,v59
v_cvt_pk_bf16_f32 v40,v8,v9
v_mfma_f32_16x16x32_bf16 v[120:123],v[172:175],a[136:139],v[120:123]
v_cvt_pk_bf16_f32 v41,v10,v11
v_cvt_pk_bf16_f32 v42,v24,v25
v_cvt_pk_bf16_f32 v43,v26,v27
v_mfma_f32_16x16x32_bf16 v[124:127],v[172:175],a[140:143],v[124:127]
s_waitcnt lgkmcnt(0)
ds_read_b64_tr_b16 v[160:161],v215 offset:0
v_mul_f32 v12,v211,v12
v_mfma_f32_16x16x32_bf16 v[64:67],v[176:179],a[144:147],v[64:67]
buffer_store_dwordx4 v[40:43],v212,s[24:27],s87 offen sc1
ds_read_b64_tr_b16 v[162:163],v215 offset:4096
v_mul_f32 v13,v211,v13
v_mfma_f32_16x16x32_bf16 v[68:71],v[176:179],a[148:151],v[68:71]
ds_read_b64_tr_b16 v[164:165],v216 offset:0
v_exp_f32 v12,v12
v_mfma_f32_16x16x32_bf16 v[72:75],v[176:179],a[152:155],v[72:75]
ds_read_b64_tr_b16 v[166:167],v216 offset:4096
v_exp_f32 v13,v13
v_mfma_f32_16x16x32_bf16 v[76:79],v[176:179],a[156:159],v[76:79]
ds_read_b64_tr_b16 v[168:169],v215 offset:1024
v_mul_f32 v14,v211,v14
v_mul_f32 v15,v211,v15
v_mfma_f32_16x16x32_bf16 v[80:83],v[180:183],a[144:147],v[80:83]
ds_read_b64_tr_b16 v[170:171],v215 offset:5120
v_exp_f32 v14,v14
v_mfma_f32_16x16x32_bf16 v[84:87],v[180:183],a[148:151],v[84:87]
ds_read_b64_tr_b16 v[172:173],v216 offset:1024
v_mul_f32 v28,v211,v28
v_mfma_f32_16x16x32_bf16 v[88:91],v[180:183],a[152:155],v[88:91]
ds_read_b64_tr_b16 v[174:175],v216 offset:5120
v_mul_f32 v29,v211,v29
v_mfma_f32_16x16x32_bf16 v[92:95],v[180:183],a[156:159],v[92:95]
v_exp_f32 v15,v15
v_mfma_f32_16x16x32_bf16 v[96:99],v[184:187],a[144:147],v[96:99]
v_exp_f32 v28,v28
v_mfma_f32_16x16x32_bf16 v[100:103],v[184:187],a[148:151],v[100:103]
v_exp_f32 v29,v29
v_mfma_f32_16x16x32_bf16 v[104:107],v[184:187],a[152:155],v[104:107]
v_mul_f32 v30,v211,v30
v_exp_f32 v30,v30
v_mfma_f32_16x16x32_bf16 v[108:111],v[184:187],a[156:159],v[108:111]
v_mul_f32 v31,v211,v31
v_exp_f32 v31,v31
v_mfma_f32_16x16x32_bf16 v[112:115],v[188:191],a[144:147],v[112:115]
v_add_f32 v12,1.0,v12
v_rcp_f32 v12,v12
v_mfma_f32_16x16x32_bf16 v[116:119],v[188:191],a[148:151],v[116:119]
v_add_f32 v13,1.0,v13
v_rcp_f32 v13,v13
v_mfma_f32_16x16x32_bf16 v[120:123],v[188:191],a[152:155],v[120:123]
v_add_f32 v14,1.0,v14
v_rcp_f32 v14,v14
v_mfma_f32_16x16x32_bf16 v[124:127],v[188:191],a[156:159],v[124:127]
s_waitcnt lgkmcnt(0)
ds_read_b64_tr_b16 v[176:177],v215 offset:8192
v_add_f32 v15,1.0,v15
v_mfma_f32_16x16x32_bf16 v[64:67],v[160:163],a[160:163],v[64:67]
ds_read_b64_tr_b16 v[178:179],v215 offset:12288
v_rcp_f32 v15,v15
v_mfma_f32_16x16x32_bf16 v[68:71],v[160:163],a[164:167],v[68:71]
ds_read_b64_tr_b16 v[180:181],v216 offset:8192
v_add_f32 v28,1.0,v28
v_mfma_f32_16x16x32_bf16 v[72:75],v[160:163],a[168:171],v[72:75]
ds_read_b64_tr_b16 v[182:183],v216 offset:12288
v_rcp_f32 v28,v28
v_mfma_f32_16x16x32_bf16 v[76:79],v[160:163],a[172:175],v[76:79]
ds_read_b64_tr_b16 v[184:185],v215 offset:9216
v_add_f32 v29,1.0,v29
v_add_f32 v30,1.0,v30
v_mfma_f32_16x16x32_bf16 v[80:83],v[164:167],a[160:163],v[80:83]
ds_read_b64_tr_b16 v[186:187],v215 offset:13312
v_add_u32 v215,92160,v215
v_add_f32 v31,1.0,v31
v_mfma_f32_16x16x32_bf16 v[84:87],v[164:167],a[164:167],v[84:87]
ds_read_b64_tr_b16 v[188:189],v216 offset:9216
v_rcp_f32 v29,v29
v_mfma_f32_16x16x32_bf16 v[88:91],v[164:167],a[168:171],v[88:91]
ds_read_b64_tr_b16 v[190:191],v216 offset:13312
v_add_u32 v216,92160,v216
v_mfma_f32_16x16x32_bf16 v[92:95],v[164:167],a[172:175],v[92:95]
v_rcp_f32 v30,v30
v_mfma_f32_16x16x32_bf16 v[96:99],v[168:171],a[160:163],v[96:99]
s_add_u32 m0,s84,73728
v_mul_f32 v12,v12,v44
v_mfma_f32_16x16x32_bf16 v[100:103],v[168:171],a[164:167],v[100:103]
v_rcp_f32 v31,v31
v_mfma_f32_16x16x32_bf16 v[104:107],v[168:171],a[168:171],v[104:107]
v_mul_f32 v13,v13,v45
v_mul_f32 v14,v14,v46
v_mul_f32 v15,v15,v47
v_mul_f32 v28,v28,v60
v_mul_f32 v29,v29,v61
v_mul_f32 v30,v30,v62
v_mul_f32 v31,v31,v63
v_cvt_pk_bf16_f32 v44,v12,v13
v_cvt_pk_bf16_f32 v45,v14,v15
v_cvt_pk_bf16_f32 v46,v28,v29
v_cvt_pk_bf16_f32 v47,v30,v31
buffer_store_dwordx4 v[44:47],v212,s[24:27],s87 offen offset:1024 sc1
v_mfma_f32_16x16x32_bf16 v[108:111],v[168:171],a[172:175],v[108:111]
s_add_u32 s86,s86,16384
s_add_u32 s87,s87,16384
v_mfma_f32_16x16x32_bf16 v[112:115],v[172:175],a[160:163],v[112:115]
v_exp_f32 v250,v250 clamp
v_mfma_f32_16x16x32_bf16 v[116:119],v[172:175],a[164:167],v[116:119]
v_max_f32 v204,s19,v204
v_add_f32 v204,v204,v249
v_mfma_f32_16x16x32_bf16 v[120:123],v[172:175],a[168:171],v[120:123]
v_fma_f32 v206,v244,v206,s19
v_mul_f32 v249,0x3fb8aa3b,v206
v_mfma_f32_16x16x32_bf16 v[124:127],v[172:175],a[172:175],v[124:127]
s_waitcnt lgkmcnt(0)
v_max_f32 v197,s19,v197
v_mfma_f32_16x16x32_bf16 v[64:67],v[176:179],a[176:179],v[64:67]
s_waitcnt vmcnt(21)
s_barrier
v_mfma_f32_16x16x32_bf16 v[68:71],v[176:179],a[180:183],v[68:71]
buffer_load_dwordx4 v213,s[8:11],s51 offen lds
ds_read_b64_tr_b16 v[160:161],v215 offset:0
v_mfma_f32_16x16x32_bf16 v[72:75],v[176:179],a[184:187],v[72:75]
ds_read_b64_tr_b16 v[162:163],v215 offset:4096
buffer_store_dword v225,v224,s[24:27],s18 offen sc1
v_mfma_f32_16x16x32_bf16 v[76:79],v[176:179],a[188:191],v[76:79]
ds_read_b64_tr_b16 v[164:165],v216 offset:0
v_add_f32 v197,v197,v250
v_mfma_f32_16x16x32_bf16 v[80:83],v[180:183],a[176:179],v[80:83]
ds_read_b64_tr_b16 v[166:167],v216 offset:4096
v_mul_f32 v250,0x3fb8aa3b,v199
v_mfma_f32_16x16x32_bf16 v[84:87],v[180:183],a[180:183],v[84:87]
buffer_load_dwordx4 v213,s[12:15],s51 offen offset:1024 lds
s_add_u32 m0,s84,81920
v_mfma_f32_16x16x32_bf16 v[88:91],v[180:183],a[184:187],v[88:91]
ds_read_b64_tr_b16 v[168:169],v215 offset:1024
v_max_f32 v206,s19,v206
v_mfma_f32_16x16x32_bf16 v[92:95],v[180:183],a[188:191],v[92:95]
ds_read_b64_tr_b16 v[170:171],v215 offset:5120
v_and_b32 v252,15,v226
v_mfma_f32_16x16x32_bf16 v[96:99],v[184:187],a[176:179],v[96:99]
ds_read_b64_tr_b16 v[172:173],v216 offset:1024
v_lshlrev_b32 v252,3,v252
v_mfma_f32_16x16x32_bf16 v[100:103],v[184:187],a[180:183],v[100:103]
buffer_load_dwordx4 v214,s[8:11],s51 offen lds
ds_read_b64_tr_b16 v[174:175],v216 offset:5120
v_mfma_f32_16x16x32_bf16 v[104:107],v[184:187],a[184:187],v[104:107]
v_exp_f32 v249,v249 clamp
v_mfma_f32_16x16x32_bf16 v[108:111],v[184:187],a[188:191],v[108:111]
v_exp_f32 v250,v250 clamp
v_mfma_f32_16x16x32_bf16 v[112:115],v[188:191],a[176:179],v[112:115]
v_add_f32 v206,v206,v249
v_lshrrev_b32 v248,4,v226
v_mfma_f32_16x16x32_bf16 v[116:119],v[188:191],a[180:183],v[116:119]
buffer_load_dwordx4 v214,s[12:15],s51 offen offset:1024 lds
s_add_u32 m0,s84,0
v_mfma_f32_16x16x32_bf16 v[120:123],v[188:191],a[184:187],v[120:123]
v_lshl_add_u32 v252,v248,8,v252
v_max_f32 v199,s19,v199
v_mfma_f32_16x16x32_bf16 v[124:127],v[188:191],a[188:191],v[124:127]
s_waitcnt lgkmcnt(0)
ds_read_b64_tr_b16 v[176:177],v215 offset:8192
v_mfma_f32_16x16x32_bf16 v[64:67],v[160:163],a[192:195],v[64:67]
ds_read_b64_tr_b16 v[178:179],v215 offset:12288
v_add_f32 v199,v199,v250
v_mfma_f32_16x16x32_bf16 v[68:71],v[160:163],a[196:199],v[68:71]
ds_read_b64_tr_b16 v[180:181],v216 offset:8192
v_mul_f32 v250,0x3fb8aa3b,v201
v_mfma_f32_16x16x32_bf16 v[72:75],v[160:163],a[200:203],v[72:75]
buffer_load_dwordx4 v213,s[8:11],s52 offen lds
ds_read_b64_tr_b16 v[182:183],v216 offset:12288
v_mfma_f32_16x16x32_bf16 v[76:79],v[160:163],a[204:207],v[76:79]
ds_read_b64_tr_b16 v[184:185],v215 offset:9216
v_max_f32 v201,s19,v201
v_mfma_f32_16x16x32_bf16 v[80:83],v[164:167],a[192:195],v[80:83]
ds_read_b64_tr_b16 v[186:187],v215 offset:13312
v_fma_f32 v205,v244,v205,s19
v_mfma_f32_16x16x32_bf16 v[84:87],v[164:167],a[196:199],v[84:87]
ds_read_b64_tr_b16 v[188:189],v216 offset:9216
v_fma_f32 v207,v244,v207,s19
v_mfma_f32_16x16x32_bf16 v[88:91],v[164:167],a[200:203],v[88:91]
buffer_load_dwordx4 v213,s[12:15],s52 offen offset:1024 lds
s_add_u32 m0,s84,8192
v_mfma_f32_16x16x32_bf16 v[92:95],v[164:167],a[204:207],v[92:95]
ds_read_b64_tr_b16 v[190:191],v216 offset:13312
s_mul_i32 s85,s3,-65536
v_mfma_f32_16x16x32_bf16 v[96:99],v[168:171],a[192:195],v[96:99]
s_lshl_b32 s58,s40,5
s_add_u32 s58,s58,s42
v_mfma_f32_16x16x32_bf16 v[100:103],v[168:171],a[196:199],v[100:103]
s_lshl_b32 s58,s58,5
s_add_u32 s58,s58,s43
v_mfma_f32_16x16x32_bf16 v[104:107],v[168:171],a[200:203],v[104:107]
s_lshl_b32 s58,s58,2
buffer_load_dwordx4 v214,s[8:11],s52 offen lds
v_mfma_f32_16x16x32_bf16 v[108:111],v[168:171],a[204:207],v[108:111]
v_exp_f32 v250,v250 clamp
v_mfma_f32_16x16x32_bf16 v[112:115],v[172:175],a[192:195],v[112:115]
v_add_f32 v201,v201,v250
v_mul_f32 v250,0x3fb8aa3b,v203
v_mfma_f32_16x16x32_bf16 v[116:119],v[172:175],a[196:199],v[116:119]
v_exp_f32 v250,v250 clamp
v_mfma_f32_16x16x32_bf16 v[120:123],v[172:175],a[200:203],v[120:123]
v_max_f32 v203,s19,v203
v_add_f32 v203,v203,v250
v_mfma_f32_16x16x32_bf16 v[124:127],v[172:175],a[204:207],v[124:127]
buffer_load_dwordx4 v214,s[12:15],s52 offen offset:1024 lds
s_waitcnt lgkmcnt(0)
v_mfma_f32_16x16x32_bf16 v[64:67],v[176:179],a[208:211],v[64:67]
ds_read_b64_tr_b16 v[160:161],v215 offset:18432
v_mul_f32 v250,0x3fb8aa3b,v205
v_mfma_f32_16x16x32_bf16 v[68:71],v[176:179],a[212:215],v[68:71]
ds_read_b64_tr_b16 v[162:163],v215 offset:22528
v_max_f32 v205,s19,v205
v_mfma_f32_16x16x32_bf16 v[72:75],v[176:179],a[216:219],v[72:75]
ds_read_b64_tr_b16 v[164:165],v216 offset:18432
s_add_u32 s85,s85,16384
v_mfma_f32_16x16x32_bf16 v[76:79],v[176:179],a[220:223],v[76:79]
ds_read_b64_tr_b16 v[166:167],v216 offset:22528
v_and_b32 v246,15,v226
v_mfma_f32_16x16x32_bf16 v[80:83],v[180:183],a[208:211],v[80:83]
ds_read_b64_tr_b16 v[168:169],v215 offset:19456
v_lshrrev_b32 v240,4,v226
v_mfma_f32_16x16x32_bf16 v[84:87],v[180:183],a[212:215],v[84:87]
ds_read_b64_tr_b16 v[170:171],v215 offset:23552
v_lshlrev_b32 v240,2,v240
v_mfma_f32_16x16x32_bf16 v[88:91],v[180:183],a[216:219],v[88:91]
ds_read_b64_tr_b16 v[172:173],v216 offset:19456
v_sub_u32 v246,v246,v240
v_mfma_f32_16x16x32_bf16 v[92:95],v[180:183],a[220:223],v[92:95]
ds_read_b64_tr_b16 v[174:175],v216 offset:23552
v_and_b32 v240,1,v246
v_mfma_f32_16x16x32_bf16 v[96:99],v[184:187],a[208:211],v[96:99]
v_exp_f32 v250,v250 clamp
v_mfma_f32_16x16x32_bf16 v[100:103],v[184:187],a[212:215],v[100:103]
v_add_f32 v205,v205,v250
v_mul_f32 v250,0x3fb8aa3b,v207
v_mfma_f32_16x16x32_bf16 v[104:107],v[184:187],a[216:219],v[104:107]
v_exp_f32 v250,v250 clamp
v_mfma_f32_16x16x32_bf16 v[108:111],v[184:187],a[220:223],v[108:111]
v_max_f32 v207,s19,v207
v_add_f32 v207,v207,v250
v_mfma_f32_16x16x32_bf16 v[112:115],v[188:191],a[208:211],v[112:115]
v_lshrrev_b32 v246,1,v246
v_lshlrev_b32 v240,4,v240
v_mfma_f32_16x16x32_bf16 v[116:119],v[188:191],a[212:215],v[116:119]
v_mov_b32 v241,0x3f80
v_lshlrev_b32 v241,v240,v241
v_mfma_f32_16x16x32_bf16 v[120:123],v[188:191],a[216:219],v[120:123]
s_and_b32 s66,s66,0xff
s_lshl_b32 s66,s66,14
v_mfma_f32_16x16x32_bf16 v[124:127],v[188:191],a[220:223],v[124:127]
s_waitcnt lgkmcnt(0)
ds_read_b64_tr_b16 v[176:177],v215 offset:26624
v_mfma_f32_16x16x32_bf16 v[64:67],v[160:163],a[224:227],v[64:67]
ds_read_b64_tr_b16 v[178:179],v215 offset:30720
v_mov_b32 v237,0x3f80
v_mfma_f32_16x16x32_bf16 v[68:71],v[160:163],a[228:231],v[68:71]
ds_read_b64_tr_b16 v[180:181],v216 offset:26624
v_mov_b32 v244,0
v_mfma_f32_16x16x32_bf16 v[72:75],v[160:163],a[232:235],v[72:75]
ds_read_b64_tr_b16 v[182:183],v216 offset:30720
v_mov_b32 v245,0
v_mfma_f32_16x16x32_bf16 v[76:79],v[160:163],a[236:239],v[76:79]
ds_read_b64_tr_b16 v[184:185],v215 offset:27648
v_mov_b32 v240,0
v_mfma_f32_16x16x32_bf16 v[80:83],v[164:167],a[224:227],v[80:83]
ds_read_b64_tr_b16 v[186:187],v215 offset:31744
s_xor_b32 s65,s45,2
v_mfma_f32_16x16x32_bf16 v[84:87],v[164:167],a[228:231],v[84:87]
ds_read_b64_tr_b16 v[188:189],v216 offset:27648
s_mul_i32 s65,s65,3072
v_mfma_f32_16x16x32_bf16 v[88:91],v[164:167],a[232:235],v[88:91]
ds_read_b64_tr_b16 v[190:191],v216 offset:31744
s_add_u32 s65,s65,147456
v_mfma_f32_16x16x32_bf16 v[92:95],v[164:167],a[236:239],v[92:95]
s_and_b32 s67,s67,0xff
s_lshl_b32 s67,s67,14
v_mfma_f32_16x16x32_bf16 v[96:99],v[168:171],a[224:227],v[96:99]
s_add_u32 m0,s84,92160
s_and_b32 s68,s68,0xff
v_mfma_f32_16x16x32_bf16 v[100:103],v[168:171],a[228:231],v[100:103]
s_lshl_b32 s68,s68,14
s_xor_b32 s91,s45,0
v_mfma_f32_16x16x32_bf16 v[104:107],v[168:171],a[232:235],v[104:107]
s_lshl_b32 s16,s40,2
s_add_u32 s91,s91,s16
v_mfma_f32_16x16x32_bf16 v[108:111],v[168:171],a[236:239],v[108:111]
s_lshl_b32 s17,s101,1
s_add_u32 s17,s17,s47
v_mfma_f32_16x16x32_bf16 v[112:115],v[172:175],a[224:227],v[112:115]
s_lshl_b32 s16,s91,6
s_add_u32 s16,s16,s17
v_mfma_f32_16x16x32_bf16 v[116:119],v[172:175],a[228:231],v[116:119]
s_lshl_b32 s16,s16,6
s_add_u32 s16,s16,2097152
v_mfma_f32_16x16x32_bf16 v[120:123],v[172:175],a[232:235],v[120:123]
s_lshl_b32 s91,s91,5
s_add_u32 s91,s91,s17
v_mfma_f32_16x16x32_bf16 v[124:127],v[172:175],a[236:239],v[124:127]
s_waitcnt lgkmcnt(0)
s_lshl_b32 s91,s91,10
v_mfma_f32_16x16x32_bf16 v[64:67],v[176:179],a[240:243],v[64:67]
s_waitcnt vmcnt(9)
s_barrier
v_mfma_f32_16x16x32_bf16 v[68:71],v[176:179],a[244:247],v[68:71]
buffer_load_dwordx4 v213,s[8:11],s53 offen lds
ds_read_b64_tr_b16 v[160:161],v215 offset:36864
v_mfma_f32_16x16x32_bf16 v[72:75],v[176:179],a[248:251],v[72:75]
buffer_load_dwordx4 v213,s[12:15],s53 offen offset:1024 lds
s_add_u32 m0,s84,100352
buffer_store_dword v225,v224,s[24:27],s58 offen sc1
v_mfma_f32_16x16x32_bf16 v[76:79],v[176:179],a[252:255],v[76:79]
ds_read_b64_tr_b16 v[162:163],v215 offset:40960
s_add_u32 s91,s91,3145728
v_mfma_f32_16x16x32_bf16 v[80:83],v[180:183],a[240:243],v[80:83]
ds_read_b64_tr_b16 v[164:165],v216 offset:36864
s_and_b32 s69,s69,0xff
v_mfma_f32_16x16x32_bf16 v[84:87],v[180:183],a[244:247],v[84:87]
ds_read_b64_tr_b16 v[166:167],v216 offset:40960
s_lshl_b32 s69,s69,14
v_mfma_f32_16x16x32_bf16 v[88:91],v[180:183],a[248:251],v[88:91]
ds_read_b64_tr_b16 v[168:169],v215 offset:37888
s_xor_b32 s18,s45,1
v_mfma_f32_16x16x32_bf16 v[92:95],v[180:183],a[252:255],v[92:95]
buffer_load_dwordx4 v214,s[8:11],s53 offen lds
ds_read_b64_tr_b16 v[170:171],v215 offset:41984
v_mfma_f32_16x16x32_bf16 v[96:99],v[184:187],a[240:243],v[96:99]
ds_read_b64_tr_b16 v[172:173],v216 offset:37888
s_add_u32 s18,s18,s57
v_mfma_f32_16x16x32_bf16 v[100:103],v[184:187],a[244:247],v[100:103]
ds_read_b64_tr_b16 v[174:175],v216 offset:41984
s_lshl_b32 s58,s101,1
v_mfma_f32_16x16x32_bf16 v[104:107],v[184:187],a[248:251],v[104:107]
s_add_u32 s58,s58,s47
s_lshl_b32 s57,s18,6
v_mfma_f32_16x16x32_bf16 v[108:111],v[184:187],a[252:255],v[108:111]
buffer_load_dwordx4 v214,s[12:15],s53 offen offset:1024 lds
s_add_u32 m0,s84,110592
v_mfma_f32_16x16x32_bf16 v[112:115],v[188:191],a[240:243],v[112:115]
s_add_u32 s57,s57,s58
s_lshl_b32 s57,s57,6
v_mfma_f32_16x16x32_bf16 v[116:119],v[188:191],a[244:247],v[116:119]
s_add_u32 s57,s57,2097152
s_lshl_b32 s18,s18,5
v_mfma_f32_16x16x32_bf16 v[120:123],v[188:191],a[248:251],v[120:123]
s_add_u32 s18,s18,s58
s_lshl_b32 s18,s18,10
v_mfma_f32_16x16x32_bf16 v[124:127],v[188:191],a[252:255],v[124:127]
buffer_load_dwordx4 v213,s[8:11],s54 offen lds
s_waitcnt lgkmcnt(0)
v_mfma_f32_16x16x32_bf16 v[64:67],v[160:163],v[128:131],v[64:67]
ds_read_b64_tr_b16 v[176:177],v215 offset:45056
s_add_u32 s18,s18,3145728
v_mfma_f32_16x16x32_bf16 v[68:71],v[160:163],v[132:135],v[68:71]
ds_read_b64_tr_b16 v[178:179],v215 offset:49152
s_and_b32 s70,s70,0xff
v_mfma_f32_16x16x32_bf16 v[72:75],v[160:163],v[136:139],v[72:75]
ds_read_b64_tr_b16 v[180:181],v216 offset:45056
s_lshl_b32 s70,s70,14
v_mfma_f32_16x16x32_bf16 v[76:79],v[160:163],v[140:143],v[76:79]
ds_read_b64_tr_b16 v[182:183],v216 offset:49152
s_and_b32 s71,s71,0xff
v_mfma_f32_16x16x32_bf16 v[80:83],v[164:167],v[128:131],v[80:83]
buffer_load_dwordx4 v213,s[12:15],s54 offen offset:1024 lds
s_add_u32 m0,s84,118784
v_mfma_f32_16x16x32_bf16 v[84:87],v[164:167],v[132:135],v[84:87]
ds_read_b64_tr_b16 v[184:185],v215 offset:46080
s_lshl_b32 s71,s71,14
v_mfma_f32_16x16x32_bf16 v[88:91],v[164:167],v[136:139],v[88:91]
ds_read_b64_tr_b16 v[186:187],v215 offset:50176
v_subrev_u32 v215,73728,v215
v_mfma_f32_16x16x32_bf16 v[92:95],v[164:167],v[140:143],v[92:95]
ds_read_b64_tr_b16 v[188:189],v216 offset:46080
s_and_b32 s72,s72,0xff
v_mfma_f32_16x16x32_bf16 v[96:99],v[168:171],v[128:131],v[96:99]
buffer_load_dwordx4 v214,s[8:11],s54 offen lds
ds_read_b64_tr_b16 v[190:191],v216 offset:50176
v_mfma_f32_16x16x32_bf16 v[100:103],v[168:171],v[132:135],v[100:103]
v_subrev_u32 v216,73728,v216
s_lshl_b32 s72,s72,14
v_mfma_f32_16x16x32_bf16 v[104:107],v[168:171],v[136:139],v[104:107]
v_cvt_pk_bf16_f32 v192,v192,v193
v_cvt_pk_bf16_f32 v193,v194,v195
v_mfma_f32_16x16x32_bf16 v[108:111],v[168:171],v[140:143],v[108:111]
v_cvt_pk_bf16_f32 v196,v196,v197
v_cvt_pk_bf16_f32 v197,v198,v199
v_mfma_f32_16x16x32_bf16 v[112:115],v[172:175],v[128:131],v[112:115]
buffer_load_dwordx4 v214,s[12:15],s54 offen offset:1024 lds
v_cvt_pk_bf16_f32 v200,v200,v201
v_mfma_f32_16x16x32_bf16 v[116:119],v[172:175],v[132:135],v[116:119]
v_cvt_pk_bf16_f32 v201,v202,v203
v_cvt_pk_bf16_f32 v204,v204,v205
v_mfma_f32_16x16x32_bf16 v[120:123],v[172:175],v[136:139],v[120:123]
v_cvt_pk_bf16_f32 v205,v206,v207
s_lshl_b32 s88,s45,9
v_mfma_f32_16x16x32_bf16 v[124:127],v[172:175],v[140:143],v[124:127]
s_waitcnt lgkmcnt(0)
ds_read_b64_tr_b16 v[160:161],v215 offset:0
v_mfma_f32_16x16x32_bf16 v[64:67],v[176:179],v[144:147],v[64:67]
ds_read_b64_tr_b16 v[162:163],v215 offset:4096
s_add_u32 s88,s88,160256
v_mfma_f32_16x16x32_bf16 v[68:71],v[176:179],v[148:151],v[68:71]
ds_read_b64_tr_b16 v[164:165],v216 offset:0
s_and_b32 s34,s92,0xffff
v_mfma_f32_16x16x32_bf16 v[72:75],v[176:179],v[152:155],v[72:75]
ds_read_b64_tr_b16 v[166:167],v216 offset:4096
s_mov_b32 s35,0
v_mfma_f32_16x16x32_bf16 v[76:79],v[176:179],v[156:159],v[76:79]
ds_read_b64_tr_b16 v[168:169],v215 offset:1024
v_mul_f32 v64,v208,v64
v_mfma_f32_16x16x32_bf16 v[80:83],v[180:183],v[144:147],v[80:83]
ds_read_b64_tr_b16 v[170:171],v215 offset:5120
v_mul_f32 v65,v208,v65
v_mfma_f32_16x16x32_bf16 v[84:87],v[180:183],v[148:151],v[84:87]
ds_read_b64_tr_b16 v[172:173],v216 offset:1024
v_mul_f32 v66,v208,v66
v_mfma_f32_16x16x32_bf16 v[88:91],v[180:183],v[152:155],v[88:91]
ds_read_b64_tr_b16 v[174:175],v216 offset:5120
v_mul_f32 v67,v208,v67
v_mfma_f32_16x16x32_bf16 v[92:95],v[180:183],v[156:159],v[92:95]
v_exp_f32 v64,v64
v_mfma_f32_16x16x32_bf16 v[96:99],v[184:187],v[144:147],v[96:99]
v_exp_f32 v65,v65
v_mfma_f32_16x16x32_bf16 v[100:103],v[184:187],v[148:151],v[100:103]
v_exp_f32 v66,v66
v_mfma_f32_16x16x32_bf16 v[104:107],v[184:187],v[152:155],v[104:107]
v_exp_f32 v67,v67
v_mfma_f32_16x16x32_bf16 v[108:111],v[184:187],v[156:159],v[108:111]
v_mul_f32 v80,v208,v80
v_mul_f32 v81,v208,v81
v_mfma_f32_16x16x32_bf16 v[112:115],v[188:191],v[144:147],v[112:115]
v_exp_f32 v80,v80
v_mfma_f32_16x16x32_bf16 v[116:119],v[188:191],v[148:151],v[116:119]
v_exp_f32 v81,v81
v_mfma_f32_16x16x32_bf16 v[120:123],v[188:191],v[152:155],v[120:123]
v_mul_f32 v82,v208,v82
v_mul_f32 v83,v208,v83
v_mfma_f32_16x16x32_bf16 v[124:127],v[188:191],v[156:159],v[124:127]
s_waitcnt lgkmcnt(0)
ds_read_b64_tr_b16 v[176:177],v215 offset:8192
v_mfma_f32_16x16x32_bf16 v[0:3],v[160:163],a[0:3],0
ds_read_b64_tr_b16 v[178:179],v215 offset:12288
v_add_f32 v64,1.0,v64
v_mfma_f32_16x16x32_bf16 v[4:7],v[160:163],a[4:7],0
ds_read_b64_tr_b16 v[180:181],v216 offset:8192
v_add_f32 v65,1.0,v65
v_mfma_f32_16x16x32_bf16 v[8:11],v[160:163],a[8:11],0
ds_read_b64_tr_b16 v[182:183],v216 offset:12288
v_add_f32 v66,1.0,v66
v_mfma_f32_16x16x32_bf16 v[12:15],v[160:163],a[12:15],0
ds_read_b64_tr_b16 v[184:185],v215 offset:9216
v_add_f32 v67,1.0,v67
v_mfma_f32_16x16x32_bf16 v[16:19],v[164:167],a[0:3],0
ds_read_b64_tr_b16 v[186:187],v215 offset:13312
v_add_f32 v80,1.0,v80
v_mfma_f32_16x16x32_bf16 v[20:23],v[164:167],a[4:7],0
ds_read_b64_tr_b16 v[188:189],v216 offset:9216
v_add_f32 v81,1.0,v81
v_mfma_f32_16x16x32_bf16 v[24:27],v[164:167],a[8:11],0
ds_read_b64_tr_b16 v[190:191],v216 offset:13312
v_mul_f32 v68,v209,v68
v_mfma_f32_16x16x32_bf16 v[28:31],v[164:167],a[12:15],0
v_exp_f32 v82,v82
v_mfma_f32_16x16x32_bf16 v[32:35],v[168:171],a[0:3],0
s_add_u32 m0,s84,129024
v_add_f32 v82,1.0,v82
v_mfma_f32_16x16x32_bf16 v[36:39],v[168:171],a[4:7],0
v_exp_f32 v83,v83
v_mfma_f32_16x16x32_bf16 v[40:43],v[168:171],a[8:11],0
v_rcp_f32 v64,v64
v_mfma_f32_16x16x32_bf16 v[44:47],v[168:171],a[12:15],0
v_rcp_f32 v65,v65
v_mfma_f32_16x16x32_bf16 v[48:51],v[172:175],a[0:3],0
v_rcp_f32 v66,v66
v_mfma_f32_16x16x32_bf16 v[52:55],v[172:175],a[4:7],0
v_rcp_f32 v67,v67
v_mfma_f32_16x16x32_bf16 v[56:59],v[172:175],a[8:11],0
v_rcp_f32 v80,v80
v_mfma_f32_16x16x32_bf16 v[60:63],v[172:175],a[12:15],0
s_waitcnt lgkmcnt(0)
v_add_f32 v83,1.0,v83
v_mfma_f32_16x16x32_bf16 v[0:3],v[176:179],a[16:19],v[0:3]
s_barrier
v_mfma_f32_16x16x32_bf16 v[4:7],v[176:179],a[20:23],v[4:7]
buffer_load_dwordx4 v213,s[8:11],s55 offen lds
ds_read_b64_tr_b16 v[160:161],v215 offset:18432
v_mfma_f32_16x16x32_bf16 v[8:11],v[176:179],a[24:27],v[8:11]
buffer_load_dwordx4 v213,s[12:15],s55 offen offset:1024 lds
s_add_u32 m0,s84,137216
v_mfma_f32_16x16x32_bf16 v[12:15],v[176:179],a[28:31],v[12:15]
ds_read_b64_tr_b16 v[162:163],v215 offset:22528
v_mul_f32 v64,v64,v96
v_mfma_f32_16x16x32_bf16 v[16:19],v[180:183],a[16:19],v[16:19]
ds_read_b64_tr_b16 v[164:165],v216 offset:18432
v_mul_f32 v65,v65,v97
v_mfma_f32_16x16x32_bf16 v[20:23],v[180:183],a[20:23],v[20:23]
ds_read_b64_tr_b16 v[166:167],v216 offset:22528
v_mul_f32 v66,v66,v98
v_mfma_f32_16x16x32_bf16 v[24:27],v[180:183],a[24:27],v[24:27]
ds_read_b64_tr_b16 v[168:169],v215 offset:19456
v_mul_f32 v67,v67,v99
v_mfma_f32_16x16x32_bf16 v[28:31],v[180:183],a[28:31],v[28:31]
buffer_load_dwordx4 v214,s[8:11],s55 offen lds
ds_read_b64_tr_b16 v[170:171],v215 offset:23552
v_mfma_f32_16x16x32_bf16 v[32:35],v[184:187],a[16:19],v[32:35]
ds_read_b64_tr_b16 v[172:173],v216 offset:19456
v_mul_f32 v80,v80,v112
v_mfma_f32_16x16x32_bf16 v[36:39],v[184:187],a[20:23],v[36:39]
ds_read_b64_tr_b16 v[174:175],v216 offset:23552
v_cvt_pk_bf16_f32 v96,v64,v65
v_mfma_f32_16x16x32_bf16 v[40:43],v[184:187],a[24:27],v[40:43]
v_rcp_f32 v81,v81
v_mfma_f32_16x16x32_bf16 v[44:47],v[184:187],a[28:31],v[44:47]
buffer_load_dwordx4 v214,s[12:15],s55 offen offset:1024 lds
s_add_u32 m0,s84,18432
v_mfma_f32_16x16x32_bf16 v[48:51],v[188:191],a[16:19],v[48:51]
v_rcp_f32 v82,v82
v_mfma_f32_16x16x32_bf16 v[52:55],v[188:191],a[20:23],v[52:55]
v_rcp_f32 v83,v83
v_mfma_f32_16x16x32_bf16 v[56:59],v[188:191],a[24:27],v[56:59]
v_mul_f32 v81,v81,v113
v_mul_f32 v82,v82,v114
v_mfma_f32_16x16x32_bf16 v[60:63],v[188:191],a[28:31],v[60:63]
buffer_load_dwordx4 v213,s[8:11],s56 offen lds
s_waitcnt lgkmcnt(0)
v_mfma_f32_16x16x32_bf16 v[0:3],v[160:163],a[32:35],v[0:3]
ds_read_b64_tr_b16 v[176:177],v215 offset:26624
v_mul_f32 v83,v83,v115
v_mfma_f32_16x16x32_bf16 v[4:7],v[160:163],a[36:39],v[4:7]
ds_read_b64_tr_b16 v[178:179],v215 offset:30720
v_cvt_pk_bf16_f32 v97,v66,v67
v_mfma_f32_16x16x32_bf16 v[8:11],v[160:163],a[40:43],v[8:11]
ds_read_b64_tr_b16 v[180:181],v216 offset:26624
v_cvt_pk_bf16_f32 v98,v80,v81
v_mfma_f32_16x16x32_bf16 v[12:15],v[160:163],a[44:47],v[12:15]
ds_read_b64_tr_b16 v[182:183],v216 offset:30720
v_cvt_pk_bf16_f32 v99,v82,v83
v_mfma_f32_16x16x32_bf16 v[16:19],v[164:167],a[32:35],v[16:19]
buffer_load_dwordx4 v213,s[12:15],s56 offen offset:1024 lds
s_add_u32 m0,s84,26624
v_mfma_f32_16x16x32_bf16 v[20:23],v[164:167],a[36:39],v[20:23]
ds_read_b64_tr_b16 v[184:185],v215 offset:27648
v_mul_f32 v69,v209,v69
v_mfma_f32_16x16x32_bf16 v[24:27],v[164:167],a[40:43],v[24:27]
ds_read_b64_tr_b16 v[186:187],v215 offset:31744
v_mul_f32 v70,v209,v70
v_mfma_f32_16x16x32_bf16 v[28:31],v[164:167],a[44:47],v[28:31]
ds_read_b64_tr_b16 v[188:189],v216 offset:27648
v_mul_f32 v71,v209,v71
v_mfma_f32_16x16x32_bf16 v[32:35],v[168:171],a[32:35],v[32:35]
buffer_load_dwordx4 v214,s[8:11],s56 offen lds
ds_read_b64_tr_b16 v[190:191],v216 offset:31744
v_mfma_f32_16x16x32_bf16 v[36:39],v[168:171],a[36:39],v[36:39]
v_exp_f32 v68,v68
v_mfma_f32_16x16x32_bf16 v[40:43],v[168:171],a[40:43],v[40:43]
v_exp_f32 v69,v69
v_mfma_f32_16x16x32_bf16 v[44:47],v[168:171],a[44:47],v[44:47]
v_exp_f32 v70,v70
v_mfma_f32_16x16x32_bf16 v[48:51],v[172:175],a[32:35],v[48:51]
buffer_load_dwordx4 v214,s[12:15],s56 offen offset:1024 lds
v_mul_f32 v84,v209,v84
v_mfma_f32_16x16x32_bf16 v[52:55],v[172:175],a[36:39],v[52:55]
v_exp_f32 v71,v71
v_mfma_f32_16x16x32_bf16 v[56:59],v[172:175],a[40:43],v[56:59]
v_exp_f32 v84,v84
v_mfma_f32_16x16x32_bf16 v[60:63],v[172:175],a[44:47],v[60:63]
s_waitcnt lgkmcnt(0)
ds_read_b64_tr_b16 v[160:161],v215 offset:36864
v_mfma_f32_16x16x32_bf16 v[0:3],v[176:179],a[48:51],v[0:3]
ds_read_b64_tr_b16 v[162:163],v215 offset:40960
v_mul_f32 v85,v209,v85
v_mfma_f32_16x16x32_bf16 v[4:7],v[176:179],a[52:55],v[4:7]
s_getpc_b64 s[0:1]
L_cp4_5:
v_min_u32 v254,L_stop_5-L_cp4_5,v253
global_load_dword v255,v254,s[0:1]
v_mfma_f32_16x16x32_bf16 v[8:11],v[176:179],a[56:59],v[8:11]
ds_read_b64_tr_b16 v[164:165],v216 offset:36864
v_mul_f32 v86,v209,v86
v_mfma_f32_16x16x32_bf16 v[12:15],v[176:179],a[60:63],v[12:15]
buffer_store_dwordx4 v[96:99],v212,s[24:27],s86 offen sc1
ds_read_b64_tr_b16 v[166:167],v216 offset:40960
v_mfma_f32_16x16x32_bf16 v[16:19],v[180:183],a[48:51],v[16:19]
ds_read_b64_tr_b16 v[168:169],v215 offset:37888
v_mul_f32 v87,v209,v87
v_mfma_f32_16x16x32_bf16 v[20:23],v[180:183],a[52:55],v[20:23]
ds_read_b64_tr_b16 v[170:171],v215 offset:41984
v_add_f32 v68,1.0,v68
v_mfma_f32_16x16x32_bf16 v[24:27],v[180:183],a[56:59],v[24:27]
ds_read_b64_tr_b16 v[172:173],v216 offset:37888
v_add_f32 v69,1.0,v69
v_mfma_f32_16x16x32_bf16 v[28:31],v[180:183],a[60:63],v[28:31]
ds_read_b64_tr_b16 v[174:175],v216 offset:41984
v_add_f32 v70,1.0,v70
v_mfma_f32_16x16x32_bf16 v[32:35],v[184:187],a[48:51],v[32:35]
v_exp_f32 v85,v85
v_mfma_f32_16x16x32_bf16 v[36:39],v[184:187],a[52:55],v[36:39]
v_exp_f32 v86,v86
v_mfma_f32_16x16x32_bf16 v[40:43],v[184:187],a[56:59],v[40:43]
v_exp_f32 v87,v87
v_mfma_f32_16x16x32_bf16 v[44:47],v[184:187],a[60:63],v[44:47]
v_rcp_f32 v68,v68
v_mfma_f32_16x16x32_bf16 v[48:51],v[188:191],a[48:51],v[48:51]
v_rcp_f32 v69,v69
v_mfma_f32_16x16x32_bf16 v[52:55],v[188:191],a[52:55],v[52:55]
v_rcp_f32 v70,v70
v_mfma_f32_16x16x32_bf16 v[56:59],v[188:191],a[56:59],v[56:59]
v_add_f32 v71,1.0,v71
v_add_f32 v84,1.0,v84
v_mfma_f32_16x16x32_bf16 v[60:63],v[188:191],a[60:63],v[60:63]
s_waitcnt lgkmcnt(0)
ds_read_b64_tr_b16 v[176:177],v215 offset:45056
v_mfma_f32_16x16x32_bf16 v[0:3],v[160:163],a[64:67],v[0:3]
ds_read_b64_tr_b16 v[178:179],v215 offset:49152
v_add_f32 v85,1.0,v85
v_mfma_f32_16x16x32_bf16 v[4:7],v[160:163],a[68:71],v[4:7]
ds_read_b64_tr_b16 v[180:181],v216 offset:45056
v_add_f32 v86,1.0,v86
v_mfma_f32_16x16x32_bf16 v[8:11],v[160:163],a[72:75],v[8:11]
ds_read_b64_tr_b16 v[182:183],v216 offset:49152
v_add_f32 v87,1.0,v87
v_mfma_f32_16x16x32_bf16 v[12:15],v[160:163],a[76:79],v[12:15]
ds_read_b64_tr_b16 v[184:185],v215 offset:46080
v_mul_f32 v68,v68,v100
v_mfma_f32_16x16x32_bf16 v[16:19],v[164:167],a[64:67],v[16:19]
ds_read_b64_tr_b16 v[186:187],v215 offset:50176
v_mul_f32 v69,v69,v101
v_mfma_f32_16x16x32_bf16 v[20:23],v[164:167],a[68:71],v[20:23]
ds_read_b64_tr_b16 v[188:189],v216 offset:46080
v_mul_f32 v70,v70,v102
v_mfma_f32_16x16x32_bf16 v[24:27],v[164:167],a[72:75],v[24:27]
ds_read_b64_tr_b16 v[190:191],v216 offset:50176
v_cvt_pk_bf16_f32 v100,v68,v69
v_mfma_f32_16x16x32_bf16 v[28:31],v[164:167],a[76:79],v[28:31]
v_rcp_f32 v71,v71
v_mfma_f32_16x16x32_bf16 v[32:35],v[168:171],a[64:67],v[32:35]
s_add_u32 m0,s84,36864
v_mul_f32 v71,v71,v103
v_mfma_f32_16x16x32_bf16 v[36:39],v[168:171],a[68:71],v[36:39]
s_add_u32 s8,s8,128
s_addc_u32 s9,s9,0
s_sub_u32 s10,s10,128
v_mfma_f32_16x16x32_bf16 v[40:43],v[168:171],a[72:75],v[40:43]
s_add_u32 s12,s12,128
s_addc_u32 s13,s13,0
s_sub_u32 s14,s14,128
v_mfma_f32_16x16x32_bf16 v[44:47],v[168:171],a[76:79],v[44:47]
v_rcp_f32 v84,v84
v_mfma_f32_16x16x32_bf16 v[48:51],v[172:175],a[64:67],v[48:51]
v_rcp_f32 v85,v85
v_mfma_f32_16x16x32_bf16 v[52:55],v[172:175],a[68:71],v[52:55]
v_rcp_f32 v86,v86
v_mfma_f32_16x16x32_bf16 v[56:59],v[172:175],a[72:75],v[56:59]
v_rcp_f32 v87,v87
v_mfma_f32_16x16x32_bf16 v[60:63],v[172:175],a[76:79],v[60:63]
s_waitcnt lgkmcnt(0)
v_mul_f32 v84,v84,v116
v_mfma_f32_16x16x32_bf16 v[0:3],v[176:179],a[80:83],v[0:3]
s_waitcnt vmcnt(19)
s_barrier
v_mfma_f32_16x16x32_bf16 v[4:7],v[176:179],a[84:87],v[4:7]
buffer_load_dwordx4 v213,s[8:11],s48 offen lds
ds_read_b64_tr_b16 v[160:161],v215 offset:55296
v_mfma_f32_16x16x32_bf16 v[8:11],v[176:179],a[88:91],v[8:11]
buffer_load_dwordx4 v213,s[12:15],s48 offen offset:1024 lds
s_add_u32 m0,s84,45056
v_mfma_f32_16x16x32_bf16 v[12:15],v[176:179],a[92:95],v[12:15]
ds_read_b64_tr_b16 v[162:163],v215 offset:59392
s_lshl_b32 s90,s101,5
v_mfma_f32_16x16x32_bf16 v[16:19],v[180:183],a[80:83],v[16:19]
ds_read_b64_tr_b16 v[164:165],v216 offset:55296
s_add_u32 s90,s90,21
v_mfma_f32_16x16x32_bf16 v[20:23],v[180:183],a[84:87],v[20:23]
ds_read_b64_tr_b16 v[166:167],v216 offset:59392
s_lshl_b32 s90,s90,7
v_mfma_f32_16x16x32_bf16 v[24:27],v[180:183],a[88:91],v[24:27]
ds_read_b64_tr_b16 v[168:169],v215 offset:56320
v_and_b32 v227,15,v226
v_mfma_f32_16x16x32_bf16 v[28:31],v[180:183],a[92:95],v[28:31]
buffer_load_dwordx4 v214,s[8:11],s48 offen lds
ds_read_b64_tr_b16 v[170:171],v215 offset:60416
v_mfma_f32_16x16x32_bf16 v[32:35],v[184:187],a[80:83],v[32:35]
v_add_u32 v215,55296,v215
ds_read_b64_tr_b16 v[172:173],v216 offset:56320
v_mfma_f32_16x16x32_bf16 v[36:39],v[184:187],a[84:87],v[36:39]
ds_read_b64_tr_b16 v[174:175],v216 offset:60416
v_add_u32 v216,55296,v216
v_mfma_f32_16x16x32_bf16 v[40:43],v[184:187],a[88:91],v[40:43]
v_mul_u32_u24 v227,4,v227
v_mul_f32 v85,v85,v117
v_mfma_f32_16x16x32_bf16 v[44:47],v[184:187],a[92:95],v[44:47]
buffer_load_dwordx4 v214,s[12:15],s48 offen offset:1024 lds
s_add_u32 m0,s84,55296
v_mfma_f32_16x16x32_bf16 v[48:51],v[188:191],a[80:83],v[48:51]
v_mul_f32 v86,v86,v118
v_mul_f32 v87,v87,v119
v_mfma_f32_16x16x32_bf16 v[52:55],v[188:191],a[84:87],v[52:55]
v_cvt_pk_bf16_f32 v101,v70,v71
v_cvt_pk_bf16_f32 v102,v84,v85
v_mfma_f32_16x16x32_bf16 v[56:59],v[188:191],a[88:91],v[56:59]
v_cvt_pk_bf16_f32 v103,v86,v87
v_mul_f32 v72,v210,v72
v_mfma_f32_16x16x32_bf16 v[60:63],v[188:191],a[92:95],v[60:63]
buffer_store_dwordx4 v[100:103],v212,s[24:27],s86 offen offset:1024 sc1
s_waitcnt lgkmcnt(0)
v_mfma_f32_16x16x32_bf16 v[0:3],v[160:163],a[96:99],v[0:3]
ds_read_b64_tr_b16 v[176:177],v215 offset:8192
v_mul_f32 v73,v210,v73
v_mfma_f32_16x16x32_bf16 v[4:7],v[160:163],a[100:103],v[4:7]
ds_read_b64_tr_b16 v[178:179],v215 offset:12288
v_mul_f32 v74,v210,v74
v_mfma_f32_16x16x32_bf16 v[8:11],v[160:163],a[104:107],v[8:11]
ds_read_b64_tr_b16 v[180:181],v216 offset:8192
v_mul_f32 v75,v210,v75
v_mfma_f32_16x16x32_bf16 v[12:15],v[160:163],a[108:111],v[12:15]
ds_read_b64_tr_b16 v[182:183],v216 offset:12288
v_mul_f32 v88,v210,v88
v_mfma_f32_16x16x32_bf16 v[16:19],v[164:167],a[96:99],v[16:19]
ds_read_b64_tr_b16 v[184:185],v215 offset:9216
v_mul_f32 v89,v210,v89
v_mfma_f32_16x16x32_bf16 v[20:23],v[164:167],a[100:103],v[20:23]
ds_read_b64_tr_b16 v[186:187],v215 offset:13312
v_subrev_u32 v215,73728,v215
v_mfma_f32_16x16x32_bf16 v[24:27],v[164:167],a[104:107],v[24:27]
ds_read_b64_tr_b16 v[188:189],v216 offset:9216
v_mul_f32 v90,v210,v90
v_mfma_f32_16x16x32_bf16 v[28:31],v[164:167],a[108:111],v[28:31]
ds_read_b64_tr_b16 v[190:191],v216 offset:13312
v_subrev_u32 v216,73728,v216
v_mfma_f32_16x16x32_bf16 v[32:35],v[168:171],a[96:99],v[32:35]
v_exp_f32 v72,v72
v_mfma_f32_16x16x32_bf16 v[36:39],v[168:171],a[100:103],v[36:39]
v_exp_f32 v73,v73
v_mfma_f32_16x16x32_bf16 v[40:43],v[168:171],a[104:107],v[40:43]
v_exp_f32 v74,v74
v_mfma_f32_16x16x32_bf16 v[44:47],v[168:171],a[108:111],v[44:47]
buffer_load_dwordx4 v213,s[8:11],s49 offen lds
v_mul_f32 v91,v210,v91
v_mfma_f32_16x16x32_bf16 v[48:51],v[172:175],a[96:99],v[48:51]
v_exp_f32 v75,v75
v_mfma_f32_16x16x32_bf16 v[52:55],v[172:175],a[100:103],v[52:55]
v_exp_f32 v88,v88
v_mfma_f32_16x16x32_bf16 v[56:59],v[172:175],a[104:107],v[56:59]
v_exp_f32 v89,v89
v_mfma_f32_16x16x32_bf16 v[60:63],v[172:175],a[108:111],v[60:63]
buffer_load_dwordx4 v213,s[12:15],s49 offen offset:1024 lds
s_add_u32 m0,s84,63488
s_waitcnt lgkmcnt(0)
v_mfma_f32_16x16x32_bf16 v[0:3],v[176:179],a[112:115],v[0:3]
ds_read_b64_tr_b16 v[160:161],v215 offset:0
buffer_load_dword v247,v227,s[24:27],s90 offen sc1
v_mfma_f32_16x16x32_bf16 v[4:7],v[176:179],a[116:119],v[4:7]
ds_read_b64_tr_b16 v[162:163],v215 offset:4096
v_add_f32 v72,1.0,v72
v_mfma_f32_16x16x32_bf16 v[8:11],v[176:179],a[120:123],v[8:11]
ds_read_b64_tr_b16 v[164:165],v216 offset:0
v_add_f32 v73,1.0,v73
v_mfma_f32_16x16x32_bf16 v[12:15],v[176:179],a[124:127],v[12:15]
buffer_load_dwordx4 v214,s[8:11],s49 offen lds
ds_read_b64_tr_b16 v[166:167],v216 offset:4096
v_mfma_f32_16x16x32_bf16 v[16:19],v[180:183],a[112:115],v[16:19]
ds_read_b64_tr_b16 v[168:169],v215 offset:1024
v_add_f32 v74,1.0,v74
v_mfma_f32_16x16x32_bf16 v[20:23],v[180:183],a[116:119],v[20:23]
ds_read_b64_tr_b16 v[170:171],v215 offset:5120
v_add_f32 v75,1.0,v75
v_mfma_f32_16x16x32_bf16 v[24:27],v[180:183],a[120:123],v[24:27]
ds_read_b64_tr_b16 v[172:173],v216 offset:1024
v_add_f32 v88,1.0,v88
v_mfma_f32_16x16x32_bf16 v[28:31],v[180:183],a[124:127],v[28:31]
ds_read_b64_tr_b16 v[174:175],v216 offset:5120
v_add_f32 v89,1.0,v89
v_mfma_f32_16x16x32_bf16 v[32:35],v[184:187],a[112:115],v[32:35]
buffer_load_dwordx4 v214,s[12:15],s49 offen offset:1024 lds
v_mul_f32 v76,v211,v76
v_mfma_f32_16x16x32_bf16 v[36:39],v[184:187],a[116:119],v[36:39]
v_exp_f32 v90,v90
v_mfma_f32_16x16x32_bf16 v[40:43],v[184:187],a[120:123],v[40:43]
v_exp_f32 v91,v91
v_mfma_f32_16x16x32_bf16 v[44:47],v[184:187],a[124:127],v[44:47]
v_rcp_f32 v72,v72
v_mfma_f32_16x16x32_bf16 v[48:51],v[188:191],a[112:115],v[48:51]
v_rcp_f32 v73,v73
v_mfma_f32_16x16x32_bf16 v[52:55],v[188:191],a[116:119],v[52:55]
v_rcp_f32 v74,v74
v_mfma_f32_16x16x32_bf16 v[56:59],v[188:191],a[120:123],v[56:59]
v_rcp_f32 v75,v75
v_mfma_f32_16x16x32_bf16 v[60:63],v[188:191],a[124:127],v[60:63]
s_waitcnt lgkmcnt(0)
ds_read_b64_tr_b16 v[176:177],v215 offset:8192
v_mfma_f32_16x16x32_bf16 v[0:3],v[160:163],a[128:131],v[0:3]
ds_read_b64_tr_b16 v[178:179],v215 offset:12288
v_add_f32 v90,1.0,v90
v_mfma_f32_16x16x32_bf16 v[4:7],v[160:163],a[132:135],v[4:7]
ds_read_b64_tr_b16 v[180:181],v216 offset:8192
v_add_f32 v91,1.0,v91
v_mfma_f32_16x16x32_bf16 v[8:11],v[160:163],a[136:139],v[8:11]
ds_read_b64_tr_b16 v[182:183],v216 offset:12288
v_mul_f32 v72,v72,v104
v_mfma_f32_16x16x32_bf16 v[12:15],v[160:163],a[140:143],v[12:15]
ds_read_b64_tr_b16 v[184:185],v215 offset:9216
v_mul_f32 v73,v73,v105
v_mfma_f32_16x16x32_bf16 v[16:19],v[164:167],a[128:131],v[16:19]
ds_read_b64_tr_b16 v[186:187],v215 offset:13312
v_add_u32 v215,92160,v215
v_mfma_f32_16x16x32_bf16 v[20:23],v[164:167],a[132:135],v[20:23]
ds_read_b64_tr_b16 v[188:189],v216 offset:9216
v_mul_f32 v74,v74,v106
v_mfma_f32_16x16x32_bf16 v[24:27],v[164:167],a[136:139],v[24:27]
ds_read_b64_tr_b16 v[190:191],v216 offset:13312
v_add_u32 v216,92160,v216
v_mfma_f32_16x16x32_bf16 v[28:31],v[164:167],a[140:143],v[28:31]
v_rcp_f32 v88,v88
v_mfma_f32_16x16x32_bf16 v[32:35],v[168:171],a[128:131],v[32:35]
s_add_u32 m0,s84,73728
v_mul_f32 v75,v75,v107
v_mfma_f32_16x16x32_bf16 v[36:39],v[168:171],a[132:135],v[36:39]
v_rcp_f32 v89,v89
v_mfma_f32_16x16x32_bf16 v[40:43],v[168:171],a[136:139],v[40:43]
v_rcp_f32 v90,v90
v_mfma_f32_16x16x32_bf16 v[44:47],v[168:171],a[140:143],v[44:47]
v_rcp_f32 v91,v91
v_mfma_f32_16x16x32_bf16 v[48:51],v[172:175],a[128:131],v[48:51]
v_mul_f32 v88,v88,v120
v_mul_f32 v89,v89,v121
v_mfma_f32_16x16x32_bf16 v[52:55],v[172:175],a[132:135],v[52:55]
v_mul_f32 v90,v90,v122
v_mul_f32 v91,v91,v123
v_mfma_f32_16x16x32_bf16 v[56:59],v[172:175],a[136:139],v[56:59]
v_cvt_pk_bf16_f32 v104,v72,v73
v_cvt_pk_bf16_f32 v105,v74,v75
v_mfma_f32_16x16x32_bf16 v[60:63],v[172:175],a[140:143],v[60:63]
s_waitcnt lgkmcnt(0)
v_cvt_pk_bf16_f32 v106,v88,v89
v_mfma_f32_16x16x32_bf16 v[0:3],v[176:179],a[144:147],v[0:3]
s_waitcnt vmcnt(20)
s_barrier
v_mfma_f32_16x16x32_bf16 v[4:7],v[176:179],a[148:151],v[4:7]
buffer_load_dwordx4 v213,s[8:11],s50 offen lds
ds_read_b64_tr_b16 v[160:161],v215 offset:0
v_mfma_f32_16x16x32_bf16 v[8:11],v[176:179],a[152:155],v[8:11]
buffer_load_dwordx4 v213,s[12:15],s50 offen offset:1024 lds
s_add_u32 m0,s84,81920
v_mfma_f32_16x16x32_bf16 v[12:15],v[176:179],a[156:159],v[12:15]
ds_read_b64_tr_b16 v[162:163],v215 offset:4096
v_cvt_pk_bf16_f32 v107,v90,v91
v_mfma_f32_16x16x32_bf16 v[16:19],v[180:183],a[144:147],v[16:19]
ds_read_b64_tr_b16 v[164:165],v216 offset:0
v_mul_f32 v77,v211,v77
v_mfma_f32_16x16x32_bf16 v[20:23],v[180:183],a[148:151],v[20:23]
ds_read_b64_tr_b16 v[166:167],v216 offset:4096
v_mul_f32 v78,v211,v78
v_mfma_f32_16x16x32_bf16 v[24:27],v[180:183],a[152:155],v[24:27]
ds_read_b64_tr_b16 v[168:169],v215 offset:1024
v_mul_f32 v79,v211,v79
v_mfma_f32_16x16x32_bf16 v[28:31],v[180:183],a[156:159],v[28:31]
buffer_store_dwordx4 v[104:107],v212,s[24:27],s87 offen sc1
ds_read_b64_tr_b16 v[170:171],v215 offset:5120
v_mfma_f32_16x16x32_bf16 v[32:35],v[184:187],a[144:147],v[32:35]
ds_read_b64_tr_b16 v[172:173],v216 offset:1024
s_waitcnt vmcnt(5)
v_mfma_f32_16x16x32_bf16 v[36:39],v[184:187],a[148:151],v[36:39]
ds_read_b64_tr_b16 v[174:175],v216 offset:5120
v_mul_f32 v92,v211,v92
v_mfma_f32_16x16x32_bf16 v[40:43],v[184:187],a[152:155],v[40:43]
v_cmp_ne_u32 vcc,1,v247
s_cbranch_vccnz L_slow_kv_5
L_back_kv_5:
v_mfma_f32_16x16x32_bf16 v[44:47],v[184:187],a[156:159],v[44:47]
v_exp_f32 v76,v76
v_mfma_f32_16x16x32_bf16 v[48:51],v[188:191],a[144:147],v[48:51]
v_exp_f32 v77,v77
v_mfma_f32_16x16x32_bf16 v[52:55],v[188:191],a[148:151],v[52:55]
v_exp_f32 v78,v78
v_mfma_f32_16x16x32_bf16 v[56:59],v[188:191],a[152:155],v[56:59]
v_exp_f32 v79,v79
v_mfma_f32_16x16x32_bf16 v[60:63],v[188:191],a[156:159],v[60:63]
s_waitcnt lgkmcnt(0)
ds_read_b64_tr_b16 v[176:177],v215 offset:8192
v_mfma_f32_16x16x32_bf16 v[0:3],v[160:163],a[160:163],v[0:3]
ds_read_b64_tr_b16 v[178:179],v215 offset:12288
v_mul_f32 v93,v211,v93
v_mfma_f32_16x16x32_bf16 v[4:7],v[160:163],a[164:167],v[4:7]
ds_read_b64_tr_b16 v[180:181],v216 offset:8192
v_mul_f32 v94,v211,v94
v_mfma_f32_16x16x32_bf16 v[8:11],v[160:163],a[168:171],v[8:11]
buffer_load_dwordx2 v[248:249],v252,s[24:27],s61 offen sc1
ds_read_b64_tr_b16 v[182:183],v216 offset:12288
v_mfma_f32_16x16x32_bf16 v[12:15],v[160:163],a[172:175],v[12:15]
ds_read_b64_tr_b16 v[184:185],v215 offset:9216
v_mul_f32 v95,v211,v95
v_mfma_f32_16x16x32_bf16 v[16:19],v[164:167],a[160:163],v[16:19]
buffer_load_dwordx2 v[250:251],v252,s[24:27],s61 offen offset:128 sc1
ds_read_b64_tr_b16 v[186:187],v215 offset:13312
v_mfma_f32_16x16x32_bf16 v[20:23],v[164:167],a[164:167],v[20:23]
ds_read_b64_tr_b16 v[188:189],v216 offset:9216
v_add_f32 v76,1.0,v76
v_mfma_f32_16x16x32_bf16 v[24:27],v[164:167],a[168:171],v[24:27]
ds_read_b64_tr_b16 v[190:191],v216 offset:13312
v_add_f32 v77,1.0,v77
v_mfma_f32_16x16x32_bf16 v[28:31],v[164:167],a[172:175],v[28:31]
buffer_load_dwordx4 v[96:99],v212,s[24:27],s60 offen sc1
v_add_f32 v78,1.0,v78
v_mfma_f32_16x16x32_bf16 v[32:35],v[168:171],a[160:163],v[32:35]
v_exp_f32 v92,v92
v_mfma_f32_16x16x32_bf16 v[36:39],v[168:171],a[164:167],v[36:39]
v_exp_f32 v93,v93
v_mfma_f32_16x16x32_bf16 v[40:43],v[168:171],a[168:171],v[40:43]
v_exp_f32 v94,v94
v_mfma_f32_16x16x32_bf16 v[44:47],v[168:171],a[172:175],v[44:47]
v_exp_f32 v95,v95
v_mfma_f32_16x16x32_bf16 v[48:51],v[172:175],a[160:163],v[48:51]
buffer_load_dwordx4 v[100:103],v212,s[24:27],s60 offen offset:1024 sc1
v_add_f32 v79,1.0,v79
v_mfma_f32_16x16x32_bf16 v[52:55],v[172:175],a[164:167],v[52:55]
v_rcp_f32 v76,v76
v_mfma_f32_16x16x32_bf16 v[56:59],v[172:175],a[168:171],v[56:59]
v_rcp_f32 v77,v77
v_mfma_f32_16x16x32_bf16 v[60:63],v[172:175],a[172:175],v[60:63]
s_waitcnt lgkmcnt(0)
ds_read_b64_tr_b16 v[160:161],v215 offset:18432
v_mfma_f32_16x16x32_bf16 v[0:3],v[176:179],a[176:179],v[0:3]
ds_read_b64_tr_b16 v[162:163],v215 offset:22528
v_add_f32 v92,1.0,v92
v_mfma_f32_16x16x32_bf16 v[4:7],v[176:179],a[180:183],v[4:7]
buffer_load_dwordx4 v[104:107],v212,s[24:27],s60 offen offset:2048 sc1
ds_read_b64_tr_b16 v[164:165],v216 offset:18432
v_mfma_f32_16x16x32_bf16 v[8:11],v[176:179],a[184:187],v[8:11]
ds_read_b64_tr_b16 v[166:167],v216 offset:22528
v_add_f32 v93,1.0,v93
v_mfma_f32_16x16x32_bf16 v[12:15],v[176:179],a[188:191],v[12:15]
ds_read_b64_tr_b16 v[168:169],v215 offset:19456
v_add_f32 v94,1.0,v94
v_mfma_f32_16x16x32_bf16 v[16:19],v[180:183],a[176:179],v[16:19]
ds_read_b64_tr_b16 v[170:171],v215 offset:23552
v_add_f32 v95,1.0,v95
v_mfma_f32_16x16x32_bf16 v[20:23],v[180:183],a[180:183],v[20:23]
ds_read_b64_tr_b16 v[172:173],v216 offset:19456
v_mul_f32 v76,v76,v108
v_mfma_f32_16x16x32_bf16 v[24:27],v[180:183],a[184:187],v[24:27]
buffer_load_dwordx4 v214,s[8:11],s50 offen lds
ds_read_b64_tr_b16 v[174:175],v216 offset:23552
v_mfma_f32_16x16x32_bf16 v[28:31],v[180:183],a[188:191],v[28:31]
v_rcp_f32 v78,v78
v_mfma_f32_16x16x32_bf16 v[32:35],v[184:187],a[176:179],v[32:35]
v_rcp_f32 v79,v79
v_mfma_f32_16x16x32_bf16 v[36:39],v[184:187],a[180:183],v[36:39]
v_rcp_f32 v92,v92
v_mfma_f32_16x16x32_bf16 v[40:43],v[184:187],a[184:187],v[40:43]
v_rcp_f32 v93,v93
v_mfma_f32_16x16x32_bf16 v[44:47],v[184:187],a[188:191],v[44:47]
buffer_load_dwordx4 v214,s[12:15],s50 offen offset:1024 lds
s_add_u32 m0,s84,0
v_mfma_f32_16x16x32_bf16 v[48:51],v[188:191],a[176:179],v[48:51]
v_rcp_f32 v94,v94
v_mfma_f32_16x16x32_bf16 v[52:55],v[188:191],a[180:183],v[52:55]
v_rcp_f32 v95,v95
v_mfma_f32_16x16x32_bf16 v[56:59],v[188:191],a[184:187],v[56:59]
v_mul_f32 v77,v77,v109
v_mul_f32 v78,v78,v110
v_mfma_f32_16x16x32_bf16 v[60:63],v[188:191],a[188:191],v[60:63]
buffer_load_dwordx4 v213,s[8:11],s51 offen lds
s_waitcnt lgkmcnt(0)
v_mfma_f32_16x16x32_bf16 v[0:3],v[160:163],a[192:195],v[0:3]
ds_read_b64_tr_b16 v[176:177],v215 offset:26624
v_mul_f32 v79,v79,v111
v_mfma_f32_16x16x32_bf16 v[4:7],v[160:163],a[196:199],v[4:7]
ds_read_b64_tr_b16 v[178:179],v215 offset:30720
v_mul_f32 v92,v92,v124
v_mfma_f32_16x16x32_bf16 v[8:11],v[160:163],a[200:203],v[8:11]
ds_read_b64_tr_b16 v[180:181],v216 offset:26624
v_mul_f32 v93,v93,v125
v_mfma_f32_16x16x32_bf16 v[12:15],v[160:163],a[204:207],v[12:15]
buffer_load_dwordx4 v213,s[12:15],s51 offen offset:1024 lds
s_add_u32 m0,s84,8192
v_mfma_f32_16x16x32_bf16 v[16:19],v[164:167],a[192:195],v[16:19]
ds_read_b64_tr_b16 v[182:183],v216 offset:30720
v_mul_f32 v94,v94,v126
v_mfma_f32_16x16x32_bf16 v[20:23],v[164:167],a[196:199],v[20:23]
ds_read_b64_tr_b16 v[184:185],v215 offset:27648
v_mul_f32 v95,v95,v127
v_mfma_f32_16x16x32_bf16 v[24:27],v[164:167],a[200:203],v[24:27]
ds_read_b64_tr_b16 v[186:187],v215 offset:31744
v_cvt_pk_bf16_f32 v108,v76,v77
v_mfma_f32_16x16x32_bf16 v[28:31],v[164:167],a[204:207],v[28:31]
ds_read_b64_tr_b16 v[188:189],v216 offset:27648
v_cvt_pk_bf16_f32 v109,v78,v79
v_mfma_f32_16x16x32_bf16 v[32:35],v[168:171],a[192:195],v[32:35]
buffer_load_dwordx4 v214,s[8:11],s51 offen lds
ds_read_b64_tr_b16 v[190:191],v216 offset:31744
v_mfma_f32_16x16x32_bf16 v[36:39],v[168:171],a[196:199],v[36:39]
v_cvt_pk_bf16_f32 v110,v92,v93
v_cvt_pk_bf16_f32 v111,v94,v95
v_mfma_f32_16x16x32_bf16 v[40:43],v[168:171],a[200:203],v[40:43]
buffer_store_dwordx4 v[108:111],v212,s[24:27],s87 offen offset:1024 sc1
s_add_u32 s86,s86,s85
v_mfma_f32_16x16x32_bf16 v[44:47],v[168:171],a[204:207],v[44:47]
s_add_u32 s87,s87,s85
v_cmp_eq_u32 vcc,0,v246
v_mfma_f32_16x16x32_bf16 v[48:51],v[172:175],a[192:195],v[48:51]
s_nop 0
v_cndmask_b32 v242,0,v241,vcc
v_cmp_eq_u32 vcc,1,v246
v_mfma_f32_16x16x32_bf16 v[52:55],v[172:175],a[196:199],v[52:55]
s_nop 0
v_cndmask_b32 v243,0,v241,vcc
v_and_b32 v246,15,v226
v_mfma_f32_16x16x32_bf16 v[56:59],v[172:175],a[200:203],v[56:59]
v_and_b32 v236,1,v246
v_lshrrev_b32 v246,1,v246
v_mfma_f32_16x16x32_bf16 v[60:63],v[172:175],a[204:207],v[60:63]
s_waitcnt lgkmcnt(0)
v_cmp_eq_u32 vcc,0,v246
v_mfma_f32_16x16x32_bf16 v[0:3],v[176:179],a[208:211],v[0:3]
s_barrier
v_mfma_f32_16x16x32_bf16 v[4:7],v[176:179],a[212:215],v[4:7]
ds_read_b64_tr_b16 v[160:161],v215 offset:36864
v_lshlrev_b32 v236,4,v236
v_mfma_f32_16x16x32_bf16 v[8:11],v[176:179],a[216:219],v[8:11]
ds_read_b64_tr_b16 v[162:163],v215 offset:40960
v_lshlrev_b32 v237,v236,v237
v_mfma_f32_16x16x32_bf16 v[12:15],v[176:179],a[220:223],v[12:15]
ds_read_b64_tr_b16 v[164:165],v216 offset:36864
v_cndmask_b32 v232,0,v237,vcc
v_mfma_f32_16x16x32_bf16 v[16:19],v[180:183],a[208:211],v[16:19]
ds_read_b64_tr_b16 v[166:167],v216 offset:40960
v_cmp_eq_u32 vcc,1,v246
v_mfma_f32_16x16x32_bf16 v[20:23],v[180:183],a[212:215],v[20:23]
ds_read_b64_tr_b16 v[168:169],v215 offset:37888
v_cndmask_b32 v233,0,v237,vcc
v_mfma_f32_16x16x32_bf16 v[24:27],v[180:183],a[216:219],v[24:27]
ds_read_b64_tr_b16 v[170:171],v215 offset:41984
v_mov_b32 v234,v232
v_mfma_f32_16x16x32_bf16 v[28:31],v[180:183],a[220:223],v[28:31]
buffer_load_dwordx4 v[108:111],v212,s[24:27],s60 offen offset:3072 sc1
s_add_u32 s60,s60,4096
v_mfma_f32_16x16x32_bf16 v[32:35],v[184:187],a[208:211],v[32:35]
ds_read_b64_tr_b16 v[172:173],v216 offset:37888
v_mov_b32 v235,v233
v_mfma_f32_16x16x32_bf16 v[36:39],v[184:187],a[212:215],v[36:39]
ds_read_b64_tr_b16 v[174:175],v216 offset:41984
v_mov_b32 v241,0
v_mfma_f32_16x16x32_bf16 v[40:43],v[184:187],a[216:219],v[40:43]
v_add_u32 v246,s65,v212
s_xor_b32 s32,s34,0xffff
v_mfma_f32_16x16x32_bf16 v[44:47],v[184:187],a[220:223],v[44:47]
s_mov_b32 s33,0
s_and_b32 s73,s73,0xff
v_mfma_f32_16x16x32_bf16 v[48:51],v[188:191],a[208:211],v[48:51]
buffer_load_dwordx4 v[112:115],v212,s[24:27],s60 offen sc1
s_lshl_b32 s73,s73,14
v_mfma_f32_16x16x32_bf16 v[52:55],v[188:191],a[212:215],v[52:55]
s_and_b32 s74,s74,0xff
s_lshl_b32 s74,s74,14
v_mfma_f32_16x16x32_bf16 v[56:59],v[188:191],a[216:219],v[56:59]
s_and_b32 s75,s75,0xff
s_lshl_b32 s75,s75,14
v_mfma_f32_16x16x32_bf16 v[60:63],v[188:191],a[220:223],v[60:63]
s_waitcnt lgkmcnt(0)
ds_read_b64_tr_b16 v[176:177],v215 offset:45056
v_mfma_f32_16x16x32_bf16 v[0:3],v[160:163],a[224:227],v[0:3]
ds_read_b64_tr_b16 v[178:179],v215 offset:49152
s_and_b32 s76,s76,0xff
v_mfma_f32_16x16x32_bf16 v[4:7],v[160:163],a[228:231],v[4:7]
ds_read_b64_tr_b16 v[180:181],v216 offset:45056
s_lshl_b32 s76,s76,14
v_mfma_f32_16x16x32_bf16 v[8:11],v[160:163],a[232:235],v[8:11]
buffer_load_dwordx4 v[116:119],v212,s[24:27],s60 offen offset:1024 sc1
ds_read_b64_tr_b16 v[182:183],v216 offset:49152
v_mfma_f32_16x16x32_bf16 v[12:15],v[160:163],a[236:239],v[12:15]
ds_read_b64_tr_b16 v[184:185],v215 offset:46080
s_and_b32 s77,s77,0xff
v_mfma_f32_16x16x32_bf16 v[16:19],v[164:167],a[224:227],v[16:19]
ds_read_b64_tr_b16 v[186:187],v215 offset:50176
v_subrev_u32 v215,73728,v215
v_mfma_f32_16x16x32_bf16 v[20:23],v[164:167],a[228:231],v[20:23]
ds_read_b64_tr_b16 v[188:189],v216 offset:46080
s_lshl_b32 s77,s77,14
v_mfma_f32_16x16x32_bf16 v[24:27],v[164:167],a[232:235],v[24:27]
ds_read_b64_tr_b16 v[190:191],v216 offset:50176
v_subrev_u32 v216,73728,v216
v_mfma_f32_16x16x32_bf16 v[28:31],v[164:167],a[236:239],v[28:31]
buffer_load_dwordx4 v[120:123],v212,s[24:27],s60 offen offset:2048 sc1
s_and_b32 s78,s78,0xff
v_mfma_f32_16x16x32_bf16 v[32:35],v[168:171],a[224:227],v[32:35]
s_lshl_b32 s62,s40,5
s_add_u32 s62,s62,s42
v_mfma_f32_16x16x32_bf16 v[36:39],v[168:171],a[228:231],v[36:39]
s_add_u32 s62,s62,4
s_lshl_b32 s62,s62,5
v_mfma_f32_16x16x32_bf16 v[40:43],v[168:171],a[232:235],v[40:43]
s_add_u32 s62,s62,s43
s_lshl_b32 s62,s62,2
v_mfma_f32_16x16x32_bf16 v[44:47],v[168:171],a[236:239],v[44:47]
s_lshl_b32 s78,s78,14
s_and_b32 s79,s79,0xff
v_mfma_f32_16x16x32_bf16 v[48:51],v[172:175],a[224:227],v[48:51]
buffer_load_dwordx4 v[124:127],v212,s[24:27],s60 offen offset:3072 sc1
s_lshl_b32 s79,s79,14
v_mfma_f32_16x16x32_bf16 v[52:55],v[172:175],a[228:231],v[52:55]
s_and_b32 s80,s80,0xff
s_lshl_b32 s80,s80,14
v_mfma_f32_16x16x32_bf16 v[56:59],v[172:175],a[232:235],v[56:59]
s_and_b32 s81,s81,0xff
s_lshl_b32 s81,s81,14
v_mfma_f32_16x16x32_bf16 v[60:63],v[172:175],a[236:239],v[60:63]
s_waitcnt lgkmcnt(0)
ds_read_b64_tr_b16 v[160:161],v215 offset:0
v_mfma_f32_16x16x32_bf16 v[0:3],v[176:179],a[240:243],v[0:3]
ds_read_b64_tr_b16 v[162:163],v215 offset:4096
s_and_b32 s82,s82,0xff
v_mfma_f32_16x16x32_bf16 v[4:7],v[176:179],a[244:247],v[4:7]
buffer_load_dwordx4 v214,s[12:15],s51 offen offset:1024 lds
s_add_u32 m0,s84,92160
v_mfma_f32_16x16x32_bf16 v[8:11],v[176:179],a[248:251],v[8:11]
ds_read_b64_tr_b16 v[164:165],v216 offset:0
s_lshl_b32 s82,s82,14
v_mfma_f32_16x16x32_bf16 v[12:15],v[176:179],a[252:255],v[12:15]
ds_read_b64_tr_b16 v[166:167],v216 offset:4096
s_and_b32 s83,s83,0xff
v_mfma_f32_16x16x32_bf16 v[16:19],v[180:183],a[240:243],v[16:19]
ds_read_b64_tr_b16 v[168:169],v215 offset:1024
s_lshl_b32 s83,s83,14
v_mfma_f32_16x16x32_bf16 v[20:23],v[180:183],a[244:247],v[20:23]
buffer_load_dwordx4 v213,s[8:11],s52 offen lds
ds_read_b64_tr_b16 v[170:171],v215 offset:5120
v_mfma_f32_16x16x32_bf16 v[24:27],v[180:183],a[248:251],v[24:27]
ds_read_b64_tr_b16 v[172:173],v216 offset:1024
s_add_u32 s58,s44,1
v_mfma_f32_16x16x32_bf16 v[28:31],v[180:183],a[252:255],v[28:31]
ds_read_b64_tr_b16 v[174:175],v216 offset:5120
s_and_b32 s58,s58,7
v_mfma_f32_16x16x32_bf16 v[32:35],v[184:187],a[240:243],v[32:35]
s_mul_i32 s58,s58,82944
s_mul_i32 s65,s47,136
v_mfma_f32_16x16x32_bf16 v[36:39],v[184:187],a[244:247],v[36:39]
s_lshl_b32 s100,s46,4
s_add_u32 s65,s65,s100
v_mfma_f32_16x16x32_bf16 v[40:43],v[184:187],a[248:251],v[40:43]
buffer_load_dwordx4 v213,s[12:15],s52 offen offset:1024 lds
s_add_u32 m0,s84,100352
v_mfma_f32_16x16x32_bf16 v[44:47],v[184:187],a[252:255],v[44:47]
s_add_u32 s60,s44,3
s_and_b32 s60,s60,7
v_mfma_f32_16x16x32_bf16 v[48:51],v[188:191],a[240:243],v[48:51]
s_mul_i32 s60,s60,82944
s_add_u32 s63,s44,6
v_mfma_f32_16x16x32_bf16 v[52:55],v[188:191],a[244:247],v[52:55]
s_and_b32 s63,s63,7
s_mul_i32 s63,s63,82944
v_mfma_f32_16x16x32_bf16 v[56:59],v[188:191],a[248:251],v[56:59]
buffer_load_dwordx4 v214,s[8:11],s52 offen lds
s_add_u32 s65,s65,16
v_mfma_f32_16x16x32_bf16 v[60:63],v[188:191],a[252:255],v[60:63]
s_waitcnt lgkmcnt(0)
ds_read_b64_tr_b16 v[176:177],v215 offset:8192
v_mfma_f32_16x16x32_bf16 v[0:3],v[160:163],v[128:131],v[0:3]
ds_read_b64_tr_b16 v[178:179],v215 offset:12288
s_mul_i32 s65,s65,1152
v_mfma_f32_16x16x32_bf16 v[4:7],v[160:163],v[132:135],v[4:7]
ds_read_b64_tr_b16 v[180:181],v216 offset:8192
v_mfma_f32_16x16x32_bf16 v[8:11],v[160:163],v[136:139],v[8:11]
buffer_load_dwordx4 v214,s[12:15],s52 offen offset:1024 lds
s_add_u32 m0,s84,110592
v_mfma_f32_16x16x32_bf16 v[12:15],v[160:163],v[140:143],v[12:15]
ds_read_b64_tr_b16 v[182:183],v216 offset:12288
v_mfma_f32_16x16x32_bf16 v[16:19],v[164:167],v[128:131],v[16:19]
ds_read_b64_tr_b16 v[184:185],v215 offset:9216
v_mfma_f32_16x16x32_bf16 v[20:23],v[164:167],v[132:135],v[20:23]
ds_read_b64_tr_b16 v[186:187],v215 offset:13312
v_mfma_f32_16x16x32_bf16 v[24:27],v[164:167],v[136:139],v[24:27]
ds_read_b64_tr_b16 v[188:189],v216 offset:9216
v_mfma_f32_16x16x32_bf16 v[28:31],v[164:167],v[140:143],v[28:31]
buffer_load_dwordx4 v213,s[8:11],s53 offen lds
ds_read_b64_tr_b16 v[190:191],v216 offset:13312
v_mfma_f32_16x16x32_bf16 v[32:35],v[168:171],v[128:131],v[32:35]
v_mfma_f32_16x16x32_bf16 v[36:39],v[168:171],v[132:135],v[36:39]
v_mfma_f32_16x16x32_bf16 v[40:43],v[168:171],v[136:139],v[40:43]
v_mfma_f32_16x16x32_bf16 v[44:47],v[168:171],v[140:143],v[44:47]
buffer_load_dwordx4 v213,s[12:15],s53 offen offset:1024 lds
s_add_u32 m0,s84,118784
v_mfma_f32_16x16x32_bf16 v[48:51],v[172:175],v[128:131],v[48:51]
s_lshl_b32 s89,s45,12
s_add_u32 s89,s89,s96
v_mfma_f32_16x16x32_bf16 v[52:55],v[172:175],v[132:135],v[52:55]
v_add_u32 v218,s89,v212
v_mfma_f32_16x16x32_bf16 v[56:59],v[172:175],v[136:139],v[56:59]
v_mfma_f32_16x16x32_bf16 v[60:63],v[172:175],v[140:143],v[60:63]
buffer_load_dwordx4 v214,s[8:11],s53 offen lds
s_waitcnt lgkmcnt(0)
v_mfma_f32_16x16x32_bf16 v[0:3],v[176:179],v[144:147],v[0:3]
s_waitcnt vmcnt(13)
s_barrier
v_mfma_f32_16x16x32_bf16 v[4:7],v[176:179],v[148:151],v[4:7]
buffer_store_dword v225,v224,s[24:27],s62 offen sc1
ds_read_b64_tr_b16 v[160:161],v215 offset:18432
v_mfma_f32_16x16x32_bf16 v[8:11],v[176:179],v[152:155],v[8:11]
ds_read_b64_tr_b16 v[162:163],v215 offset:22528
s_add_u32 s62,s44,5
v_mfma_f32_16x16x32_bf16 v[12:15],v[176:179],v[156:159],v[12:15]
ds_read_b64_tr_b16 v[164:165],v216 offset:18432
v_mul_f32 v0,v208,v0
v_mfma_f32_16x16x32_bf16 v[16:19],v[180:183],v[144:147],v[16:19]
buffer_load_dwordx4 v214,s[12:15],s53 offen offset:1024 lds
s_add_u32 m0,s84,129024
v_mfma_f32_16x16x32_bf16 v[20:23],v[180:183],v[148:151],v[20:23]
ds_read_b64_tr_b16 v[166:167],v216 offset:22528
v_mul_f32 v1,v208,v1
v_mfma_f32_16x16x32_bf16 v[24:27],v[180:183],v[152:155],v[24:27]
ds_read_b64_tr_b16 v[168:169],v215 offset:19456
v_mul_f32 v2,v208,v2
v_mfma_f32_16x16x32_bf16 v[28:31],v[180:183],v[156:159],v[28:31]
ds_read_b64_tr_b16 v[170:171],v215 offset:23552
v_mul_f32 v3,v208,v3
v_mfma_f32_16x16x32_bf16 v[32:35],v[184:187],v[144:147],v[32:35]
buffer_load_dwordx4 v213,s[8:11],s54 offen lds
ds_read_b64_tr_b16 v[172:173],v216 offset:19456
v_mfma_f32_16x16x32_bf16 v[36:39],v[184:187],v[148:151],v[36:39]
ds_read_b64_tr_b16 v[174:175],v216 offset:23552
v_mul_f32 v16,v208,v16
v_mfma_f32_16x16x32_bf16 v[40:43],v[184:187],v[152:155],v[40:43]
v_exp_f32 v0,v0
v_mfma_f32_16x16x32_bf16 v[44:47],v[184:187],v[156:159],v[44:47]
v_exp_f32 v1,v1
v_mfma_f32_16x16x32_bf16 v[48:51],v[188:191],v[144:147],v[48:51]
buffer_load_dwordx4 v213,s[12:15],s54 offen offset:1024 lds
s_add_u32 m0,s84,137216
v_mfma_f32_16x16x32_bf16 v[52:55],v[188:191],v[148:151],v[52:55]
v_exp_f32 v2,v2
v_mfma_f32_16x16x32_bf16 v[56:59],v[188:191],v[152:155],v[56:59]
v_exp_f32 v3,v3
v_mfma_f32_16x16x32_bf16 v[60:63],v[188:191],v[156:159],v[60:63]
s_waitcnt vmcnt(12)
v_mul_f32 v17,v208,v17
v_mfma_f32_16x16x32_bf16 v[236:239],v[232:235],v[248:251],0
v_exp_f32 v16,v16
v_mfma_f32_16x16x32_bf16 v[228:231],v[242:245],v[96:99],0
buffer_load_dwordx4 v214,s[8:11],s54 offen lds
v_mul_f32 v18,v208,v18
v_mfma_f32_16x16x32_bf16 v[232:235],v[240:243],v[96:99],0
s_lshl_b32 s90,s40,5
s_add_u32 s90,s90,s42
v_mfma_f32_16x16x32_bf16 v[228:231],v[242:245],v[100:103],v[228:231]
s_lshl_b32 s90,s90,7
v_and_b32 v227,3,v226
v_mfma_f32_16x16x32_bf16 v[232:235],v[240:243],v[100:103],v[232:235]
v_mul_u32_u24 v227,4,v227
v_mul_f32 v19,v208,v19
v_mfma_f32_16x16x32_bf16 v[228:231],v[242:245],v[104:107],v[228:231]
buffer_load_dwordx4 v214,s[12:15],s54 offen offset:1024 lds
s_add_u32 m0,s84,18432
v_mfma_f32_16x16x32_bf16 v[232:235],v[240:243],v[104:107],v[232:235]
v_exp_f32 v17,v17
v_mfma_f32_16x16x32_bf16 v[228:231],v[242:245],v[108:111],v[228:231]
v_exp_f32 v18,v18
v_mfma_f32_16x16x32_bf16 v[232:235],v[240:243],v[108:111],v[232:235]
v_exp_f32 v19,v19
v_mfma_f32_16x16x32_bf16 v[228:231],v[242:245],v[112:115],v[228:231]
buffer_load_dwordx4 v213,s[8:11],s55 offen lds
v_add_f32 v0,1.0,v0
v_mfma_f32_16x16x32_bf16 v[232:235],v[240:243],v[112:115],v[232:235]
v_rcp_f32 v0,v0
v_mfma_f32_16x16x32_bf16 v[228:231],v[242:245],v[116:119],v[228:231]
v_add_f32 v1,1.0,v1
v_add_f32 v2,1.0,v2
v_mfma_f32_16x16x32_bf16 v[232:235],v[240:243],v[116:119],v[232:235]
v_rcp_f32 v1,v1
v_mfma_f32_16x16x32_bf16 v[228:231],v[242:245],v[120:123],v[228:231]
v_rcp_f32 v2,v2
v_mfma_f32_16x16x32_bf16 v[232:235],v[240:243],v[120:123],v[232:235]
buffer_load_dwordx4 v213,s[12:15],s55 offen offset:1024 lds
s_add_u32 m0,s84,26624
v_mfma_f32_16x16x32_bf16 v[228:231],v[242:245],v[124:127],v[228:231]
v_add_u32 v245,s64,v212
ds_write_b128 v245,v[236:239] offset:2048
v_mfma_f32_16x16x32_bf16 v[232:235],v[240:243],v[124:127],v[232:235]
s_waitcnt lgkmcnt(1)
ds_read_b64_tr_b16 v[176:177],v215 offset:26624
v_mfma_f32_16x16x32_bf16 v[64:67],v[160:163],a[0:3],0
ds_read_b64_tr_b16 v[178:179],v215 offset:30720
v_add_f32 v3,1.0,v3
v_mfma_f32_16x16x32_bf16 v[68:71],v[160:163],a[4:7],0
buffer_load_dwordx4 v214,s[8:11],s55 offen lds
ds_read_b64_tr_b16 v[180:181],v216 offset:26624
v_mfma_f32_16x16x32_bf16 v[72:75],v[160:163],a[8:11],0
ds_read_b64_tr_b16 v[182:183],v216 offset:30720
v_add_f32 v16,1.0,v16
v_mfma_f32_16x16x32_bf16 v[76:79],v[160:163],a[12:15],0
ds_read_b64_tr_b16 v[184:185],v215 offset:27648
v_add_f32 v17,1.0,v17
v_mfma_f32_16x16x32_bf16 v[80:83],v[164:167],a[0:3],0
ds_read_b64_tr_b16 v[186:187],v215 offset:31744
v_add_f32 v18,1.0,v18
v_mfma_f32_16x16x32_bf16 v[84:87],v[164:167],a[4:7],0
ds_read_b64_tr_b16 v[188:189],v216 offset:27648
v_add_f32 v19,1.0,v19
v_mfma_f32_16x16x32_bf16 v[88:91],v[164:167],a[8:11],0
buffer_load_dwordx4 v214,s[12:15],s55 offen offset:1024 lds
ds_read_b64_tr_b16 v[190:191],v216 offset:31744
v_mfma_f32_16x16x32_bf16 v[92:95],v[164:167],a[12:15],0
ds_write_b128 v245,v[228:231] offset:0
v_mul_f32 v0,v0,v32
v_mfma_f32_16x16x32_bf16 v[96:99],v[168:171],a[0:3],0
ds_write_b128 v245,v[232:235] offset:1024
v_mul_f32 v1,v1,v33
v_mfma_f32_16x16x32_bf16 v[100:103],v[168:171],a[4:7],0
v_rcp_f32 v3,v3
v_mfma_f32_16x16x32_bf16 v[104:107],v[168:171],a[8:11],0
v_rcp_f32 v16,v16
v_mfma_f32_16x16x32_bf16 v[108:111],v[168:171],a[12:15],0
v_rcp_f32 v17,v17
v_mfma_f32_16x16x32_bf16 v[112:115],v[172:175],a[0:3],0
v_rcp_f32 v18,v18
v_mfma_f32_16x16x32_bf16 v[116:119],v[172:175],a[4:7],0
v_rcp_f32 v19,v19
v_mfma_f32_16x16x32_bf16 v[120:123],v[172:175],a[8:11],0
v_mul_f32 v2,v2,v34
v_mul_f32 v3,v3,v35
v_mfma_f32_16x16x32_bf16 v[124:127],v[172:175],a[12:15],0
s_waitcnt lgkmcnt(2)
ds_read_b64_tr_b16 v[160:161],v215 offset:36864
v_mfma_f32_16x16x32_bf16 v[64:67],v[176:179],a[16:19],v[64:67]
ds_read_b64_tr_b16 v[162:163],v215 offset:40960
buffer_load_dword v247,v227,s[24:27],s90 offen sc1
v_mfma_f32_16x16x32_bf16 v[68:71],v[176:179],a[20:23],v[68:71]
ds_read_b64_tr_b16 v[164:165],v216 offset:36864
v_mul_f32 v16,v16,v48
v_mfma_f32_16x16x32_bf16 v[72:75],v[176:179],a[24:27],v[72:75]
ds_read_b64_tr_b16 v[166:167],v216 offset:40960
v_mul_f32 v17,v17,v49
v_mfma_f32_16x16x32_bf16 v[76:79],v[176:179],a[28:31],v[76:79]
ds_read_b64_tr_b16 v[168:169],v215 offset:37888
v_mul_f32 v18,v18,v50
v_mfma_f32_16x16x32_bf16 v[80:83],v[180:183],a[16:19],v[80:83]
ds_read_b64_tr_b16 v[170:171],v215 offset:41984
v_mul_f32 v19,v19,v51
v_mfma_f32_16x16x32_bf16 v[84:87],v[180:183],a[20:23],v[84:87]
ds_read_b64_tr_b16 v[172:173],v216 offset:37888
v_cvt_pk_bf16_f32 v32,v0,v1
v_mfma_f32_16x16x32_bf16 v[88:91],v[180:183],a[24:27],v[88:91]
ds_read_b64_tr_b16 v[174:175],v216 offset:41984
v_cvt_pk_bf16_f32 v33,v2,v3
v_mfma_f32_16x16x32_bf16 v[92:95],v[180:183],a[28:31],v[92:95]
v_cvt_pk_bf16_f32 v34,v16,v17
v_cvt_pk_bf16_f32 v35,v18,v19
v_mfma_f32_16x16x32_bf16 v[96:99],v[184:187],a[16:19],v[96:99]
buffer_store_dwordx4 v[32:35],v212,s[24:27],s86 offen sc1
v_mul_f32 v4,v209,v4
v_mfma_f32_16x16x32_bf16 v[100:103],v[184:187],a[20:23],v[100:103]
v_exp_f32 v4,v4
v_mfma_f32_16x16x32_bf16 v[104:107],v[184:187],a[24:27],v[104:107]
v_mul_f32 v5,v209,v5
v_mul_f32 v6,v209,v6
v_mfma_f32_16x16x32_bf16 v[108:111],v[184:187],a[28:31],v[108:111]
v_exp_f32 v5,v5
v_mfma_f32_16x16x32_bf16 v[112:115],v[188:191],a[16:19],v[112:115]
v_exp_f32 v6,v6
v_mfma_f32_16x16x32_bf16 v[116:119],v[188:191],a[20:23],v[116:119]
v_mul_f32 v7,v209,v7
v_mul_f32 v20,v209,v20
v_mfma_f32_16x16x32_bf16 v[120:123],v[188:191],a[24:27],v[120:123]
v_exp_f32 v7,v7
v_mfma_f32_16x16x32_bf16 v[124:127],v[188:191],a[28:31],v[124:127]
s_waitcnt lgkmcnt(0)
ds_read_b64_tr_b16 v[176:177],v215 offset:45056
v_mfma_f32_16x16x32_bf16 v[64:67],v[160:163],a[32:35],v[64:67]
ds_read_b64_tr_b16 v[178:179],v215 offset:49152
v_mul_f32 v21,v209,v21
v_mfma_f32_16x16x32_bf16 v[68:71],v[160:163],a[36:39],v[68:71]
ds_read_b64_tr_b16 v[180:181],v216 offset:45056
v_mul_f32 v22,v209,v22
v_mfma_f32_16x16x32_bf16 v[72:75],v[160:163],a[40:43],v[72:75]
ds_read_b64_tr_b16 v[182:183],v216 offset:49152
v_mul_f32 v23,v209,v23
v_mfma_f32_16x16x32_bf16 v[76:79],v[160:163],a[44:47],v[76:79]
ds_read_b64_tr_b16 v[184:185],v215 offset:46080
v_add_f32 v4,1.0,v4
v_mfma_f32_16x16x32_bf16 v[80:83],v[164:167],a[32:35],v[80:83]
ds_read_b64_tr_b16 v[186:187],v215 offset:50176
v_add_f32 v5,1.0,v5
v_mfma_f32_16x16x32_bf16 v[84:87],v[164:167],a[36:39],v[84:87]
ds_read_b64_tr_b16 v[188:189],v216 offset:46080
v_add_f32 v6,1.0,v6
v_mfma_f32_16x16x32_bf16 v[88:91],v[164:167],a[40:43],v[88:91]
ds_read_b64_tr_b16 v[190:191],v216 offset:50176
v_add_f32 v7,1.0,v7
v_mfma_f32_16x16x32_bf16 v[92:95],v[164:167],a[44:47],v[92:95]
v_exp_f32 v20,v20
v_mfma_f32_16x16x32_bf16 v[96:99],v[168:171],a[32:35],v[96:99]
s_add_u32 m0,s84,36864
s_mul_i32 s98,s66,9
v_mfma_f32_16x16x32_bf16 v[100:103],v[168:171],a[36:39],v[100:103]
s_lshr_b32 s98,s98,1
v_add_f32 v20,1.0,v20
v_mfma_f32_16x16x32_bf16 v[104:107],v[168:171],a[40:43],v[104:107]
v_exp_f32 v21,v21
v_mfma_f32_16x16x32_bf16 v[108:111],v[168:171],a[44:47],v[108:111]
v_exp_f32 v22,v22
v_mfma_f32_16x16x32_bf16 v[112:115],v[172:175],a[32:35],v[112:115]
v_exp_f32 v23,v23
v_mfma_f32_16x16x32_bf16 v[116:119],v[172:175],a[36:39],v[116:119]
v_rcp_f32 v4,v4
v_mfma_f32_16x16x32_bf16 v[120:123],v[172:175],a[40:43],v[120:123]
v_rcp_f32 v5,v5
v_mfma_f32_16x16x32_bf16 v[124:127],v[172:175],a[44:47],v[124:127]
s_getpc_b64 s[0:1]
L_cp5_5:
v_min_u32 v254,L_stop_5-L_cp5_5,v253
global_load_dword v255,v254,s[0:1]
s_waitcnt lgkmcnt(0)
v_mfma_f32_16x16x32_bf16 v[64:67],v[176:179],a[48:51],v[64:67]
s_waitcnt vmcnt(20)
s_barrier
v_mfma_f32_16x16x32_bf16 v[68:71],v[176:179],a[52:55],v[68:71]
buffer_load_dwordx4 v213,s[8:11],s56 offen lds
ds_read_b64_tr_b16 v[160:161],v215 offset:55296
v_mfma_f32_16x16x32_bf16 v[72:75],v[176:179],a[56:59],v[72:75]
buffer_load_dwordx4 v213,s[12:15],s56 offen offset:1024 lds
s_add_u32 m0,s84,45056
v_mfma_f32_16x16x32_bf16 v[76:79],v[176:179],a[60:63],v[76:79]
ds_read_b64_tr_b16 v[162:163],v215 offset:59392
v_add_f32 v21,1.0,v21
v_mfma_f32_16x16x32_bf16 v[80:83],v[180:183],a[48:51],v[80:83]
ds_read_b64_tr_b16 v[164:165],v216 offset:55296
v_add_f32 v22,1.0,v22
v_mfma_f32_16x16x32_bf16 v[84:87],v[180:183],a[52:55],v[84:87]
ds_read_b64_tr_b16 v[166:167],v216 offset:59392
v_add_f32 v23,1.0,v23
v_mfma_f32_16x16x32_bf16 v[88:91],v[180:183],a[56:59],v[88:91]
ds_read_b64_tr_b16 v[168:169],v215 offset:56320
v_mul_f32 v4,v4,v36
v_mfma_f32_16x16x32_bf16 v[92:95],v[180:183],a[60:63],v[92:95]
buffer_load_dwordx4 v214,s[8:11],s56 offen lds
ds_read_b64_tr_b16 v[170:171],v215 offset:60416
v_mfma_f32_16x16x32_bf16 v[96:99],v[184:187],a[48:51],v[96:99]
v_add_u32 v215,55296,v215
ds_read_b64_tr_b16 v[172:173],v216 offset:56320
v_mfma_f32_16x16x32_bf16 v[100:103],v[184:187],a[52:55],v[100:103]
ds_read_b64_tr_b16 v[174:175],v216 offset:60416
v_add_u32 v216,55296,v216
v_mfma_f32_16x16x32_bf16 v[104:107],v[184:187],a[56:59],v[104:107]
s_waitcnt vmcnt(5)
v_mul_f32 v5,v5,v37
v_mfma_f32_16x16x32_bf16 v[108:111],v[184:187],a[60:63],v[108:111]
buffer_load_dwordx4 v214,s[12:15],s56 offen offset:1024 lds
s_add_u32 m0,s84,55296
v_cmp_ne_u32 vcc,1,v247
s_cbranch_vccnz L_slow_ha_5
L_back_ha_5:
v_mfma_f32_16x16x32_bf16 v[112:115],v[188:191],a[48:51],v[112:115]
v_rcp_f32 v6,v6
v_mfma_f32_16x16x32_bf16 v[116:119],v[188:191],a[52:55],v[116:119]
v_rcp_f32 v7,v7
v_mfma_f32_16x16x32_bf16 v[120:123],v[188:191],a[56:59],v[120:123]
v_rcp_f32 v20,v20
v_mfma_f32_16x16x32_bf16 v[124:127],v[188:191],a[60:63],v[124:127]
buffer_load_dwordx4 v219,s[20:23],s98 offen lds
s_waitcnt lgkmcnt(0)
v_mfma_f32_16x16x32_bf16 v[64:67],v[160:163],a[64:67],v[64:67]
ds_read_b64_tr_b16 v[176:177],v215 offset:8192
v_mul_f32 v6,v6,v38
v_mfma_f32_16x16x32_bf16 v[68:71],v[160:163],a[68:71],v[68:71]
ds_read_b64_tr_b16 v[178:179],v215 offset:12288
v_mul_f32 v7,v7,v39
v_mfma_f32_16x16x32_bf16 v[72:75],v[160:163],a[72:75],v[72:75]
ds_read_b64_tr_b16 v[180:181],v216 offset:8192
v_mul_f32 v20,v20,v52
v_mfma_f32_16x16x32_bf16 v[76:79],v[160:163],a[76:79],v[76:79]
buffer_load_dwordx4 v220,s[20:23],s98 offen offset:1024 lds
s_add_u32 m0,s84,63488
v_mfma_f32_16x16x32_bf16 v[80:83],v[164:167],a[64:67],v[80:83]
ds_read_b64_tr_b16 v[182:183],v216 offset:12288
v_cvt_pk_bf16_f32 v36,v4,v5
v_mfma_f32_16x16x32_bf16 v[84:87],v[164:167],a[68:71],v[84:87]
ds_read_b64_tr_b16 v[184:185],v215 offset:9216
v_cvt_pk_bf16_f32 v37,v6,v7
v_mfma_f32_16x16x32_bf16 v[88:91],v[164:167],a[72:75],v[88:91]
ds_read_b64_tr_b16 v[186:187],v215 offset:13312
v_subrev_u32 v215,73728,v215
v_mfma_f32_16x16x32_bf16 v[92:95],v[164:167],a[76:79],v[92:95]
ds_read_b64_tr_b16 v[188:189],v216 offset:9216
v_mul_f32 v8,v210,v8
v_mfma_f32_16x16x32_bf16 v[96:99],v[168:171],a[64:67],v[96:99]
buffer_load_dwordx4 v221,s[20:23],s98 offen lds
ds_read_b64_tr_b16 v[190:191],v216 offset:13312
v_mfma_f32_16x16x32_bf16 v[100:103],v[168:171],a[68:71],v[100:103]
v_subrev_u32 v216,73728,v216
v_mul_f32 v9,v210,v9
v_mfma_f32_16x16x32_bf16 v[104:107],v[168:171],a[72:75],v[104:107]
v_rcp_f32 v21,v21
v_mfma_f32_16x16x32_bf16 v[108:111],v[168:171],a[76:79],v[108:111]
v_rcp_f32 v22,v22
v_mfma_f32_16x16x32_bf16 v[112:115],v[172:175],a[64:67],v[112:115]
buffer_load_dwordx4 v222,s[20:23],s98 offen offset:1024 lds
v_mul_f32 v21,v21,v53
v_mfma_f32_16x16x32_bf16 v[116:119],v[172:175],a[68:71],v[116:119]
v_rcp_f32 v23,v23
v_mfma_f32_16x16x32_bf16 v[120:123],v[172:175],a[72:75],v[120:123]
v_mul_f32 v22,v22,v54
v_mul_f32 v23,v23,v55
v_mfma_f32_16x16x32_bf16 v[124:127],v[172:175],a[76:79],v[124:127]
s_waitcnt lgkmcnt(0)
ds_read_b64_tr_b16 v[160:161],v215 offset:0
v_mfma_f32_16x16x32_bf16 v[64:67],v[176:179],a[80:83],v[64:67]
buffer_load_dwordx4 a[0:3],v218,s[24:27],s66 offen sc1
ds_read_b64_tr_b16 v[162:163],v215 offset:4096
v_mfma_f32_16x16x32_bf16 v[68:71],v[176:179],a[84:87],v[68:71]
ds_read_b64_tr_b16 v[164:165],v216 offset:0
v_cvt_pk_bf16_f32 v38,v20,v21
v_mfma_f32_16x16x32_bf16 v[72:75],v[176:179],a[88:91],v[72:75]
ds_read_b64_tr_b16 v[166:167],v216 offset:4096
v_cvt_pk_bf16_f32 v39,v22,v23
v_mfma_f32_16x16x32_bf16 v[76:79],v[176:179],a[92:95],v[76:79]
ds_read_b64_tr_b16 v[168:169],v215 offset:1024
v_mul_f32 v10,v210,v10
v_mfma_f32_16x16x32_bf16 v[80:83],v[180:183],a[80:83],v[80:83]
ds_read_b64_tr_b16 v[170:171],v215 offset:5120
v_mul_f32 v11,v210,v11
v_mfma_f32_16x16x32_bf16 v[84:87],v[180:183],a[84:87],v[84:87]
buffer_store_dwordx4 v[36:39],v212,s[24:27],s86 offen offset:1024 sc1
ds_read_b64_tr_b16 v[172:173],v216 offset:1024
v_mfma_f32_16x16x32_bf16 v[88:91],v[180:183],a[88:91],v[88:91]
ds_read_b64_tr_b16 v[174:175],v216 offset:5120
v_mul_f32 v24,v210,v24
v_mfma_f32_16x16x32_bf16 v[92:95],v[180:183],a[92:95],v[92:95]
v_exp_f32 v8,v8
v_mfma_f32_16x16x32_bf16 v[96:99],v[184:187],a[80:83],v[96:99]
v_exp_f32 v9,v9
v_mfma_f32_16x16x32_bf16 v[100:103],v[184:187],a[84:87],v[100:103]
v_exp_f32 v10,v10
v_mfma_f32_16x16x32_bf16 v[104:107],v[184:187],a[88:91],v[104:107]
v_exp_f32 v11,v11
v_mfma_f32_16x16x32_bf16 v[108:111],v[184:187],a[92:95],v[108:111]
v_exp_f32 v24,v24
v_mfma_f32_16x16x32_bf16 v[112:115],v[188:191],a[80:83],v[112:115]
v_mul_f32 v25,v210,v25
v_mul_f32 v26,v210,v26
v_mfma_f32_16x16x32_bf16 v[116:119],v[188:191],a[84:87],v[116:119]
v_exp_f32 v25,v25
v_mfma_f32_16x16x32_bf16 v[120:123],v[188:191],a[88:91],v[120:123]
v_exp_f32 v26,v26
v_mfma_f32_16x16x32_bf16 v[124:127],v[188:191],a[92:95],v[124:127]
s_waitcnt lgkmcnt(0)
ds_read_b64_tr_b16 v[176:177],v215 offset:8192
v_mfma_f32_16x16x32_bf16 v[64:67],v[160:163],a[96:99],v[64:67]
buffer_load_dwordx4 a[4:7],v218,s[24:27],s66 offen offset:1024 sc1
ds_read_b64_tr_b16 v[178:179],v215 offset:12288
v_mfma_f32_16x16x32_bf16 v[68:71],v[160:163],a[100:103],v[68:71]
ds_read_b64_tr_b16 v[180:181],v216 offset:8192
v_mul_f32 v27,v210,v27
v_mfma_f32_16x16x32_bf16 v[72:75],v[160:163],a[104:107],v[72:75]
ds_read_b64_tr_b16 v[182:183],v216 offset:12288
v_add_f32 v8,1.0,v8
v_mfma_f32_16x16x32_bf16 v[76:79],v[160:163],a[108:111],v[76:79]
ds_read_b64_tr_b16 v[184:185],v215 offset:9216
v_add_f32 v9,1.0,v9
v_mfma_f32_16x16x32_bf16 v[80:83],v[164:167],a[96:99],v[80:83]
buffer_load_dwordx4 a[8:11],v218,s[24:27],s66 offen offset:2048 sc1
ds_read_b64_tr_b16 v[186:187],v215 offset:13312
v_mfma_f32_16x16x32_bf16 v[84:87],v[164:167],a[100:103],v[84:87]
v_add_u32 v215,92160,v215
ds_read_b64_tr_b16 v[188:189],v216 offset:9216
v_mfma_f32_16x16x32_bf16 v[88:91],v[164:167],a[104:107],v[88:91]
ds_read_b64_tr_b16 v[190:191],v216 offset:13312
v_add_u32 v216,92160,v216
v_mfma_f32_16x16x32_bf16 v[92:95],v[164:167],a[108:111],v[92:95]
v_exp_f32 v27,v27
v_mfma_f32_16x16x32_bf16 v[96:99],v[168:171],a[96:99],v[96:99]
s_add_u32 m0,s84,73728
s_mul_i32 s98,s67,9
v_mfma_f32_16x16x32_bf16 v[100:103],v[168:171],a[100:103],v[100:103]
s_lshr_b32 s98,s98,1
buffer_load_dwordx4 a[12:15],v218,s[24:27],s66 offen offset:3072 sc1
v_mfma_f32_16x16x32_bf16 v[104:107],v[168:171],a[104:107],v[104:107]
v_rcp_f32 v8,v8
v_mfma_f32_16x16x32_bf16 v[108:111],v[168:171],a[108:111],v[108:111]
v_rcp_f32 v9,v9
v_mfma_f32_16x16x32_bf16 v[112:115],v[172:175],a[96:99],v[112:115]
buffer_load_dwordx4 a[16:19],v218,s[24:27],s67 offen sc1
v_add_f32 v10,1.0,v10
v_mfma_f32_16x16x32_bf16 v[116:119],v[172:175],a[100:103],v[116:119]
v_rcp_f32 v10,v10
v_mfma_f32_16x16x32_bf16 v[120:123],v[172:175],a[104:107],v[120:123]
v_add_f32 v11,1.0,v11
v_add_f32 v24,1.0,v24
v_mfma_f32_16x16x32_bf16 v[124:127],v[172:175],a[108:111],v[124:127]
s_waitcnt lgkmcnt(0)
v_add_f32 v25,1.0,v25
v_mfma_f32_16x16x32_bf16 v[64:67],v[176:179],a[112:115],v[64:67]
buffer_load_dwordx4 a[20:23],v218,s[24:27],s67 offen offset:1024 sc1
v_mfma_f32_16x16x32_bf16 v[68:71],v[176:179],a[116:119],v[68:71]
s_barrier
ds_read_b64_tr_b16 v[160:161],v215 offset:0
v_mfma_f32_16x16x32_bf16 v[72:75],v[176:179],a[120:123],v[72:75]
ds_read_b64_tr_b16 v[162:163],v215 offset:4096
s_lshl_b32 s90,s40,5
v_mfma_f32_16x16x32_bf16 v[76:79],v[176:179],a[124:127],v[76:79]
ds_read_b64_tr_b16 v[164:165],v216 offset:0
s_add_u32 s90,s90,s42
v_mfma_f32_16x16x32_bf16 v[80:83],v[180:183],a[112:115],v[80:83]
ds_read_b64_tr_b16 v[166:167],v216 offset:4096
s_add_u32 s90,s90,4
v_mfma_f32_16x16x32_bf16 v[84:87],v[180:183],a[116:119],v[84:87]
buffer_load_dwordx4 v219,s[20:23],s98 offen lds
ds_read_b64_tr_b16 v[168:169],v215 offset:1024
v_mfma_f32_16x16x32_bf16 v[88:91],v[180:183],a[120:123],v[88:91]
ds_read_b64_tr_b16 v[170:171],v215 offset:5120
s_lshl_b32 s90,s90,7
v_mfma_f32_16x16x32_bf16 v[92:95],v[180:183],a[124:127],v[92:95]
ds_read_b64_tr_b16 v[172:173],v216 offset:1024
v_and_b32 v227,3,v226
v_mfma_f32_16x16x32_bf16 v[96:99],v[184:187],a[112:115],v[96:99]
ds_read_b64_tr_b16 v[174:175],v216 offset:5120
v_mul_u32_u24 v227,4,v227
v_mfma_f32_16x16x32_bf16 v[100:103],v[184:187],a[116:119],v[100:103]
buffer_load_dwordx4 v220,s[20:23],s98 offen offset:1024 lds
s_add_u32 m0,s84,81920
v_mfma_f32_16x16x32_bf16 v[104:107],v[184:187],a[120:123],v[104:107]
v_rcp_f32 v11,v11
v_mfma_f32_16x16x32_bf16 v[108:111],v[184:187],a[124:127],v[108:111]
v_rcp_f32 v24,v24
v_mfma_f32_16x16x32_bf16 v[112:115],v[188:191],a[112:115],v[112:115]
v_rcp_f32 v25,v25
v_mfma_f32_16x16x32_bf16 v[116:119],v[188:191],a[116:119],v[116:119]
buffer_load_dwordx4 v221,s[20:23],s98 offen lds
v_add_f32 v26,1.0,v26
v_mfma_f32_16x16x32_bf16 v[120:123],v[188:191],a[120:123],v[120:123]
v_rcp_f32 v26,v26
v_mfma_f32_16x16x32_bf16 v[124:127],v[188:191],a[124:127],v[124:127]
s_waitcnt lgkmcnt(0)
ds_read_b64_tr_b16 v[176:177],v215 offset:8192
v_mfma_f32_16x16x32_bf16 v[64:67],v[160:163],a[128:131],v[64:67]
ds_read_b64_tr_b16 v[178:179],v215 offset:12288
v_add_f32 v27,1.0,v27
v_mfma_f32_16x16x32_bf16 v[68:71],v[160:163],a[132:135],v[68:71]
ds_read_b64_tr_b16 v[180:181],v216 offset:8192
v_mul_f32 v8,v8,v40
v_mfma_f32_16x16x32_bf16 v[72:75],v[160:163],a[136:139],v[72:75]
buffer_load_dwordx4 v222,s[20:23],s98 offen offset:1024 lds
s_add_u32 m0,s84,0
v_mfma_f32_16x16x32_bf16 v[76:79],v[160:163],a[140:143],v[76:79]
s_mul_i32 s98,s68,9
s_lshr_b32 s98,s98,1
v_mfma_f32_16x16x32_bf16 v[80:83],v[164:167],a[128:131],v[80:83]
ds_read_b64_tr_b16 v[182:183],v216 offset:12288
v_mul_f32 v9,v9,v41
v_mfma_f32_16x16x32_bf16 v[84:87],v[164:167],a[132:135],v[84:87]
ds_read_b64_tr_b16 v[184:185],v215 offset:9216
v_mul_f32 v10,v10,v42
v_mfma_f32_16x16x32_bf16 v[88:91],v[164:167],a[136:139],v[88:91]
buffer_load_dwordx4 v219,s[20:23],s98 offen lds
ds_read_b64_tr_b16 v[186:187],v215 offset:13312
v_mfma_f32_16x16x32_bf16 v[92:95],v[164:167],a[140:143],v[92:95]
ds_read_b64_tr_b16 v[188:189],v216 offset:9216
v_mul_f32 v11,v11,v43
v_mfma_f32_16x16x32_bf16 v[96:99],v[168:171],a[128:131],v[96:99]
ds_read_b64_tr_b16 v[190:191],v216 offset:13312
v_mul_f32 v24,v24,v56
v_mfma_f32_16x16x32_bf16 v[100:103],v[168:171],a[132:135],v[100:103]
v_rcp_f32 v27,v27
v_mfma_f32_16x16x32_bf16 v[104:107],v[168:171],a[136:139],v[104:107]
buffer_load_dwordx4 v220,s[20:23],s98 offen offset:1024 lds
s_add_u32 m0,s84,8192
v_mfma_f32_16x16x32_bf16 v[108:111],v[168:171],a[140:143],v[108:111]
v_mul_f32 v25,v25,v57
v_mul_f32 v26,v26,v58
v_mfma_f32_16x16x32_bf16 v[112:115],v[172:175],a[128:131],v[112:115]
v_mul_f32 v27,v27,v59
v_cvt_pk_bf16_f32 v40,v8,v9
v_mfma_f32_16x16x32_bf16 v[116:119],v[172:175],a[132:135],v[116:119]
v_cvt_pk_bf16_f32 v41,v10,v11
v_cvt_pk_bf16_f32 v42,v24,v25
v_mfma_f32_16x16x32_bf16 v[120:123],v[172:175],a[136:139],v[120:123]
v_cvt_pk_bf16_f32 v43,v26,v27
v_mul_f32 v12,v211,v12
v_mfma_f32_16x16x32_bf16 v[124:127],v[172:175],a[140:143],v[124:127]
buffer_store_dwordx4 v[40:43],v212,s[24:27],s87 offen sc1
s_waitcnt lgkmcnt(0)
ds_read_b64_tr_b16 v[160:161],v215 offset:18432
v_mfma_f32_16x16x32_bf16 v[64:67],v[176:179],a[144:147],v[64:67]
ds_read_b64_tr_b16 v[162:163],v215 offset:22528
buffer_load_dword v247,v227,s[24:27],s90 offen sc1
v_mfma_f32_16x16x32_bf16 v[68:71],v[176:179],a[148:151],v[68:71]
ds_read_b64_tr_b16 v[164:165],v216 offset:18432
v_mul_f32 v13,v211,v13
v_mfma_f32_16x16x32_bf16 v[72:75],v[176:179],a[152:155],v[72:75]
ds_read_b64_tr_b16 v[166:167],v216 offset:22528
v_exp_f32 v12,v12
v_mfma_f32_16x16x32_bf16 v[76:79],v[176:179],a[156:159],v[76:79]
ds_read_b64_tr_b16 v[168:169],v215 offset:19456
v_exp_f32 v13,v13
v_mfma_f32_16x16x32_bf16 v[80:83],v[180:183],a[144:147],v[80:83]
ds_read_b64_tr_b16 v[170:171],v215 offset:23552
v_mul_f32 v14,v211,v14
v_mul_f32 v15,v211,v15
v_mfma_f32_16x16x32_bf16 v[84:87],v[180:183],a[148:151],v[84:87]
ds_read_b64_tr_b16 v[172:173],v216 offset:19456
v_mul_f32 v28,v211,v28
v_mfma_f32_16x16x32_bf16 v[88:91],v[180:183],a[152:155],v[88:91]
ds_read_b64_tr_b16 v[174:175],v216 offset:23552
v_mul_f32 v29,v211,v29
v_mfma_f32_16x16x32_bf16 v[92:95],v[180:183],a[156:159],v[92:95]
v_exp_f32 v14,v14
v_mfma_f32_16x16x32_bf16 v[96:99],v[184:187],a[144:147],v[96:99]
v_exp_f32 v15,v15
v_mfma_f32_16x16x32_bf16 v[100:103],v[184:187],a[148:151],v[100:103]
buffer_load_dwordx4 v221,s[20:23],s98 offen lds
v_mul_f32 v30,v211,v30
v_mfma_f32_16x16x32_bf16 v[104:107],v[184:187],a[152:155],v[104:107]
v_exp_f32 v28,v28
v_mfma_f32_16x16x32_bf16 v[108:111],v[184:187],a[156:159],v[108:111]
v_exp_f32 v29,v29
v_mul_f32 v31,v211,v31
v_mfma_f32_16x16x32_bf16 v[112:115],v[188:191],a[144:147],v[112:115]
v_exp_f32 v30,v30
v_mfma_f32_16x16x32_bf16 v[116:119],v[188:191],a[148:151],v[116:119]
v_exp_f32 v31,v31
v_mfma_f32_16x16x32_bf16 v[120:123],v[188:191],a[152:155],v[120:123]
buffer_load_dwordx4 v222,s[20:23],s98 offen offset:1024 lds
v_add_f32 v12,1.0,v12
v_mfma_f32_16x16x32_bf16 v[124:127],v[188:191],a[156:159],v[124:127]
s_waitcnt lgkmcnt(0)
ds_read_b64_tr_b16 v[176:177],v215 offset:26624
v_mfma_f32_16x16x32_bf16 v[64:67],v[160:163],a[160:163],v[64:67]
ds_read_b64_tr_b16 v[178:179],v215 offset:30720
v_add_f32 v13,1.0,v13
v_mfma_f32_16x16x32_bf16 v[68:71],v[160:163],a[164:167],v[68:71]
ds_read_b64_tr_b16 v[180:181],v216 offset:26624
v_add_f32 v14,1.0,v14
v_mfma_f32_16x16x32_bf16 v[72:75],v[160:163],a[168:171],v[72:75]
buffer_load_dwordx4 a[24:27],v218,s[24:27],s67 offen offset:2048 sc1
ds_read_b64_tr_b16 v[182:183],v216 offset:30720
v_add_f32 v15,1.0,v15
v_mfma_f32_16x16x32_bf16 v[76:79],v[160:163],a[172:175],v[76:79]
ds_read_b64_tr_b16 v[184:185],v215 offset:27648
v_rcp_f32 v12,v12
v_mfma_f32_16x16x32_bf16 v[80:83],v[164:167],a[160:163],v[80:83]
ds_read_b64_tr_b16 v[186:187],v215 offset:31744
v_rcp_f32 v13,v13
v_mfma_f32_16x16x32_bf16 v[84:87],v[164:167],a[164:167],v[84:87]
ds_read_b64_tr_b16 v[188:189],v216 offset:27648
v_add_f32 v28,1.0,v28
v_mfma_f32_16x16x32_bf16 v[88:91],v[164:167],a[168:171],v[88:91]
buffer_load_dwordx4 a[28:31],v218,s[24:27],s67 offen offset:3072 sc1
ds_read_b64_tr_b16 v[190:191],v216 offset:31744
v_mfma_f32_16x16x32_bf16 v[92:95],v[164:167],a[172:175],v[92:95]
v_rcp_f32 v14,v14
v_mfma_f32_16x16x32_bf16 v[96:99],v[168:171],a[160:163],v[96:99]
s_add_u32 m0,s84,92160
s_mul_i32 s98,s69,9
v_mfma_f32_16x16x32_bf16 v[100:103],v[168:171],a[164:167],v[100:103]
s_lshr_b32 s98,s98,1
v_add_f32 v29,1.0,v29
v_mfma_f32_16x16x32_bf16 v[104:107],v[168:171],a[168:171],v[104:107]
buffer_load_dwordx4 a[32:35],v218,s[24:27],s68 offen sc1
v_rcp_f32 v15,v15
v_mfma_f32_16x16x32_bf16 v[108:111],v[168:171],a[172:175],v[108:111]
v_rcp_f32 v28,v28
v_add_f32 v30,1.0,v30
v_mfma_f32_16x16x32_bf16 v[112:115],v[172:175],a[160:163],v[112:115]
v_rcp_f32 v29,v29
v_add_f32 v31,1.0,v31
v_mfma_f32_16x16x32_bf16 v[116:119],v[172:175],a[164:167],v[116:119]
buffer_load_dwordx4 a[36:39],v218,s[24:27],s68 offen offset:1024 sc1
v_rcp_f32 v30,v30
v_mfma_f32_16x16x32_bf16 v[120:123],v[172:175],a[168:171],v[120:123]
v_rcp_f32 v31,v31
v_mfma_f32_16x16x32_bf16 v[124:127],v[172:175],a[172:175],v[124:127]
s_waitcnt lgkmcnt(0)
v_mul_f32 v12,v12,v44
v_mfma_f32_16x16x32_bf16 v[64:67],v[176:179],a[176:179],v[64:67]
s_barrier
v_mfma_f32_16x16x32_bf16 v[68:71],v[176:179],a[180:183],v[68:71]
buffer_load_dwordx4 v219,s[20:23],s98 offen lds
ds_read_b64_tr_b16 v[160:161],v215 offset:36864
v_mfma_f32_16x16x32_bf16 v[72:75],v[176:179],a[184:187],v[72:75]
ds_read_b64_tr_b16 v[162:163],v215 offset:40960
v_mul_f32 v13,v13,v45
v_mul_f32 v14,v14,v46
v_mul_f32 v15,v15,v47
v_mul_f32 v28,v28,v60
v_mul_f32 v29,v29,v61
v_mul_f32 v30,v30,v62
v_mul_f32 v31,v31,v63
v_cvt_pk_bf16_f32 v44,v12,v13
v_cvt_pk_bf16_f32 v45,v14,v15
v_cvt_pk_bf16_f32 v46,v28,v29
v_cvt_pk_bf16_f32 v47,v30,v31
buffer_store_dwordx4 v[44:47],v212,s[24:27],s87 offen offset:1024 sc1
v_mfma_f32_16x16x32_bf16 v[76:79],v[176:179],a[188:191],v[76:79]
ds_read_b64_tr_b16 v[164:165],v216 offset:36864
v_and_b32 v244,15,v226
v_mfma_f32_16x16x32_bf16 v[80:83],v[180:183],a[176:179],v[80:83]
ds_read_b64_tr_b16 v[166:167],v216 offset:40960
v_lshl_add_u32 v244,v244,3,s88
v_mfma_f32_16x16x32_bf16 v[84:87],v[180:183],a[180:183],v[84:87]
ds_read_b64_tr_b16 v[168:169],v215 offset:37888
s_mul_i32 s88,s47,-1024
v_mfma_f32_16x16x32_bf16 v[88:91],v[180:183],a[184:187],v[88:91]
ds_read_b64_tr_b16 v[170:171],v215 offset:41984
s_add_u32 s88,s88,512
v_mfma_f32_16x16x32_bf16 v[92:95],v[180:183],a[188:191],v[92:95]
ds_read_b64_tr_b16 v[172:173],v216 offset:37888
s_waitcnt vmcnt(8)
v_mfma_f32_16x16x32_bf16 v[96:99],v[184:187],a[176:179],v[96:99]
ds_read_b64_tr_b16 v[174:175],v216 offset:41984
v_add_u32 v245,s88,v244
v_mfma_f32_16x16x32_bf16 v[100:103],v[184:187],a[180:183],v[100:103]
ds_read_b128 v[248:251],v246 offset:0
s_add_u32 s86,s86,16384
v_mfma_f32_16x16x32_bf16 v[104:107],v[184:187],a[184:187],v[104:107]
v_cmp_ne_u32 vcc,1,v247
s_cbranch_vccnz L_slow_hb_5
L_back_hb_5:
v_mfma_f32_16x16x32_bf16 v[108:111],v[184:187],a[188:191],v[108:111]
ds_read_b64_tr_b16 v[194:195],v244 offset:0
s_add_u32 s87,s87,16384
v_mfma_f32_16x16x32_bf16 v[112:115],v[188:191],a[176:179],v[112:115]
ds_read_b64_tr_b16 v[198:199],v244 offset:128
v_and_b32 v244,15,v226
v_mfma_f32_16x16x32_bf16 v[116:119],v[188:191],a[180:183],v[116:119]
ds_read_b64_tr_b16 v[202:203],v245 offset:0
v_lshlrev_b32 v244,2,v244
v_mfma_f32_16x16x32_bf16 v[120:123],v[188:191],a[184:187],v[120:123]
ds_read_b64_tr_b16 v[206:207],v245 offset:128
v_mov_b32 v245,2147483648
v_mfma_f32_16x16x32_bf16 v[124:127],v[188:191],a[188:191],v[124:127]
buffer_load_dwordx4 v220,s[20:23],s98 offen offset:1024 lds
s_add_u32 m0,s84,100352
s_waitcnt lgkmcnt(5)
v_mfma_f32_16x16x32_bf16 v[64:67],v[160:163],a[192:195],v[64:67]
s_waitcnt lgkmcnt(4)
v_add_f32 v228,v228,v248
v_mfma_f32_16x16x32_bf16 v[68:71],v[160:163],a[196:199],v[68:71]
v_add_f32 v229,v229,v249
v_add_f32 v230,v230,v250
v_mfma_f32_16x16x32_bf16 v[72:75],v[160:163],a[200:203],v[72:75]
v_add_f32 v231,v231,v251
ds_read_b128 v[248:251],v246 offset:1024
v_mfma_f32_16x16x32_bf16 v[76:79],v[160:163],a[204:207],v[76:79]
buffer_load_dwordx4 v221,s[20:23],s98 offen lds
ds_read_b64_tr_b16 v[176:177],v215 offset:45056
v_mfma_f32_16x16x32_bf16 v[80:83],v[164:167],a[192:195],v[80:83]
ds_read_b64_tr_b16 v[178:179],v215 offset:49152
v_cvt_pk_bf16_f32 v240,v228,v229
v_mfma_f32_16x16x32_bf16 v[84:87],v[164:167],a[196:199],v[84:87]
ds_read_b64_tr_b16 v[180:181],v216 offset:45056
v_cvt_pk_bf16_f32 v241,v230,v231
v_mfma_f32_16x16x32_bf16 v[88:91],v[164:167],a[200:203],v[88:91]
ds_read_b64_tr_b16 v[182:183],v216 offset:49152
s_waitcnt lgkmcnt(5)
v_mfma_f32_16x16x32_bf16 v[92:95],v[164:167],a[204:207],v[92:95]
buffer_load_dwordx4 a[40:43],v218,s[24:27],s68 offen offset:2048 sc1
ds_read_b64_tr_b16 v[184:185],v215 offset:46080
s_and_b32 s62,s62,7
v_mfma_f32_16x16x32_bf16 v[96:99],v[168:171],a[192:195],v[96:99]
s_waitcnt lgkmcnt(5)
v_add_f32 v232,v232,v248
v_add_f32 v233,v233,v249
v_add_f32 v234,v234,v250
v_add_f32 v235,v235,v251
ds_read_b128 v[248:251],v246 offset:2048
v_mfma_f32_16x16x32_bf16 v[100:103],v[168:171],a[196:199],v[100:103]
ds_read_b64_tr_b16 v[186:187],v215 offset:50176
v_subrev_u32 v215,73728,v215
v_mfma_f32_16x16x32_bf16 v[104:107],v[168:171],a[200:203],v[104:107]
buffer_load_dwordx4 v222,s[20:23],s98 offen offset:1024 lds
s_add_u32 m0,s84,110592
v_mfma_f32_16x16x32_bf16 v[108:111],v[168:171],a[204:207],v[108:111]
s_mul_i32 s98,s70,9
s_lshr_b32 s98,s98,1
v_mfma_f32_16x16x32_bf16 v[112:115],v[172:175],a[192:195],v[112:115]
ds_read_b64_tr_b16 v[188:189],v216 offset:46080
v_cvt_pk_bf16_f32 v228,v232,v233
v_mfma_f32_16x16x32_bf16 v[116:119],v[172:175],a[196:199],v[116:119]
ds_read_b64_tr_b16 v[190:191],v216 offset:50176
v_subrev_u32 v216,73728,v216
v_mfma_f32_16x16x32_bf16 v[120:123],v[172:175],a[200:203],v[120:123]
s_waitcnt lgkmcnt(3)
v_add_f32 v236,v236,v248
v_add_f32 v237,v237,v249
v_cvt_pk_bf16_f32 v243,v236,v237
v_cndmask_b32 v242,0,v243,s[32:33]
v_cndmask_b32 v243,0,v243,s[34:35]
v_mfma_f32_16x16x32_bf16 v[124:127],v[172:175],a[204:207],v[124:127]
buffer_load_dwordx4 a[44:47],v218,s[24:27],s68 offen offset:3072 sc1
v_add_f32 v238,v238,v250
v_add_f32 v239,v239,v251
v_cvt_pk_bf16_f32 v229,v234,v235
v_cvt_pk_bf16_f32 v231,v238,v239
v_cndmask_b32 v230,0,v231,s[32:33]
v_cndmask_b32 v231,0,v231,s[34:35]
v_mfma_f32_16x16x32_bf16 v[0:3],v[240:243],v[192:195],0
s_lshl_b32 s59,s40,5
s_add_u32 s59,s59,s42
v_mfma_f32_16x16x32_bf16 v[4:7],v[228:231],v[192:195],0
s_add_u32 s59,s59,8
s_lshl_b32 s59,s59,5
v_mfma_f32_16x16x32_bf16 v[8:11],v[240:243],v[196:199],0
s_add_u32 s59,s59,s43
s_lshl_b32 s59,s59,2
v_mfma_f32_16x16x32_bf16 v[12:15],v[228:231],v[196:199],0
buffer_load_dwordx4 v219,s[20:23],s98 offen lds
v_lshrrev_b32 v246,4,v226
v_mfma_f32_16x16x32_bf16 v[16:19],v[240:243],v[200:203],0
v_cmp_eq_u32 vcc,1,v246
v_cndmask_b32 v246,v6,v4,s[92:93]
v_mfma_f32_16x16x32_bf16 v[20:23],v[228:231],v[200:203],0
buffer_load_dwordx4 v220,s[20:23],s98 offen offset:1024 lds
s_add_u32 m0,s84,118784
v_mfma_f32_16x16x32_bf16 v[24:27],v[240:243],v[204:207],0
v_cndmask_b32 v4,v4,v6,s[92:93]
v_add_f32 v6,0x358637bd,v246
v_mfma_f32_16x16x32_bf16 v[28:31],v[228:231],v[204:207],0
s_waitcnt lgkmcnt(0)
ds_read_b64_tr_b16 v[160:161],v215 offset:0
v_mfma_f32_16x16x32_bf16 v[64:67],v[176:179],a[208:211],v[64:67]
ds_read_b64_tr_b16 v[162:163],v215 offset:4096
v_cndmask_b32 v244,v245,v244,vcc
v_mfma_f32_16x16x32_bf16 v[68:71],v[176:179],a[212:215],v[68:71]
ds_read_b64_tr_b16 v[164:165],v216 offset:0
v_cndmask_b32 v5,v5,v7,s[92:93]
v_mfma_f32_16x16x32_bf16 v[72:75],v[176:179],a[216:219],v[72:75]
buffer_load_dwordx4 a[48:51],v218,s[24:27],s69 offen sc1
ds_read_b64_tr_b16 v[166:167],v216 offset:4096
v_mfma_f32_16x16x32_bf16 v[76:79],v[176:179],a[220:223],v[76:79]
ds_read_b64_tr_b16 v[168:169],v215 offset:1024
v_cndmask_b32 v246,v14,v12,s[92:93]
v_mfma_f32_16x16x32_bf16 v[80:83],v[180:183],a[208:211],v[80:83]
ds_read_b64_tr_b16 v[170:171],v215 offset:5120
v_cndmask_b32 v12,v12,v14,s[92:93]
v_mfma_f32_16x16x32_bf16 v[84:87],v[180:183],a[212:215],v[84:87]
ds_read_b64_tr_b16 v[172:173],v216 offset:1024
v_add_f32 v14,0x358637bd,v246
v_mfma_f32_16x16x32_bf16 v[88:91],v[180:183],a[216:219],v[88:91]
buffer_load_dwordx4 v221,s[20:23],s98 offen lds
ds_read_b64_tr_b16 v[174:175],v216 offset:5120
v_mfma_f32_16x16x32_bf16 v[92:95],v[180:183],a[220:223],v[92:95]
v_rcp_f32 v6,v6
v_mfma_f32_16x16x32_bf16 v[96:99],v[184:187],a[208:211],v[96:99]
v_mul_f32 v4,v6,v4
v_mul_f32 v5,v6,v5
v_mfma_f32_16x16x32_bf16 v[100:103],v[184:187],a[212:215],v[100:103]
v_cvt_pk_bf16_f32 v4,v4,v5
v_cndmask_b32 v13,v13,v15,s[92:93]
v_mfma_f32_16x16x32_bf16 v[104:107],v[184:187],a[216:219],v[104:107]
buffer_store_dword v4,v244,s[24:27],s16 offen sc1
v_mul_f32 v0,v6,v0
v_mfma_f32_16x16x32_bf16 v[108:111],v[184:187],a[220:223],v[108:111]
buffer_load_dwordx4 a[52:55],v218,s[24:27],s69 offen offset:1024 sc1
v_mul_f32 v1,v6,v1
v_mfma_f32_16x16x32_bf16 v[112:115],v[188:191],a[208:211],v[112:115]
v_rcp_f32 v14,v14
v_mfma_f32_16x16x32_bf16 v[116:119],v[188:191],a[212:215],v[116:119]
v_mul_f32 v12,v14,v12
v_mul_f32 v13,v14,v13
v_mfma_f32_16x16x32_bf16 v[120:123],v[188:191],a[216:219],v[120:123]
v_cvt_pk_bf16_f32 v12,v12,v13
v_mul_f32 v2,v6,v2
v_mfma_f32_16x16x32_bf16 v[124:127],v[188:191],a[220:223],v[124:127]
buffer_store_dword v12,v244,s[24:27],s16 offen offset:2048 sc1
s_waitcnt lgkmcnt(0)
v_mfma_f32_16x16x32_bf16 v[64:67],v[160:163],a[224:227],v[64:67]
ds_read_b64_tr_b16 v[176:177],v215 offset:8192
v_mul_f32 v3,v6,v3
v_mfma_f32_16x16x32_bf16 v[68:71],v[160:163],a[228:231],v[68:71]
buffer_load_dwordx4 v222,s[20:23],s98 offen offset:1024 lds
ds_read_b64_tr_b16 v[178:179],v215 offset:12288
v_mfma_f32_16x16x32_bf16 v[72:75],v[160:163],a[232:235],v[72:75]
ds_read_b64_tr_b16 v[180:181],v216 offset:8192
v_cvt_pk_bf16_f32 v0,v0,v1
v_mfma_f32_16x16x32_bf16 v[76:79],v[160:163],a[236:239],v[76:79]
ds_read_b64_tr_b16 v[182:183],v216 offset:12288
v_cvt_pk_bf16_f32 v1,v2,v3
v_mfma_f32_16x16x32_bf16 v[80:83],v[164:167],a[224:227],v[80:83]
ds_read_b64_tr_b16 v[184:185],v215 offset:9216
v_mul_f32 v8,v14,v8
v_mfma_f32_16x16x32_bf16 v[84:87],v[164:167],a[228:231],v[84:87]
buffer_load_dwordx4 a[56:59],v218,s[24:27],s69 offen offset:2048 sc1
ds_read_b64_tr_b16 v[186:187],v215 offset:13312
v_mfma_f32_16x16x32_bf16 v[88:91],v[164:167],a[232:235],v[88:91]
ds_read_b64_tr_b16 v[188:189],v216 offset:9216
v_mul_f32 v9,v14,v9
v_mfma_f32_16x16x32_bf16 v[92:95],v[164:167],a[236:239],v[92:95]
s_lshl_b32 s61,s47,6
ds_read_b64_tr_b16 v[190:191],v216 offset:13312
v_mfma_f32_16x16x32_bf16 v[96:99],v[168:171],a[224:227],v[96:99]
s_add_u32 m0,s84,129024
s_mul_i32 s98,s71,9
v_mfma_f32_16x16x32_bf16 v[100:103],v[168:171],a[228:231],v[100:103]
buffer_load_dwordx4 a[60:63],v218,s[24:27],s69 offen offset:3072 sc1
s_lshr_b32 s98,s98,1
v_mfma_f32_16x16x32_bf16 v[104:107],v[168:171],a[232:235],v[104:107]
v_mul_f32 v10,v14,v10
v_mul_f32 v11,v14,v11
v_mfma_f32_16x16x32_bf16 v[108:111],v[168:171],a[236:239],v[108:111]
v_cvt_pk_bf16_f32 v2,v8,v9
v_cvt_pk_bf16_f32 v3,v10,v11
v_mfma_f32_16x16x32_bf16 v[112:115],v[172:175],a[224:227],v[112:115]
v_cndmask_b32 v246,v22,v20,s[92:93]
v_cndmask_b32 v20,v20,v22,s[92:93]
v_mfma_f32_16x16x32_bf16 v[116:119],v[172:175],a[228:231],v[116:119]
buffer_store_dwordx4 v[0:3],v212,s[24:27],s91 offen sc1
v_add_f32 v22,0x358637bd,v246
v_mfma_f32_16x16x32_bf16 v[120:123],v[172:175],a[232:235],v[120:123]
v_rcp_f32 v22,v22
v_mfma_f32_16x16x32_bf16 v[124:127],v[172:175],a[236:239],v[124:127]
s_waitcnt lgkmcnt(0)
v_cndmask_b32 v21,v21,v23,s[92:93]
v_mfma_f32_16x16x32_bf16 v[64:67],v[176:179],a[240:243],v[64:67]
s_waitcnt vmcnt(16)
s_barrier
v_mfma_f32_16x16x32_bf16 v[68:71],v[176:179],a[244:247],v[68:71]
ds_read_b64_tr_b16 v[160:161],v215 offset:18432
buffer_store_dword v225,v224,s[24:27],s59 offen sc1
v_mfma_f32_16x16x32_bf16 v[72:75],v[176:179],a[248:251],v[72:75]
ds_read_b64_tr_b16 v[162:163],v215 offset:22528
v_mul_f32 v20,v22,v20
v_mfma_f32_16x16x32_bf16 v[76:79],v[176:179],a[252:255],v[76:79]
ds_read_b64_tr_b16 v[164:165],v216 offset:18432
v_mul_f32 v21,v22,v21
v_mfma_f32_16x16x32_bf16 v[80:83],v[180:183],a[240:243],v[80:83]
ds_read_b64_tr_b16 v[166:167],v216 offset:22528
v_cvt_pk_bf16_f32 v20,v20,v21
v_mfma_f32_16x16x32_bf16 v[84:87],v[180:183],a[244:247],v[84:87]
ds_read_b64_tr_b16 v[168:169],v215 offset:19456
v_cndmask_b32 v246,v30,v28,s[92:93]
v_mfma_f32_16x16x32_bf16 v[88:91],v[180:183],a[248:251],v[88:91]
ds_read_b64_tr_b16 v[170:171],v215 offset:23552
v_cndmask_b32 v28,v28,v30,s[92:93]
v_mfma_f32_16x16x32_bf16 v[92:95],v[180:183],a[252:255],v[92:95]
ds_read_b64_tr_b16 v[172:173],v216 offset:19456
v_add_f32 v30,0x358637bd,v246
v_mfma_f32_16x16x32_bf16 v[96:99],v[184:187],a[240:243],v[96:99]
ds_read_b64_tr_b16 v[174:175],v216 offset:23552
v_mul_f32 v16,v22,v16
v_mfma_f32_16x16x32_bf16 v[100:103],v[184:187],a[244:247],v[100:103]
buffer_store_dword v20,v244,s[24:27],s57 offen sc1
v_mul_f32 v17,v22,v17
v_mfma_f32_16x16x32_bf16 v[104:107],v[184:187],a[248:251],v[104:107]
buffer_load_dwordx4 v219,s[20:23],s98 offen lds
v_mul_f32 v18,v22,v18
v_mfma_f32_16x16x32_bf16 v[108:111],v[184:187],a[252:255],v[108:111]
v_rcp_f32 v30,v30
v_mfma_f32_16x16x32_bf16 v[112:115],v[188:191],a[240:243],v[112:115]
v_mul_f32 v19,v22,v19
v_cvt_pk_bf16_f32 v16,v16,v17
v_mfma_f32_16x16x32_bf16 v[116:119],v[188:191],a[244:247],v[116:119]
v_cvt_pk_bf16_f32 v17,v18,v19
v_mul_f32 v24,v30,v24
v_mfma_f32_16x16x32_bf16 v[120:123],v[188:191],a[248:251],v[120:123]
buffer_load_dwordx4 a[64:67],v218,s[24:27],s70 offen sc1
v_mul_f32 v25,v30,v25
v_mfma_f32_16x16x32_bf16 v[124:127],v[188:191],a[252:255],v[124:127]
s_waitcnt lgkmcnt(0)
ds_read_b64_tr_b16 v[176:177],v215 offset:26624
v_mfma_f32_16x16x32_bf16 v[64:67],v[160:163],v[128:131],v[64:67]
ds_read_b64_tr_b16 v[178:179],v215 offset:30720
v_mul_f32 v26,v30,v26
v_mfma_f32_16x16x32_bf16 v[68:71],v[160:163],v[132:135],v[68:71]
ds_read_b64_tr_b16 v[180:181],v216 offset:26624
v_mul_f32 v27,v30,v27
v_mfma_f32_16x16x32_bf16 v[72:75],v[160:163],v[136:139],v[72:75]
buffer_load_dwordx4 v220,s[20:23],s98 offen offset:1024 lds
s_add_u32 m0,s84,137216
v_mfma_f32_16x16x32_bf16 v[76:79],v[160:163],v[140:143],v[76:79]
ds_read_b64_tr_b16 v[182:183],v216 offset:30720
v_cvt_pk_bf16_f32 v18,v24,v25
v_mfma_f32_16x16x32_bf16 v[80:83],v[164:167],v[128:131],v[80:83]
ds_read_b64_tr_b16 v[184:185],v215 offset:27648
v_cvt_pk_bf16_f32 v19,v26,v27
v_mfma_f32_16x16x32_bf16 v[84:87],v[164:167],v[132:135],v[84:87]
ds_read_b64_tr_b16 v[186:187],v215 offset:31744
v_xor_b32 v215,s61,v215
v_mfma_f32_16x16x32_bf16 v[88:91],v[164:167],v[136:139],v[88:91]
v_xor_b32 v217,64,v215
ds_read_b64_tr_b16 v[188:189],v216 offset:27648
v_mfma_f32_16x16x32_bf16 v[92:95],v[164:167],v[140:143],v[92:95]
buffer_store_dwordx4 v[16:19],v212,s[24:27],s18 offen sc1
ds_read_b64_tr_b16 v[190:191],v216 offset:31744
v_mfma_f32_16x16x32_bf16 v[96:99],v[168:171],v[128:131],v[96:99]
v_xor_b32 v216,s61,v216
v_xor_b32 v213,64,v216
v_mfma_f32_16x16x32_bf16 v[100:103],v[168:171],v[132:135],v[100:103]
v_cndmask_b32 v29,v29,v31,s[92:93]
v_mul_f32 v28,v30,v28
v_mfma_f32_16x16x32_bf16 v[104:107],v[168:171],v[136:139],v[104:107]
v_mul_f32 v29,v30,v29
v_cvt_pk_bf16_f32 v28,v28,v29
v_mfma_f32_16x16x32_bf16 v[108:111],v[168:171],v[140:143],v[108:111]
s_add_u32 s59,s44,2
s_and_b32 s59,s59,7
v_mfma_f32_16x16x32_bf16 v[112:115],v[172:175],v[128:131],v[112:115]
s_mul_i32 s59,s59,82944
s_add_u32 s61,s44,4
v_mfma_f32_16x16x32_bf16 v[116:119],v[172:175],v[132:135],v[116:119]
s_and_b32 s61,s61,7
s_mul_i32 s61,s61,82944
v_mfma_f32_16x16x32_bf16 v[120:123],v[172:175],v[136:139],v[120:123]
s_mul_i32 s62,s62,82944
s_add_u32 s64,s44,7
v_mfma_f32_16x16x32_bf16 v[124:127],v[172:175],v[140:143],v[124:127]
s_waitcnt lgkmcnt(0)
s_and_b32 s64,s64,7
v_mfma_f32_16x16x32_bf16 v[64:67],v[176:179],v[144:147],v[64:67]
ds_read_b64_tr_b16 v[160:161],v215 offset:36864
s_mul_i32 s64,s64,82944
v_mfma_f32_16x16x32_bf16 v[68:71],v[176:179],v[148:151],v[68:71]
ds_read_b64_tr_b16 v[162:163],v215 offset:40960
v_lshrrev_b32 v248,5,v226
v_mfma_f32_16x16x32_bf16 v[72:75],v[176:179],v[152:155],v[72:75]
buffer_store_dword v28,v244,s[24:27],s57 offen offset:2048 sc1
ds_read_b64_tr_b16 v[164:165],v216 offset:36864
v_mfma_f32_16x16x32_bf16 v[76:79],v[176:179],v[156:159],v[76:79]
buffer_load_dwordx4 a[68:71],v218,s[24:27],s70 offen offset:1024 sc1
ds_read_b64_tr_b16 v[166:167],v216 offset:40960
v_mfma_f32_16x16x32_bf16 v[80:83],v[180:183],v[144:147],v[80:83]
ds_read_b64_tr_b16 v[168:169],v217 offset:36864
v_mul_f32 v64,v208,v64
v_mfma_f32_16x16x32_bf16 v[84:87],v[180:183],v[148:151],v[84:87]
ds_read_b64_tr_b16 v[170:171],v217 offset:40960
v_mul_f32 v65,v208,v65
v_mfma_f32_16x16x32_bf16 v[88:91],v[180:183],v[152:155],v[88:91]
ds_read_b64_tr_b16 v[172:173],v213 offset:36864
v_mul_f32 v66,v208,v66
v_mfma_f32_16x16x32_bf16 v[92:95],v[180:183],v[156:159],v[92:95]
buffer_load_dwordx4 v221,s[20:23],s98 offen lds
ds_read_b64_tr_b16 v[174:175],v213 offset:40960
v_mfma_f32_16x16x32_bf16 v[96:99],v[184:187],v[144:147],v[96:99]
v_exp_f32 v64,v64
v_mfma_f32_16x16x32_bf16 v[100:103],v[184:187],v[148:151],v[100:103]
v_exp_f32 v65,v65
v_mfma_f32_16x16x32_bf16 v[104:107],v[184:187],v[152:155],v[104:107]
v_exp_f32 v66,v66
v_mfma_f32_16x16x32_bf16 v[108:111],v[184:187],v[156:159],v[108:111]
v_mul_f32 v67,v208,v67
v_exp_f32 v67,v67
v_mfma_f32_16x16x32_bf16 v[112:115],v[188:191],v[144:147],v[112:115]
buffer_load_dwordx4 a[72:75],v218,s[24:27],s70 offen offset:2048 sc1
v_mul_f32 v80,v208,v80
v_mul_f32 v81,v208,v81
v_mfma_f32_16x16x32_bf16 v[116:119],v[188:191],v[148:151],v[116:119]
v_exp_f32 v80,v80
v_mul_f32 v82,v208,v82
v_mfma_f32_16x16x32_bf16 v[120:123],v[188:191],v[152:155],v[120:123]
v_exp_f32 v81,v81
v_mul_f32 v83,v208,v83
v_mfma_f32_16x16x32_bf16 v[124:127],v[188:191],v[156:159],v[124:127]
s_getpc_b64 s[0:1]
L_cp6_5:
v_min_u32 v254,L_stop_5-L_cp6_5,v253
global_load_dword v255,v254,s[0:1]
s_waitcnt lgkmcnt(0)
v_mfma_f32_16x16x32_bf16 v[0:3],v[160:163],a[0:3],0
ds_read_b64_tr_b16 v[176:177],v215 offset:37888
ds_read_b64_tr_b16 v[178:179],v215 offset:41984
ds_read_b64_tr_b16 v[180:181],v216 offset:37888
v_mfma_f32_16x16x32_bf16 v[4:7],v[160:163],a[4:7],0
buffer_load_dwordx4 v222,s[20:23],s98 offen offset:1024 lds
s_add_u32 m0,s84,18432
s_mul_i32 s98,s72,9
v_mfma_f32_16x16x32_bf16 v[8:11],v[164:167],a[0:3],0
s_lshr_b32 s98,s98,1
ds_read_b64_tr_b16 v[182:183],v216 offset:41984
ds_read_b64_tr_b16 v[184:185],v217 offset:37888
v_mfma_f32_16x16x32_bf16 v[12:15],v[164:167],a[4:7],0
ds_read_b64_tr_b16 v[186:187],v217 offset:41984
ds_read_b64_tr_b16 v[188:189],v213 offset:37888
ds_read_b64_tr_b16 v[190:191],v213 offset:41984
v_mfma_f32_16x16x32_bf16 v[16:19],v[168:171],a[0:3],0
ds_read_b64_tr_b16 v[160:161],v215 offset:45056
ds_read_b64_tr_b16 v[162:163],v215 offset:49152
v_add_f32 v64,1.0,v64
v_mfma_f32_16x16x32_bf16 v[20:23],v[168:171],a[4:7],0
buffer_load_dwordx4 a[76:79],v218,s[24:27],s70 offen offset:3072 sc1
ds_read_b64_tr_b16 v[164:165],v216 offset:45056
ds_read_b64_tr_b16 v[166:167],v216 offset:49152
v_mfma_f32_16x16x32_bf16 v[24:27],v[172:175],a[0:3],0
v_exp_f32 v82,v82
v_add_f32 v65,1.0,v65
v_mfma_f32_16x16x32_bf16 v[28:31],v[172:175],a[4:7],0
ds_read_b64_tr_b16 v[168:169],v217 offset:45056
ds_read_b64_tr_b16 v[170:171],v217 offset:49152
s_waitcnt lgkmcnt(6)
v_mfma_f32_16x16x32_bf16 v[32:35],v[176:179],a[0:3],0
buffer_load_dwordx4 v219,s[20:23],s98 offen lds
v_exp_f32 v83,v83
v_mfma_f32_16x16x32_bf16 v[36:39],v[176:179],a[4:7],0
ds_read_b64_tr_b16 v[172:173],v213 offset:45056
ds_read_b64_tr_b16 v[174:175],v213 offset:49152
v_add_f32 v66,1.0,v66
v_mfma_f32_16x16x32_bf16 v[40:43],v[180:183],a[0:3],0
v_rcp_f32 v64,v64
v_add_f32 v67,1.0,v67
v_mfma_f32_16x16x32_bf16 v[44:47],v[180:183],a[4:7],0
ds_read_b64_tr_b16 v[176:177],v215 offset:46080
ds_read_b64_tr_b16 v[178:179],v215 offset:50176
v_add_f32 v80,1.0,v80
v_mfma_f32_16x16x32_bf16 v[48:51],v[184:187],a[0:3],0
buffer_load_dwordx4 v220,s[20:23],s98 offen offset:1024 lds
s_add_u32 m0,s84,26624
v_add_f32 v81,1.0,v81
v_mfma_f32_16x16x32_bf16 v[52:55],v[184:187],a[4:7],0
ds_read_b64_tr_b16 v[180:181],v216 offset:46080
ds_read_b64_tr_b16 v[182:183],v216 offset:50176
v_rcp_f32 v65,v65
v_mfma_f32_16x16x32_bf16 v[56:59],v[188:191],a[0:3],0
v_rcp_f32 v66,v66
v_rcp_f32 v67,v67
v_mfma_f32_16x16x32_bf16 v[60:63],v[188:191],a[4:7],0
buffer_load_dwordx4 a[80:83],v218,s[24:27],s71 offen sc1
ds_read_b64_tr_b16 v[184:185],v217 offset:46080
ds_read_b64_tr_b16 v[186:187],v217 offset:50176
s_waitcnt lgkmcnt(6)
v_mfma_f32_16x16x32_bf16 v[0:3],v[160:163],a[8:11],v[0:3]
v_rcp_f32 v80,v80
v_rcp_f32 v81,v81
v_mfma_f32_16x16x32_bf16 v[4:7],v[160:163],a[12:15],v[4:7]
ds_read_b64_tr_b16 v[188:189],v213 offset:46080
ds_read_b64_tr_b16 v[190:191],v213 offset:50176
v_add_f32 v82,1.0,v82
v_mfma_f32_16x16x32_bf16 v[8:11],v[164:167],a[8:11],v[8:11]
v_rcp_f32 v82,v82
v_add_f32 v83,1.0,v83
v_mfma_f32_16x16x32_bf16 v[12:15],v[164:167],a[12:15],v[12:15]
buffer_load_dwordx4 v221,s[20:23],s98 offen lds
s_barrier
v_mfma_f32_16x16x32_bf16 v[16:19],v[168:171],a[8:11],v[16:19]
ds_read_b64_tr_b16 v[160:161],v215 offset:55296
ds_read_b64_tr_b16 v[162:163],v215 offset:59392
v_mul_f32 v64,v64,v96
v_mfma_f32_16x16x32_bf16 v[20:23],v[168:171],a[12:15],v[20:23]
ds_read_b64_tr_b16 v[164:165],v216 offset:55296
ds_read_b64_tr_b16 v[166:167],v216 offset:59392
v_mul_f32 v65,v65,v97
v_mfma_f32_16x16x32_bf16 v[24:27],v[172:175],a[8:11],v[24:27]
buffer_load_dwordx4 a[84:87],v218,s[24:27],s71 offen offset:1024 sc1
v_rcp_f32 v83,v83
v_mfma_f32_16x16x32_bf16 v[28:31],v[172:175],a[12:15],v[28:31]
ds_read_b64_tr_b16 v[168:169],v217 offset:55296
ds_read_b64_tr_b16 v[170:171],v217 offset:59392
s_waitcnt lgkmcnt(6)
v_mfma_f32_16x16x32_bf16 v[32:35],v[176:179],a[8:11],v[32:35]
v_mul_f32 v66,v66,v98
v_mul_f32 v67,v67,v99
v_mul_f32 v80,v80,v112
v_mfma_f32_16x16x32_bf16 v[36:39],v[176:179],a[12:15],v[36:39]
ds_read_b64_tr_b16 v[172:173],v213 offset:55296
ds_read_b64_tr_b16 v[174:175],v213 offset:59392
v_mul_f32 v81,v81,v113
v_mfma_f32_16x16x32_bf16 v[40:43],v[180:183],a[8:11],v[40:43]
buffer_load_dwordx4 v222,s[20:23],s98 offen offset:1024 lds
s_add_u32 m0,s84,36864
s_mul_i32 s98,s73,9
v_mfma_f32_16x16x32_bf16 v[44:47],v[180:183],a[12:15],v[44:47]
s_lshr_b32 s98,s98,1
ds_read_b64_tr_b16 v[176:177],v215 offset:56320
ds_read_b64_tr_b16 v[178:179],v215 offset:60416
v_mfma_f32_16x16x32_bf16 v[48:51],v[184:187],a[8:11],v[48:51]
v_mul_f32 v82,v82,v114
v_mul_f32 v83,v83,v115
v_cvt_pk_bf16_f32 v96,v64,v65
v_mfma_f32_16x16x32_bf16 v[52:55],v[184:187],a[12:15],v[52:55]
ds_read_b64_tr_b16 v[180:181],v216 offset:56320
ds_read_b64_tr_b16 v[182:183],v216 offset:60416
v_cvt_pk_bf16_f32 v97,v66,v67
v_mfma_f32_16x16x32_bf16 v[56:59],v[188:191],a[8:11],v[56:59]
buffer_load_dwordx4 a[88:91],v218,s[24:27],s71 offen offset:2048 sc1
v_cvt_pk_bf16_f32 v98,v80,v81
v_cvt_pk_bf16_f32 v99,v82,v83
v_mfma_f32_16x16x32_bf16 v[60:63],v[188:191],a[12:15],v[60:63]
ds_read_b64_tr_b16 v[184:185],v217 offset:56320
ds_read_b64_tr_b16 v[186:187],v217 offset:60416
s_waitcnt lgkmcnt(6)
v_mfma_f32_16x16x32_bf16 v[0:3],v[160:163],a[16:19],v[0:3]
v_mul_f32 v68,v209,v68
v_exp_f32 v68,v68
v_mfma_f32_16x16x32_bf16 v[4:7],v[160:163],a[20:23],v[4:7]
buffer_load_dwordx4 a[92:95],v218,s[24:27],s71 offen offset:3072 sc1
ds_read_b64_tr_b16 v[188:189],v213 offset:56320
ds_read_b64_tr_b16 v[190:191],v213 offset:60416
v_mfma_f32_16x16x32_bf16 v[8:11],v[164:167],a[16:19],v[8:11]
v_mul_f32 v69,v209,v69
v_exp_f32 v69,v69
v_mfma_f32_16x16x32_bf16 v[12:15],v[164:167],a[20:23],v[12:15]
v_add_u32 v215,55296,v215
ds_read_b64_tr_b16 v[160:161],v215 offset:8192
ds_read_b64_tr_b16 v[162:163],v215 offset:12288
v_mfma_f32_16x16x32_bf16 v[16:19],v[168:171],a[16:19],v[16:19]
v_mul_f32 v70,v209,v70
v_exp_f32 v70,v70
v_mfma_f32_16x16x32_bf16 v[20:23],v[168:171],a[20:23],v[20:23]
buffer_store_dwordx4 v[96:99],v212,s[24:27],s86 offen sc1
v_add_u32 v216,55296,v216
ds_read_b64_tr_b16 v[164:165],v216 offset:8192
v_mfma_f32_16x16x32_bf16 v[24:27],v[172:175],a[16:19],v[24:27]
ds_read_b64_tr_b16 v[166:167],v216 offset:12288
v_mul_f32 v71,v209,v71
v_mul_f32 v84,v209,v84
v_mfma_f32_16x16x32_bf16 v[28:31],v[172:175],a[20:23],v[28:31]
v_add_u32 v217,55296,v217
ds_read_b64_tr_b16 v[168:169],v217 offset:8192
ds_read_b64_tr_b16 v[170:171],v217 offset:12288
s_waitcnt lgkmcnt(6)
v_mfma_f32_16x16x32_bf16 v[32:35],v[176:179],a[16:19],v[32:35]
v_exp_f32 v71,v71
v_mul_f32 v85,v209,v85
v_mfma_f32_16x16x32_bf16 v[36:39],v[176:179],a[20:23],v[36:39]
v_add_u32 v213,55296,v213
ds_read_b64_tr_b16 v[172:173],v213 offset:8192
ds_read_b64_tr_b16 v[174:175],v213 offset:12288
v_mfma_f32_16x16x32_bf16 v[40:43],v[180:183],a[16:19],v[40:43]
v_exp_f32 v84,v84
v_mul_f32 v86,v209,v86
v_mfma_f32_16x16x32_bf16 v[44:47],v[180:183],a[20:23],v[44:47]
ds_read_b64_tr_b16 v[176:177],v215 offset:9216
ds_read_b64_tr_b16 v[178:179],v215 offset:13312
s_lshl_b32 s91,s40,5
v_mfma_f32_16x16x32_bf16 v[48:51],v[184:187],a[16:19],v[48:51]
s_add_u32 s91,s91,20
s_lshl_b32 s91,s91,5
s_add_u32 s91,s91,s41
v_mfma_f32_16x16x32_bf16 v[52:55],v[184:187],a[20:23],v[52:55]
ds_read_b64_tr_b16 v[180:181],v216 offset:9216
ds_read_b64_tr_b16 v[182:183],v216 offset:13312
s_lshl_b32 s91,s91,2
v_mfma_f32_16x16x32_bf16 v[56:59],v[188:191],a[16:19],v[56:59]
v_exp_f32 v85,v85
v_mul_f32 v87,v209,v87
v_mfma_f32_16x16x32_bf16 v[60:63],v[188:191],a[20:23],v[60:63]
buffer_load_dwordx4 v219,s[20:23],s98 offen lds
ds_read_b64_tr_b16 v[184:185],v217 offset:9216
ds_read_b64_tr_b16 v[186:187],v217 offset:13312
s_waitcnt lgkmcnt(6)
v_mfma_f32_16x16x32_bf16 v[0:3],v[160:163],a[24:27],v[0:3]
v_exp_f32 v86,v86
v_add_f32 v68,1.0,v68
v_mfma_f32_16x16x32_bf16 v[4:7],v[160:163],a[28:31],v[4:7]
ds_read_b64_tr_b16 v[188:189],v213 offset:9216
ds_read_b64_tr_b16 v[190:191],v213 offset:13312
v_add_f32 v69,1.0,v69
v_mfma_f32_16x16x32_bf16 v[8:11],v[164:167],a[24:27],v[8:11]
buffer_load_dwordx4 a[96:99],v218,s[24:27],s72 offen sc1
v_exp_f32 v87,v87
v_mfma_f32_16x16x32_bf16 v[12:15],v[164:167],a[28:31],v[12:15]
v_subrev_u32 v215,73728,v215
ds_read_b64_tr_b16 v[160:161],v215 offset:0
ds_read_b64_tr_b16 v[162:163],v215 offset:4096
v_mfma_f32_16x16x32_bf16 v[16:19],v[168:171],a[24:27],v[16:19]
v_rcp_f32 v68,v68
v_add_f32 v70,1.0,v70
v_mfma_f32_16x16x32_bf16 v[20:23],v[168:171],a[28:31],v[20:23]
v_subrev_u32 v216,73728,v216
ds_read_b64_tr_b16 v[164:165],v216 offset:0
ds_read_b64_tr_b16 v[166:167],v216 offset:4096
v_mfma_f32_16x16x32_bf16 v[24:27],v[172:175],a[24:27],v[24:27]
buffer_load_dwordx4 v220,s[20:23],s98 offen offset:1024 lds
s_add_u32 m0,s84,45056
v_add_f32 v71,1.0,v71
v_mfma_f32_16x16x32_bf16 v[28:31],v[172:175],a[28:31],v[28:31]
v_subrev_u32 v217,73728,v217
ds_read_b64_tr_b16 v[168:169],v217 offset:0
ds_read_b64_tr_b16 v[170:171],v217 offset:4096
s_waitcnt lgkmcnt(6)
v_mfma_f32_16x16x32_bf16 v[32:35],v[176:179],a[24:27],v[32:35]
v_rcp_f32 v69,v69
v_add_f32 v84,1.0,v84
v_mfma_f32_16x16x32_bf16 v[36:39],v[176:179],a[28:31],v[36:39]
buffer_load_dwordx4 a[100:103],v218,s[24:27],s72 offen offset:1024 sc1
v_subrev_u32 v213,73728,v213
ds_read_b64_tr_b16 v[172:173],v213 offset:0
v_mfma_f32_16x16x32_bf16 v[40:43],v[180:183],a[24:27],v[40:43]
ds_read_b64_tr_b16 v[174:175],v213 offset:4096
v_rcp_f32 v70,v70
v_mfma_f32_16x16x32_bf16 v[44:47],v[180:183],a[28:31],v[44:47]
ds_read_b64_tr_b16 v[176:177],v215 offset:1024
ds_read_b64_tr_b16 v[178:179],v215 offset:5120
v_add_f32 v85,1.0,v85
v_mfma_f32_16x16x32_bf16 v[48:51],v[184:187],a[24:27],v[48:51]
v_rcp_f32 v71,v71
v_add_f32 v86,1.0,v86
v_mfma_f32_16x16x32_bf16 v[52:55],v[184:187],a[28:31],v[52:55]
buffer_load_dwordx4 v221,s[20:23],s98 offen lds
ds_read_b64_tr_b16 v[180:181],v216 offset:1024
ds_read_b64_tr_b16 v[182:183],v216 offset:5120
v_mfma_f32_16x16x32_bf16 v[56:59],v[188:191],a[24:27],v[56:59]
v_rcp_f32 v84,v84
v_add_f32 v87,1.0,v87
v_mfma_f32_16x16x32_bf16 v[60:63],v[188:191],a[28:31],v[60:63]
ds_read_b64_tr_b16 v[184:185],v217 offset:1024
ds_read_b64_tr_b16 v[186:187],v217 offset:5120
s_waitcnt lgkmcnt(6)
s_waitcnt vmcnt(38)
v_mfma_f32_16x16x32_bf16 v[0:3],v[160:163],a[32:35],v[0:3]
v_rcp_f32 v85,v85
v_mul_f32 v68,v68,v100
v_mfma_f32_16x16x32_bf16 v[4:7],v[160:163],a[36:39],v[4:7]
buffer_load_dwordx4 a[104:107],v218,s[24:27],s72 offen offset:2048 sc1
ds_read_b64_tr_b16 v[188:189],v213 offset:1024
ds_read_b64_tr_b16 v[190:191],v213 offset:5120
v_mfma_f32_16x16x32_bf16 v[8:11],v[164:167],a[32:35],v[8:11]
v_rcp_f32 v86,v86
v_mul_f32 v69,v69,v101
v_mfma_f32_16x16x32_bf16 v[12:15],v[164:167],a[36:39],v[12:15]
ds_read_b64_tr_b16 v[160:161],v215 offset:8192
ds_read_b64_tr_b16 v[162:163],v215 offset:12288
v_mul_f32 v70,v70,v102
v_mfma_f32_16x16x32_bf16 v[16:19],v[168:171],a[32:35],v[16:19]
buffer_load_dwordx4 v222,s[20:23],s98 offen offset:1024 lds
v_rcp_f32 v87,v87
v_mfma_f32_16x16x32_bf16 v[20:23],v[168:171],a[36:39],v[20:23]
ds_read_b64_tr_b16 v[164:165],v216 offset:8192
ds_read_b64_tr_b16 v[166:167],v216 offset:12288
v_mul_f32 v71,v71,v103
v_mfma_f32_16x16x32_bf16 v[24:27],v[172:175],a[32:35],v[24:27]
v_mul_f32 v84,v84,v116
v_mul_f32 v85,v85,v117
v_mul_f32 v86,v86,v118
v_mfma_f32_16x16x32_bf16 v[28:31],v[172:175],a[36:39],v[28:31]
ds_read_b64_tr_b16 v[168:169],v217 offset:8192
ds_read_b64_tr_b16 v[170:171],v217 offset:12288
s_waitcnt lgkmcnt(6)
v_mfma_f32_16x16x32_bf16 v[32:35],v[176:179],a[32:35],v[32:35]
buffer_load_dwordx4 a[108:111],v218,s[24:27],s72 offen offset:3072 sc1
v_mul_f32 v87,v87,v119
v_cvt_pk_bf16_f32 v100,v68,v69
v_mfma_f32_16x16x32_bf16 v[36:39],v[176:179],a[36:39],v[36:39]
ds_read_b64_tr_b16 v[172:173],v213 offset:8192
ds_read_b64_tr_b16 v[174:175],v213 offset:12288
v_cvt_pk_bf16_f32 v101,v70,v71
v_mfma_f32_16x16x32_bf16 v[40:43],v[180:183],a[32:35],v[40:43]
v_cvt_pk_bf16_f32 v102,v84,v85
v_cvt_pk_bf16_f32 v103,v86,v87
v_mul_f32 v72,v210,v72
v_mfma_f32_16x16x32_bf16 v[44:47],v[180:183],a[36:39],v[44:47]
s_add_u32 m0,s84,55296
s_mul_i32 s98,s74,9
s_lshr_b32 s98,s98,1
v_mfma_f32_16x16x32_bf16 v[48:51],v[184:187],a[32:35],v[48:51]
buffer_store_dwordx4 v[100:103],v212,s[24:27],s86 offen offset:1024 sc1
ds_read_b64_tr_b16 v[176:177],v215 offset:9216
ds_read_b64_tr_b16 v[178:179],v215 offset:13312
v_mfma_f32_16x16x32_bf16 v[52:55],v[184:187],a[36:39],v[52:55]
ds_read_b64_tr_b16 v[180:181],v216 offset:9216
ds_read_b64_tr_b16 v[182:183],v216 offset:13312
v_exp_f32 v72,v72
v_mfma_f32_16x16x32_bf16 v[56:59],v[188:191],a[32:35],v[56:59]
v_mul_f32 v73,v210,v73
v_exp_f32 v73,v73
v_mul_f32 v74,v210,v74
v_mfma_f32_16x16x32_bf16 v[60:63],v[188:191],a[36:39],v[60:63]
ds_read_b64_tr_b16 v[184:185],v217 offset:9216
ds_read_b64_tr_b16 v[186:187],v217 offset:13312
s_waitcnt lgkmcnt(6)
v_mfma_f32_16x16x32_bf16 v[0:3],v[160:163],a[40:43],v[0:3]
v_exp_f32 v74,v74
v_mul_f32 v75,v210,v75
v_mfma_f32_16x16x32_bf16 v[4:7],v[160:163],a[44:47],v[4:7]
ds_read_b64_tr_b16 v[188:189],v213 offset:9216
ds_read_b64_tr_b16 v[190:191],v213 offset:13312
v_mul_f32 v88,v210,v88
v_mfma_f32_16x16x32_bf16 v[8:11],v[164:167],a[40:43],v[8:11]
v_exp_f32 v75,v75
v_mul_f32 v89,v210,v89
v_mfma_f32_16x16x32_bf16 v[12:15],v[164:167],a[44:47],v[12:15]
v_add_u32 v215,92160,v215
s_waitcnt vmcnt(24)
s_barrier
v_mfma_f32_16x16x32_bf16 v[16:19],v[168:171],a[40:43],v[16:19]
ds_read_b64_tr_b16 v[160:161],v215 offset:0
ds_read_b64_tr_b16 v[162:163],v215 offset:4096
buffer_store_dword v225,v224,s[24:27],s91 offen sc1
v_mfma_f32_16x16x32_bf16 v[20:23],v[168:171],a[44:47],v[20:23]
buffer_load_dwordx4 v219,s[20:23],s98 offen lds
v_add_u32 v216,92160,v216
ds_read_b64_tr_b16 v[164:165],v216 offset:0
v_mfma_f32_16x16x32_bf16 v[24:27],v[172:175],a[40:43],v[24:27]
ds_read_b64_tr_b16 v[166:167],v216 offset:4096
v_exp_f32 v88,v88
v_mfma_f32_16x16x32_bf16 v[28:31],v[172:175],a[44:47],v[28:31]
v_add_u32 v217,92160,v217
ds_read_b64_tr_b16 v[168:169],v217 offset:0
ds_read_b64_tr_b16 v[170:171],v217 offset:4096
s_waitcnt lgkmcnt(6)
v_mfma_f32_16x16x32_bf16 v[32:35],v[176:179],a[40:43],v[32:35]
v_exp_f32 v89,v89
v_mul_f32 v90,v210,v90
v_mfma_f32_16x16x32_bf16 v[36:39],v[176:179],a[44:47],v[36:39]
buffer_load_dwordx4 v220,s[20:23],s98 offen offset:1024 lds
s_add_u32 m0,s84,63488
v_add_u32 v213,92160,v213
v_mfma_f32_16x16x32_bf16 v[40:43],v[180:183],a[40:43],v[40:43]
ds_read_b64_tr_b16 v[172:173],v213 offset:0
ds_read_b64_tr_b16 v[174:175],v213 offset:4096
v_mul_f32 v91,v210,v91
v_mfma_f32_16x16x32_bf16 v[44:47],v[180:183],a[44:47],v[44:47]
ds_read_b64_tr_b16 v[176:177],v215 offset:1024
ds_read_b64_tr_b16 v[178:179],v215 offset:5120
v_add_f32 v72,1.0,v72
v_mfma_f32_16x16x32_bf16 v[48:51],v[184:187],a[40:43],v[48:51]
v_exp_f32 v90,v90
v_add_f32 v73,1.0,v73
v_mfma_f32_16x16x32_bf16 v[52:55],v[184:187],a[44:47],v[52:55]
buffer_load_dwordx4 a[112:115],v218,s[24:27],s73 offen sc1
ds_read_b64_tr_b16 v[180:181],v216 offset:1024
ds_read_b64_tr_b16 v[182:183],v216 offset:5120
v_mfma_f32_16x16x32_bf16 v[56:59],v[188:191],a[40:43],v[56:59]
v_exp_f32 v91,v91
v_add_f32 v74,1.0,v74
v_mfma_f32_16x16x32_bf16 v[60:63],v[188:191],a[44:47],v[60:63]
ds_read_b64_tr_b16 v[184:185],v217 offset:1024
ds_read_b64_tr_b16 v[186:187],v217 offset:5120
s_waitcnt lgkmcnt(6)
v_mfma_f32_16x16x32_bf16 v[0:3],v[160:163],a[48:51],v[0:3]
buffer_load_dwordx4 v221,s[20:23],s98 offen lds
v_rcp_f32 v72,v72
v_mfma_f32_16x16x32_bf16 v[4:7],v[160:163],a[52:55],v[4:7]
ds_read_b64_tr_b16 v[188:189],v213 offset:1024
ds_read_b64_tr_b16 v[190:191],v213 offset:5120
v_add_f32 v75,1.0,v75
v_mfma_f32_16x16x32_bf16 v[8:11],v[164:167],a[48:51],v[8:11]
v_rcp_f32 v73,v73
v_add_f32 v88,1.0,v88
v_mfma_f32_16x16x32_bf16 v[12:15],v[164:167],a[52:55],v[12:15]
ds_read_b64_tr_b16 v[160:161],v215 offset:8192
ds_read_b64_tr_b16 v[162:163],v215 offset:12288
v_add_f32 v89,1.0,v89
v_mfma_f32_16x16x32_bf16 v[16:19],v[168:171],a[48:51],v[16:19]
buffer_load_dwordx4 a[116:119],v218,s[24:27],s73 offen offset:1024 sc1
v_rcp_f32 v74,v74
v_mfma_f32_16x16x32_bf16 v[20:23],v[168:171],a[52:55],v[20:23]
ds_read_b64_tr_b16 v[164:165],v216 offset:8192
ds_read_b64_tr_b16 v[166:167],v216 offset:12288
v_add_f32 v90,1.0,v90
v_mfma_f32_16x16x32_bf16 v[24:27],v[172:175],a[48:51],v[24:27]
v_rcp_f32 v75,v75
v_add_f32 v91,1.0,v91
v_mfma_f32_16x16x32_bf16 v[28:31],v[172:175],a[52:55],v[28:31]
buffer_load_dwordx4 v222,s[20:23],s98 offen offset:1024 lds
s_add_u32 m0,s84,73728
s_mul_i32 s98,s75,9
s_waitcnt lgkmcnt(4)
v_mfma_f32_16x16x32_bf16 v[32:35],v[176:179],a[48:51],v[32:35]
s_lshr_b32 s98,s98,1
ds_read_b64_tr_b16 v[168:169],v217 offset:8192
ds_read_b64_tr_b16 v[170:171],v217 offset:12288
v_mfma_f32_16x16x32_bf16 v[36:39],v[176:179],a[52:55],v[36:39]
ds_read_b64_tr_b16 v[172:173],v213 offset:8192
ds_read_b64_tr_b16 v[174:175],v213 offset:12288
v_mul_f32 v72,v72,v104
v_mfma_f32_16x16x32_bf16 v[40:43],v[180:183],a[48:51],v[40:43]
v_rcp_f32 v88,v88
v_mul_f32 v73,v73,v105
v_mfma_f32_16x16x32_bf16 v[44:47],v[180:183],a[52:55],v[44:47]
buffer_load_dwordx4 a[120:123],v218,s[24:27],s73 offen offset:2048 sc1
ds_read_b64_tr_b16 v[176:177],v215 offset:9216
ds_read_b64_tr_b16 v[178:179],v215 offset:13312
v_mfma_f32_16x16x32_bf16 v[48:51],v[184:187],a[48:51],v[48:51]
v_rcp_f32 v89,v89
v_rcp_f32 v90,v90
v_mfma_f32_16x16x32_bf16 v[52:55],v[184:187],a[52:55],v[52:55]
ds_read_b64_tr_b16 v[180:181],v216 offset:9216
ds_read_b64_tr_b16 v[182:183],v216 offset:13312
v_rcp_f32 v91,v91
v_mfma_f32_16x16x32_bf16 v[56:59],v[188:191],a[48:51],v[56:59]
buffer_load_dwordx4 a[124:127],v218,s[24:27],s73 offen offset:3072 sc1
v_mul_f32 v74,v74,v106
v_mul_f32 v75,v75,v107
v_mul_f32 v88,v88,v120
v_mfma_f32_16x16x32_bf16 v[60:63],v[188:191],a[52:55],v[60:63]
ds_read_b64_tr_b16 v[184:185],v217 offset:9216
ds_read_b64_tr_b16 v[186:187],v217 offset:13312
s_waitcnt lgkmcnt(6)
v_mul_f32 v89,v89,v121
v_mfma_f32_16x16x32_bf16 v[0:3],v[160:163],a[56:59],v[0:3]
v_mul_f32 v90,v90,v122
v_mul_f32 v91,v91,v123
v_cvt_pk_bf16_f32 v104,v72,v73
v_mfma_f32_16x16x32_bf16 v[4:7],v[160:163],a[60:63],v[4:7]
buffer_load_dwordx4 v219,s[20:23],s98 offen lds
ds_read_b64_tr_b16 v[188:189],v213 offset:9216
ds_read_b64_tr_b16 v[190:191],v213 offset:13312
v_mfma_f32_16x16x32_bf16 v[8:11],v[164:167],a[56:59],v[8:11]
v_cvt_pk_bf16_f32 v105,v74,v75
v_cvt_pk_bf16_f32 v106,v88,v89
v_cvt_pk_bf16_f32 v107,v90,v91
v_mfma_f32_16x16x32_bf16 v[12:15],v[164:167],a[60:63],v[12:15]
ds_read_b64_tr_b16 v[160:161],v215 offset:18432
ds_read_b64_tr_b16 v[162:163],v215 offset:22528
v_mul_f32 v76,v211,v76
v_mfma_f32_16x16x32_bf16 v[16:19],v[168:171],a[56:59],v[16:19]
v_exp_f32 v76,v76
v_mul_f32 v77,v211,v77
v_mfma_f32_16x16x32_bf16 v[20:23],v[168:171],a[60:63],v[20:23]
buffer_store_dwordx4 v[104:107],v212,s[24:27],s87 offen sc1
ds_read_b64_tr_b16 v[164:165],v216 offset:18432
ds_read_b64_tr_b16 v[166:167],v216 offset:22528
v_mfma_f32_16x16x32_bf16 v[24:27],v[172:175],a[56:59],v[24:27]
v_exp_f32 v77,v77
v_mul_f32 v78,v211,v78
v_mfma_f32_16x16x32_bf16 v[28:31],v[172:175],a[60:63],v[28:31]
ds_read_b64_tr_b16 v[168:169],v217 offset:18432
ds_read_b64_tr_b16 v[170:171],v217 offset:22528
s_waitcnt lgkmcnt(6)
v_mfma_f32_16x16x32_bf16 v[32:35],v[176:179],a[56:59],v[32:35]
v_exp_f32 v78,v78
v_mul_f32 v79,v211,v79
v_mfma_f32_16x16x32_bf16 v[36:39],v[176:179],a[60:63],v[36:39]
ds_read_b64_tr_b16 v[172:173],v213 offset:18432
ds_read_b64_tr_b16 v[174:175],v213 offset:22528
v_mul_f32 v92,v211,v92
v_mfma_f32_16x16x32_bf16 v[40:43],v[180:183],a[56:59],v[40:43]
v_exp_f32 v79,v79
v_mul_f32 v93,v211,v93
v_mfma_f32_16x16x32_bf16 v[44:47],v[180:183],a[60:63],v[44:47]
ds_read_b64_tr_b16 v[176:177],v215 offset:19456
ds_read_b64_tr_b16 v[178:179],v215 offset:23552
v_mul_f32 v94,v211,v94
v_mfma_f32_16x16x32_bf16 v[48:51],v[184:187],a[56:59],v[48:51]
v_exp_f32 v92,v92
v_mul_f32 v95,v211,v95
v_mfma_f32_16x16x32_bf16 v[52:55],v[184:187],a[60:63],v[52:55]
ds_read_b64_tr_b16 v[180:181],v216 offset:19456
ds_read_b64_tr_b16 v[182:183],v216 offset:23552
v_exp_f32 v93,v93
v_mfma_f32_16x16x32_bf16 v[56:59],v[188:191],a[56:59],v[56:59]
v_exp_f32 v94,v94
v_exp_f32 v95,v95
v_mfma_f32_16x16x32_bf16 v[60:63],v[188:191],a[60:63],v[60:63]
buffer_load_dwordx4 a[128:131],v218,s[24:27],s74 offen sc1
ds_read_b64_tr_b16 v[184:185],v217 offset:19456
ds_read_b64_tr_b16 v[186:187],v217 offset:23552
s_waitcnt lgkmcnt(6)
s_waitcnt vmcnt(30)
v_mfma_f32_16x16x32_bf16 v[0:3],v[160:163],a[64:67],v[0:3]
v_add_f32 v76,1.0,v76
v_rcp_f32 v76,v76
v_mfma_f32_16x16x32_bf16 v[4:7],v[160:163],a[68:71],v[4:7]
ds_read_b64_tr_b16 v[188:189],v213 offset:19456
ds_read_b64_tr_b16 v[190:191],v213 offset:23552
v_add_f32 v77,1.0,v77
v_mfma_f32_16x16x32_bf16 v[8:11],v[164:167],a[64:67],v[8:11]
buffer_load_dwordx4 v220,s[20:23],s98 offen offset:1024 lds
s_add_u32 m0,s84,81920
v_add_f32 v78,1.0,v78
v_mfma_f32_16x16x32_bf16 v[12:15],v[164:167],a[68:71],v[12:15]
ds_read_b64_tr_b16 v[160:161],v215 offset:26624
ds_read_b64_tr_b16 v[162:163],v215 offset:30720
v_add_f32 v79,1.0,v79
v_mfma_f32_16x16x32_bf16 v[16:19],v[168:171],a[64:67],v[16:19]
v_rcp_f32 v77,v77
v_add_f32 v92,1.0,v92
v_mfma_f32_16x16x32_bf16 v[20:23],v[168:171],a[68:71],v[20:23]
ds_read_b64_tr_b16 v[164:165],v216 offset:26624
ds_read_b64_tr_b16 v[166:167],v216 offset:30720
v_rcp_f32 v78,v78
v_mfma_f32_16x16x32_bf16 v[24:27],v[172:175],a[64:67],v[24:27]
buffer_load_dwordx4 a[132:135],v218,s[24:27],s74 offen offset:1024 sc1
v_rcp_f32 v79,v79
v_add_f32 v93,1.0,v93
v_mfma_f32_16x16x32_bf16 v[28:31],v[172:175],a[68:71],v[28:31]
ds_read_b64_tr_b16 v[168:169],v217 offset:26624
ds_read_b64_tr_b16 v[170:171],v217 offset:30720
s_waitcnt lgkmcnt(6)
v_add_f32 v94,1.0,v94
v_mfma_f32_16x16x32_bf16 v[32:35],v[176:179],a[64:67],v[32:35]
v_rcp_f32 v92,v92
v_add_f32 v95,1.0,v95
v_mfma_f32_16x16x32_bf16 v[36:39],v[176:179],a[68:71],v[36:39]
buffer_load_dwordx4 v221,s[20:23],s98 offen lds
ds_read_b64_tr_b16 v[172:173],v213 offset:26624
ds_read_b64_tr_b16 v[174:175],v213 offset:30720
v_mfma_f32_16x16x32_bf16 v[40:43],v[180:183],a[64:67],v[40:43]
v_rcp_f32 v93,v93
v_mul_f32 v76,v76,v108
v_mfma_f32_16x16x32_bf16 v[44:47],v[180:183],a[68:71],v[44:47]
ds_read_b64_tr_b16 v[176:177],v215 offset:27648
ds_read_b64_tr_b16 v[178:179],v215 offset:31744
v_mfma_f32_16x16x32_bf16 v[48:51],v[184:187],a[64:67],v[48:51]
v_rcp_f32 v94,v94
v_rcp_f32 v95,v95
v_mfma_f32_16x16x32_bf16 v[52:55],v[184:187],a[68:71],v[52:55]
buffer_load_dwordx4 a[136:139],v218,s[24:27],s74 offen offset:2048 sc1
ds_read_b64_tr_b16 v[180:181],v216 offset:27648
ds_read_b64_tr_b16 v[182:183],v216 offset:31744
v_mul_f32 v77,v77,v109
v_mul_f32 v78,v78,v110
v_mul_f32 v79,v79,v111
v_mul_f32 v92,v92,v124
v_mul_f32 v93,v93,v125
v_mul_f32 v94,v94,v126
v_mul_f32 v95,v95,v127
v_cvt_pk_bf16_f32 v108,v76,v77
v_cvt_pk_bf16_f32 v109,v78,v79
v_cvt_pk_bf16_f32 v110,v92,v93
v_cvt_pk_bf16_f32 v111,v94,v95
buffer_store_dwordx4 v[108:111],v212,s[24:27],s87 offen offset:1024 sc1
v_mfma_f32_16x16x32_bf16 v[56:59],v[188:191],a[64:67],v[56:59]
s_lshl_b32 s90,s40,5
s_add_u32 s90,s90,s42
v_mfma_f32_16x16x32_bf16 v[60:63],v[188:191],a[68:71],v[60:63]
ds_read_b64_tr_b16 v[184:185],v217 offset:27648
ds_read_b64_tr_b16 v[186:187],v217 offset:31744
s_waitcnt lgkmcnt(6)
v_mfma_f32_16x16x32_bf16 v[0:3],v[160:163],a[72:75],v[0:3]
s_add_u32 s90,s90,8
s_lshl_b32 s90,s90,7
v_mfma_f32_16x16x32_bf16 v[4:7],v[160:163],a[76:79],v[4:7]
ds_read_b64_tr_b16 v[188:189],v213 offset:27648
ds_read_b64_tr_b16 v[190:191],v213 offset:31744
v_mfma_f32_16x16x32_bf16 v[8:11],v[164:167],a[72:75],v[8:11]
v_and_b32 v227,3,v226
v_mul_u32_u24 v227,4,v227
v_mfma_f32_16x16x32_bf16 v[12:15],v[164:167],a[76:79],v[12:15]
s_waitcnt vmcnt(29)
s_barrier
v_mfma_f32_16x16x32_bf16 v[16:19],v[168:171],a[72:75],v[16:19]
ds_read_b64_tr_b16 v[160:161],v215 offset:36864
ds_read_b64_tr_b16 v[162:163],v215 offset:40960
v_mfma_f32_16x16x32_bf16 v[20:23],v[168:171],a[76:79],v[20:23]
ds_read_b64_tr_b16 v[164:165],v216 offset:36864
ds_read_b64_tr_b16 v[166:167],v216 offset:40960
v_mfma_f32_16x16x32_bf16 v[24:27],v[172:175],a[72:75],v[24:27]
s_add_u32 s86,s86,16384
s_add_u32 s87,s87,16384
v_mfma_f32_16x16x32_bf16 v[28:31],v[172:175],a[76:79],v[28:31]
ds_read_b64_tr_b16 v[168:169],v217 offset:36864
ds_read_b64_tr_b16 v[170:171],v217 offset:40960
s_waitcnt lgkmcnt(6)
v_mfma_f32_16x16x32_bf16 v[32:35],v[176:179],a[72:75],v[32:35]
s_add_u32 s57,s44,0
s_and_b32 s57,s57,7
v_mfma_f32_16x16x32_bf16 v[36:39],v[176:179],a[76:79],v[36:39]
buffer_load_dwordx4 v222,s[20:23],s98 offen offset:1024 lds
s_add_u32 m0,s84,0
v_mfma_f32_16x16x32_bf16 v[40:43],v[180:183],a[72:75],v[40:43]
s_mul_i32 s98,s76,9
s_lshr_b32 s98,s98,1
v_mfma_f32_16x16x32_bf16 v[44:47],v[180:183],a[76:79],v[44:47]
ds_read_b64_tr_b16 v[172:173],v213 offset:36864
ds_read_b64_tr_b16 v[174:175],v213 offset:40960
v_mfma_f32_16x16x32_bf16 v[48:51],v[184:187],a[72:75],v[48:51]
ds_read_b64_tr_b16 v[176:177],v215 offset:37888
ds_read_b64_tr_b16 v[178:179],v215 offset:41984
v_mfma_f32_16x16x32_bf16 v[52:55],v[184:187],a[76:79],v[52:55]
buffer_load_dwordx4 a[140:143],v218,s[24:27],s74 offen offset:3072 sc1
ds_read_b64_tr_b16 v[180:181],v216 offset:37888
v_mfma_f32_16x16x32_bf16 v[56:59],v[188:191],a[72:75],v[56:59]
ds_read_b64_tr_b16 v[182:183],v216 offset:41984
s_mul_i32 s57,s57,82944
v_mfma_f32_16x16x32_bf16 v[60:63],v[188:191],a[76:79],v[60:63]
ds_read_b64_tr_b16 v[184:185],v217 offset:37888
ds_read_b64_tr_b16 v[186:187],v217 offset:41984
s_waitcnt lgkmcnt(6)
s_waitcnt vmcnt(29)
v_mfma_f32_16x16x32_bf16 v[0:3],v[160:163],a[80:83],v[0:3]
buffer_load_dword v247,v227,s[24:27],s90 offen sc1
v_mul_u32_u24 v248,78336,v248
v_mfma_f32_16x16x32_bf16 v[4:7],v[160:163],a[84:87],v[4:7]
buffer_load_dwordx4 v219,s[20:23],s98 offen lds
ds_read_b64_tr_b16 v[188:189],v213 offset:37888
v_mfma_f32_16x16x32_bf16 v[8:11],v[164:167],a[80:83],v[8:11]
ds_read_b64_tr_b16 v[190:191],v213 offset:41984
v_add_u32 v194,v248,v221
v_mfma_f32_16x16x32_bf16 v[12:15],v[164:167],a[84:87],v[12:15]
ds_read_b64_tr_b16 v[160:161],v215 offset:45056
ds_read_b64_tr_b16 v[162:163],v215 offset:49152
v_mfma_f32_16x16x32_bf16 v[16:19],v[168:171],a[80:83],v[16:19]
v_add_u32 v195,v248,v222
v_add_u32 v240,147456,v212
v_mfma_f32_16x16x32_bf16 v[20:23],v[168:171],a[84:87],v[20:23]
buffer_load_dwordx4 v220,s[20:23],s98 offen offset:1024 lds
s_add_u32 m0,s84,8192
v_mfma_f32_16x16x32_bf16 v[24:27],v[172:175],a[80:83],v[24:27]
ds_read_b64_tr_b16 v[164:165],v216 offset:45056
ds_read_b64_tr_b16 v[166:167],v216 offset:49152
v_mfma_f32_16x16x32_bf16 v[28:31],v[172:175],a[84:87],v[28:31]
ds_read_b64_tr_b16 v[168:169],v217 offset:45056
ds_read_b64_tr_b16 v[170:171],v217 offset:49152
s_waitcnt lgkmcnt(6)
v_mfma_f32_16x16x32_bf16 v[32:35],v[176:179],a[80:83],v[32:35]
v_add_u32 v192,v248,v219
v_add_u32 v193,v248,v220
v_mfma_f32_16x16x32_bf16 v[36:39],v[176:179],a[84:87],v[36:39]
buffer_load_dwordx4 a[144:147],v218,s[24:27],s75 offen sc1
ds_read_b64_tr_b16 v[172:173],v213 offset:45056
v_mfma_f32_16x16x32_bf16 v[40:43],v[180:183],a[80:83],v[40:43]
ds_read_b64_tr_b16 v[174:175],v213 offset:49152
v_add_u32 v194,294912,v194
v_mfma_f32_16x16x32_bf16 v[44:47],v[180:183],a[84:87],v[44:47]
ds_read_b64_tr_b16 v[176:177],v215 offset:46080
ds_read_b64_tr_b16 v[178:179],v215 offset:50176
v_mfma_f32_16x16x32_bf16 v[48:51],v[184:187],a[80:83],v[48:51]
s_lshl_b32 s17,s40,5
s_add_u32 s17,s17,s42
v_mfma_f32_16x16x32_bf16 v[52:55],v[184:187],a[84:87],v[52:55]
buffer_load_dwordx4 v221,s[20:23],s98 offen lds
ds_read_b64_tr_b16 v[180:181],v216 offset:46080
v_mfma_f32_16x16x32_bf16 v[56:59],v[188:191],a[80:83],v[56:59]
ds_read_b64_tr_b16 v[182:183],v216 offset:50176
s_add_u32 s17,s17,12
v_mfma_f32_16x16x32_bf16 v[60:63],v[188:191],a[84:87],v[60:63]
ds_read_b64_tr_b16 v[184:185],v217 offset:46080
ds_read_b64_tr_b16 v[186:187],v217 offset:50176
s_waitcnt lgkmcnt(6)
v_mfma_f32_16x16x32_bf16 v[0:3],v[160:163],a[88:91],v[0:3]
s_lshl_b32 s17,s17,5
s_add_u32 s17,s17,s43
v_mfma_f32_16x16x32_bf16 v[4:7],v[160:163],a[92:95],v[4:7]
ds_read_b64_tr_b16 v[188:189],v213 offset:46080
ds_read_b64_tr_b16 v[190:191],v213 offset:50176
v_mfma_f32_16x16x32_bf16 v[8:11],v[164:167],a[88:91],v[8:11]
buffer_load_dwordx4 a[148:151],v218,s[24:27],s75 offen offset:1024 sc1
s_lshl_b32 s17,s17,2
v_mfma_f32_16x16x32_bf16 v[12:15],v[164:167],a[92:95],v[12:15]
v_subrev_u32 v215,73728,v215
ds_read_b64_tr_b16 v[160:161],v215 offset:0
v_mfma_f32_16x16x32_bf16 v[16:19],v[168:171],a[88:91],v[16:19]
ds_read_b64_tr_b16 v[162:163],v215 offset:4096
v_add_u32 v195,294912,v195
v_mfma_f32_16x16x32_bf16 v[20:23],v[168:171],a[92:95],v[20:23]
v_subrev_u32 v216,73728,v216
ds_read_b64_tr_b16 v[164:165],v216 offset:0
v_mfma_f32_16x16x32_bf16 v[24:27],v[172:175],a[88:91],v[24:27]
buffer_load_dwordx4 v222,s[20:23],s98 offen offset:1024 lds
s_add_u32 m0,s84,92160
v_mfma_f32_16x16x32_bf16 v[28:31],v[172:175],a[92:95],v[28:31]
s_mul_i32 s98,s77,9
s_lshr_b32 s98,s98,1
s_waitcnt lgkmcnt(3)
v_mfma_f32_16x16x32_bf16 v[32:35],v[176:179],a[88:91],v[32:35]
v_subrev_u32 v217,73728,v217
ds_read_b64_tr_b16 v[166:167],v216 offset:4096
v_mfma_f32_16x16x32_bf16 v[36:39],v[176:179],a[92:95],v[36:39]
v_subrev_u32 v213,73728,v213
ds_read_b64_tr_b16 v[168:169],v217 offset:0
v_mfma_f32_16x16x32_bf16 v[40:43],v[180:183],a[88:91],v[40:43]
buffer_load_dwordx4 a[152:155],v218,s[24:27],s75 offen offset:2048 sc1
ds_read_b64_tr_b16 v[170:171],v217 offset:4096
v_mfma_f32_16x16x32_bf16 v[44:47],v[180:183],a[92:95],v[44:47]
ds_read_b64_tr_b16 v[172:173],v213 offset:0
ds_read_b64_tr_b16 v[174:175],v213 offset:4096
v_mfma_f32_16x16x32_bf16 v[48:51],v[184:187],a[88:91],v[48:51]
ds_read_b64_tr_b16 v[176:177],v215 offset:1024
ds_read_b64_tr_b16 v[178:179],v215 offset:5120
v_mfma_f32_16x16x32_bf16 v[52:55],v[184:187],a[92:95],v[52:55]
ds_read_b64_tr_b16 v[180:181],v216 offset:1024
ds_read_b64_tr_b16 v[182:183],v216 offset:5120
v_mfma_f32_16x16x32_bf16 v[56:59],v[188:191],a[88:91],v[56:59]
buffer_load_dwordx4 a[156:159],v218,s[24:27],s75 offen offset:3072 sc1
v_mfma_f32_16x16x32_bf16 v[60:63],v[188:191],a[92:95],v[60:63]
ds_read_b64_tr_b16 v[184:185],v217 offset:1024
ds_read_b64_tr_b16 v[186:187],v217 offset:5120
s_waitcnt lgkmcnt(6)
s_waitcnt vmcnt(29)
v_mfma_f32_16x16x32_bf16 v[0:3],v[160:163],a[96:99],v[0:3]
v_mfma_f32_16x16x32_bf16 v[4:7],v[160:163],a[100:103],v[4:7]
ds_read_b64_tr_b16 v[188:189],v213 offset:1024
ds_read_b64_tr_b16 v[190:191],v213 offset:5120
v_mfma_f32_16x16x32_bf16 v[8:11],v[164:167],a[96:99],v[8:11]
buffer_load_dwordx4 v219,s[20:23],s98 offen lds
v_mfma_f32_16x16x32_bf16 v[12:15],v[164:167],a[100:103],v[12:15]
ds_read_b64_tr_b16 v[160:161],v215 offset:8192
ds_read_b64_tr_b16 v[162:163],v215 offset:12288
v_mfma_f32_16x16x32_bf16 v[16:19],v[168:171],a[96:99],v[16:19]
v_mfma_f32_16x16x32_bf16 v[20:23],v[168:171],a[100:103],v[20:23]
ds_read_b64_tr_b16 v[164:165],v216 offset:8192
ds_read_b64_tr_b16 v[166:167],v216 offset:12288
v_mfma_f32_16x16x32_bf16 v[24:27],v[172:175],a[96:99],v[24:27]
buffer_load_dwordx4 a[160:163],v218,s[24:27],s76 offen sc1
v_mfma_f32_16x16x32_bf16 v[28:31],v[172:175],a[100:103],v[28:31]
ds_read_b64_tr_b16 v[168:169],v217 offset:8192
ds_read_b64_tr_b16 v[170:171],v217 offset:12288
s_waitcnt lgkmcnt(6)
v_mfma_f32_16x16x32_bf16 v[32:35],v[176:179],a[96:99],v[32:35]
s_waitcnt vmcnt(10)
v_mfma_f32_16x16x32_bf16 v[36:39],v[176:179],a[100:103],v[36:39]
ds_read_b64_tr_b16 v[172:173],v213 offset:8192
ds_read_b64_tr_b16 v[174:175],v213 offset:12288
v_mfma_f32_16x16x32_bf16 v[40:43],v[180:183],a[96:99],v[40:43]
buffer_load_dwordx4 v220,s[20:23],s98 offen offset:1024 lds
s_add_u32 m0,s84,100352
v_mfma_f32_16x16x32_bf16 v[44:47],v[180:183],a[100:103],v[44:47]
ds_read_b64_tr_b16 v[176:177],v215 offset:9216
ds_read_b64_tr_b16 v[178:179],v215 offset:13312
v_cmp_ne_u32 vcc,1,v247
s_cbranch_vccnz L_slow_hc_5
L_back_hc_5:
v_mfma_f32_16x16x32_bf16 v[48:51],v[184:187],a[96:99],v[48:51]
v_mfma_f32_16x16x32_bf16 v[52:55],v[184:187],a[100:103],v[52:55]
ds_read_b64_tr_b16 v[180:181],v216 offset:9216
ds_read_b64_tr_b16 v[182:183],v216 offset:13312
v_mfma_f32_16x16x32_bf16 v[56:59],v[188:191],a[96:99],v[56:59]
buffer_load_dwordx4 a[164:167],v218,s[24:27],s76 offen offset:1024 sc1
v_mfma_f32_16x16x32_bf16 v[60:63],v[188:191],a[100:103],v[60:63]
ds_read_b64_tr_b16 v[184:185],v217 offset:9216
ds_read_b64_tr_b16 v[186:187],v217 offset:13312
s_waitcnt lgkmcnt(6)
v_mfma_f32_16x16x32_bf16 v[0:3],v[160:163],a[104:107],v[0:3]
v_mfma_f32_16x16x32_bf16 v[4:7],v[160:163],a[108:111],v[4:7]
ds_read_b64_tr_b16 v[188:189],v213 offset:9216
ds_read_b64_tr_b16 v[190:191],v213 offset:13312
v_mfma_f32_16x16x32_bf16 v[8:11],v[164:167],a[104:107],v[8:11]
buffer_load_dwordx4 v221,s[20:23],s98 offen lds
v_mfma_f32_16x16x32_bf16 v[12:15],v[164:167],a[108:111],v[12:15]
s_barrier
v_mfma_f32_16x16x32_bf16 v[16:19],v[168:171],a[104:107],v[16:19]
ds_read_b64_tr_b16 v[160:161],v215 offset:18432
ds_read_b64_tr_b16 v[162:163],v215 offset:22528
v_mfma_f32_16x16x32_bf16 v[20:23],v[168:171],a[108:111],v[20:23]
ds_read_b64_tr_b16 v[164:165],v216 offset:18432
ds_read_b64_tr_b16 v[166:167],v216 offset:22528
buffer_store_dword v225,v224,s[24:27],s17 offen sc1
v_mfma_f32_16x16x32_bf16 v[24:27],v[172:175],a[104:107],v[24:27]
buffer_load_dwordx4 a[168:171],v218,s[24:27],s76 offen offset:2048 sc1
v_mfma_f32_16x16x32_bf16 v[28:31],v[172:175],a[108:111],v[28:31]
ds_read_b64_tr_b16 v[168:169],v217 offset:18432
ds_read_b64_tr_b16 v[170:171],v217 offset:22528
s_waitcnt lgkmcnt(6)
v_mfma_f32_16x16x32_bf16 v[32:35],v[176:179],a[104:107],v[32:35]
s_cmp_eq_u32 s45,s42
s_cselect_b32 s16,-1,0
s_mov_b32 s17,s16
v_mfma_f32_16x16x32_bf16 v[36:39],v[176:179],a[108:111],v[36:39]
ds_read_b64_tr_b16 v[172:173],v213 offset:18432
ds_read_b64_tr_b16 v[174:175],v213 offset:22528
v_mfma_f32_16x16x32_bf16 v[40:43],v[180:183],a[104:107],v[40:43]
buffer_load_dwordx4 v222,s[20:23],s98 offen offset:1024 lds
s_add_u32 m0,s84,110592
v_mfma_f32_16x16x32_bf16 v[44:47],v[180:183],a[108:111],v[44:47]
s_mul_i32 s98,s78,9
s_lshr_b32 s98,s98,1
v_mfma_f32_16x16x32_bf16 v[48:51],v[184:187],a[104:107],v[48:51]
ds_read_b64_tr_b16 v[176:177],v215 offset:19456
ds_read_b64_tr_b16 v[178:179],v215 offset:23552
v_mfma_f32_16x16x32_bf16 v[52:55],v[184:187],a[108:111],v[52:55]
ds_read_b64_tr_b16 v[180:181],v216 offset:19456
ds_read_b64_tr_b16 v[182:183],v216 offset:23552
v_mfma_f32_16x16x32_bf16 v[56:59],v[188:191],a[104:107],v[56:59]
buffer_load_dwordx4 a[172:175],v218,s[24:27],s76 offen offset:3072 sc1
s_lshl_b32 s18,s16,31
v_mfma_f32_16x16x32_bf16 v[60:63],v[188:191],a[108:111],v[60:63]
ds_read_b64_tr_b16 v[184:185],v217 offset:19456
ds_read_b64_tr_b16 v[186:187],v217 offset:23552
s_waitcnt lgkmcnt(6)
v_mfma_f32_16x16x32_bf16 v[0:3],v[160:163],a[112:115],v[0:3]
v_or_b32 v239,s18,v212
v_mfma_f32_16x16x32_bf16 v[4:7],v[160:163],a[116:119],v[4:7]
ds_read_b64_tr_b16 v[188:189],v213 offset:19456
ds_read_b64_tr_b16 v[190:191],v213 offset:23552
v_mfma_f32_16x16x32_bf16 v[8:11],v[164:167],a[112:115],v[8:11]
buffer_load_dwordx4 v219,s[20:23],s98 offen lds
v_mfma_f32_16x16x32_bf16 v[12:15],v[164:167],a[116:119],v[12:15]
ds_read_b64_tr_b16 v[160:161],v215 offset:26624
ds_read_b64_tr_b16 v[162:163],v215 offset:30720
v_mfma_f32_16x16x32_bf16 v[16:19],v[168:171],a[112:115],v[16:19]
v_mfma_f32_16x16x32_bf16 v[20:23],v[168:171],a[116:119],v[20:23]
ds_read_b64_tr_b16 v[164:165],v216 offset:26624
ds_read_b64_tr_b16 v[166:167],v216 offset:30720
v_mfma_f32_16x16x32_bf16 v[24:27],v[172:175],a[112:115],v[24:27]
v_mfma_f32_16x16x32_bf16 v[28:31],v[172:175],a[116:119],v[28:31]
buffer_load_dwordx4 v220,s[20:23],s98 offen offset:1024 lds
s_add_u32 m0,s84,118784
s_waitcnt lgkmcnt(4)
v_mfma_f32_16x16x32_bf16 v[32:35],v[176:179],a[112:115],v[32:35]
ds_read_b64_tr_b16 v[168:169],v217 offset:26624
ds_read_b64_tr_b16 v[170:171],v217 offset:30720
v_mfma_f32_16x16x32_bf16 v[36:39],v[176:179],a[116:119],v[36:39]
ds_read_b64_tr_b16 v[172:173],v213 offset:26624
ds_read_b64_tr_b16 v[174:175],v213 offset:30720
v_mfma_f32_16x16x32_bf16 v[40:43],v[180:183],a[112:115],v[40:43]
v_mfma_f32_16x16x32_bf16 v[44:47],v[180:183],a[116:119],v[44:47]
buffer_load_dwordx4 a[176:179],v218,s[24:27],s77 offen sc1
ds_read_b64_tr_b16 v[176:177],v215 offset:27648
v_mfma_f32_16x16x32_bf16 v[48:51],v[184:187],a[112:115],v[48:51]
ds_read_b64_tr_b16 v[178:179],v215 offset:31744
v_mfma_f32_16x16x32_bf16 v[52:55],v[184:187],a[116:119],v[52:55]
ds_read_b64_tr_b16 v[180:181],v216 offset:27648
ds_read_b64_tr_b16 v[182:183],v216 offset:31744
v_mfma_f32_16x16x32_bf16 v[56:59],v[188:191],a[112:115],v[56:59]
v_mfma_f32_16x16x32_bf16 v[60:63],v[188:191],a[116:119],v[60:63]
buffer_load_dwordx4 v221,s[20:23],s98 offen lds
ds_read_b64_tr_b16 v[184:185],v217 offset:27648
s_waitcnt lgkmcnt(5)
v_mfma_f32_16x16x32_bf16 v[0:3],v[160:163],a[120:123],v[0:3]
ds_read_b64_tr_b16 v[186:187],v217 offset:31744
v_mfma_f32_16x16x32_bf16 v[4:7],v[160:163],a[124:127],v[4:7]
ds_read_b64_tr_b16 v[188:189],v213 offset:27648
ds_read_b64_tr_b16 v[190:191],v213 offset:31744
v_mfma_f32_16x16x32_bf16 v[8:11],v[164:167],a[120:123],v[8:11]
v_mfma_f32_16x16x32_bf16 v[12:15],v[164:167],a[124:127],v[12:15]
buffer_load_dwordx4 a[180:183],v218,s[24:27],s77 offen offset:1024 sc1
ds_read_b64_tr_b16 v[160:161],v215 offset:36864
v_mfma_f32_16x16x32_bf16 v[16:19],v[168:171],a[120:123],v[16:19]
ds_read_b64_tr_b16 v[162:163],v215 offset:40960
v_mfma_f32_16x16x32_bf16 v[20:23],v[168:171],a[124:127],v[20:23]
ds_read_b64_tr_b16 v[164:165],v216 offset:36864
ds_read_b64_tr_b16 v[166:167],v216 offset:40960
v_mfma_f32_16x16x32_bf16 v[24:27],v[172:175],a[120:123],v[24:27]
v_mfma_f32_16x16x32_bf16 v[28:31],v[172:175],a[124:127],v[28:31]
buffer_load_dwordx4 v222,s[20:23],s98 offen offset:1024 lds
s_add_u32 m0,s84,129024
s_waitcnt lgkmcnt(4)
v_mfma_f32_16x16x32_bf16 v[32:35],v[176:179],a[120:123],v[32:35]
s_mul_i32 s98,s79,9
s_lshr_b32 s98,s98,1
v_mfma_f32_16x16x32_bf16 v[36:39],v[176:179],a[124:127],v[36:39]
ds_read_b64_tr_b16 v[168:169],v217 offset:36864
ds_read_b64_tr_b16 v[170:171],v217 offset:40960
v_mfma_f32_16x16x32_bf16 v[40:43],v[180:183],a[120:123],v[40:43]
ds_read_b64_tr_b16 v[172:173],v213 offset:36864
ds_read_b64_tr_b16 v[174:175],v213 offset:40960
v_mfma_f32_16x16x32_bf16 v[44:47],v[180:183],a[124:127],v[44:47]
buffer_load_dwordx4 a[184:187],v218,s[24:27],s77 offen offset:2048 sc1
ds_read_b64_tr_b16 v[176:177],v215 offset:37888
v_mfma_f32_16x16x32_bf16 v[48:51],v[184:187],a[120:123],v[48:51]
ds_read_b64_tr_b16 v[178:179],v215 offset:41984
v_mfma_f32_16x16x32_bf16 v[52:55],v[184:187],a[124:127],v[52:55]
ds_read_b64_tr_b16 v[180:181],v216 offset:37888
ds_read_b64_tr_b16 v[182:183],v216 offset:41984
v_mfma_f32_16x16x32_bf16 v[56:59],v[188:191],a[120:123],v[56:59]
v_mfma_f32_16x16x32_bf16 v[60:63],v[188:191],a[124:127],v[60:63]
s_getpc_b64 s[0:1]
L_cp7_5:
v_min_u32 v254,L_stop_5-L_cp7_5,v253
global_load_dword v255,v254,s[0:1]
s_waitcnt lgkmcnt(4)
v_mfma_f32_16x16x32_bf16 v[0:3],v[160:163],a[128:131],v[0:3]
ds_read_b64_tr_b16 v[184:185],v217 offset:37888
ds_read_b64_tr_b16 v[186:187],v217 offset:41984
v_mfma_f32_16x16x32_bf16 v[4:7],v[160:163],a[132:135],v[4:7]
buffer_load_dwordx4 a[188:191],v218,s[24:27],s77 offen offset:3072 sc1
ds_read_b64_tr_b16 v[188:189],v213 offset:37888
v_mfma_f32_16x16x32_bf16 v[8:11],v[164:167],a[128:131],v[8:11]
ds_read_b64_tr_b16 v[190:191],v213 offset:41984
v_mfma_f32_16x16x32_bf16 v[12:15],v[164:167],a[132:135],v[12:15]
ds_read_b64_tr_b16 v[160:161],v215 offset:45056
ds_read_b64_tr_b16 v[162:163],v215 offset:49152
v_mfma_f32_16x16x32_bf16 v[16:19],v[168:171],a[128:131],v[16:19]
v_mfma_f32_16x16x32_bf16 v[20:23],v[168:171],a[132:135],v[20:23]
buffer_load_dwordx4 v219,s[20:23],s98 offen lds
ds_read_b64_tr_b16 v[164:165],v216 offset:45056
v_mfma_f32_16x16x32_bf16 v[24:27],v[172:175],a[128:131],v[24:27]
ds_read_b64_tr_b16 v[166:167],v216 offset:49152
v_mfma_f32_16x16x32_bf16 v[28:31],v[172:175],a[132:135],v[28:31]
ds_read_b64_tr_b16 v[168:169],v217 offset:45056
ds_read_b64_tr_b16 v[170:171],v217 offset:49152
s_waitcnt lgkmcnt(6)
v_mfma_f32_16x16x32_bf16 v[32:35],v[176:179],a[128:131],v[32:35]
v_mfma_f32_16x16x32_bf16 v[36:39],v[176:179],a[132:135],v[36:39]
buffer_load_dwordx4 a[192:195],v218,s[24:27],s78 offen sc1
ds_read_b64_tr_b16 v[172:173],v213 offset:45056
v_mfma_f32_16x16x32_bf16 v[40:43],v[180:183],a[128:131],v[40:43]
ds_read_b64_tr_b16 v[174:175],v213 offset:49152
v_mfma_f32_16x16x32_bf16 v[44:47],v[180:183],a[132:135],v[44:47]
ds_read_b64_tr_b16 v[176:177],v215 offset:46080
ds_read_b64_tr_b16 v[178:179],v215 offset:50176
v_mfma_f32_16x16x32_bf16 v[48:51],v[184:187],a[128:131],v[48:51]
v_mfma_f32_16x16x32_bf16 v[52:55],v[184:187],a[132:135],v[52:55]
ds_read_b64_tr_b16 v[180:181],v216 offset:46080
ds_read_b64_tr_b16 v[182:183],v216 offset:50176
v_mfma_f32_16x16x32_bf16 v[56:59],v[188:191],a[128:131],v[56:59]
buffer_load_dwordx4 v220,s[20:23],s98 offen offset:1024 lds
s_add_u32 m0,s84,137216
v_mfma_f32_16x16x32_bf16 v[60:63],v[188:191],a[132:135],v[60:63]
ds_read_b64_tr_b16 v[184:185],v217 offset:46080
ds_read_b64_tr_b16 v[186:187],v217 offset:50176
s_waitcnt lgkmcnt(6)
v_mfma_f32_16x16x32_bf16 v[0:3],v[160:163],a[136:139],v[0:3]
v_mfma_f32_16x16x32_bf16 v[4:7],v[160:163],a[140:143],v[4:7]
ds_read_b64_tr_b16 v[188:189],v213 offset:46080
ds_read_b64_tr_b16 v[190:191],v213 offset:50176
v_mfma_f32_16x16x32_bf16 v[8:11],v[164:167],a[136:139],v[8:11]
buffer_load_dwordx4 a[196:199],v218,s[24:27],s78 offen offset:1024 sc1
v_mfma_f32_16x16x32_bf16 v[12:15],v[164:167],a[140:143],v[12:15]
s_waitcnt vmcnt(24)
s_barrier
v_mfma_f32_16x16x32_bf16 v[16:19],v[168:171],a[136:139],v[16:19]
ds_read_b64_tr_b16 v[160:161],v215 offset:55296
ds_read_b64_tr_b16 v[162:163],v215 offset:59392
v_mfma_f32_16x16x32_bf16 v[20:23],v[168:171],a[140:143],v[20:23]
ds_read_b64_tr_b16 v[164:165],v216 offset:55296
ds_read_b64_tr_b16 v[166:167],v216 offset:59392
v_mfma_f32_16x16x32_bf16 v[24:27],v[172:175],a[136:139],v[24:27]
buffer_load_dwordx4 v221,s[20:23],s98 offen lds
v_mfma_f32_16x16x32_bf16 v[28:31],v[172:175],a[140:143],v[28:31]
ds_read_b64_tr_b16 v[168:169],v217 offset:55296
ds_read_b64_tr_b16 v[170:171],v217 offset:59392
s_waitcnt lgkmcnt(6)
v_mfma_f32_16x16x32_bf16 v[32:35],v[176:179],a[136:139],v[32:35]
v_mfma_f32_16x16x32_bf16 v[36:39],v[176:179],a[140:143],v[36:39]
ds_read_b64_tr_b16 v[172:173],v213 offset:55296
ds_read_b64_tr_b16 v[174:175],v213 offset:59392
v_mfma_f32_16x16x32_bf16 v[40:43],v[180:183],a[136:139],v[40:43]
buffer_load_dwordx4 a[200:203],v218,s[24:27],s78 offen offset:2048 sc1
v_mfma_f32_16x16x32_bf16 v[44:47],v[180:183],a[140:143],v[44:47]
ds_read_b64_tr_b16 v[176:177],v215 offset:56320
ds_read_b64_tr_b16 v[178:179],v215 offset:60416
v_mfma_f32_16x16x32_bf16 v[48:51],v[184:187],a[136:139],v[48:51]
v_mfma_f32_16x16x32_bf16 v[52:55],v[184:187],a[140:143],v[52:55]
ds_read_b64_tr_b16 v[180:181],v216 offset:56320
ds_read_b64_tr_b16 v[182:183],v216 offset:60416
v_mfma_f32_16x16x32_bf16 v[56:59],v[188:191],a[136:139],v[56:59]
buffer_load_dwordx4 v222,s[20:23],s98 offen offset:1024 lds
s_add_u32 m0,s84,18432
v_mfma_f32_16x16x32_bf16 v[60:63],v[188:191],a[140:143],v[60:63]
s_mul_i32 s98,s80,9
s_lshr_b32 s98,s98,1
s_waitcnt lgkmcnt(4)
s_waitcnt vmcnt(25)
v_mfma_f32_16x16x32_bf16 v[0:3],v[160:163],a[144:147],v[0:3]
ds_read_b64_tr_b16 v[184:185],v217 offset:56320
ds_read_b64_tr_b16 v[186:187],v217 offset:60416
v_mfma_f32_16x16x32_bf16 v[4:7],v[160:163],a[148:151],v[4:7]
ds_read_b64_tr_b16 v[188:189],v213 offset:56320
ds_read_b64_tr_b16 v[190:191],v213 offset:60416
v_mfma_f32_16x16x32_bf16 v[8:11],v[164:167],a[144:147],v[8:11]
buffer_load_dwordx4 a[204:207],v218,s[24:27],s78 offen offset:3072 sc1
s_lshl_b32 s90,s40,5
v_mfma_f32_16x16x32_bf16 v[12:15],v[164:167],a[148:151],v[12:15]
v_add_u32 v215,55296,v215
ds_read_b64_tr_b16 v[160:161],v215 offset:8192
v_mfma_f32_16x16x32_bf16 v[16:19],v[168:171],a[144:147],v[16:19]
ds_read_b64_tr_b16 v[162:163],v215 offset:12288
s_add_u32 s90,s90,s42
v_mfma_f32_16x16x32_bf16 v[20:23],v[168:171],a[148:151],v[20:23]
v_add_u32 v216,55296,v216
ds_read_b64_tr_b16 v[164:165],v216 offset:8192
v_mfma_f32_16x16x32_bf16 v[24:27],v[172:175],a[144:147],v[24:27]
buffer_load_dwordx4 v219,s[20:23],s98 offen lds
ds_read_b64_tr_b16 v[166:167],v216 offset:12288
v_mfma_f32_16x16x32_bf16 v[28:31],v[172:175],a[148:151],v[28:31]
v_add_u32 v217,55296,v217
ds_read_b64_tr_b16 v[168:169],v217 offset:8192
s_waitcnt lgkmcnt(5)
v_mfma_f32_16x16x32_bf16 v[32:35],v[176:179],a[144:147],v[32:35]
ds_read_b64_tr_b16 v[170:171],v217 offset:12288
s_add_u32 s90,s90,12
v_mfma_f32_16x16x32_bf16 v[36:39],v[176:179],a[148:151],v[36:39]
v_add_u32 v213,55296,v213
ds_read_b64_tr_b16 v[172:173],v213 offset:8192
v_mfma_f32_16x16x32_bf16 v[40:43],v[180:183],a[144:147],v[40:43]
ds_read_b64_tr_b16 v[174:175],v213 offset:12288
s_lshl_b32 s90,s90,7
v_mfma_f32_16x16x32_bf16 v[44:47],v[180:183],a[148:151],v[44:47]
buffer_load_dwordx4 v220,s[20:23],s98 offen offset:1024 lds
s_add_u32 m0,s84,26624
v_mfma_f32_16x16x32_bf16 v[48:51],v[184:187],a[144:147],v[48:51]
ds_read_b64_tr_b16 v[176:177],v215 offset:9216
ds_read_b64_tr_b16 v[178:179],v215 offset:13312
v_mfma_f32_16x16x32_bf16 v[52:55],v[184:187],a[148:151],v[52:55]
ds_read_b64_tr_b16 v[180:181],v216 offset:9216
ds_read_b64_tr_b16 v[182:183],v216 offset:13312
v_mfma_f32_16x16x32_bf16 v[56:59],v[188:191],a[144:147],v[56:59]
s_lshl_b32 s86,s40,2
s_add_u32 s86,s86,s43
v_mfma_f32_16x16x32_bf16 v[60:63],v[188:191],a[148:151],v[60:63]
buffer_load_dwordx4 a[208:211],v218,s[24:27],s79 offen sc1
ds_read_b64_tr_b16 v[184:185],v217 offset:9216
s_waitcnt lgkmcnt(5)
v_mfma_f32_16x16x32_bf16 v[0:3],v[160:163],a[152:155],v[0:3]
ds_read_b64_tr_b16 v[186:187],v217 offset:13312
s_lshl_b32 s86,s86,2
v_mfma_f32_16x16x32_bf16 v[4:7],v[160:163],a[156:159],v[4:7]
ds_read_b64_tr_b16 v[188:189],v213 offset:9216
ds_read_b64_tr_b16 v[190:191],v213 offset:13312
v_mfma_f32_16x16x32_bf16 v[8:11],v[164:167],a[152:155],v[8:11]
s_add_u32 s86,s86,s45
s_lshl_b32 s86,s86,2
v_mfma_f32_16x16x32_bf16 v[12:15],v[164:167],a[156:159],v[12:15]
buffer_load_dwordx4 v221,s[20:23],s98 offen lds
v_subrev_u32 v215,73728,v215
v_mfma_f32_16x16x32_bf16 v[16:19],v[168:171],a[152:155],v[16:19]
ds_read_b64_tr_b16 v[160:161],v215 offset:0
ds_read_b64_tr_b16 v[162:163],v215 offset:4096
v_mfma_f32_16x16x32_bf16 v[20:23],v[168:171],a[156:159],v[20:23]
v_subrev_u32 v216,73728,v216
ds_read_b64_tr_b16 v[164:165],v216 offset:0
v_mfma_f32_16x16x32_bf16 v[24:27],v[172:175],a[152:155],v[24:27]
ds_read_b64_tr_b16 v[166:167],v216 offset:4096
s_add_u32 s86,s86,s42
v_mfma_f32_16x16x32_bf16 v[28:31],v[172:175],a[156:159],v[28:31]
buffer_load_dwordx4 a[212:215],v218,s[24:27],s79 offen offset:1024 sc1
v_subrev_u32 v217,73728,v217
s_waitcnt lgkmcnt(4)
v_mfma_f32_16x16x32_bf16 v[32:35],v[176:179],a[152:155],v[32:35]
ds_read_b64_tr_b16 v[168:169],v217 offset:0
ds_read_b64_tr_b16 v[170:171],v217 offset:4096
v_mfma_f32_16x16x32_bf16 v[36:39],v[176:179],a[156:159],v[36:39]
v_subrev_u32 v213,73728,v213
ds_read_b64_tr_b16 v[172:173],v213 offset:0
v_mfma_f32_16x16x32_bf16 v[40:43],v[180:183],a[152:155],v[40:43]
ds_read_b64_tr_b16 v[174:175],v213 offset:4096
s_mul_i32 s86,s86,10240
v_mfma_f32_16x16x32_bf16 v[44:47],v[180:183],a[156:159],v[44:47]
buffer_load_dwordx4 v222,s[20:23],s98 offen offset:1024 lds
s_add_u32 m0,s84,36864
v_mfma_f32_16x16x32_bf16 v[48:51],v[184:187],a[152:155],v[48:51]
s_mul_i32 s98,s81,9
s_lshr_b32 s98,s98,1
v_mfma_f32_16x16x32_bf16 v[52:55],v[184:187],a[156:159],v[52:55]
ds_read_b64_tr_b16 v[176:177],v215 offset:1024
ds_read_b64_tr_b16 v[178:179],v215 offset:5120
v_mfma_f32_16x16x32_bf16 v[56:59],v[188:191],a[152:155],v[56:59]
ds_read_b64_tr_b16 v[180:181],v216 offset:1024
ds_read_b64_tr_b16 v[182:183],v216 offset:5120
v_mfma_f32_16x16x32_bf16 v[60:63],v[188:191],a[156:159],v[60:63]
buffer_load_dwordx4 a[216:219],v218,s[24:27],s79 offen offset:2048 sc1
ds_read_b64_tr_b16 v[184:185],v217 offset:1024
s_waitcnt lgkmcnt(5)
s_waitcnt vmcnt(24)
v_mfma_f32_16x16x32_bf16 v[0:3],v[160:163],a[160:163],v[0:3]
ds_read_b64_tr_b16 v[186:187],v217 offset:5120
s_add_u32 s86,s86,5242880
v_mfma_f32_16x16x32_bf16 v[4:7],v[160:163],a[164:167],v[4:7]
ds_read_b64_tr_b16 v[188:189],v213 offset:1024
ds_read_b64_tr_b16 v[190:191],v213 offset:5120
v_mfma_f32_16x16x32_bf16 v[8:11],v[164:167],a[160:163],v[8:11]
s_add_u32 s87,s86,4096
v_and_b32 v227,1,v226
v_mfma_f32_16x16x32_bf16 v[12:15],v[164:167],a[164:167],v[12:15]
buffer_load_dwordx4 a[220:223],v218,s[24:27],s79 offen offset:3072 sc1
ds_read_b64_tr_b16 v[160:161],v215 offset:8192
v_mfma_f32_16x16x32_bf16 v[16:19],v[168:171],a[160:163],v[16:19]
ds_read_b64_tr_b16 v[162:163],v215 offset:12288
v_mul_u32_u24 v227,12,v227
v_mfma_f32_16x16x32_bf16 v[20:23],v[168:171],a[164:167],v[20:23]
ds_read_b64_tr_b16 v[164:165],v216 offset:8192
ds_read_b64_tr_b16 v[166:167],v216 offset:12288
buffer_load_dword v247,v227,s[24:27],s90 offen sc1
v_mfma_f32_16x16x32_bf16 v[24:27],v[172:175],a[160:163],v[24:27]
s_add_u32 s48,s86,8192
v_mfma_f32_16x16x32_bf16 v[28:31],v[172:175],a[164:167],v[28:31]
buffer_load_dwordx4 v219,s[20:23],s98 offen lds
ds_read_b64_tr_b16 v[168:169],v217 offset:8192
s_waitcnt lgkmcnt(5)
v_mfma_f32_16x16x32_bf16 v[32:35],v[176:179],a[160:163],v[32:35]
ds_read_b64_tr_b16 v[170:171],v217 offset:12288
v_mfma_f32_16x16x32_bf16 v[36:39],v[176:179],a[164:167],v[36:39]
ds_read_b64_tr_b16 v[172:173],v213 offset:8192
ds_read_b64_tr_b16 v[174:175],v213 offset:12288
v_mfma_f32_16x16x32_bf16 v[40:43],v[180:183],a[160:163],v[40:43]
v_mfma_f32_16x16x32_bf16 v[44:47],v[180:183],a[164:167],v[44:47]
buffer_load_dwordx4 a[224:227],v218,s[24:27],s80 offen sc1
ds_read_b64_tr_b16 v[176:177],v215 offset:9216
v_mfma_f32_16x16x32_bf16 v[48:51],v[184:187],a[160:163],v[48:51]
ds_read_b64_tr_b16 v[178:179],v215 offset:13312
v_mfma_f32_16x16x32_bf16 v[52:55],v[184:187],a[164:167],v[52:55]
ds_read_b64_tr_b16 v[180:181],v216 offset:9216
ds_read_b64_tr_b16 v[182:183],v216 offset:13312
v_mfma_f32_16x16x32_bf16 v[56:59],v[188:191],a[160:163],v[56:59]
v_mfma_f32_16x16x32_bf16 v[60:63],v[188:191],a[164:167],v[60:63]
ds_read_b64_tr_b16 v[184:185],v217 offset:9216
ds_read_b64_tr_b16 v[186:187],v217 offset:13312
s_waitcnt lgkmcnt(6)
v_mfma_f32_16x16x32_bf16 v[0:3],v[160:163],a[168:171],v[0:3]
buffer_load_dwordx4 v220,s[20:23],s98 offen offset:1024 lds
s_add_u32 m0,s84,45056
v_mfma_f32_16x16x32_bf16 v[4:7],v[160:163],a[172:175],v[4:7]
ds_read_b64_tr_b16 v[188:189],v213 offset:9216
ds_read_b64_tr_b16 v[190:191],v213 offset:13312
v_mfma_f32_16x16x32_bf16 v[8:11],v[164:167],a[168:171],v[8:11]
v_mfma_f32_16x16x32_bf16 v[12:15],v[164:167],a[172:175],v[12:15]
v_add_u32 v215,92160,v215
s_waitcnt vmcnt(23)
v_mfma_f32_16x16x32_bf16 v[16:19],v[168:171],a[168:171],v[16:19]
buffer_load_dwordx4 a[228:231],v218,s[24:27],s80 offen offset:1024 sc1
s_barrier
v_mfma_f32_16x16x32_bf16 v[20:23],v[168:171],a[172:175],v[20:23]
v_add_u32 v216,92160,v216
ds_read_b64_tr_b16 v[160:161],v215 offset:0
v_mfma_f32_16x16x32_bf16 v[24:27],v[172:175],a[168:171],v[24:27]
ds_read_b64_tr_b16 v[162:163],v215 offset:4096
ds_read_b64_tr_b16 v[164:165],v216 offset:0
v_mfma_f32_16x16x32_bf16 v[28:31],v[172:175],a[172:175],v[28:31]
v_add_u32 v217,92160,v217
ds_read_b64_tr_b16 v[166:167],v216 offset:4096
s_waitcnt lgkmcnt(4)
v_mfma_f32_16x16x32_bf16 v[32:35],v[176:179],a[168:171],v[32:35]
buffer_load_dwordx4 v221,s[20:23],s98 offen lds
ds_read_b64_tr_b16 v[168:169],v217 offset:0
v_mfma_f32_16x16x32_bf16 v[36:39],v[176:179],a[172:175],v[36:39]
v_add_u32 v213,92160,v213
ds_read_b64_tr_b16 v[170:171],v217 offset:4096
v_mfma_f32_16x16x32_bf16 v[40:43],v[180:183],a[168:171],v[40:43]
ds_read_b64_tr_b16 v[172:173],v213 offset:0
ds_read_b64_tr_b16 v[174:175],v213 offset:4096
v_mfma_f32_16x16x32_bf16 v[44:47],v[180:183],a[172:175],v[44:47]
ds_read_b64_tr_b16 v[176:177],v215 offset:1024
ds_read_b64_tr_b16 v[178:179],v215 offset:5120
v_mfma_f32_16x16x32_bf16 v[48:51],v[184:187],a[168:171],v[48:51]
buffer_load_dwordx4 a[232:235],v218,s[24:27],s80 offen offset:2048 sc1
v_mfma_f32_16x16x32_bf16 v[52:55],v[184:187],a[172:175],v[52:55]
ds_read_b64_tr_b16 v[180:181],v216 offset:1024
ds_read_b64_tr_b16 v[182:183],v216 offset:5120
v_mfma_f32_16x16x32_bf16 v[56:59],v[188:191],a[168:171],v[56:59]
v_mfma_f32_16x16x32_bf16 v[60:63],v[188:191],a[172:175],v[60:63]
ds_read_b64_tr_b16 v[184:185],v217 offset:1024
ds_read_b64_tr_b16 v[186:187],v217 offset:5120
s_waitcnt lgkmcnt(6)
s_waitcnt vmcnt(23)
v_mfma_f32_16x16x32_bf16 v[0:3],v[160:163],a[176:179],v[0:3]
buffer_load_dwordx4 v222,s[20:23],s98 offen offset:1024 lds
s_add_u32 m0,s84,55296
v_mfma_f32_16x16x32_bf16 v[4:7],v[160:163],a[180:183],v[4:7]
s_mul_i32 s98,s82,9
s_lshr_b32 s98,s98,1
v_mfma_f32_16x16x32_bf16 v[8:11],v[164:167],a[176:179],v[8:11]
ds_read_b64_tr_b16 v[188:189],v213 offset:1024
ds_read_b64_tr_b16 v[190:191],v213 offset:5120
v_mfma_f32_16x16x32_bf16 v[12:15],v[164:167],a[180:183],v[12:15]
ds_read_b64_tr_b16 v[160:161],v215 offset:8192
ds_read_b64_tr_b16 v[162:163],v215 offset:12288
v_mfma_f32_16x16x32_bf16 v[16:19],v[168:171],a[176:179],v[16:19]
buffer_load_dwordx4 a[236:239],v218,s[24:27],s80 offen offset:3072 sc1
s_waitcnt vmcnt(8)
v_mfma_f32_16x16x32_bf16 v[20:23],v[168:171],a[180:183],v[20:23]
ds_read_b64_tr_b16 v[164:165],v216 offset:8192
ds_read_b64_tr_b16 v[166:167],v216 offset:12288
v_cmp_ne_u32 vcc,1,v247
s_cbranch_vccnz L_slow_hd_5
L_back_hd_5:
v_mfma_f32_16x16x32_bf16 v[24:27],v[172:175],a[176:179],v[24:27]
s_lshl_b32 s90,s40,5
s_add_u32 s90,s90,20
v_mfma_f32_16x16x32_bf16 v[28:31],v[172:175],a[180:183],v[28:31]
ds_read_b64_tr_b16 v[168:169],v217 offset:8192
ds_read_b64_tr_b16 v[170:171],v217 offset:12288
s_waitcnt lgkmcnt(6)
v_mfma_f32_16x16x32_bf16 v[32:35],v[176:179],a[176:179],v[32:35]
buffer_load_dwordx4 v219,s[20:23],s98 offen lds
s_lshl_b32 s90,s90,7
v_mfma_f32_16x16x32_bf16 v[36:39],v[176:179],a[180:183],v[36:39]
ds_read_b64_tr_b16 v[172:173],v213 offset:8192
ds_read_b64_tr_b16 v[174:175],v213 offset:12288
v_mfma_f32_16x16x32_bf16 v[40:43],v[180:183],a[176:179],v[40:43]
v_and_b32 v227,15,v226
v_mul_u32_u24 v227,4,v227
v_mfma_f32_16x16x32_bf16 v[44:47],v[180:183],a[180:183],v[44:47]
ds_read_b64_tr_b16 v[176:177],v215 offset:9216
ds_read_b64_tr_b16 v[178:179],v215 offset:13312
v_mfma_f32_16x16x32_bf16 v[48:51],v[184:187],a[176:179],v[48:51]
buffer_load_dwordx4 v220,s[20:23],s98 offen offset:1024 lds
s_add_u32 m0,s84,63488
v_mfma_f32_16x16x32_bf16 v[52:55],v[184:187],a[180:183],v[52:55]
ds_read_b64_tr_b16 v[180:181],v216 offset:9216
ds_read_b64_tr_b16 v[182:183],v216 offset:13312
v_mfma_f32_16x16x32_bf16 v[56:59],v[188:191],a[176:179],v[56:59]
v_mfma_f32_16x16x32_bf16 v[60:63],v[188:191],a[180:183],v[60:63]
ds_read_b64_tr_b16 v[184:185],v217 offset:9216
ds_read_b64_tr_b16 v[186:187],v217 offset:13312
s_waitcnt lgkmcnt(6)
v_mfma_f32_16x16x32_bf16 v[0:3],v[160:163],a[184:187],v[0:3]
buffer_load_dwordx4 a[240:243],v218,s[24:27],s81 offen sc1
v_mfma_f32_16x16x32_bf16 v[4:7],v[160:163],a[188:191],v[4:7]
ds_read_b64_tr_b16 v[188:189],v213 offset:9216
ds_read_b64_tr_b16 v[190:191],v213 offset:13312
v_mfma_f32_16x16x32_bf16 v[8:11],v[164:167],a[184:187],v[8:11]
v_mfma_f32_16x16x32_bf16 v[12:15],v[164:167],a[188:191],v[12:15]
ds_read_b64_tr_b16 v[160:161],v215 offset:18432
ds_read_b64_tr_b16 v[162:163],v215 offset:22528
v_mfma_f32_16x16x32_bf16 v[16:19],v[168:171],a[184:187],v[16:19]
buffer_load_dwordx4 v221,s[20:23],s98 offen lds
v_mfma_f32_16x16x32_bf16 v[20:23],v[168:171],a[188:191],v[20:23]
s_lshl_b32 s49,s40,2
s_add_u32 s49,s49,s42
v_mfma_f32_16x16x32_bf16 v[24:27],v[172:175],a[184:187],v[24:27]
s_lshl_b32 s50,s49,15
s_add_u32 s50,s50,3145728
v_mfma_f32_16x16x32_bf16 v[28:31],v[172:175],a[188:191],v[28:31]
s_lshl_b32 s51,s45,1
s_add_u32 s51,s51,s44
s_waitcnt lgkmcnt(2)
v_mfma_f32_16x16x32_bf16 v[32:35],v[176:179],a[184:187],v[32:35]
s_add_u32 s51,s51,0
s_and_b32 s51,s51,7
v_mfma_f32_16x16x32_bf16 v[36:39],v[176:179],a[188:191],v[36:39]
buffer_load_dwordx4 a[244:247],v218,s[24:27],s81 offen offset:1024 sc1
s_lshl_b32 s51,s51,12
v_mfma_f32_16x16x32_bf16 v[40:43],v[180:183],a[184:187],v[40:43]
s_add_u32 s51,s51,s50
s_lshl_b32 s52,s45,1
v_mfma_f32_16x16x32_bf16 v[44:47],v[180:183],a[188:191],v[44:47]
s_add_u32 s52,s52,s44
s_add_u32 s52,s52,1
v_mfma_f32_16x16x32_bf16 v[48:51],v[184:187],a[184:187],v[48:51]
s_and_b32 s52,s52,7
s_lshl_b32 s52,s52,12
ds_read_b64_tr_b16 v[164:165],v216 offset:18432
ds_read_b64_tr_b16 v[166:167],v216 offset:22528
ds_read_b64_tr_b16 v[168:169],v217 offset:18432
ds_read_b64_tr_b16 v[170:171],v217 offset:22528
ds_read_b64_tr_b16 v[172:173],v213 offset:18432
ds_read_b64_tr_b16 v[174:175],v213 offset:22528
v_mfma_f32_16x16x32_bf16 v[52:55],v[184:187],a[188:191],v[52:55]
buffer_load_dwordx4 v222,s[20:23],s98 offen offset:1024 lds
s_add_u32 m0,s84,73728
v_mfma_f32_16x16x32_bf16 v[56:59],v[188:191],a[184:187],v[56:59]
s_mul_i32 s98,s83,9
s_lshr_b32 s98,s98,1
v_mfma_f32_16x16x32_bf16 v[60:63],v[188:191],a[188:191],v[60:63]
s_add_u32 s52,s52,s50
s_lshl_b32 s49,s49,1
s_waitcnt lgkmcnt(0)
v_mfma_f32_16x16x32_bf16 v[0:3],v[160:163],a[192:195],v[0:3]
buffer_load_dwordx4 a[248:251],v218,s[24:27],s81 offen offset:2048 sc1
s_add_u32 s49,s49,s47
v_mfma_f32_16x16x32_bf16 v[4:7],v[160:163],a[196:199],v[4:7]
s_lshl_b32 s49,s49,1
s_add_u32 s49,s49,s46
v_mfma_f32_16x16x32_bf16 v[8:11],v[164:167],a[192:195],v[8:11]
s_lshl_b32 s49,s49,10
s_add_u32 s49,s49,2097152
v_mfma_f32_16x16x32_bf16 v[12:15],v[164:167],a[196:199],v[12:15]
buffer_load_dwordx4 a[252:255],v218,s[24:27],s81 offen offset:3072 sc1
ds_read_b64_tr_b16 v[176:177],v215 offset:19456
v_mfma_f32_16x16x32_bf16 v[16:19],v[168:171],a[192:195],v[16:19]
ds_read_b64_tr_b16 v[178:179],v215 offset:23552
ds_read_b64_tr_b16 v[180:181],v216 offset:19456
ds_read_b64_tr_b16 v[182:183],v216 offset:23552
ds_read_b64_tr_b16 v[184:185],v217 offset:19456
ds_read_b64_tr_b16 v[186:187],v217 offset:23552
ds_read_b64_tr_b16 v[188:189],v213 offset:19456
ds_read_b64_tr_b16 v[190:191],v213 offset:23552
v_mfma_f32_16x16x32_bf16 v[20:23],v[168:171],a[196:199],v[20:23]
ds_read_b64_tr_b16 v[160:161],v215 offset:26624
ds_read_b64_tr_b16 v[162:163],v215 offset:30720
buffer_load_dword v247,v227,s[24:27],s90 offen sc1
v_mfma_f32_16x16x32_bf16 v[24:27],v[172:175],a[192:195],v[24:27]
buffer_load_dwordx4 v219,s[20:23],s98 offen lds
ds_read_b64_tr_b16 v[164:165],v216 offset:26624
v_mfma_f32_16x16x32_bf16 v[28:31],v[172:175],a[196:199],v[28:31]
ds_read_b64_tr_b16 v[166:167],v216 offset:30720
ds_read_b64_tr_b16 v[168:169],v217 offset:26624
s_waitcnt lgkmcnt(5)
v_mfma_f32_16x16x32_bf16 v[32:35],v[176:179],a[192:195],v[32:35]
ds_read_b64_tr_b16 v[170:171],v217 offset:30720
v_lshrrev_b32 v244,4,v226
v_mfma_f32_16x16x32_bf16 v[36:39],v[176:179],a[196:199],v[36:39]
ds_read_b64_tr_b16 v[172:173],v213 offset:26624
ds_read_b64_tr_b16 v[174:175],v213 offset:30720
v_mfma_f32_16x16x32_bf16 v[40:43],v[180:183],a[192:195],v[40:43]
v_lshlrev_b32 v244,8,v244
v_and_b32 v245,15,v226
v_mfma_f32_16x16x32_bf16 v[44:47],v[180:183],a[196:199],v[44:47]
buffer_load_dwordx4 v220,s[20:23],s98 offen offset:1024 lds
s_add_u32 m0,s84,81920
v_mfma_f32_16x16x32_bf16 v[48:51],v[184:187],a[192:195],v[48:51]
ds_read_b64_tr_b16 v[176:177],v215 offset:27648
ds_read_b64_tr_b16 v[178:179],v215 offset:31744
v_mfma_f32_16x16x32_bf16 v[52:55],v[184:187],a[196:199],v[52:55]
ds_read_b64_tr_b16 v[180:181],v216 offset:27648
ds_read_b64_tr_b16 v[182:183],v216 offset:31744
v_mfma_f32_16x16x32_bf16 v[56:59],v[188:191],a[192:195],v[56:59]
v_lshl_add_u32 v244,v245,2,v244
v_mfma_f32_16x16x32_bf16 v[60:63],v[188:191],a[196:199],v[60:63]
buffer_load_dwordx4 a[0:3],v218,s[24:27],s82 offen sc1
ds_read_b64_tr_b16 v[184:185],v217 offset:27648
s_waitcnt lgkmcnt(5)
v_mfma_f32_16x16x32_bf16 v[0:3],v[160:163],a[200:203],v[0:3]
ds_read_b64_tr_b16 v[186:187],v217 offset:31744
v_and_b32 v248,15,v226
v_mfma_f32_16x16x32_bf16 v[4:7],v[160:163],a[204:207],v[4:7]
ds_read_b64_tr_b16 v[188:189],v213 offset:27648
ds_read_b64_tr_b16 v[190:191],v213 offset:31744
v_mfma_f32_16x16x32_bf16 v[8:11],v[164:167],a[200:203],v[8:11]
v_lshrrev_b32 v200,4,v226
v_lshlrev_b32 v200,2,v200
v_mfma_f32_16x16x32_bf16 v[12:15],v[164:167],a[204:207],v[12:15]
buffer_load_dwordx4 a[16:19],v218,s[24:27],s83 offen sc1
v_mfma_f32_16x16x32_bf16 v[16:19],v[168:171],a[200:203],v[16:19]
s_barrier
ds_read_b64_tr_b16 v[160:161],v215 offset:36864
v_mfma_f32_16x16x32_bf16 v[20:23],v[168:171],a[204:207],v[20:23]
ds_read_b64_tr_b16 v[162:163],v215 offset:40960
ds_read_b64_tr_b16 v[164:165],v216 offset:36864
v_mfma_f32_16x16x32_bf16 v[24:27],v[172:175],a[200:203],v[24:27]
ds_read_b64_tr_b16 v[166:167],v216 offset:40960
v_sub_u32 v248,v248,v200
v_mfma_f32_16x16x32_bf16 v[28:31],v[172:175],a[204:207],v[28:31]
buffer_load_dwordx4 v221,s[20:23],s98 offen lds
ds_read_b64_tr_b16 v[168:169],v217 offset:36864
s_waitcnt lgkmcnt(5)
v_mfma_f32_16x16x32_bf16 v[32:35],v[176:179],a[200:203],v[32:35]
ds_read_b64_tr_b16 v[170:171],v217 offset:40960
v_and_b32 v200,1,v248
v_mfma_f32_16x16x32_bf16 v[36:39],v[176:179],a[204:207],v[36:39]
ds_read_b64_tr_b16 v[172:173],v213 offset:36864
ds_read_b64_tr_b16 v[174:175],v213 offset:40960
v_mfma_f32_16x16x32_bf16 v[40:43],v[180:183],a[200:203],v[40:43]
v_lshrrev_b32 v248,1,v248
v_lshlrev_b32 v200,4,v200
v_mfma_f32_16x16x32_bf16 v[44:47],v[180:183],a[204:207],v[44:47]
buffer_load_dwordx4 a[4:7],v218,s[24:27],s82 offen offset:1024 sc1
ds_read_b64_tr_b16 v[176:177],v215 offset:37888
v_mfma_f32_16x16x32_bf16 v[48:51],v[184:187],a[200:203],v[48:51]
ds_read_b64_tr_b16 v[178:179],v215 offset:41984
v_mov_b32 v201,0x3f80
v_mfma_f32_16x16x32_bf16 v[52:55],v[184:187],a[204:207],v[52:55]
ds_read_b64_tr_b16 v[180:181],v216 offset:37888
ds_read_b64_tr_b16 v[182:183],v216 offset:41984
v_mfma_f32_16x16x32_bf16 v[56:59],v[188:191],a[200:203],v[56:59]
s_waitcnt vmcnt(6)
v_lshlrev_b32 v201,v200,v201
v_mfma_f32_16x16x32_bf16 v[60:63],v[188:191],a[204:207],v[60:63]
buffer_load_dwordx4 a[20:23],v218,s[24:27],s83 offen offset:1024 sc1
ds_read_b64_tr_b16 v[184:185],v217 offset:37888
s_waitcnt lgkmcnt(5)
v_mfma_f32_16x16x32_bf16 v[0:3],v[160:163],a[208:211],v[0:3]
ds_read_b64_tr_b16 v[186:187],v217 offset:41984
v_mov_b32 v200,0
v_mfma_f32_16x16x32_bf16 v[4:7],v[160:163],a[212:215],v[4:7]
ds_read_b64_tr_b16 v[188:189],v213 offset:37888
ds_read_b64_tr_b16 v[190:191],v213 offset:41984
v_cmp_ne_u32 vcc,1,v247
s_cbranch_vccnz L_slow_o_5
L_back_o_5:
v_mfma_f32_16x16x32_bf16 v[8:11],v[164:167],a[208:211],v[8:11]
v_cmp_eq_u32 vcc,0,v248
v_mov_b32 v204,0
v_mfma_f32_16x16x32_bf16 v[12:15],v[164:167],a[212:215],v[12:15]
buffer_load_dwordx4 v[64:67],v212,s[24:27],s51 offen sc1
ds_read_b64_tr_b16 v[160:161],v215 offset:45056
v_mfma_f32_16x16x32_bf16 v[16:19],v[168:171],a[208:211],v[16:19]
ds_read_b64_tr_b16 v[162:163],v215 offset:49152
v_cndmask_b32 v202,0,v201,vcc
v_mfma_f32_16x16x32_bf16 v[20:23],v[168:171],a[212:215],v[20:23]
ds_read_b64_tr_b16 v[164:165],v216 offset:45056
ds_read_b64_tr_b16 v[166:167],v216 offset:49152
v_mfma_f32_16x16x32_bf16 v[24:27],v[172:175],a[208:211],v[24:27]
v_cmp_eq_u32 vcc,1,v248
v_mov_b32 v205,0
v_mfma_f32_16x16x32_bf16 v[28:31],v[172:175],a[212:215],v[28:31]
buffer_load_dwordx4 v[68:71],v212,s[24:27],s51 offen offset:1024 sc1
ds_read_b64_tr_b16 v[168:169],v217 offset:45056
s_waitcnt lgkmcnt(5)
v_mfma_f32_16x16x32_bf16 v[32:35],v[176:179],a[208:211],v[32:35]
ds_read_b64_tr_b16 v[170:171],v217 offset:49152
v_cndmask_b32 v203,0,v201,vcc
v_mfma_f32_16x16x32_bf16 v[36:39],v[176:179],a[212:215],v[36:39]
ds_read_b64_tr_b16 v[172:173],v213 offset:45056
ds_read_b64_tr_b16 v[174:175],v213 offset:49152
v_mfma_f32_16x16x32_bf16 v[40:43],v[180:183],a[208:211],v[40:43]
v_mov_b32 v201,0
v_mfma_f32_16x16x32_bf16 v[44:47],v[180:183],a[212:215],v[44:47]
buffer_load_dwordx4 v[72:75],v212,s[24:27],s51 offen offset:2048 sc1
ds_read_b64_tr_b16 v[176:177],v215 offset:46080
v_mfma_f32_16x16x32_bf16 v[48:51],v[184:187],a[208:211],v[48:51]
ds_read_b64_tr_b16 v[178:179],v215 offset:50176
v_mfma_f32_16x16x32_bf16 v[52:55],v[184:187],a[212:215],v[52:55]
ds_read_b64_tr_b16 v[180:181],v216 offset:46080
ds_read_b64_tr_b16 v[182:183],v216 offset:50176
v_mfma_f32_16x16x32_bf16 v[56:59],v[188:191],a[208:211],v[56:59]
v_mfma_f32_16x16x32_bf16 v[60:63],v[188:191],a[212:215],v[60:63]
buffer_load_dwordx4 v222,s[20:23],s98 offen offset:1024 lds
ds_read_b64_tr_b16 v[184:185],v217 offset:46080
s_waitcnt lgkmcnt(5)
v_mfma_f32_16x16x32_bf16 v[0:3],v[160:163],a[216:219],v[0:3]
ds_read_b64_tr_b16 v[186:187],v217 offset:50176
v_mfma_f32_16x16x32_bf16 v[4:7],v[160:163],a[220:223],v[4:7]
ds_read_b64_tr_b16 v[188:189],v213 offset:46080
ds_read_b64_tr_b16 v[190:191],v213 offset:50176
v_mfma_f32_16x16x32_bf16 v[8:11],v[164:167],a[216:219],v[8:11]
v_mfma_f32_16x16x32_bf16 v[12:15],v[164:167],a[220:223],v[12:15]
buffer_load_dwordx4 a[8:11],v218,s[24:27],s82 offen offset:2048 sc1
v_subrev_u32 v215,73728,v215
ds_read_b64_tr_b16 v[160:161],v215 offset:0
v_mfma_f32_16x16x32_bf16 v[16:19],v[168:171],a[216:219],v[16:19]
ds_read_b64_tr_b16 v[162:163],v215 offset:4096
v_mfma_f32_16x16x32_bf16 v[20:23],v[168:171],a[220:223],v[20:23]
v_subrev_u32 v216,73728,v216
ds_read_b64_tr_b16 v[164:165],v216 offset:0
ds_read_b64_tr_b16 v[166:167],v216 offset:4096
v_mfma_f32_16x16x32_bf16 v[24:27],v[172:175],a[216:219],v[24:27]
v_mfma_f32_16x16x32_bf16 v[28:31],v[172:175],a[220:223],v[28:31]
buffer_load_dwordx4 v[76:79],v212,s[24:27],s51 offen offset:3072 sc1
v_subrev_u32 v217,73728,v217
s_waitcnt lgkmcnt(4)
v_mfma_f32_16x16x32_bf16 v[32:35],v[176:179],a[216:219],v[32:35]
ds_read_b64_tr_b16 v[168:169],v217 offset:0
ds_read_b64_tr_b16 v[170:171],v217 offset:4096
v_mfma_f32_16x16x32_bf16 v[36:39],v[176:179],a[220:223],v[36:39]
v_subrev_u32 v213,73728,v213
ds_read_b64_tr_b16 v[172:173],v213 offset:0
v_mfma_f32_16x16x32_bf16 v[40:43],v[180:183],a[216:219],v[40:43]
ds_read_b64_tr_b16 v[174:175],v213 offset:4096
v_mfma_f32_16x16x32_bf16 v[44:47],v[180:183],a[220:223],v[44:47]
buffer_load_dwordx4 a[24:27],v218,s[24:27],s83 offen offset:2048 sc1
ds_read_b64_tr_b16 v[176:177],v215 offset:1024
v_mfma_f32_16x16x32_bf16 v[48:51],v[184:187],a[216:219],v[48:51]
ds_read_b64_tr_b16 v[178:179],v215 offset:5120
v_mfma_f32_16x16x32_bf16 v[52:55],v[184:187],a[220:223],v[52:55]
ds_read_b64_tr_b16 v[180:181],v216 offset:1024
ds_read_b64_tr_b16 v[182:183],v216 offset:5120
v_mfma_f32_16x16x32_bf16 v[56:59],v[188:191],a[216:219],v[56:59]
v_mfma_f32_16x16x32_bf16 v[60:63],v[188:191],a[220:223],v[60:63]
buffer_load_dwordx4 a[12:15],v218,s[24:27],s82 offen offset:3072 sc1
ds_read_b64_tr_b16 v[184:185],v217 offset:1024
ds_read_b64_tr_b16 v[186:187],v217 offset:5120
s_waitcnt lgkmcnt(6)
v_mfma_f32_16x16x32_bf16 v[0:3],v[160:163],a[224:227],v[0:3]
v_mfma_f32_16x16x32_bf16 v[4:7],v[160:163],a[228:231],v[4:7]
ds_read_b64_tr_b16 v[188:189],v213 offset:1024
ds_read_b64_tr_b16 v[190:191],v213 offset:5120
s_mov_b32 s55,18432
v_mfma_f32_16x16x32_bf16 v[8:11],v[164:167],a[224:227],v[8:11]
buffer_load_dwordx4 v[80:83],v212,s[24:27],s52 offen sc1
v_and_b32 v251,15,v226
s_lshl_b32 s53,s40,2
v_mfma_f32_16x16x32_bf16 v[12:15],v[164:167],a[228:231],v[12:15]
ds_read_b64_tr_b16 v[160:161],v215 offset:8192
ds_read_b64_tr_b16 v[162:163],v215 offset:12288
s_add_u32 s53,s53,s42
v_mfma_f32_16x16x32_bf16 v[16:19],v[168:171],a[224:227],v[16:19]
s_lshl_b32 s53,s53,5
v_add_u32 v211,s53,v251
v_mul_u32_u24 v211,1152,v211
v_mfma_f32_16x16x32_bf16 v[20:23],v[168:171],a[228:231],v[20:23]
ds_read_b64_tr_b16 v[164:165],v216 offset:8192
ds_read_b64_tr_b16 v[166:167],v216 offset:12288
v_lshrrev_b32 v250,5,v226
v_mfma_f32_16x16x32_bf16 v[24:27],v[172:175],a[224:227],v[24:27]
buffer_load_dwordx4 a[28:31],v218,s[24:27],s83 offen offset:3072 sc1
v_lshl_add_u32 v211,v250,4,v211
s_lshl_b32 s53,s43,3
v_mfma_f32_16x16x32_bf16 v[28:31],v[172:175],a[228:231],v[28:31]
ds_read_b64_tr_b16 v[168:169],v217 offset:8192
ds_read_b64_tr_b16 v[170:171],v217 offset:12288
s_waitcnt lgkmcnt(6)
v_mfma_f32_16x16x32_bf16 v[32:35],v[176:179],a[224:227],v[32:35]
s_mul_i32 s54,s46,92160
s_add_u32 s54,s54,0
v_add_u32 v245,s54,v212
v_mfma_f32_16x16x32_bf16 v[36:39],v[176:179],a[228:231],v[36:39]
ds_read_b64_tr_b16 v[172:173],v213 offset:8192
ds_read_b64_tr_b16 v[174:175],v213 offset:12288
s_lshl_b32 s100,s47,13
v_mfma_f32_16x16x32_bf16 v[40:43],v[180:183],a[224:227],v[40:43]
buffer_load_dwordx4 v[84:87],v212,s[24:27],s52 offen offset:1024 sc1
s_lshr_b32 s53,0x0e0a0400,s53
s_and_b32 s53,s53,0xff
v_mfma_f32_16x16x32_bf16 v[44:47],v[180:183],a[228:231],v[44:47]
s_add_u32 m0,s84,110592
ds_read_b64_tr_b16 v[176:177],v215 offset:9216
ds_read_b64_tr_b16 v[178:179],v215 offset:13312
v_mfma_f32_16x16x32_bf16 v[48:51],v[184:187],a[224:227],v[48:51]
v_add_u32 v221,4608,v221
v_add_u32 v222,4608,v222
s_add_u32 s53,s53,s45
v_mfma_f32_16x16x32_bf16 v[52:55],v[184:187],a[228:231],v[52:55]
buffer_load_dwordx4 v[88:91],v212,s[24:27],s52 offen offset:2048 sc1
ds_read_b64_tr_b16 v[180:181],v216 offset:9216
ds_read_b64_tr_b16 v[182:183],v216 offset:13312
v_mfma_f32_16x16x32_bf16 v[56:59],v[188:191],a[224:227],v[56:59]
s_lshl_b32 s53,s53,6
v_bfe_u32 v250,v226,4,1
v_lshl_add_u32 v210,v250,5,v211
v_mfma_f32_16x16x32_bf16 v[60:63],v[188:191],a[228:231],v[60:63]
ds_read_b64_tr_b16 v[184:185],v217 offset:9216
ds_read_b64_tr_b16 v[186:187],v217 offset:13312
s_waitcnt lgkmcnt(6)
v_mfma_f32_16x16x32_bf16 v[0:3],v[160:163],a[232:235],v[0:3]
v_add_u32 v210,s53,v210
s_lshl_b32 s53,s42,7
s_add_u32 s53,s53,159744
v_mfma_f32_16x16x32_bf16 v[4:7],v[160:163],a[236:239],v[4:7]
buffer_load_dwordx4 v[92:95],v212,s[24:27],s52 offen offset:3072 sc1
ds_read_b64_tr_b16 v[188:189],v213 offset:9216
ds_read_b64_tr_b16 v[190:191],v213 offset:13312
v_mfma_f32_16x16x32_bf16 v[8:11],v[164:167],a[232:235],v[8:11]
v_lshl_add_u32 v251,v251,2,s53
v_mfma_f32_16x16x32_bf16 v[12:15],v[164:167],a[236:239],v[12:15]
s_barrier
ds_read_b64_tr_b16 v[160:161],v215 offset:18432
v_mfma_f32_16x16x32_bf16 v[16:19],v[168:171],a[232:235],v[16:19]
ds_read_b64_tr_b16 v[162:163],v215 offset:22528
v_mfma_f32_16x16x32_bf16 v[20:23],v[168:171],a[236:239],v[20:23]
buffer_load_dword v144,v244,s[24:27],s49 offen sc1
ds_read_b64_tr_b16 v[164:165],v216 offset:18432
ds_read_b64_tr_b16 v[166:167],v216 offset:22528
v_mfma_f32_16x16x32_bf16 v[24:27],v[172:175],a[232:235],v[24:27]
buffer_load_dword v145,v244,s[24:27],s49 offen offset:64 sc1
v_mfma_f32_16x16x32_bf16 v[28:31],v[172:175],a[236:239],v[28:31]
ds_read_b64_tr_b16 v[168:169],v217 offset:18432
ds_read_b64_tr_b16 v[170:171],v217 offset:22528
s_waitcnt lgkmcnt(6)
v_mfma_f32_16x16x32_bf16 v[32:35],v[176:179],a[232:235],v[32:35]
buffer_load_dword v146,v244,s[24:27],s49 offen offset:128 sc1
v_mfma_f32_16x16x32_bf16 v[36:39],v[176:179],a[236:239],v[36:39]
buffer_load_dword v147,v244,s[24:27],s49 offen offset:192 sc1
ds_read_b64_tr_b16 v[172:173],v213 offset:18432
ds_read_b64_tr_b16 v[174:175],v213 offset:22528
v_mfma_f32_16x16x32_bf16 v[40:43],v[180:183],a[232:235],v[40:43]
v_add_u32 v244,s100,v245
s_lshl_b32 s100,s47,10
s_add_u32 s100,s100,16384
v_mfma_f32_16x16x32_bf16 v[44:47],v[180:183],a[236:239],v[44:47]
buffer_load_dwordx4 v219,s[36:39],s57 offen lds
ds_read_b64_tr_b16 v[176:177],v215 offset:19456
ds_read_b64_tr_b16 v[178:179],v215 offset:23552
v_mfma_f32_16x16x32_bf16 v[48:51],v[184:187],a[232:235],v[48:51]
v_add_u32 v245,s100,v245
v_add_u32 v246,8,v244
v_mfma_f32_16x16x32_bf16 v[52:55],v[184:187],a[236:239],v[52:55]
ds_read_b64_tr_b16 v[180:181],v216 offset:19456
ds_read_b64_tr_b16 v[182:183],v216 offset:23552
v_mfma_f32_16x16x32_bf16 v[56:59],v[188:191],a[232:235],v[56:59]
v_mfma_f32_16x16x32_bf16 v[60:63],v[188:191],a[236:239],v[60:63]
buffer_load_dwordx4 v220,s[36:39],s57 offen offset:1024 lds
s_add_u32 m0,s84,118784
ds_read_b64_tr_b16 v[184:185],v217 offset:19456
s_waitcnt lgkmcnt(5)
v_mfma_f32_16x16x32_bf16 v[0:3],v[160:163],a[240:243],v[0:3]
ds_read_b64_tr_b16 v[186:187],v217 offset:23552
v_mfma_f32_16x16x32_bf16 v[4:7],v[160:163],a[244:247],v[4:7]
ds_read_b64_tr_b16 v[188:189],v213 offset:19456
ds_read_b64_tr_b16 v[190:191],v213 offset:23552
v_mfma_f32_16x16x32_bf16 v[8:11],v[164:167],a[240:243],v[8:11]
v_mfma_f32_16x16x32_bf16 v[12:15],v[164:167],a[244:247],v[12:15]
buffer_load_dwordx4 v221,s[36:39],s57 offen lds
ds_read_b64_tr_b16 v[160:161],v215 offset:26624
ds_read_b64_tr_b16 v[162:163],v215 offset:30720
v_mfma_f32_16x16x32_bf16 v[16:19],v[168:171],a[240:243],v[16:19]
v_mfma_f32_16x16x32_bf16 v[20:23],v[168:171],a[244:247],v[20:23]
ds_read_b64_tr_b16 v[164:165],v216 offset:26624
ds_read_b64_tr_b16 v[166:167],v216 offset:30720
v_mfma_f32_16x16x32_bf16 v[24:27],v[172:175],a[240:243],v[24:27]
v_mfma_f32_16x16x32_bf16 v[28:31],v[172:175],a[244:247],v[28:31]
buffer_load_dwordx4 v222,s[36:39],s57 offen offset:1024 lds
s_add_u32 m0,s84,129024
ds_read_b64_tr_b16 v[168:169],v217 offset:26624
s_waitcnt lgkmcnt(5)
v_mfma_f32_16x16x32_bf16 v[32:35],v[176:179],a[240:243],v[32:35]
ds_read_b64_tr_b16 v[170:171],v217 offset:30720
v_mfma_f32_16x16x32_bf16 v[36:39],v[176:179],a[244:247],v[36:39]
ds_read_b64_tr_b16 v[172:173],v213 offset:26624
ds_read_b64_tr_b16 v[174:175],v213 offset:30720
v_mfma_f32_16x16x32_bf16 v[40:43],v[180:183],a[240:243],v[40:43]
v_mfma_f32_16x16x32_bf16 v[44:47],v[180:183],a[244:247],v[44:47]
buffer_load_dwordx4 v219,s[36:39],s58 offen lds
ds_read_b64_tr_b16 v[176:177],v215 offset:27648
ds_read_b64_tr_b16 v[178:179],v215 offset:31744
v_mfma_f32_16x16x32_bf16 v[48:51],v[184:187],a[240:243],v[48:51]
v_mfma_f32_16x16x32_bf16 v[52:55],v[184:187],a[244:247],v[52:55]
ds_read_b64_tr_b16 v[180:181],v216 offset:27648
ds_read_b64_tr_b16 v[182:183],v216 offset:31744
v_mfma_f32_16x16x32_bf16 v[56:59],v[188:191],a[240:243],v[56:59]
v_mfma_f32_16x16x32_bf16 v[60:63],v[188:191],a[244:247],v[60:63]
buffer_load_dwordx4 v220,s[36:39],s58 offen offset:1024 lds
s_add_u32 m0,s84,137216
ds_read_b64_tr_b16 v[184:185],v217 offset:27648
s_waitcnt lgkmcnt(5)
v_mfma_f32_16x16x32_bf16 v[0:3],v[160:163],a[248:251],v[0:3]
ds_read_b64_tr_b16 v[186:187],v217 offset:31744
v_mfma_f32_16x16x32_bf16 v[4:7],v[160:163],a[252:255],v[4:7]
ds_read_b64_tr_b16 v[188:189],v213 offset:27648
ds_read_b64_tr_b16 v[190:191],v213 offset:31744
v_mfma_f32_16x16x32_bf16 v[8:11],v[164:167],a[248:251],v[8:11]
v_mfma_f32_16x16x32_bf16 v[12:15],v[164:167],a[252:255],v[12:15]
buffer_load_dwordx4 v221,s[36:39],s58 offen lds
ds_read_b64_tr_b16 v[160:161],v215 offset:36864
ds_read_b64_tr_b16 v[162:163],v215 offset:40960
v_mfma_f32_16x16x32_bf16 v[16:19],v[168:171],a[248:251],v[16:19]
ds_read_b32 v208,v251 offset:0
ds_read_b32 v209,v251 offset:64
v_mfma_f32_16x16x32_bf16 v[20:23],v[168:171],a[252:255],v[20:23]
ds_read_b64_tr_b16 v[164:165],v215 offset:45056
ds_read_b64_tr_b16 v[166:167],v215 offset:49152
v_mfma_f32_16x16x32_bf16 v[24:27],v[172:175],a[248:251],v[24:27]
v_mfma_f32_16x16x32_bf16 v[28:31],v[172:175],a[252:255],v[28:31]
buffer_load_dwordx4 v222,s[36:39],s58 offen offset:1024 lds
s_add_u32 m0,s84,18432
s_waitcnt vmcnt(21)
s_waitcnt lgkmcnt(6)
v_mfma_f32_16x16x32_bf16 v[32:35],v[176:179],a[248:251],v[32:35]
s_barrier
ds_read_b64_tr_b16 v[168:169],v215 offset:55296
ds_read_b64_tr_b16 v[170:171],v215 offset:59392
v_mfma_f32_16x16x32_bf16 v[36:39],v[176:179],a[252:255],v[36:39]
v_add_u32 v215,55296,v215
ds_read_b64_tr_b16 v[172:173],v215 offset:8192
ds_read_b64_tr_b16 v[174:175],v215 offset:12288
v_mfma_f32_16x16x32_bf16 v[40:43],v[180:183],a[248:251],v[40:43]
v_mfma_f32_16x16x32_bf16 v[44:47],v[180:183],a[252:255],v[44:47]
buffer_load_dwordx4 v219,s[36:39],s59 offen lds
ds_read_b64_tr_b16 v[176:177],v216 offset:36864
ds_read_b64_tr_b16 v[178:179],v216 offset:40960
v_mfma_f32_16x16x32_bf16 v[48:51],v[184:187],a[248:251],v[48:51]
v_mfma_f32_16x16x32_bf16 v[52:55],v[184:187],a[252:255],v[52:55]
ds_read_b64_tr_b16 v[180:181],v216 offset:45056
ds_read_b64_tr_b16 v[182:183],v216 offset:49152
v_mfma_f32_16x16x32_bf16 v[56:59],v[188:191],a[248:251],v[56:59]
v_mfma_f32_16x16x32_bf16 v[60:63],v[188:191],a[252:255],v[60:63]
s_getpc_b64 s[0:1]
L_cp8_5:
v_min_u32 v254,L_stop_5-L_cp8_5,v253
global_load_dword v255,v254,s[0:1]
s_waitcnt lgkmcnt(4)
s_waitcnt vmcnt(19)
v_mfma_f32_16x16x32_bf16 v[0:3],v[160:163],a[0:3],v[0:3]
ds_read_b64_tr_b16 v[184:185],v216 offset:55296
ds_read_b64_tr_b16 v[186:187],v216 offset:59392
v_mfma_f32_16x16x32_bf16 v[4:7],v[160:163],a[4:7],v[4:7]
buffer_load_dwordx4 v220,s[36:39],s59 offen offset:1024 lds
s_add_u32 m0,s84,26624
v_add_u32 v216,55296,v216
v_mfma_f32_16x16x32_bf16 v[0:3],v[164:167],a[8:11],v[0:3]
ds_read_b64_tr_b16 v[188:189],v216 offset:8192
ds_read_b64_tr_b16 v[190:191],v216 offset:12288
v_mfma_f32_16x16x32_bf16 v[4:7],v[164:167],a[12:15],v[4:7]
ds_read_b64_tr_b16 v[160:161],v217 offset:36864
ds_read_b64_tr_b16 v[162:163],v217 offset:40960
s_waitcnt vmcnt(18)
v_mfma_f32_16x16x32_bf16 v[0:3],v[168:171],a[16:19],v[0:3]
v_mfma_f32_16x16x32_bf16 v[4:7],v[168:171],a[20:23],v[4:7]
buffer_load_dwordx4 v221,s[36:39],s59 offen lds
ds_read_b64_tr_b16 v[164:165],v217 offset:45056
ds_read_b64_tr_b16 v[166:167],v217 offset:49152
v_mfma_f32_16x16x32_bf16 v[0:3],v[172:175],a[24:27],v[0:3]
v_mfma_f32_16x16x32_bf16 v[4:7],v[172:175],a[28:31],v[4:7]
ds_read_b64_tr_b16 v[168:169],v217 offset:55296
ds_read_b64_tr_b16 v[170:171],v217 offset:59392
s_waitcnt lgkmcnt(6)
v_mfma_f32_16x16x32_bf16 v[8:11],v[176:179],a[0:3],v[8:11]
v_mfma_f32_16x16x32_bf16 v[12:15],v[176:179],a[4:7],v[12:15]
buffer_load_dwordx4 v222,s[36:39],s59 offen offset:1024 lds
v_add_u32 v217,55296,v217
v_cvt_pk_bf16_f32 v0,v0,v1
v_cvt_pk_bf16_f32 v1,v2,v3
v_mfma_f32_16x16x32_bf16 v[8:11],v[180:183],a[8:11],v[8:11]
v_cvt_pk_bf16_f32 v4,v4,v5
v_cvt_pk_bf16_f32 v5,v6,v7
ds_read_b64_tr_b16 v[172:173],v217 offset:8192
v_mfma_f32_16x16x32_bf16 v[12:15],v[180:183],a[12:15],v[12:15]
ds_read_b64_tr_b16 v[174:175],v217 offset:12288
ds_read_b64_tr_b16 v[176:177],v213 offset:36864
ds_read_b64_tr_b16 v[178:179],v213 offset:40960
v_mfma_f32_16x16x32_bf16 v[8:11],v[184:187],a[16:19],v[8:11]
v_mfma_f32_16x16x32_bf16 v[12:15],v[184:187],a[20:23],v[12:15]
ds_read_b64_tr_b16 v[180:181],v213 offset:45056
ds_read_b64_tr_b16 v[182:183],v213 offset:49152
v_mfma_f32_16x16x32_bf16 v[8:11],v[188:191],a[24:27],v[8:11]
v_mfma_f32_16x16x32_bf16 v[12:15],v[188:191],a[28:31],v[12:15]
ds_read_b64_tr_b16 v[184:185],v213 offset:55296
ds_read_b64_tr_b16 v[186:187],v213 offset:59392
s_waitcnt lgkmcnt(6)
v_mfma_f32_16x16x32_bf16 v[16:19],v[160:163],a[0:3],v[16:19]
v_mfma_f32_16x16x32_bf16 v[20:23],v[160:163],a[4:7],v[20:23]
v_add_u32 v213,55296,v213
s_nop 0
v_cvt_pk_bf16_f32 v2,v8,v9
v_cvt_pk_bf16_f32 v3,v10,v11
buffer_store_dwordx4 v[0:3],v239,s[24:27],s86 offen sc1
v_mfma_f32_16x16x32_bf16 v[16:19],v[164:167],a[8:11],v[16:19]
v_cvt_pk_bf16_f32 v6,v12,v13
v_cvt_pk_bf16_f32 v7,v14,v15
buffer_store_dwordx4 v[4:7],v239,s[24:27],s87 offen sc1
v_mfma_f32_16x16x32_bf16 v[20:23],v[164:167],a[12:15],v[20:23]
v_subrev_u32 v215,18432,v215
ds_read_b64_tr_b16 v[188:189],v213 offset:8192
ds_read_b64_tr_b16 v[190:191],v213 offset:12288
v_mfma_f32_16x16x32_bf16 v[16:19],v[168:171],a[16:19],v[16:19]
ds_read_b64_tr_b16 v[160:161],v215 offset:1024
ds_read_b64_tr_b16 v[162:163],v215 offset:5120
v_mfma_f32_16x16x32_bf16 v[20:23],v[168:171],a[20:23],v[20:23]
ds_read_b64_tr_b16 v[164:165],v215 offset:9216
ds_read_b64_tr_b16 v[166:167],v215 offset:13312
v_mfma_f32_16x16x32_bf16 v[16:19],v[172:175],a[24:27],v[16:19]
s_mov_b64 exec,s[16:17]
ds_write_b128 v240,v[0:3] offset:0
s_mov_b64 exec,-1
s_nop 0
v_mfma_f32_16x16x32_bf16 v[20:23],v[172:175],a[28:31],v[20:23]
ds_read_b64_tr_b16 v[168:169],v215 offset:19456
ds_read_b64_tr_b16 v[170:171],v215 offset:23552
s_waitcnt lgkmcnt(6)
v_mfma_f32_16x16x32_bf16 v[24:27],v[176:179],a[0:3],v[24:27]
s_mov_b64 exec,s[16:17]
ds_write_b128 v240,v[4:7] offset:4096
s_mov_b64 exec,-1
s_nop 0
v_mfma_f32_16x16x32_bf16 v[28:31],v[176:179],a[4:7],v[28:31]
v_cvt_pk_bf16_f32 v16,v16,v17
v_cvt_pk_bf16_f32 v17,v18,v19
ds_read_b64_tr_b16 v[172:173],v215 offset:27648
v_mfma_f32_16x16x32_bf16 v[24:27],v[180:183],a[8:11],v[24:27]
v_cvt_pk_bf16_f32 v20,v20,v21
v_cvt_pk_bf16_f32 v21,v22,v23
ds_read_b64_tr_b16 v[174:175],v215 offset:31744
v_mfma_f32_16x16x32_bf16 v[28:31],v[180:183],a[12:15],v[28:31]
v_subrev_u32 v216,18432,v216
ds_read_b64_tr_b16 v[176:177],v216 offset:1024
ds_read_b64_tr_b16 v[178:179],v216 offset:5120
v_mfma_f32_16x16x32_bf16 v[24:27],v[184:187],a[16:19],v[24:27]
v_mfma_f32_16x16x32_bf16 v[28:31],v[184:187],a[20:23],v[28:31]
ds_read_b64_tr_b16 v[180:181],v216 offset:9216
ds_read_b64_tr_b16 v[182:183],v216 offset:13312
v_mfma_f32_16x16x32_bf16 v[24:27],v[188:191],a[24:27],v[24:27]
v_mfma_f32_16x16x32_bf16 v[28:31],v[188:191],a[28:31],v[28:31]
ds_read_b64_tr_b16 v[184:185],v216 offset:19456
ds_read_b64_tr_b16 v[186:187],v216 offset:23552
s_waitcnt lgkmcnt(6)
v_mfma_f32_16x16x32_bf16 v[32:35],v[160:163],a[0:3],v[32:35]
v_mfma_f32_16x16x32_bf16 v[36:39],v[160:163],a[4:7],v[36:39]
s_nop 1
v_cvt_pk_bf16_f32 v18,v24,v25
v_cvt_pk_bf16_f32 v19,v26,v27
buffer_store_dwordx4 v[16:19],v239,s[24:27],s86 offen offset:1024 sc1
ds_read_b64_tr_b16 v[188:189],v216 offset:27648
v_mfma_f32_16x16x32_bf16 v[32:35],v[164:167],a[8:11],v[32:35]
v_cvt_pk_bf16_f32 v22,v28,v29
v_cvt_pk_bf16_f32 v23,v30,v31
buffer_store_dwordx4 v[20:23],v239,s[24:27],s87 offen offset:1024 sc1
ds_read_b64_tr_b16 v[190:191],v216 offset:31744
v_mfma_f32_16x16x32_bf16 v[36:39],v[164:167],a[12:15],v[36:39]
v_subrev_u32 v217,18432,v217
ds_read_b64_tr_b16 v[160:161],v217 offset:1024
ds_read_b64_tr_b16 v[162:163],v217 offset:5120
v_mfma_f32_16x16x32_bf16 v[32:35],v[168:171],a[16:19],v[32:35]
s_mov_b64 exec,s[16:17]
ds_write_b128 v240,v[16:19] offset:1024
s_mov_b64 exec,-1
s_nop 0
v_mfma_f32_16x16x32_bf16 v[36:39],v[168:171],a[20:23],v[36:39]
ds_read_b64_tr_b16 v[164:165],v217 offset:9216
ds_read_b64_tr_b16 v[166:167],v217 offset:13312
s_waitcnt vmcnt(17)
v_mfma_f32_16x16x32_bf16 v[32:35],v[172:175],a[24:27],v[32:35]
ds_write2st64_b64 v244,v[64:65],v[66:67] offset0:0 offset1:2
ds_write2st64_b64 v246,v[68:69],v[70:71] offset0:0 offset1:2
ds_write2st64_b64 v244,v[72:73],v[74:75] offset0:4 offset1:6
v_mfma_f32_16x16x32_bf16 v[36:39],v[172:175],a[28:31],v[36:39]
ds_read_b64_tr_b16 v[168:169],v217 offset:19456
ds_read_b64_tr_b16 v[170:171],v217 offset:23552
s_waitcnt lgkmcnt(9)
v_mfma_f32_16x16x32_bf16 v[40:43],v[176:179],a[0:3],v[40:43]
ds_write2st64_b64 v246,v[76:77],v[78:79] offset0:4 offset1:6
ds_write2st64_b64 v244,v[80:81],v[82:83] offset0:8 offset1:10
ds_write2st64_b64 v246,v[84:85],v[86:87] offset0:8 offset1:10
v_mfma_f32_16x16x32_bf16 v[44:47],v[176:179],a[4:7],v[44:47]
v_cvt_pk_bf16_f32 v32,v32,v33
v_cvt_pk_bf16_f32 v33,v34,v35
ds_read_b64_tr_b16 v[172:173],v217 offset:27648
v_mfma_f32_16x16x32_bf16 v[40:43],v[180:183],a[8:11],v[40:43]
v_cvt_pk_bf16_f32 v36,v36,v37
v_cvt_pk_bf16_f32 v37,v38,v39
ds_read_b64_tr_b16 v[174:175],v217 offset:31744
v_mfma_f32_16x16x32_bf16 v[44:47],v[180:183],a[12:15],v[44:47]
v_subrev_u32 v213,18432,v213
ds_read_b64_tr_b16 v[176:177],v213 offset:1024
ds_read_b64_tr_b16 v[178:179],v213 offset:5120
v_mfma_f32_16x16x32_bf16 v[40:43],v[184:187],a[16:19],v[40:43]
ds_write2st64_b64 v244,v[88:89],v[90:91] offset0:12 offset1:14
ds_write2st64_b64 v246,v[92:93],v[94:95] offset0:12 offset1:14
ds_write_b128 v245,v[144:147]
v_mfma_f32_16x16x32_bf16 v[44:47],v[184:187],a[20:23],v[44:47]
ds_read_b64_tr_b16 v[180:181],v213 offset:9216
ds_read_b64_tr_b16 v[182:183],v213 offset:13312
v_mov_b32 v245,v212
v_mfma_f32_16x16x32_bf16 v[40:43],v[188:191],a[24:27],v[40:43]
s_mov_b64 exec,s[16:17]
ds_write_b128 v240,v[20:23] offset:5120
s_mov_b64 exec,-1
s_nop 0
v_mfma_f32_16x16x32_bf16 v[44:47],v[188:191],a[28:31],v[44:47]
ds_read_b64_tr_b16 v[184:185],v213 offset:19456
ds_read_b64_tr_b16 v[186:187],v213 offset:23552
s_waitcnt lgkmcnt(9)
v_mfma_f32_16x16x32_bf16 v[48:51],v[160:163],a[0:3],v[48:51]
s_lshl_b32 s91,s40,5
s_add_u32 s91,s91,s43
s_add_u32 s91,s91,16
v_mfma_f32_16x16x32_bf16 v[52:55],v[160:163],a[4:7],v[52:55]
v_cvt_pk_bf16_f32 v34,v40,v41
v_cvt_pk_bf16_f32 v35,v42,v43
buffer_store_dwordx4 v[32:35],v239,s[24:27],s86 offen offset:2048 sc1
ds_read_b64_tr_b16 v[188:189],v213 offset:27648
ds_read_b64_tr_b16 v[190:191],v213 offset:31744
v_mfma_f32_16x16x32_bf16 v[48:51],v[164:167],a[8:11],v[48:51]
v_cvt_pk_bf16_f32 v38,v44,v45
v_cvt_pk_bf16_f32 v39,v46,v47
buffer_store_dwordx4 v[36:39],v239,s[24:27],s87 offen offset:2048 sc1
s_lshl_b32 s91,s91,5
v_mfma_f32_16x16x32_bf16 v[52:55],v[164:167],a[12:15],v[52:55]
s_mov_b64 exec,s[16:17]
ds_write_b128 v240,v[32:35] offset:2048
s_mov_b64 exec,-1
s_lshl_b32 s54,s47,6
v_mfma_f32_16x16x32_bf16 v[48:51],v[168:171],a[16:19],v[48:51]
s_add_u32 m0,s84,36864
s_waitcnt lgkmcnt(0)
v_xor_b32 v236,s54,v215
v_mfma_f32_16x16x32_bf16 v[52:55],v[168:171],a[20:23],v[52:55]
s_lshl_b32 s54,s46,10
v_add_u32 v236,s54,v236
v_xor_b32 v237,32,v236
v_mfma_f32_16x16x32_bf16 v[48:51],v[172:175],a[24:27],v[48:51]
s_mov_b64 exec,s[16:17]
ds_write_b128 v240,v[36:39] offset:6144
s_mov_b64 exec,-1
s_nop 0
v_mfma_f32_16x16x32_bf16 v[52:55],v[172:175],a[28:31],v[52:55]
s_add_u32 s91,s91,s42
s_lshl_b32 s91,s91,2
v_mfma_f32_16x16x32_bf16 v[56:59],v[176:179],a[0:3],v[56:59]
v_mfma_f32_16x16x32_bf16 v[60:63],v[176:179],a[4:7],v[60:63]
v_cvt_pk_bf16_f32 v48,v48,v49
v_cvt_pk_bf16_f32 v49,v50,v51
v_mfma_f32_16x16x32_bf16 v[56:59],v[180:183],a[8:11],v[56:59]
s_nop 0
v_cvt_pk_bf16_f32 v52,v52,v53
v_cvt_pk_bf16_f32 v53,v54,v55
v_mfma_f32_16x16x32_bf16 v[60:63],v[180:183],a[12:15],v[60:63]
v_mfma_f32_16x16x32_bf16 v[56:59],v[184:187],a[16:19],v[56:59]
s_waitcnt vmcnt(11)
s_barrier
buffer_load_dwordx4 v219,s[36:39],s60 offen lds
buffer_load_dwordx4 v220,s[36:39],s60 offen offset:1024 lds
s_add_u32 m0,s84,45056
v_mfma_f32_16x16x32_bf16 v[60:63],v[184:187],a[20:23],v[60:63]
buffer_load_dwordx4 v221,s[36:39],s60 offen lds
buffer_load_dwordx4 v222,s[36:39],s60 offen offset:1024 lds
s_add_u32 m0,s84,55296
ds_read_b64_tr_b16 a[32:33],v236 offset:55296
ds_read_b64_tr_b16 a[34:35],v236 offset:59392
ds_read_b64_tr_b16 a[36:37],v237 offset:55296
ds_read_b64_tr_b16 a[38:39],v237 offset:59392
ds_read_b128 a[96:99],v245 offset:0
ds_read_b128 a[100:103],v245 offset:1024
v_mfma_f32_16x16x32_bf16 v[56:59],v[188:191],a[24:27],v[56:59]
buffer_load_dwordx4 v219,s[36:39],s61 offen lds
buffer_load_dwordx4 v220,s[36:39],s61 offen offset:1024 lds
s_add_u32 m0,s84,63488
v_mfma_f32_16x16x32_bf16 v[60:63],v[188:191],a[28:31],v[60:63]
buffer_load_dwordx4 v221,s[36:39],s61 offen lds
s_waitcnt lgkmcnt(0)
v_mfma_f32_16x16x32_bf16 v[144:147],a[32:35],a[96:99],0
buffer_load_dwordx4 v222,s[36:39],s61 offen offset:1024 lds
s_add_u32 m0,s84,73728
v_add_u32 v236,55296,v236
v_add_u32 v237,55296,v237
ds_read_b64_tr_b16 a[44:45],v236 offset:8192
v_mfma_f32_16x16x32_bf16 v[152:155],a[32:35],a[100:103],0
buffer_load_dwordx4 v219,s[36:39],s62 offen lds
v_cvt_pk_bf16_f32 v50,v56,v57
v_cvt_pk_bf16_f32 v51,v58,v59
buffer_store_dwordx4 v[48:51],v239,s[24:27],s86 offen offset:3072 sc1
ds_read_b64_tr_b16 a[46:47],v236 offset:12288
ds_read_b64_tr_b16 a[48:49],v237 offset:8192
ds_read_b64_tr_b16 a[50:51],v237 offset:12288
ds_read_b128 a[104:107],v245 offset:2048
ds_read_b128 a[108:111],v245 offset:3072
v_mfma_f32_16x16x32_bf16 v[148:151],a[36:39],a[96:99],0
buffer_load_dwordx4 v220,s[36:39],s62 offen offset:1024 lds
s_add_u32 m0,s84,81920
v_cvt_pk_bf16_f32 v54,v60,v61
v_cvt_pk_bf16_f32 v55,v62,v63
buffer_store_dwordx4 v[52:55],v239,s[24:27],s87 offen offset:3072 sc1
v_mfma_f32_16x16x32_bf16 v[156:159],a[36:39],a[100:103],0
buffer_load_dwordx4 v221,s[36:39],s62 offen lds
s_waitcnt lgkmcnt(0)
v_mfma_f32_16x16x32_bf16 v[144:147],a[44:47],a[104:107],v[144:147]
buffer_load_dwordx4 v222,s[36:39],s62 offen offset:1024 lds
s_add_u32 m0,s84,110592
ds_read_b64_tr_b16 a[32:33],v236 offset:18432
ds_read_b64_tr_b16 a[34:35],v236 offset:22528
v_mfma_f32_16x16x32_bf16 v[152:155],a[44:47],a[108:111],v[152:155]
ds_read_b64_tr_b16 a[36:37],v237 offset:18432
ds_read_b64_tr_b16 a[38:39],v237 offset:22528
ds_read_b128 a[96:99],v245 offset:4096
ds_read_b128 a[100:103],v245 offset:5120
v_mfma_f32_16x16x32_bf16 v[148:151],a[48:51],a[104:107],v[148:151]
s_mov_b64 exec,s[16:17]
ds_write_b128 v240,v[48:51] offset:3072
s_mov_b64 exec,-1
s_nop 0
v_mfma_f32_16x16x32_bf16 v[156:159],a[48:51],a[108:111],v[156:159]
s_waitcnt lgkmcnt(0)
v_mfma_f32_16x16x32_bf16 v[144:147],a[32:35],a[96:99],v[144:147]
ds_read_b64_tr_b16 a[44:45],v236 offset:26624
ds_read_b64_tr_b16 a[46:47],v236 offset:30720
ds_read_b64_tr_b16 a[48:49],v237 offset:26624
ds_read_b64_tr_b16 a[50:51],v237 offset:30720
s_mov_b64 exec,s[16:17]
ds_write_b128 v240,v[52:55] offset:7168
s_mov_b64 exec,-1
s_nop 0
v_mfma_f32_16x16x32_bf16 v[152:155],a[32:35],a[100:103],v[152:155]
ds_read_b128 a[104:107],v245 offset:6144
ds_read_b128 a[108:111],v245 offset:7168
v_mfma_f32_16x16x32_bf16 v[148:151],a[36:39],a[96:99],v[148:151]
v_mfma_f32_16x16x32_bf16 v[156:159],a[36:39],a[100:103],v[156:159]
s_waitcnt lgkmcnt(0)
s_lshl_b32 s56,s40,2
s_add_u32 s56,s56,s43
s_lshl_b32 s56,s56,2
v_mfma_f32_16x16x32_bf16 v[144:147],a[44:47],a[104:107],v[144:147]
v_subrev_u32 v236,92160,v236
v_subrev_u32 v237,92160,v237
s_waitcnt vmcnt(2)
s_barrier
ds_read_b64_tr_b16 a[32:33],v236 offset:0
v_mfma_f32_16x16x32_bf16 v[152:155],a[44:47],a[108:111],v[152:155]
buffer_load_dwordx4 v219,s[36:39],s63 offen lds
ds_read_b64_tr_b16 a[34:35],v236 offset:4096
ds_read_b64_tr_b16 a[36:37],v237 offset:0
ds_read_b64_tr_b16 a[38:39],v237 offset:4096
ds_read_b128 a[96:99],v245 offset:8192
ds_read_b128 a[100:103],v245 offset:9216
v_mfma_f32_16x16x32_bf16 v[148:151],a[48:51],a[104:107],v[148:151]
buffer_load_dwordx4 v220,s[36:39],s63 offen offset:1024 lds
s_add_u32 m0,s84,118784
buffer_store_dword v225,v224,s[24:27],s91 offen sc1
v_mfma_f32_16x16x32_bf16 v[156:159],a[48:51],a[108:111],v[156:159]
buffer_load_dwordx4 v221,s[36:39],s63 offen lds
s_waitcnt lgkmcnt(0)
s_add_u32 s56,s56,s42
v_mfma_f32_16x16x32_bf16 v[144:147],a[32:35],a[96:99],v[144:147]
buffer_load_dwordx4 v222,s[36:39],s63 offen offset:1024 lds
s_add_u32 m0,s84,129024
ds_read_b64_tr_b16 a[44:45],v236 offset:8192
v_mfma_f32_16x16x32_bf16 v[152:155],a[32:35],a[100:103],v[152:155]
buffer_load_dwordx4 v219,s[36:39],s64 offen lds
ds_read_b64_tr_b16 a[46:47],v236 offset:12288
ds_read_b64_tr_b16 a[48:49],v237 offset:8192
ds_read_b64_tr_b16 a[50:51],v237 offset:12288
ds_read_b128 a[104:107],v245 offset:10240
ds_read_b128 a[108:111],v245 offset:11264
v_mfma_f32_16x16x32_bf16 v[148:151],a[36:39],a[96:99],v[148:151]
buffer_load_dwordx4 v220,s[36:39],s64 offen offset:1024 lds
s_add_u32 m0,s84,137216
s_mul_i32 s56,s56,40960
v_mfma_f32_16x16x32_bf16 v[156:159],a[36:39],a[100:103],v[156:159]
buffer_load_dwordx4 v221,s[36:39],s64 offen lds
s_waitcnt lgkmcnt(0)
s_add_u32 s56,s56,5242880
v_mfma_f32_16x16x32_bf16 v[144:147],a[44:47],a[104:107],v[144:147]
buffer_load_dwordx4 v222,s[36:39],s64 offen offset:1024 lds
s_add_u32 m0,s84,18432
ds_read_b64_tr_b16 a[32:33],v236 offset:18432
v_mfma_f32_16x16x32_bf16 v[152:155],a[44:47],a[108:111],v[152:155]
ds_read_b64_tr_b16 a[34:35],v236 offset:22528
ds_read_b64_tr_b16 a[36:37],v237 offset:18432
ds_read_b64_tr_b16 a[38:39],v237 offset:22528
ds_read_b128 a[96:99],v245 offset:12288
ds_read_b128 a[100:103],v245 offset:13312
v_mfma_f32_16x16x32_bf16 v[148:151],a[48:51],a[104:107],v[148:151]
s_lshl_b32 s90,s40,5
s_add_u32 s90,s90,s43
s_add_u32 s90,s90,16
v_mfma_f32_16x16x32_bf16 v[156:159],a[48:51],a[108:111],v[156:159]
s_waitcnt lgkmcnt(0)
s_lshl_b32 s90,s90,7
v_and_b32 v227,3,v226
v_mfma_f32_16x16x32_bf16 v[144:147],a[32:35],a[96:99],v[144:147]
ds_read_b64_tr_b16 a[44:45],v236 offset:26624
ds_read_b64_tr_b16 a[46:47],v236 offset:30720
ds_read_b64_tr_b16 a[48:49],v237 offset:26624
v_mfma_f32_16x16x32_bf16 v[152:155],a[32:35],a[100:103],v[152:155]
ds_read_b64_tr_b16 a[50:51],v237 offset:30720
ds_read_b128 a[104:107],v245 offset:14336
ds_read_b128 a[108:111],v245 offset:15360
v_mfma_f32_16x16x32_bf16 v[148:151],a[36:39],a[96:99],v[148:151]
v_mul_u32_u24 v227,4,v227
s_lshl_b32 s100,s45,10
v_add_u32 v213,s100,v212
v_mfma_f32_16x16x32_bf16 v[156:159],a[36:39],a[100:103],v[156:159]
s_waitcnt lgkmcnt(0)
s_add_u32 s49,s42,1
s_and_b32 s49,s49,3
v_mfma_f32_16x16x32_bf16 v[144:147],a[44:47],a[104:107],v[144:147]
v_add_u32 v245,92160,v245
s_waitcnt vmcnt(9)
s_barrier
ds_read_b64_tr_b16 a[32:33],v236 offset:36864
v_mfma_f32_16x16x32_bf16 v[152:155],a[44:47],a[108:111],v[152:155]
ds_read_b64_tr_b16 a[34:35],v236 offset:40960
ds_read_b64_tr_b16 a[36:37],v237 offset:36864
ds_read_b64_tr_b16 a[38:39],v237 offset:40960
ds_read_b128 a[96:99],v245 offset:0
ds_read_b128 a[100:103],v245 offset:1024
v_mfma_f32_16x16x32_bf16 v[148:151],a[48:51],a[104:107],v[148:151]
buffer_load_dwordx4 v192,s[36:39],s65 offen lds
s_mul_i32 s49,s49,10240
s_add_u32 s49,s49,s56
v_mfma_f32_16x16x32_bf16 v[156:159],a[48:51],a[108:111],v[156:159]
s_waitcnt lgkmcnt(0)
s_add_u32 s50,s42,2
s_and_b32 s50,s50,3
v_mfma_f32_16x16x32_bf16 v[144:147],a[32:35],a[96:99],v[144:147]
ds_read_b64_tr_b16 a[44:45],v236 offset:45056
ds_read_b64_tr_b16 a[46:47],v236 offset:49152
ds_read_b64_tr_b16 a[48:49],v237 offset:45056
v_mfma_f32_16x16x32_bf16 v[152:155],a[32:35],a[100:103],v[152:155]
ds_read_b64_tr_b16 a[50:51],v237 offset:49152
ds_read_b128 a[104:107],v245 offset:2048
ds_read_b128 a[108:111],v245 offset:3072
v_mfma_f32_16x16x32_bf16 v[148:151],a[36:39],a[96:99],v[148:151]
buffer_load_dwordx4 v193,s[36:39],s65 offen offset:1024 lds
s_add_u32 m0,s84,26624
s_mul_i32 s50,s50,10240
v_mfma_f32_16x16x32_bf16 v[156:159],a[36:39],a[100:103],v[156:159]
buffer_load_dwordx4 v194,s[36:39],s65 offen lds
s_waitcnt lgkmcnt(0)
s_add_u32 s50,s50,s56
v_mfma_f32_16x16x32_bf16 v[144:147],a[44:47],a[104:107],v[144:147]
buffer_load_dwordx4 v195,s[36:39],s65 offen offset:1024 lds
ds_read_b64_tr_b16 a[32:33],v236 offset:55296
ds_read_b64_tr_b16 a[34:35],v236 offset:59392
v_mfma_f32_16x16x32_bf16 v[152:155],a[44:47],a[108:111],v[152:155]
ds_read_b64_tr_b16 a[36:37],v237 offset:55296
ds_read_b64_tr_b16 a[38:39],v237 offset:59392
ds_read_b128 a[96:99],v245 offset:4096
ds_read_b128 a[100:103],v245 offset:5120
v_mfma_f32_16x16x32_bf16 v[148:151],a[48:51],a[104:107],v[148:151]
s_add_u32 s51,s42,3
s_and_b32 s51,s51,3
s_mul_i32 s51,s51,10240
v_mfma_f32_16x16x32_bf16 v[156:159],a[48:51],a[108:111],v[156:159]
s_waitcnt lgkmcnt(0)
s_add_u32 s51,s51,s56
v_xor_b32 v214,4096,v213
v_mfma_f32_16x16x32_bf16 v[144:147],a[32:35],a[96:99],v[144:147]
v_add_u32 v236,55296,v236
v_add_u32 v237,55296,v237
ds_read_b64_tr_b16 a[44:45],v236 offset:8192
v_mfma_f32_16x16x32_bf16 v[152:155],a[32:35],a[100:103],v[152:155]
ds_read_b64_tr_b16 a[46:47],v236 offset:12288
ds_read_b64_tr_b16 a[48:49],v237 offset:8192
ds_read_b64_tr_b16 a[50:51],v237 offset:12288
ds_read_b128 a[104:107],v245 offset:6144
ds_read_b128 a[108:111],v245 offset:7168
v_mfma_f32_16x16x32_bf16 v[148:151],a[36:39],a[96:99],v[148:151]
v_add_u32 v240,147456,v213
ds_read_b128 v[0:3],v240
v_add_u32 v241,147456,v214
v_mfma_f32_16x16x32_bf16 v[156:159],a[36:39],a[100:103],v[156:159]
s_waitcnt lgkmcnt(1)
ds_read_b128 v[16:19],v241
v_mfma_f32_16x16x32_bf16 v[144:147],a[44:47],a[104:107],v[144:147]
s_waitcnt vmcnt(4)
s_barrier
ds_read_b64_tr_b16 a[32:33],v236 offset:36864
v_mfma_f32_16x16x32_bf16 v[152:155],a[44:47],a[108:111],v[152:155]
buffer_load_dwordx4 v[100:103],v210,s[4:7],0 offen offset:0
ds_read_b64_tr_b16 a[34:35],v236 offset:40960
ds_read_b64_tr_b16 a[36:37],v237 offset:36864
ds_read_b64_tr_b16 a[38:39],v237 offset:40960
ds_read_b128 a[96:99],v245 offset:8192
ds_read_b128 a[100:103],v245 offset:9216
v_mfma_f32_16x16x32_bf16 v[148:151],a[48:51],a[104:107],v[148:151]
v_mfma_f32_16x16x32_bf16 v[156:159],a[48:51],a[108:111],v[156:159]
s_waitcnt lgkmcnt(0)
v_mfma_f32_16x16x32_bf16 v[144:147],a[32:35],a[96:99],v[144:147]
ds_read_b64_tr_b16 a[44:45],v236 offset:45056
ds_read_b64_tr_b16 a[46:47],v236 offset:49152
ds_read_b64_tr_b16 a[48:49],v237 offset:45056
v_mfma_f32_16x16x32_bf16 v[152:155],a[32:35],a[100:103],v[152:155]
ds_read_b64_tr_b16 a[50:51],v237 offset:49152
ds_read_b128 a[104:107],v245 offset:10240
ds_read_b128 a[108:111],v245 offset:11264
v_mfma_f32_16x16x32_bf16 v[148:151],a[36:39],a[96:99],v[148:151]
v_mfma_f32_16x16x32_bf16 v[156:159],a[36:39],a[100:103],v[156:159]
s_waitcnt lgkmcnt(0)
buffer_load_dword v247,v227,s[24:27],s90 offen sc1
v_mfma_f32_16x16x32_bf16 v[144:147],a[44:47],a[104:107],v[144:147]
ds_read_b64_tr_b16 a[32:33],v236 offset:55296
ds_read_b64_tr_b16 a[34:35],v236 offset:59392
ds_read_b64_tr_b16 a[36:37],v237 offset:55296
v_mfma_f32_16x16x32_bf16 v[152:155],a[44:47],a[108:111],v[152:155]
buffer_load_dwordx4 v[104:107],v210,s[4:7],s55 offen offset:0
ds_read_b64_tr_b16 a[38:39],v237 offset:59392
ds_read_b128 a[96:99],v245 offset:12288
ds_read_b128 a[100:103],v245 offset:13312
v_mfma_f32_16x16x32_bf16 v[148:151],a[48:51],a[104:107],v[148:151]
v_mfma_f32_16x16x32_bf16 v[156:159],a[48:51],a[108:111],v[156:159]
s_waitcnt lgkmcnt(0)
v_mfma_f32_16x16x32_bf16 v[144:147],a[32:35],a[96:99],v[144:147]
v_add_u32 v236,55296,v236
v_add_u32 v237,55296,v237
ds_read_b64_tr_b16 a[44:45],v236 offset:8192
v_mfma_f32_16x16x32_bf16 v[152:155],a[32:35],a[100:103],v[152:155]
ds_read_b64_tr_b16 a[46:47],v236 offset:12288
ds_read_b64_tr_b16 a[48:49],v237 offset:8192
ds_read_b64_tr_b16 a[50:51],v237 offset:12288
ds_read_b128 a[104:107],v245 offset:14336
ds_read_b128 a[108:111],v245 offset:15360
v_mfma_f32_16x16x32_bf16 v[148:151],a[36:39],a[96:99],v[148:151]
v_mfma_f32_16x16x32_bf16 v[156:159],a[36:39],a[100:103],v[156:159]
s_waitcnt lgkmcnt(0)
v_mfma_f32_16x16x32_bf16 v[144:147],a[44:47],a[104:107],v[144:147]
v_subrev_u32 v236,110592,v236
v_subrev_u32 v237,110592,v237
v_subrev_u32 v245,92160,v245
s_waitcnt vmcnt(3)
s_barrier
ds_read_b64_tr_b16 a[32:33],v236 offset:0
v_mfma_f32_16x16x32_bf16 v[152:155],a[44:47],a[108:111],v[152:155]
ds_read_b64_tr_b16 a[34:35],v236 offset:4096
ds_read_b64_tr_b16 a[36:37],v237 offset:0
ds_read_b64_tr_b16 a[38:39],v237 offset:4096
ds_read_b128 a[96:99],v245 offset:16384
ds_read_b128 a[100:103],v245 offset:17408
v_mfma_f32_16x16x32_bf16 v[148:151],a[48:51],a[104:107],v[148:151]
v_mfma_f32_16x16x32_bf16 v[156:159],a[48:51],a[108:111],v[156:159]
s_waitcnt lgkmcnt(0)
v_mfma_f32_16x16x32_bf16 v[144:147],a[32:35],a[96:99],v[144:147]
v_add_u32 v245,92160,v245
ds_read_b64_tr_b16 a[44:45],v236 offset:8192
ds_read_b64_tr_b16 a[46:47],v236 offset:12288
v_mfma_f32_16x16x32_bf16 v[152:155],a[32:35],a[100:103],v[152:155]
ds_read_b64_tr_b16 a[48:49],v237 offset:8192
ds_read_b64_tr_b16 a[50:51],v237 offset:12288
ds_read_b128 a[104:107],v245 offset:16384
ds_read_b128 a[108:111],v245 offset:17408
v_mfma_f32_16x16x32_bf16 v[148:151],a[36:39],a[96:99],v[148:151]
v_mfma_f32_16x16x32_bf16 v[156:159],a[36:39],a[100:103],v[156:159]
s_waitcnt vmcnt(1)
v_cmp_ne_u32 vcc,1,v247
s_cbranch_vccnz L_slow_p_5
L_back_p_5:
buffer_load_dwordx4 v[4:7],v213,s[24:27],s49 offen sc1
buffer_load_dwordx4 v[8:11],v213,s[24:27],s50 offen sc1
buffer_load_dwordx4 v[12:15],v213,s[24:27],s51 offen sc1
buffer_load_dwordx4 v[20:23],v214,s[24:27],s49 offen sc1
buffer_load_dwordx4 v[24:27],v214,s[24:27],s50 offen sc1
buffer_load_dwordx4 v[28:31],v214,s[24:27],s51 offen sc1
s_waitcnt lgkmcnt(0)
v_mfma_f32_16x16x32_bf16 v[144:147],a[44:47],a[104:107],v[144:147]
v_mfma_f32_16x16x32_bf16 v[152:155],a[44:47],a[108:111],v[152:155]
v_mfma_f32_16x16x32_bf16 v[148:151],a[48:51],a[104:107],v[148:151]
v_mfma_f32_16x16x32_bf16 v[156:159],a[48:51],a[108:111],v[156:159]
v_permlane16_swap_b32 v100,v102
v_permlane16_swap_b32 v101,v103
s_waitcnt vmcnt(6)
v_permlane16_swap_b32 v104,v106
v_permlane16_swap_b32 v105,v107
v_mfma_f32_16x16x32_bf16 v[64:67],v[202:205],v[0:3],0
v_mfma_f32_16x16x32_bf16 v[68:71],v[200:203],v[0:3],0
s_waitcnt vmcnt(5)
v_mfma_f32_16x16x32_bf16 v[64:67],v[202:205],v[4:7],v[64:67]
v_mfma_f32_16x16x32_bf16 v[68:71],v[200:203],v[4:7],v[68:71]
s_waitcnt vmcnt(4)
v_mfma_f32_16x16x32_bf16 v[64:67],v[202:205],v[8:11],v[64:67]
v_mfma_f32_16x16x32_bf16 v[68:71],v[200:203],v[8:11],v[68:71]
s_waitcnt vmcnt(3)
v_mfma_f32_16x16x32_bf16 v[64:67],v[202:205],v[12:15],v[64:67]
v_mfma_f32_16x16x32_bf16 v[68:71],v[200:203],v[12:15],v[68:71]
s_nop 6
v_mul_f32 v64,v208,v64
v_mul_f32 v65,v208,v65
v_mul_f32 v66,v208,v66
v_mul_f32 v67,v208,v67
v_mfma_f32_16x16x32_bf16 v[72:75],v[202:205],v[16:19],0
v_mul_f32 v160,0xbfb8aa3b,v64
v_mul_f32 v162,0xbfb8aa3b,v65
v_mul_f32 v164,0xbfb8aa3b,v66
v_mul_f32 v166,0xbfb8aa3b,v67
v_exp_f32 v160,v160
v_exp_f32 v162,v162
v_mfma_f32_16x16x32_bf16 v[76:79],v[200:203],v[16:19],0
v_exp_f32 v164,v164
v_exp_f32 v166,v166
v_mul_f32 v64,v64,v144
v_mul_f32 v65,v65,v145
v_mul_f32 v66,v66,v146
v_mul_f32 v67,v67,v147
s_waitcnt vmcnt(2)
v_mfma_f32_16x16x32_bf16 v[72:75],v[202:205],v[20:23],v[72:75]
v_add_f32 v160,1.0,v160
v_add_f32 v162,1.0,v162
v_add_f32 v164,1.0,v164
v_add_f32 v166,1.0,v166
v_rcp_f32 v160,v160
v_rcp_f32 v162,v162
v_mfma_f32_16x16x32_bf16 v[76:79],v[200:203],v[20:23],v[76:79]
v_rcp_f32 v164,v164
v_rcp_f32 v166,v166
v_lshlrev_b32 v161,16,v100
v_and_b32 v163,0xffff0000,v100
v_lshlrev_b32 v165,16,v101
v_and_b32 v167,0xffff0000,v101
v_fma_f32 v64,v64,v160,v161
v_fma_f32 v65,v65,v162,v163
v_fma_f32 v66,v66,v164,v165
v_fma_f32 v67,v67,v166,v167
v_cvt_pk_bf16_f32 v64,v64,v65
v_cvt_pk_bf16_f32 v65,v66,v67
v_mul_f32 v68,v208,v68
v_mul_f32 v69,v208,v69
v_mul_f32 v70,v208,v70
v_mul_f32 v71,v208,v71
s_waitcnt vmcnt(1)
v_mfma_f32_16x16x32_bf16 v[72:75],v[202:205],v[24:27],v[72:75]
v_mul_f32 v168,0xbfb8aa3b,v68
v_mul_f32 v170,0xbfb8aa3b,v69
v_mul_f32 v172,0xbfb8aa3b,v70
v_mul_f32 v174,0xbfb8aa3b,v71
v_exp_f32 v168,v168
v_exp_f32 v170,v170
v_mfma_f32_16x16x32_bf16 v[76:79],v[200:203],v[24:27],v[76:79]
v_exp_f32 v172,v172
v_exp_f32 v174,v174
v_mul_f32 v68,v68,v148
v_mul_f32 v69,v69,v149
v_mul_f32 v70,v70,v150
v_mul_f32 v71,v71,v151
s_waitcnt vmcnt(0)
v_mfma_f32_16x16x32_bf16 v[72:75],v[202:205],v[28:31],v[72:75]
v_add_f32 v168,1.0,v168
v_add_f32 v170,1.0,v170
v_add_f32 v172,1.0,v172
v_add_f32 v174,1.0,v174
v_rcp_f32 v168,v168
v_rcp_f32 v170,v170
v_mfma_f32_16x16x32_bf16 v[76:79],v[200:203],v[28:31],v[76:79]
v_rcp_f32 v172,v172
v_rcp_f32 v174,v174
v_lshlrev_b32 v169,16,v102
v_and_b32 v171,0xffff0000,v102
v_lshlrev_b32 v173,16,v103
v_and_b32 v175,0xffff0000,v103
v_fma_f32 v68,v68,v168,v169
v_fma_f32 v69,v69,v170,v171
v_fma_f32 v70,v70,v172,v173
v_fma_f32 v71,v71,v174,v175
v_cvt_pk_bf16_f32 v66,v68,v69
v_cvt_pk_bf16_f32 v67,v70,v71
s_nop 0
v_permlane16_swap_b32 v64,v66
v_permlane16_swap_b32 v65,v67
buffer_store_dwordx4 v[64:67],v210,s[28:31],0 offen offset:0
v_mul_f32 v72,v209,v72
v_mul_f32 v73,v209,v73
v_mul_f32 v74,v209,v74
v_mul_f32 v75,v209,v75
v_mul_f32 v160,0xbfb8aa3b,v72
v_mul_f32 v162,0xbfb8aa3b,v73
v_mul_f32 v164,0xbfb8aa3b,v74
v_mul_f32 v166,0xbfb8aa3b,v75
v_exp_f32 v160,v160
v_exp_f32 v162,v162
v_exp_f32 v164,v164
v_exp_f32 v166,v166
v_mul_f32 v72,v72,v152
v_mul_f32 v73,v73,v153
v_mul_f32 v74,v74,v154
v_mul_f32 v75,v75,v155
v_add_f32 v160,1.0,v160
v_add_f32 v162,1.0,v162
v_add_f32 v164,1.0,v164
v_add_f32 v166,1.0,v166
v_rcp_f32 v160,v160
v_rcp_f32 v162,v162
v_rcp_f32 v164,v164
v_rcp_f32 v166,v166
v_lshlrev_b32 v161,16,v104
v_and_b32 v163,0xffff0000,v104
v_lshlrev_b32 v165,16,v105
v_and_b32 v167,0xffff0000,v105
v_fma_f32 v72,v72,v160,v161
v_fma_f32 v73,v73,v162,v163
v_fma_f32 v74,v74,v164,v165
v_fma_f32 v75,v75,v166,v167
v_cvt_pk_bf16_f32 v72,v72,v73
v_cvt_pk_bf16_f32 v73,v74,v75
v_mul_f32 v76,v209,v76
v_mul_f32 v77,v209,v77
v_mul_f32 v78,v209,v78
v_mul_f32 v79,v209,v79
v_mul_f32 v168,0xbfb8aa3b,v76
v_mul_f32 v170,0xbfb8aa3b,v77
v_mul_f32 v172,0xbfb8aa3b,v78
v_mul_f32 v174,0xbfb8aa3b,v79
v_exp_f32 v168,v168
v_exp_f32 v170,v170
v_exp_f32 v172,v172
v_exp_f32 v174,v174
v_mul_f32 v76,v76,v156
v_mul_f32 v77,v77,v157
v_mul_f32 v78,v78,v158
v_mul_f32 v79,v79,v159
v_add_f32 v168,1.0,v168
v_add_f32 v170,1.0,v170
v_add_f32 v172,1.0,v172
v_add_f32 v174,1.0,v174
v_rcp_f32 v168,v168
v_rcp_f32 v170,v170
v_rcp_f32 v172,v172
v_rcp_f32 v174,v174
v_lshlrev_b32 v169,16,v106
v_and_b32 v171,0xffff0000,v106
v_lshlrev_b32 v173,16,v107
v_and_b32 v175,0xffff0000,v107
v_fma_f32 v76,v76,v168,v169
v_fma_f32 v77,v77,v170,v171
v_fma_f32 v78,v78,v172,v173
v_fma_f32 v79,v79,v174,v175
v_cvt_pk_bf16_f32 v74,v76,v77
v_cvt_pk_bf16_f32 v75,v78,v79
s_nop 0
v_permlane16_swap_b32 v72,v74
v_permlane16_swap_b32 v73,v75
buffer_store_dwordx4 v[72:75],v210,s[28:31],s55 offen offset:0
s_endpgm
L_slow_clr_5:
s_mov_b32 s97,0
L_spin_clr_5:
buffer_load_dword v247,v227,s[32:35],0 offen sc1
s_waitcnt vmcnt(0)
v_cmp_ne_u32 vcc,1,v247
s_add_u32 s97,s97,1
s_cbranch_vccz L_exit_clr_5
s_cmp_lt_u32 s97,200000
s_cbranch_scc1 L_spin_clr_5
L_exit_clr_5:

s_branch L_back_clr_5
L_slow_kv_5:
s_mov_b32 s97,0
L_spin_kv_5:
buffer_load_dword v247,v227,s[24:27],s90 offen sc1
s_waitcnt vmcnt(0)
v_cmp_ne_u32 vcc,1,v247
s_add_u32 s97,s97,1
s_cbranch_vccz L_exit_kv_5
s_cmp_lt_u32 s97,200000
s_cbranch_scc1 L_spin_kv_5
L_exit_kv_5:

s_branch L_back_kv_5
L_slow_ha_5:
s_mov_b32 s97,0
L_spin_ha_5:
buffer_load_dword v247,v227,s[24:27],s90 offen sc1
s_waitcnt vmcnt(0)
v_cmp_ne_u32 vcc,1,v247
s_add_u32 s97,s97,1
s_cbranch_vccz L_exit_ha_5
s_cmp_lt_u32 s97,200000
s_cbranch_scc1 L_spin_ha_5
L_exit_ha_5:

s_branch L_back_ha_5
L_slow_hb_5:
s_mov_b32 s97,0
L_spin_hb_5:
buffer_load_dword v247,v227,s[24:27],s90 offen sc1
s_waitcnt vmcnt(0)
v_cmp_ne_u32 vcc,1,v247
s_add_u32 s97,s97,1
s_cbranch_vccz L_exit_hb_5
s_cmp_lt_u32 s97,200000
s_cbranch_scc1 L_spin_hb_5
L_exit_hb_5:

s_branch L_back_hb_5
L_slow_hc_5:
s_mov_b32 s97,0
L_spin_hc_5:
buffer_load_dword v247,v227,s[24:27],s90 offen sc1
s_waitcnt vmcnt(0)
v_cmp_ne_u32 vcc,1,v247
s_add_u32 s97,s97,1
s_cbranch_vccz L_exit_hc_5
s_cmp_lt_u32 s97,200000
s_cbranch_scc1 L_spin_hc_5
L_exit_hc_5:

s_branch L_back_hc_5
L_slow_hd_5:
s_mov_b32 s97,0
L_spin_hd_5:
buffer_load_dword v247,v227,s[24:27],s90 offen sc1
s_waitcnt vmcnt(0)
v_cmp_ne_u32 vcc,1,v247
s_add_u32 s97,s97,1
s_cbranch_vccz L_exit_hd_5
s_cmp_lt_u32 s97,200000
s_cbranch_scc1 L_spin_hd_5
L_exit_hd_5:

s_branch L_back_hd_5
L_slow_o_5:
s_mov_b32 s97,0
L_spin_o_5:
buffer_load_dword v247,v227,s[24:27],s90 offen sc1
s_waitcnt vmcnt(0)
v_cmp_ne_u32 vcc,1,v247
s_add_u32 s97,s97,1
s_cbranch_vccz L_exit_o_5
s_cmp_lt_u32 s97,200000
s_cbranch_scc1 L_spin_o_5
L_exit_o_5:

s_branch L_back_o_5
L_slow_p_5:
s_mov_b32 s97,0
L_spin_p_5:
buffer_load_dword v247,v227,s[24:27],s90 offen sc1
s_waitcnt vmcnt(0)
v_cmp_ne_u32 vcc,1,v247
s_add_u32 s97,s97,1
s_cbranch_vccz L_exit_p_5
s_cmp_lt_u32 s97,200000
s_cbranch_scc1 L_spin_p_5
L_exit_p_5:

s_branch L_back_p_5
L_stop_5:
s_endpgm
.p2align 6
L_four:
s_getpc_b64 s[90:91]
L_pc_4:
s_lshr_b32 s89,s2,3
v_and_b32 v226,63,v0
v_lshrrev_b32 v1,6,v0
s_lshr_b32 s88,s2,4
s_and_b32 s88,s88,14
s_bfe_u32 s98,s2,0x10003
s_or_b32 s88,s88,s98
v_lshl_add_u32 v2,v226,4,s88
v_readfirstlane_b32 s45,v1
v_lshlrev_b32 v2,7,v2
v_min_u32 v2,L_stop_4-L_pc_4,v2
v_cmp_gt_u32 vcc,32,v0
s_nop 1
s_and_saveexec_b64 s[98:99],vcc
s_cbranch_execz L_nowarm_4
global_load_dword v255,v2,s[90:91]
L_nowarm_4:
s_mov_b64 exec,-1
s_and_b32 s43,s89,3
s_lshr_b32 s44,s89,2
s_and_b32 s88,s2,1
s_lshl_b32 s88,s88,3
s_add_u32 s40,s88,s44
s_lshl_b32 s88,s43,1
s_add_u32 s88,s88,s44
s_sub_u32 s90,s88,9
s_cselect_b32 s88,s88,s90
s_lshl_b32 s66,s88,7
s_lshl_b32 s89,s40,2
s_add_u32 s89,s89,s45
s_lshl_b32 s89,s89,5
v_lshrrev_b32 v4,3,v226
v_add_u32 v4,s89,v4
v_mul_u32_u24 v4,1152,v4
v_bfe_u32 v5,v226,4,2
v_lshlrev_b32 v5,1,v5
v_and_b32 v6,7,v226
v_xor_b32 v213,v5,v6
v_lshl_add_u32 v230,v213,4,v4
v_add_u32 v231,8192,v230
v_add_u32 v232,18432,v230
v_add_u32 v233,26624,v230
s_mul_i32 s85,s45,18432
s_add_u32 s85,s85,16384
s_add_u32 s75,s85,73728
v_mov_b32 v253,v0
s_waitcnt lgkmcnt(0)
s_mov_b32 s16,s6
s_mov_b32 s17,s7
s_mov_b32 s6,2359296
s_mov_b32 s7,0x20000
s_add_u32 m0,s85,0
s_nop 0
buffer_load_dwordx4 v230,s[4:7],s66 offen lds
buffer_load_dwordx4 v231,s[4:7],s66 offen offset:1024 lds
s_add_u32 s67,s66,128
s_cmp_eq_u32 s67,1152
s_cselect_b32 s67,0,s67
s_add_u32 m0,s85,2048
s_nop 0
buffer_load_dwordx4 v230,s[4:7],s67 offen lds
buffer_load_dwordx4 v231,s[4:7],s67 offen offset:1024 lds
s_add_u32 s68,s67,128
s_cmp_eq_u32 s68,1152
s_cselect_b32 s68,0,s68
s_add_u32 m0,s85,4096
s_nop 0
buffer_load_dwordx4 v230,s[4:7],s68 offen lds
buffer_load_dwordx4 v231,s[4:7],s68 offen offset:1024 lds
s_add_u32 m0,s75,0
s_nop 0
buffer_load_dwordx4 v232,s[4:7],s66 offen lds
buffer_load_dwordx4 v233,s[4:7],s66 offen offset:1024 lds
s_add_u32 m0,s75,2048
s_nop 0
buffer_load_dwordx4 v232,s[4:7],s67 offen lds
buffer_load_dwordx4 v233,s[4:7],s67 offen offset:1024 lds
s_add_u32 m0,s75,4096
s_nop 0
buffer_load_dwordx4 v232,s[4:7],s68 offen lds
buffer_load_dwordx4 v233,s[4:7],s68 offen offset:1024 lds
s_add_u32 s69,s68,128
s_cmp_eq_u32 s69,1152
s_cselect_b32 s69,0,s69
s_add_u32 s70,s69,128
s_cmp_eq_u32 s70,1152
s_cselect_b32 s70,0,s70
s_add_u32 s71,s70,128
s_cmp_eq_u32 s71,1152
s_cselect_b32 s71,0,s71
s_add_u32 s72,s71,128
s_cmp_eq_u32 s72,1152
s_cselect_b32 s72,0,s72
s_add_u32 s73,s72,128
s_cmp_eq_u32 s73,1152
s_cselect_b32 s73,0,s73
s_add_u32 s74,s73,128
s_cmp_eq_u32 s74,1152
s_cselect_b32 s74,0,s74
s_mov_b32 s24,s34
s_mov_b32 s25,s35
s_mov_b32 s26,67108864
s_mov_b32 s27,0x20000
s_bfe_u32 s42,s2,0x20001
s_lshl_b32 s41,s42,2
s_and_b32 s88,s43,2
s_add_u32 s41,s41,s88
s_lshr_b32 s88,s42,1
s_xor_b32 s88,s88,1
s_add_u32 s41,s41,s88
s_lshr_b32 s3,s40,3
s_and_b32 s3,s3,1
s_xor_b32 s101,s41,1
s_lshr_b32 s46,s45,1
s_and_b32 s47,s45,1
v_mov_b32 v225,1
v_min_u32 v224,1,v253
v_lshlrev_b32 v224,31,v224
v_lshlrev_b32 v212,4,v226
v_mov_b32 v192,0x3f803f80
v_mov_b32 v193,0x3f803f80
v_mov_b32 v194,0x3f803f80
v_mov_b32 v195,0x3f803f80
v_and_b32 v238,15,v226
v_lshrrev_b32 v239,4,v226
v_bfe_u32 v244,v226,1,2
v_lshlrev_b32 v244,1,v244
v_xor_b32 v244,v244,v239
v_lshlrev_b32 v244,4,v244
v_lshl_add_u32 v244,v238,7,v244
s_mov_b32 s88,s85
v_add_u32 v244,s88,v244
v_xor_b32 v245,64,v244
v_lshlrev_b32 v239,3,v239
v_sub_u32 v238,v238,v239
v_mov_b32 v239,0x3f80
v_mov_b32 v242,0x3f800000
v_cmp_eq_u32 vcc,0,v238
v_cmp_eq_u32 s[98:99],1,v238
v_mov_b32 v240,0
v_cndmask_b32 v196,0,v239,vcc
v_cndmask_b32 v196,v196,v242,s[98:99]
v_cmp_eq_u32 vcc,2,v238
v_cmp_eq_u32 s[98:99],3,v238
v_mov_b32 v240,0
v_cndmask_b32 v197,0,v239,vcc
v_cndmask_b32 v197,v197,v242,s[98:99]
v_cmp_eq_u32 vcc,4,v238
v_cmp_eq_u32 s[98:99],5,v238
v_mov_b32 v240,0
v_cndmask_b32 v198,0,v239,vcc
v_cndmask_b32 v198,v198,v242,s[98:99]
v_cmp_eq_u32 vcc,6,v238
v_cmp_eq_u32 s[98:99],7,v238
v_mov_b32 v240,0
v_cndmask_b32 v199,0,v239,vcc
v_cndmask_b32 v199,v199,v242,s[98:99]
v_cmp_eq_u32 vcc,-16,v238
v_cmp_eq_u32 s[98:99],-15,v238
v_mov_b32 v240,0
v_cndmask_b32 v200,0,v239,vcc
v_cndmask_b32 v200,v200,v242,s[98:99]
v_cmp_eq_u32 vcc,-14,v238
v_cmp_eq_u32 s[98:99],-13,v238
v_mov_b32 v240,0
v_cndmask_b32 v201,0,v239,vcc
v_cndmask_b32 v201,v201,v242,s[98:99]
v_cmp_eq_u32 vcc,-12,v238
v_cmp_eq_u32 s[98:99],-11,v238
v_mov_b32 v240,0
v_cndmask_b32 v202,0,v239,vcc
v_cndmask_b32 v202,v202,v242,s[98:99]
v_cmp_eq_u32 vcc,-10,v238
v_cmp_eq_u32 s[98:99],-9,v238
v_mov_b32 v240,0
v_cndmask_b32 v203,0,v239,vcc
v_cndmask_b32 v203,v203,v242,s[98:99]
v_add_u32 v242,s88,v212
s_xor_b32 s89,s45,1
s_mul_i32 s89,s89,18432
s_add_u32 s89,s89,16384
v_add_u32 v243,s89,v212
v_mov_b32 v238,0
v_mov_b32 v239,0
v_mov_b32 v241,0
s_add_u32 m0,s85,6144
s_nop 0
buffer_load_dwordx4 v230,s[4:7],s69 offen lds
s_mul_i32 s48,s66,4608
s_mul_i32 s57,s66,1728
s_mul_i32 s49,s67,4608
s_mul_i32 s58,s67,1728
s_mul_i32 s50,s68,4608
s_mul_i32 s59,s68,1728
s_mul_i32 s51,s69,4608
s_mul_i32 s60,s69,1728
s_mul_i32 s52,s70,4608
s_mul_i32 s61,s70,1728
s_mul_i32 s53,s71,4608
s_mul_i32 s62,s71,1728
s_mul_i32 s54,s72,4608
s_mul_i32 s63,s72,1728
s_mul_i32 s55,s73,4608
s_mul_i32 s64,s73,1728
s_mul_i32 s56,s74,4608
s_mul_i32 s65,s74,1728
s_mov_b32 s12,s10
s_mov_b32 s13,s11
buffer_load_dwordx4 v231,s[4:7],s69 offen offset:1024 lds
s_mov_b32 s28,s22
s_mov_b32 s29,s23
s_mov_b32 s30,2359296
s_mov_b32 s31,0x20000
s_mov_b32 s34,256
s_mov_b32 s35,0x20000
s_lshl_b32 s89,s43,3
s_lshr_b32 s97,0x0d090500,s89
s_and_b32 s97,s97,0xff
s_lshl_b32 s88,s97,7
s_mul_i32 s89,s42,2304
s_add_u32 s88,s88,s89
s_add_u32 s8,s8,s88
s_addc_u32 s9,s9,0
s_sub_u32 s10,5308416,s88
s_mov_b32 s11,0x20000
s_add_u32 s12,s12,s88
s_addc_u32 s13,s13,0
s_sub_u32 s12,s12,1024
s_subb_u32 s13,s13,0
s_sub_u32 s14,5309440,s88
s_mov_b32 s15,0x20000
s_mov_b32 s18,1990656
s_mov_b32 s19,0x20000
s_add_u32 m0,s85,8192
s_nop 0
buffer_load_dwordx4 v230,s[4:7],s70 offen lds
s_lshl_b32 s89,s43,3
s_lshr_b32 s88,0x07050200,s89
s_and_b32 s88,s88,0xff
s_lshl_b32 s88,s88,7
s_mul_i32 s89,s46,4608
s_add_u32 s89,s89,s88
s_add_u32 s36,s36,s89
s_addc_u32 s37,s37,0
s_sub_u32 s36,s36,1024
s_subb_u32 s37,s37,0
s_sub_u32 s38,664576,s89
s_mov_b32 s39,0x20000
s_mul_i32 s89,s42,1327104
s_add_u32 s88,s88,s89
s_add_u32 s20,s20,s88
s_addc_u32 s21,s21,0
s_sub_u32 s20,s20,1024
s_subb_u32 s21,s21,0
s_sub_u32 s22,5309440,s88
s_mov_b32 s23,0x20000
s_lshl_b32 s84,s45,11
v_lshrrev_b32 v237,3,v226
s_lshl_b32 s88,s45,3
v_add_u32 v237,s88,v237
buffer_load_dwordx4 v231,s[4:7],s70 offen offset:1024 lds
v_mul_u32_u24 v237,9216,v237
v_lshl_add_u32 v213,v213,4,v237
v_add_u32 v214,294912,v213
v_lshrrev_b32 v236,2,v226
v_lshrrev_b32 v237,5,v226
v_lshlrev_b32 v237,11,v237
v_and_b32 v235,7,v236
v_lshl_add_u32 v237,v235,7,v237
v_bfe_u32 v235,v226,3,2
s_lshl_b32 s88,s47,1
v_xor_b32 v235,s88,v235
v_lshl_add_u32 v237,v235,5,v237
v_and_b32 v235,3,v226
v_lshl_add_u32 v215,v235,3,v237
v_xor_b32 v216,32,v215
s_sub_u32 s92,0,s47
s_mov_b32 s93,s92
s_lshl_b32 s88,s47,1
s_lshr_b32 s94,0x44444444,s88
s_mov_b32 s95,s94
s_lshl_b32 s88,s40,2
s_add_u32 m0,s85,10240
s_nop 0
buffer_load_dwordx4 v230,s[4:7],s71 offen lds
s_add_u32 s88,s88,s42
s_mul_i32 s96,s88,294912
s_add_u32 s96,s96,16777216
s_lshl_b32 s88,s97,14
s_add_u32 s88,s88,s96
s_lshl_b32 s89,s47,11
s_add_u32 s88,s88,s89
s_lshl_b32 s89,s45,12
s_add_u32 s86,s88,s89
s_xor_b32 s89,s89,4096
s_add_u32 s87,s88,s89
s_mul_i32 s98,s101,72
s_and_b32 s98,s98,-16
v_mov_b32 v252,s98
s_mul_i32 s98,s41,72
s_and_b32 s98,s98,-16
v_lshrrev_b32 v248,4,v226
v_add_u32 v248,0,v248
v_and_b32 v249,7,v248
v_lshlrev_b32 v249,1,v249
buffer_load_dwordx4 v231,s[4:7],s71 offen offset:1024 lds
v_and_b32 v250,15,v226
v_xor_b32 v249,v249,v250
v_mul_u32_u24 v250,52,v249
v_lshrrev_b32 v250,8,v250
v_mul_u32_u24 v251,5,v250
v_sub_u32 v249,v249,v251
v_lshlrev_b32 v249,4,v249
v_add_u32 v251,1,v250
v_mul_u32_u24 v251,1152,v251
v_add_u32 v251,s98,v251
v_cmp_eq_u32 vcc,2,v250
s_nop 1
v_cndmask_b32 v251,v251,v252,vcc
v_add_u32 v249,v249,v251
v_add_u32 v250,1,v250
v_lshrrev_b32 v250,2,v250
v_lshl_or_b32 v249,v250,31,v249
s_lshl_b32 s100,s45,4
v_add_u32 v248,s100,v248
v_mul_u32_u24 v248,3456,v248
v_add_u32 v219,v248,v249
v_lshrrev_b32 v248,4,v226
s_add_u32 m0,s85,12288
s_nop 0
buffer_load_dwordx4 v230,s[4:7],s72 offen lds
v_add_u32 v248,4,v248
v_and_b32 v249,7,v248
v_lshlrev_b32 v249,1,v249
v_and_b32 v250,15,v226
v_xor_b32 v249,v249,v250
v_mul_u32_u24 v250,52,v249
v_lshrrev_b32 v250,8,v250
v_mul_u32_u24 v251,5,v250
v_sub_u32 v249,v249,v251
v_lshlrev_b32 v249,4,v249
v_add_u32 v251,1,v250
v_mul_u32_u24 v251,1152,v251
v_add_u32 v251,s98,v251
v_cmp_eq_u32 vcc,2,v250
s_nop 1
v_cndmask_b32 v251,v251,v252,vcc
v_add_u32 v249,v249,v251
v_add_u32 v250,1,v250
v_lshrrev_b32 v250,2,v250
v_lshl_or_b32 v249,v250,31,v249
s_lshl_b32 s100,s45,4
buffer_load_dwordx4 v231,s[4:7],s72 offen offset:1024 lds
v_add_u32 v248,s100,v248
v_mul_u32_u24 v248,3456,v248
v_add_u32 v220,v248,v249
v_subrev_u32 v220,1024,v220
v_lshrrev_b32 v248,4,v226
v_add_u32 v248,8,v248
v_and_b32 v249,7,v248
v_lshlrev_b32 v249,1,v249
v_and_b32 v250,15,v226
v_xor_b32 v249,v249,v250
v_mul_u32_u24 v250,52,v249
v_lshrrev_b32 v250,8,v250
v_mul_u32_u24 v251,5,v250
v_sub_u32 v249,v249,v251
v_lshlrev_b32 v249,4,v249
v_add_u32 v251,1,v250
v_mul_u32_u24 v251,1152,v251
v_add_u32 v251,s98,v251
v_cmp_eq_u32 vcc,2,v250
s_nop 1
v_cndmask_b32 v251,v251,v252,vcc
v_add_u32 v249,v249,v251
s_add_u32 m0,s85,14336
s_nop 0
buffer_load_dwordx4 v230,s[4:7],s73 offen lds
v_add_u32 v250,1,v250
v_lshrrev_b32 v250,2,v250
v_lshl_or_b32 v249,v250,31,v249
s_lshl_b32 s100,s45,4
v_add_u32 v248,s100,v248
v_mul_u32_u24 v248,3456,v248
v_add_u32 v221,v248,v249
v_subrev_u32 v221,2048,v221
v_lshrrev_b32 v248,4,v226
v_add_u32 v248,12,v248
v_and_b32 v249,7,v248
v_lshlrev_b32 v249,1,v249
v_and_b32 v250,15,v226
v_xor_b32 v249,v249,v250
v_mul_u32_u24 v250,52,v249
v_lshrrev_b32 v250,8,v250
v_mul_u32_u24 v251,5,v250
v_sub_u32 v249,v249,v251
v_lshlrev_b32 v249,4,v249
v_add_u32 v251,1,v250
buffer_load_dwordx4 v231,s[4:7],s73 offen offset:1024 lds
v_mul_u32_u24 v251,1152,v251
v_add_u32 v251,s98,v251
v_cmp_eq_u32 vcc,2,v250
s_nop 1
v_cndmask_b32 v251,v251,v252,vcc
v_add_u32 v249,v249,v251
v_add_u32 v250,1,v250
v_lshrrev_b32 v250,2,v250
v_lshl_or_b32 v249,v250,31,v249
s_lshl_b32 s100,s45,4
v_add_u32 v248,s100,v248
v_mul_u32_u24 v248,3456,v248
v_add_u32 v222,v248,v249
v_subrev_u32 v222,3072,v222
s_and_b32 s98,s41,1
s_lshl_b32 s98,s98,3
s_mul_i32 s99,s47,40
s_and_b32 s100,s101,1
s_lshl_b32 s100,s100,3
s_add_u32 s100,s100,s99
s_add_u32 s99,s99,s98
s_add_u32 s98,s98,32
s_add_u32 m0,s85,16384
s_nop 0
buffer_load_dwordx4 v230,s[4:7],s74 offen lds
v_and_b32 v248,3,v226
v_lshl_add_u32 v248,v248,3,s99
v_add_u32 v248,0,v248
v_bfe_u32 v249,v226,2,3
v_lshlrev_b32 v249,5,v249
v_xor_b32 v248,v248,v249
v_lshrrev_b32 v249,2,v226
v_lshl_add_u32 v218,v249,8,v248
v_and_b32 v248,3,v226
v_lshl_add_u32 v248,v248,3,s99
v_add_u32 v248,80,v248
v_bfe_u32 v249,v226,2,3
v_lshlrev_b32 v249,5,v249
v_xor_b32 v248,v248,v249
v_lshrrev_b32 v249,2,v226
v_lshl_add_u32 v228,v249,8,v248
v_and_b32 v248,3,v226
v_lshl_add_u32 v248,v248,3,s100
v_add_u32 v248,160,v248
v_bfe_u32 v249,v226,2,3
buffer_load_dwordx4 v231,s[4:7],s74 offen offset:1024 lds
v_lshlrev_b32 v249,5,v249
v_xor_b32 v248,v248,v249
v_lshrrev_b32 v249,2,v226
v_lshl_add_u32 v229,v249,8,v248
v_and_b32 v248,3,v226
v_min_u32 v248,2,v248
v_lshrrev_b32 v250,1,v248
v_mul_u32_u24 v248,80,v248
v_add_u32 v248,s98,v248
v_lshlrev_b32 v250,3,v250
v_and_b32 v250,8,v250
v_xor_b32 v248,v248,v250
v_bfe_u32 v249,v226,2,3
v_lshlrev_b32 v249,5,v249
v_xor_b32 v248,v248,v249
v_lshrrev_b32 v249,2,v226
v_lshl_add_u32 v223,v249,8,v248
s_waitcnt vmcnt(22)
ds_read_b128 v[0:3],v244 offset:0
ds_read_b128 v[4:7],v245 offset:0
s_waitcnt vmcnt(20)
ds_read_b128 v[8:11],v244 offset:2048
s_waitcnt lgkmcnt(0)
v_mfma_f32_16x16x32_bf16 v[204:207],v[192:195],v[0:3],0
ds_read_b128 v[12:15],v245 offset:2048
s_add_u32 m0,s75,6144
s_waitcnt vmcnt(18)
ds_read_b128 v[16:19],v244 offset:4096
ds_read_b128 v[20:23],v245 offset:4096
v_mfma_f32_16x16x32_bf16 v[204:207],v[192:195],v[4:7],v[204:207]
buffer_load_dwordx4 v232,s[4:7],s69 offen lds
buffer_load_dwordx4 v233,s[4:7],s69 offen offset:1024 lds
s_add_u32 m0,s75,8192
s_waitcnt vmcnt(8)
ds_read_b128 v[24:27],v244 offset:6144
v_mfma_f32_16x16x32_bf16 v[204:207],v[192:195],v[8:11],v[204:207]
ds_read_b128 v[28:31],v245 offset:6144
ds_read_b128 v[32:35],v244 offset:8192
ds_read_b128 v[36:39],v245 offset:8192
ds_read_b128 v[40:43],v244 offset:10240
ds_read_b128 v[44:47],v245 offset:10240
s_waitcnt lgkmcnt(6)
v_mfma_f32_16x16x32_bf16 v[204:207],v[192:195],v[12:15],v[204:207]
buffer_load_dwordx4 v232,s[4:7],s70 offen lds
buffer_load_dwordx4 v233,s[4:7],s70 offen offset:1024 lds
s_add_u32 m0,s75,10240
s_waitcnt vmcnt(4)
ds_read_b128 v[48:51],v244 offset:12288
v_mfma_f32_16x16x32_bf16 v[204:207],v[192:195],v[16:19],v[204:207]
ds_read_b128 v[52:55],v245 offset:12288
ds_read_b128 v[56:59],v244 offset:14336
ds_read_b128 v[60:63],v245 offset:14336
ds_read_b128 v[120:123],v244 offset:16384
ds_read_b128 v[124:127],v245 offset:16384
v_mfma_f32_16x16x32_bf16 v[204:207],v[192:195],v[20:23],v[204:207]
buffer_load_dwordx4 v232,s[4:7],s71 offen lds
buffer_load_dwordx4 v233,s[4:7],s71 offen offset:1024 lds
s_add_u32 m0,s75,12288
s_waitcnt lgkmcnt(9)
s_sub_u32 s88,s75,s85
v_mfma_f32_16x16x32_bf16 v[204:207],v[192:195],v[24:27],v[204:207]
buffer_load_dwordx4 v232,s[4:7],s72 offen lds
buffer_load_dwordx4 v233,s[4:7],s72 offen offset:1024 lds
s_add_u32 m0,s75,14336
v_add_u32 v244,s88,v244
v_add_u32 v245,s88,v245
v_mfma_f32_16x16x32_bf16 v[204:207],v[192:195],v[28:31],v[204:207]
buffer_load_dwordx4 v232,s[4:7],s73 offen lds
buffer_load_dwordx4 v233,s[4:7],s73 offen offset:1024 lds
s_add_u32 m0,s75,16384
s_lshl_b32 s88,s45,10
s_add_u32 s88,s88,143360
v_mfma_f32_16x16x32_bf16 v[204:207],v[192:195],v[32:35],v[204:207]
buffer_load_dwordx4 v232,s[4:7],s74 offen lds
buffer_load_dwordx4 v233,s[4:7],s74 offen offset:1024 lds
s_waitcnt lgkmcnt(6)
v_mfma_f32_16x16x32_bf16 v[204:207],v[192:195],v[36:39],v[204:207]
v_mfma_f32_16x16x32_bf16 v[204:207],v[192:195],v[40:43],v[204:207]
v_mfma_f32_16x16x32_bf16 v[204:207],v[192:195],v[44:47],v[204:207]
s_waitcnt lgkmcnt(3)
v_mfma_f32_16x16x32_bf16 v[204:207],v[192:195],v[48:51],v[204:207]
v_mfma_f32_16x16x32_bf16 v[204:207],v[192:195],v[52:55],v[204:207]
v_mfma_f32_16x16x32_bf16 v[204:207],v[192:195],v[56:59],v[204:207]
s_waitcnt lgkmcnt(0)
v_mfma_f32_16x16x32_bf16 v[204:207],v[192:195],v[60:63],v[204:207]
v_mfma_f32_16x16x32_bf16 v[204:207],v[192:195],v[120:123],v[204:207]
v_mfma_f32_16x16x32_bf16 v[204:207],v[192:195],v[124:127],v[204:207]
s_nop 7
v_mul_f32 v204,0xbae38e39,v204
v_mul_f32 v205,0xbae38e39,v205
v_mul_f32 v206,0xbae38e39,v206
v_mul_f32 v207,0xbae38e39,v207
s_nop 1
v_mfma_f32_16x16x32_bf16 v[176:179],v[196:199],v[0:3],v[204:207]
v_mfma_f32_16x16x32_bf16 v[180:183],v[200:203],v[0:3],v[204:207]
v_mfma_f32_16x16x32_bf16 v[184:187],v[196:199],v[4:7],v[204:207]
v_mfma_f32_16x16x32_bf16 v[188:191],v[200:203],v[4:7],v[204:207]
s_nop 4
v_cvt_pk_bf16_f32 v246,v176,v177
v_cvt_pk_bf16_f32 v247,v178,v179
v_cvt_pk_bf16_f32 v248,v180,v181
v_cvt_pk_bf16_f32 v249,v182,v183
v_accvgpr_write_b32 a0,v246
s_nop 0
v_mfma_f32_16x16x32_bf16 v[238:241],v[246:249],v[246:249],0
ds_write_b128 v242,v[246:249] offset:0
v_accvgpr_write_b32 a1,v247
v_accvgpr_write_b32 a2,v248
v_accvgpr_write_b32 a3,v249
v_mfma_f32_16x16x32_bf16 v[176:179],v[196:199],v[8:11],v[204:207]
v_cvt_pk_bf16_f32 v250,v184,v185
v_cvt_pk_bf16_f32 v251,v186,v187
v_accvgpr_write_b32 a16,v250
v_accvgpr_write_b32 a17,v251
v_mfma_f32_16x16x32_bf16 v[180:183],v[200:203],v[8:11],v[204:207]
s_add_u32 m0,s84,0
v_cvt_pk_bf16_f32 v252,v188,v189
v_cvt_pk_bf16_f32 v253,v190,v191
ds_write_b128 v242,v[250:253] offset:1024
v_accvgpr_write_b32 a18,v252
v_mfma_f32_16x16x32_bf16 v[238:241],v[250:253],v[250:253],v[238:241]
buffer_load_dwordx4 v213,s[8:11],s48 offen lds
buffer_load_dwordx4 v213,s[12:15],s48 offen offset:1024 lds
s_add_u32 m0,s84,8192
v_accvgpr_write_b32 a19,v253
v_mfma_f32_16x16x32_bf16 v[184:187],v[196:199],v[12:15],v[204:207]
buffer_load_dwordx4 v214,s[8:11],s48 offen lds
buffer_load_dwordx4 v214,s[12:15],s48 offen offset:1024 lds
v_cvt_pk_bf16_f32 v208,v176,v177
v_cvt_pk_bf16_f32 v209,v178,v179
v_accvgpr_write_b32 a32,v208
v_mfma_f32_16x16x32_bf16 v[188:191],v[200:203],v[12:15],v[204:207]
v_cvt_pk_bf16_f32 v210,v180,v181
v_cvt_pk_bf16_f32 v211,v182,v183
ds_write_b128 v242,v[208:211] offset:2048
v_accvgpr_write_b32 a33,v209
v_accvgpr_write_b32 a34,v210
v_mfma_f32_16x16x32_bf16 v[238:241],v[208:211],v[208:211],v[238:241]
v_accvgpr_write_b32 a35,v211
v_mfma_f32_16x16x32_bf16 v[176:179],v[196:199],v[16:19],v[204:207]
v_cvt_pk_bf16_f32 v246,v184,v185
v_cvt_pk_bf16_f32 v247,v186,v187
v_accvgpr_write_b32 a48,v246
v_accvgpr_write_b32 a49,v247
v_mfma_f32_16x16x32_bf16 v[180:183],v[200:203],v[16:19],v[204:207]
v_cvt_pk_bf16_f32 v248,v188,v189
v_cvt_pk_bf16_f32 v249,v190,v191
ds_write_b128 v242,v[246:249] offset:3072
v_accvgpr_write_b32 a50,v248
v_accvgpr_write_b32 a51,v249
v_mfma_f32_16x16x32_bf16 v[238:241],v[246:249],v[246:249],v[238:241]
v_mfma_f32_16x16x32_bf16 v[184:187],v[196:199],v[20:23],v[204:207]
v_cvt_pk_bf16_f32 v250,v176,v177
v_cvt_pk_bf16_f32 v251,v178,v179
v_accvgpr_write_b32 a64,v250
v_accvgpr_write_b32 a65,v251
v_mfma_f32_16x16x32_bf16 v[188:191],v[200:203],v[20:23],v[204:207]
v_cvt_pk_bf16_f32 v252,v180,v181
v_cvt_pk_bf16_f32 v253,v182,v183
ds_write_b128 v242,v[250:253] offset:4096
v_accvgpr_write_b32 a66,v252
v_accvgpr_write_b32 a67,v253
v_mfma_f32_16x16x32_bf16 v[238:241],v[250:253],v[250:253],v[238:241]
v_mfma_f32_16x16x32_bf16 v[176:179],v[196:199],v[24:27],v[204:207]
v_cvt_pk_bf16_f32 v208,v184,v185
v_cvt_pk_bf16_f32 v209,v186,v187
v_accvgpr_write_b32 a80,v208
v_accvgpr_write_b32 a81,v209
v_mfma_f32_16x16x32_bf16 v[180:183],v[200:203],v[24:27],v[204:207]
v_cvt_pk_bf16_f32 v210,v188,v189
v_cvt_pk_bf16_f32 v211,v190,v191
ds_write_b128 v242,v[208:211] offset:5120
v_accvgpr_write_b32 a82,v210
v_accvgpr_write_b32 a83,v211
v_mfma_f32_16x16x32_bf16 v[238:241],v[208:211],v[208:211],v[238:241]
v_mfma_f32_16x16x32_bf16 v[184:187],v[196:199],v[28:31],v[204:207]
v_cvt_pk_bf16_f32 v246,v176,v177
v_cvt_pk_bf16_f32 v247,v178,v179
v_accvgpr_write_b32 a96,v246
v_accvgpr_write_b32 a97,v247
v_mfma_f32_16x16x32_bf16 v[188:191],v[200:203],v[28:31],v[204:207]
v_cvt_pk_bf16_f32 v248,v180,v181
v_cvt_pk_bf16_f32 v249,v182,v183
ds_write_b128 v242,v[246:249] offset:6144
v_accvgpr_write_b32 a98,v248
v_accvgpr_write_b32 a99,v249
v_mfma_f32_16x16x32_bf16 v[238:241],v[246:249],v[246:249],v[238:241]
v_mfma_f32_16x16x32_bf16 v[176:179],v[196:199],v[32:35],v[204:207]
v_cvt_pk_bf16_f32 v250,v184,v185
v_cvt_pk_bf16_f32 v251,v186,v187
v_accvgpr_write_b32 a112,v250
v_accvgpr_write_b32 a113,v251
s_waitcnt lgkmcnt(1)
v_mfma_f32_16x16x32_bf16 v[180:183],v[200:203],v[32:35],v[204:207]
v_cvt_pk_bf16_f32 v252,v188,v189
v_cvt_pk_bf16_f32 v253,v190,v191
ds_write_b128 v242,v[250:253] offset:7168
v_accvgpr_write_b32 a114,v252
v_accvgpr_write_b32 a115,v253
v_mfma_f32_16x16x32_bf16 v[238:241],v[250:253],v[250:253],v[238:241]
s_barrier
ds_read_b128 a[8:11],v243 offset:0
ds_read_b128 a[24:27],v243 offset:1024
ds_read_b128 a[40:43],v243 offset:2048
ds_read_b128 a[56:59],v243 offset:3072
v_mfma_f32_16x16x32_bf16 v[184:187],v[196:199],v[36:39],v[204:207]
v_cvt_pk_bf16_f32 v208,v176,v177
v_cvt_pk_bf16_f32 v209,v178,v179
v_accvgpr_write_b32 a128,v208
v_accvgpr_write_b32 a129,v209
v_mfma_f32_16x16x32_bf16 v[188:191],v[200:203],v[36:39],v[204:207]
ds_read_b128 v[160:163],v244 offset:0
ds_read_b128 v[164:167],v245 offset:0
v_cvt_pk_bf16_f32 v210,v180,v181
v_cvt_pk_bf16_f32 v211,v182,v183
ds_write_b128 v242,v[208:211] offset:8192
s_nop 0
v_mfma_f32_16x16x32_bf16 v[238:241],v[208:211],v[208:211],v[238:241]
v_accvgpr_write_b32 a130,v210
v_accvgpr_write_b32 a131,v211
ds_read_b128 v[168:171],v244 offset:2048
ds_read_b128 v[172:175],v245 offset:2048
v_mfma_f32_16x16x32_bf16 v[176:179],v[196:199],v[40:43],v[204:207]
v_cvt_pk_bf16_f32 v246,v184,v185
v_cvt_pk_bf16_f32 v247,v186,v187
v_accvgpr_write_b32 a144,v246
v_accvgpr_write_b32 a145,v247
v_mfma_f32_16x16x32_bf16 v[180:183],v[200:203],v[40:43],v[204:207]
ds_read_b128 v[64:67],v244 offset:4096
ds_read_b128 v[68:71],v245 offset:4096
v_cvt_pk_bf16_f32 v248,v188,v189
v_cvt_pk_bf16_f32 v249,v190,v191
ds_write_b128 v242,v[246:249] offset:9216
s_nop 0
v_mfma_f32_16x16x32_bf16 v[238:241],v[246:249],v[246:249],v[238:241]
v_accvgpr_write_b32 a146,v248
v_accvgpr_write_b32 a147,v249
s_waitcnt vmcnt(10)
ds_read_b128 v[72:75],v244 offset:6144
ds_read_b128 v[76:79],v245 offset:6144
v_mfma_f32_16x16x32_bf16 v[184:187],v[196:199],v[44:47],v[204:207]
v_cvt_pk_bf16_f32 v250,v176,v177
v_cvt_pk_bf16_f32 v251,v178,v179
ds_read_b128 v[80:83],v244 offset:8192
ds_read_b128 v[84:87],v245 offset:8192
ds_read_b128 v[88:91],v244 offset:10240
v_mfma_f32_16x16x32_bf16 v[188:191],v[200:203],v[44:47],v[204:207]
v_cvt_pk_bf16_f32 v252,v180,v181
v_cvt_pk_bf16_f32 v253,v182,v183
ds_read_b128 v[92:95],v245 offset:10240
ds_write_b128 v242,v[250:253] offset:10240
v_accvgpr_write_b32 a160,v250
v_mfma_f32_16x16x32_bf16 v[238:241],v[250:253],v[250:253],v[238:241]
v_accvgpr_write_b32 a161,v251
v_accvgpr_write_b32 a162,v252
v_accvgpr_write_b32 a163,v253
s_waitcnt vmcnt(4)
ds_read_b128 v[96:99],v244 offset:12288
v_mfma_f32_16x16x32_bf16 v[176:179],v[196:199],v[48:51],v[204:207]
v_cvt_pk_bf16_f32 v208,v184,v185
v_cvt_pk_bf16_f32 v209,v186,v187
ds_read_b128 v[100:103],v245 offset:12288
ds_read_b128 v[104:107],v244 offset:14336
ds_read_b128 v[108:111],v245 offset:14336
v_mfma_f32_16x16x32_bf16 v[180:183],v[200:203],v[48:51],v[204:207]
v_cvt_pk_bf16_f32 v210,v188,v189
v_cvt_pk_bf16_f32 v211,v190,v191
ds_read_b128 v[112:115],v244 offset:16384
ds_read_b128 v[116:119],v245 offset:16384
ds_write_b128 v242,v[208:211] offset:11264
v_mfma_f32_16x16x32_bf16 v[238:241],v[208:211],v[208:211],v[238:241]
s_waitcnt lgkmcnt(15)
v_accvgpr_write_b32 a176,v208
v_accvgpr_write_b32 a177,v209
v_accvgpr_write_b32 a178,v210
v_accvgpr_write_b32 a179,v211
v_mfma_f32_16x16x32_bf16 v[230:233],v[192:195],v[160:163],0
v_cvt_pk_bf16_f32 v246,v176,v177
v_cvt_pk_bf16_f32 v247,v178,v179
v_accvgpr_write_b32 a192,v246
v_accvgpr_write_b32 a193,v247
ds_read_b128 a[72:75],v243 offset:4096
v_mfma_f32_16x16x32_bf16 v[230:233],v[192:195],v[164:167],v[230:233]
v_cvt_pk_bf16_f32 v248,v180,v181
v_cvt_pk_bf16_f32 v249,v182,v183
ds_write_b128 v242,v[246:249] offset:12288
v_accvgpr_write_b32 a194,v248
v_accvgpr_write_b32 a195,v249
v_mfma_f32_16x16x32_bf16 v[230:233],v[192:195],v[168:171],v[230:233]
ds_read_b128 a[88:91],v243 offset:5120
v_add_u32 v244,s88,v212
v_xor_b32 v245,1024,v244
v_mfma_f32_16x16x32_bf16 v[184:187],v[196:199],v[52:55],v[204:207]
s_waitcnt lgkmcnt(3)
s_barrier
s_add_u32 m0,s84,102400
ds_read_b128 a[104:107],v243 offset:6144
ds_read_b128 a[120:123],v243 offset:7168
v_mfma_f32_16x16x32_bf16 v[188:191],v[200:203],v[52:55],v[204:207]
buffer_load_dwordx4 v213,s[8:11],s49 offen lds
ds_read_b128 a[136:139],v243 offset:8192
ds_read_b128 a[152:155],v243 offset:9216
ds_read_b128 a[168:171],v243 offset:10240
ds_read_b128 a[184:187],v243 offset:11264
v_mfma_f32_16x16x32_bf16 v[238:241],v[246:249],v[246:249],v[238:241]
buffer_load_dwordx4 v213,s[12:15],s49 offen offset:1024 lds
s_add_u32 m0,s84,110592
v_mfma_f32_16x16x32_bf16 v[230:233],v[192:195],v[172:175],v[230:233]
v_cvt_pk_bf16_f32 v250,v184,v185
v_cvt_pk_bf16_f32 v251,v186,v187
v_accvgpr_write_b32 a208,v250
v_accvgpr_write_b32 a209,v251
v_mfma_f32_16x16x32_bf16 v[230:233],v[192:195],v[64:67],v[230:233]
v_cvt_pk_bf16_f32 v252,v188,v189
v_cvt_pk_bf16_f32 v253,v190,v191
ds_write_b128 v242,v[250:253] offset:13312
v_accvgpr_write_b32 a210,v252
v_accvgpr_write_b32 a211,v253
v_mfma_f32_16x16x32_bf16 v[230:233],v[192:195],v[68:71],v[230:233]
buffer_load_dwordx4 v214,s[8:11],s49 offen lds
v_mfma_f32_16x16x32_bf16 v[176:179],v[196:199],v[56:59],v[204:207]
v_mfma_f32_16x16x32_bf16 v[180:183],v[200:203],v[56:59],v[204:207]
v_mfma_f32_16x16x32_bf16 v[238:241],v[250:253],v[250:253],v[238:241]
v_mfma_f32_16x16x32_bf16 v[230:233],v[192:195],v[72:75],v[230:233]
s_nop 4
v_cvt_pk_bf16_f32 v208,v176,v177
v_cvt_pk_bf16_f32 v209,v178,v179
buffer_load_dwordx4 v214,s[12:15],s49 offen offset:1024 lds
s_add_u32 m0,s84,122880
v_accvgpr_write_b32 a224,v208
v_mfma_f32_16x16x32_bf16 v[230:233],v[192:195],v[76:79],v[230:233]
v_cvt_pk_bf16_f32 v210,v180,v181
v_cvt_pk_bf16_f32 v211,v182,v183
ds_write_b128 v242,v[208:211] offset:14336
v_accvgpr_write_b32 a225,v209
v_accvgpr_write_b32 a226,v210
v_mfma_f32_16x16x32_bf16 v[230:233],v[192:195],v[80:83],v[230:233]
v_accvgpr_write_b32 a227,v211
v_mfma_f32_16x16x32_bf16 v[184:187],v[196:199],v[60:63],v[204:207]
v_mfma_f32_16x16x32_bf16 v[188:191],v[200:203],v[60:63],v[204:207]
buffer_load_dwordx4 v213,s[8:11],s50 offen lds
v_mfma_f32_16x16x32_bf16 v[238:241],v[208:211],v[208:211],v[238:241]
v_mfma_f32_16x16x32_bf16 v[230:233],v[192:195],v[84:87],v[230:233]
s_nop 3
v_cvt_pk_bf16_f32 v246,v184,v185
v_cvt_pk_bf16_f32 v247,v186,v187
v_accvgpr_write_b32 a240,v246
v_accvgpr_write_b32 a241,v247
v_mfma_f32_16x16x32_bf16 v[230:233],v[192:195],v[88:91],v[230:233]
buffer_load_dwordx4 v213,s[12:15],s50 offen offset:1024 lds
s_add_u32 m0,s84,131072
v_cvt_pk_bf16_f32 v248,v188,v189
v_cvt_pk_bf16_f32 v249,v190,v191
ds_write_b128 v242,v[246:249] offset:15360
v_mfma_f32_16x16x32_bf16 v[230:233],v[192:195],v[92:95],v[230:233]
v_accvgpr_write_b32 a242,v248
v_accvgpr_write_b32 a243,v249
v_mfma_f32_16x16x32_bf16 v[176:179],v[196:199],v[120:123],v[204:207]
v_mfma_f32_16x16x32_bf16 v[180:183],v[200:203],v[120:123],v[204:207]
v_mfma_f32_16x16x32_bf16 v[238:241],v[246:249],v[246:249],v[238:241]
buffer_load_dwordx4 v214,s[8:11],s50 offen lds
v_mfma_f32_16x16x32_bf16 v[230:233],v[192:195],v[96:99],v[230:233]
s_nop 3
v_cvt_pk_bf16_f32 v250,v176,v177
v_cvt_pk_bf16_f32 v251,v178,v179
v_mov_b32 v128,v250
v_mov_b32 v129,v251
v_mfma_f32_16x16x32_bf16 v[230:233],v[192:195],v[100:103],v[230:233]
v_cvt_pk_bf16_f32 v252,v180,v181
v_cvt_pk_bf16_f32 v253,v182,v183
ds_write_b128 v242,v[250:253] offset:16384
v_mov_b32 v130,v252
v_mov_b32 v131,v253
v_mfma_f32_16x16x32_bf16 v[230:233],v[192:195],v[104:107],v[230:233]
v_mfma_f32_16x16x32_bf16 v[184:187],v[196:199],v[124:127],v[204:207]
buffer_load_dwordx4 v214,s[12:15],s50 offen offset:1024 lds
v_mfma_f32_16x16x32_bf16 v[188:191],v[200:203],v[124:127],v[204:207]
v_mfma_f32_16x16x32_bf16 v[238:241],v[250:253],v[250:253],v[238:241]
v_mfma_f32_16x16x32_bf16 v[230:233],v[192:195],v[108:111],v[230:233]
s_nop 3
v_cvt_pk_bf16_f32 v208,v184,v185
v_cvt_pk_bf16_f32 v209,v186,v187
v_mov_b32 v144,v208
v_mov_b32 v145,v209
v_mfma_f32_16x16x32_bf16 v[230:233],v[192:195],v[112:115],v[230:233]
v_cvt_pk_bf16_f32 v210,v188,v189
v_cvt_pk_bf16_f32 v211,v190,v191
ds_write_b128 v242,v[208:211] offset:17408
v_mov_b32 v146,v210
v_mov_b32 v147,v211
v_mfma_f32_16x16x32_bf16 v[230:233],v[192:195],v[116:119],v[230:233]
s_nop 7
v_mul_f32 v230,0xbae38e39,v230
v_mul_f32 v231,0xbae38e39,v231
v_mul_f32 v232,0xbae38e39,v232
v_mul_f32 v233,0xbae38e39,v233
s_nop 1
v_mfma_f32_16x16x32_bf16 v[176:179],v[196:199],v[160:163],v[230:233]
v_mfma_f32_16x16x32_bf16 v[180:183],v[200:203],v[160:163],v[230:233]
v_mfma_f32_16x16x32_bf16 v[238:241],v[208:211],v[208:211],v[238:241]
v_mfma_f32_16x16x32_bf16 v[184:187],v[196:199],v[164:167],v[230:233]
s_waitcnt lgkmcnt(0)
s_barrier
s_nop 2
v_cvt_pk_bf16_f32 v246,v176,v177
v_cvt_pk_bf16_f32 v247,v178,v179
ds_read_b128 a[200:203],v243 offset:12288
v_mfma_f32_16x16x32_bf16 v[188:191],v[200:203],v[164:167],v[230:233]
v_cvt_pk_bf16_f32 v248,v180,v181
v_cvt_pk_bf16_f32 v249,v182,v183
ds_read_b128 a[216:219],v243 offset:13312
ds_read_b128 a[232:235],v243 offset:14336
ds_read_b128 a[248:251],v243 offset:15360
v_mfma_f32_16x16x32_bf16 v[234:237],v[246:249],v[246:249],0
ds_read_b128 v[136:139],v243 offset:16384
ds_read_b128 v[152:155],v243 offset:17408
ds_write_b128 v244,v[246:249] offset:0
v_accvgpr_write_b32 a4,v246
v_accvgpr_write_b32 a5,v247
v_mfma_f32_16x16x32_bf16 v[176:179],v[196:199],v[168:171],v[230:233]
v_cvt_pk_bf16_f32 v250,v184,v185
v_cvt_pk_bf16_f32 v251,v186,v187
v_accvgpr_write_b32 a6,v248
v_accvgpr_write_b32 a7,v249
v_accvgpr_write_b32 a20,v250
v_mfma_f32_16x16x32_bf16 v[180:183],v[200:203],v[168:171],v[230:233]
v_cvt_pk_bf16_f32 v252,v188,v189
v_cvt_pk_bf16_f32 v253,v190,v191
ds_write_b128 v244,v[250:253] offset:4096
v_accvgpr_write_b32 a21,v251
v_accvgpr_write_b32 a22,v252
v_mfma_f32_16x16x32_bf16 v[234:237],v[250:253],v[250:253],v[234:237]
v_accvgpr_write_b32 a23,v253
v_mfma_f32_16x16x32_bf16 v[184:187],v[196:199],v[172:175],v[230:233]
v_cvt_pk_bf16_f32 v208,v176,v177
v_cvt_pk_bf16_f32 v209,v178,v179
v_accvgpr_write_b32 a36,v208
v_accvgpr_write_b32 a37,v209
v_mfma_f32_16x16x32_bf16 v[188:191],v[200:203],v[172:175],v[230:233]
v_cvt_pk_bf16_f32 v210,v180,v181
v_cvt_pk_bf16_f32 v211,v182,v183
ds_write_b128 v244,v[208:211] offset:8192
v_accvgpr_write_b32 a38,v210
v_accvgpr_write_b32 a39,v211
v_mfma_f32_16x16x32_bf16 v[234:237],v[208:211],v[208:211],v[234:237]
v_cvt_pk_bf16_f32 v246,v184,v185
v_cvt_pk_bf16_f32 v247,v186,v187
v_cvt_pk_bf16_f32 v248,v188,v189
v_cvt_pk_bf16_f32 v249,v190,v191
s_nop 1
v_mfma_f32_16x16x32_bf16 v[234:237],v[246:249],v[246:249],v[234:237]
ds_write_b128 v244,v[246:249] offset:12288
v_accvgpr_write_b32 a52,v246
v_accvgpr_write_b32 a53,v247
v_accvgpr_write_b32 a54,v248
v_accvgpr_write_b32 a55,v249
s_waitcnt vmcnt(8) lgkmcnt(0)
s_barrier
ds_read_b128 a[12:15],v245 offset:0
ds_read_b128 a[28:31],v245 offset:4096
ds_read_b64_tr_b16 v[160:161],v215 offset:0
ds_read_b64_tr_b16 v[162:163],v215 offset:4096
ds_read_b64_tr_b16 v[164:165],v216 offset:0
ds_read_b64_tr_b16 v[166:167],v216 offset:4096
ds_read_b64_tr_b16 v[168:169],v215 offset:1024
ds_read_b64_tr_b16 v[170:171],v215 offset:5120
ds_read_b64_tr_b16 v[172:173],v216 offset:1024
ds_read_b64_tr_b16 v[174:175],v216 offset:5120
s_waitcnt lgkmcnt(0)
v_mfma_f32_16x16x32_bf16 v[0:3],v[160:163],a[0:3],0
s_add_u32 m0,s84,20480
v_add_u32 v218,122880,v218
v_mfma_f32_16x16x32_bf16 v[4:7],v[160:163],a[4:7],0
buffer_load_dwordx4 v213,s[8:11],s51 offen lds
v_add_u32 v228,122880,v228
v_mfma_f32_16x16x32_bf16 v[8:11],v[160:163],a[8:11],0
buffer_load_dwordx4 v213,s[12:15],s51 offen offset:1024 lds
s_add_u32 m0,s84,28672
v_mfma_f32_16x16x32_bf16 v[12:15],v[160:163],a[12:15],0
ds_read_b64_tr_b16 v[176:177],v215 offset:8192
v_add_u32 v229,122880,v229
v_mfma_f32_16x16x32_bf16 v[16:19],v[164:167],a[0:3],0
ds_read_b64_tr_b16 v[178:179],v215 offset:12288
v_add_u32 v223,122880,v223
v_mfma_f32_16x16x32_bf16 v[20:23],v[164:167],a[4:7],0
ds_read_b64_tr_b16 v[180:181],v216 offset:8192
s_mov_b32 vcc_lo,0x22222222
v_mfma_f32_16x16x32_bf16 v[24:27],v[164:167],a[8:11],0
ds_read_b64_tr_b16 v[182:183],v216 offset:12288
s_mov_b32 vcc_hi,0x22222222
v_mfma_f32_16x16x32_bf16 v[28:31],v[164:167],a[12:15],0
buffer_load_dwordx4 v214,s[8:11],s51 offen lds
ds_read_b64_tr_b16 v[184:185],v215 offset:9216
v_mfma_f32_16x16x32_bf16 v[32:35],v[168:171],a[0:3],0
ds_read_b64_tr_b16 v[186:187],v215 offset:13312
v_add_u32 v215,102400,v215
v_mfma_f32_16x16x32_bf16 v[36:39],v[168:171],a[4:7],0
ds_read_b64_tr_b16 v[188:189],v216 offset:9216
v_cndmask_b32 v238,v238,v239,vcc
v_mfma_f32_16x16x32_bf16 v[40:43],v[168:171],a[8:11],0
ds_read_b64_tr_b16 v[190:191],v216 offset:13312
v_add_u32 v216,102400,v216
v_mfma_f32_16x16x32_bf16 v[44:47],v[168:171],a[12:15],0
buffer_load_dwordx4 v214,s[12:15],s51 offen offset:1024 lds
s_add_u32 m0,s84,40960
v_mfma_f32_16x16x32_bf16 v[48:51],v[172:175],a[0:3],0
s_mov_b32 vcc_lo,0x44444444
s_mov_b32 s89,0x3ae38e39
v_mfma_f32_16x16x32_bf16 v[52:55],v[172:175],a[4:7],0
s_mov_b32 vcc_hi,0x44444444
s_lshl_b32 s88,s45,7
v_mfma_f32_16x16x32_bf16 v[56:59],v[172:175],a[8:11],0
v_cndmask_b32 v238,v238,v240,vcc
s_mov_b32 vcc_lo,0x88888888
v_mfma_f32_16x16x32_bf16 v[60:63],v[172:175],a[12:15],0
buffer_load_dwordx4 v213,s[8:11],s52 offen lds
s_mov_b32 vcc_hi,0x88888888
v_mfma_f32_16x16x32_bf16 v[246:249],v[196:199],v[64:67],v[230:233]
v_cndmask_b32 v238,v238,v241,vcc
s_mov_b32 vcc_lo,0x00f0000f
v_mfma_f32_16x16x32_bf16 v[250:253],v[200:203],v[64:67],v[230:233]
s_waitcnt lgkmcnt(0)
s_mov_b32 vcc_hi,0xf0000f00
v_mfma_f32_16x16x32_bf16 v[0:3],v[176:179],a[16:19],v[0:3]
s_waitcnt vmcnt(9)
s_barrier
v_mfma_f32_16x16x32_bf16 v[4:7],v[176:179],a[20:23],v[4:7]
ds_read_b128 a[44:47],v245 offset:8192
v_cvt_pk_bf16_f32 v192,v246,v247
v_mfma_f32_16x16x32_bf16 v[8:11],v[176:179],a[24:27],v[8:11]
buffer_load_dwordx4 v213,s[12:15],s52 offen offset:1024 lds
s_add_u32 m0,s84,49152
v_mfma_f32_16x16x32_bf16 v[12:15],v[176:179],a[28:31],v[12:15]
ds_read_b128 a[60:63],v245 offset:12288
v_cvt_pk_bf16_f32 v193,v248,v249
v_mfma_f32_16x16x32_bf16 v[16:19],v[180:183],a[16:19],v[16:19]
ds_read_b64_tr_b16 v[160:161],v215 offset:0
v_cvt_pk_bf16_f32 v194,v250,v251
v_mfma_f32_16x16x32_bf16 v[20:23],v[180:183],a[20:23],v[20:23]
ds_read_b64_tr_b16 v[162:163],v215 offset:4096
v_cvt_pk_bf16_f32 v195,v252,v253
v_mfma_f32_16x16x32_bf16 v[24:27],v[180:183],a[24:27],v[24:27]
buffer_load_dwordx4 v214,s[8:11],s52 offen lds
ds_read_b64_tr_b16 v[164:165],v216 offset:0
v_mfma_f32_16x16x32_bf16 v[28:31],v[180:183],a[28:31],v[28:31]
ds_read_b64_tr_b16 v[166:167],v216 offset:4096
v_accvgpr_write_b32 a68,v192
v_mfma_f32_16x16x32_bf16 v[32:35],v[184:187],a[16:19],v[32:35]
ds_read_b64_tr_b16 v[168:169],v215 offset:1024
v_accvgpr_write_b32 a69,v193
v_mfma_f32_16x16x32_bf16 v[36:39],v[184:187],a[20:23],v[36:39]
ds_read_b64_tr_b16 v[170:171],v215 offset:5120
v_accvgpr_write_b32 a70,v194
v_mfma_f32_16x16x32_bf16 v[40:43],v[184:187],a[24:27],v[40:43]
buffer_load_dwordx4 v214,s[12:15],s52 offen offset:1024 lds
s_add_u32 m0,s84,61440
v_mfma_f32_16x16x32_bf16 v[44:47],v[184:187],a[28:31],v[44:47]
ds_read_b64_tr_b16 v[172:173],v216 offset:1024
v_accvgpr_write_b32 a71,v195
v_mfma_f32_16x16x32_bf16 v[48:51],v[188:191],a[16:19],v[48:51]
ds_read_b64_tr_b16 v[174:175],v216 offset:5120
v_cndmask_b32 v238,0,v238,vcc
v_mfma_f32_16x16x32_bf16 v[52:55],v[188:191],a[20:23],v[52:55]
ds_write_b128 v244,v[192:195] offset:0
s_mov_b32 vcc_lo,0x22222222
v_mfma_f32_16x16x32_bf16 v[56:59],v[188:191],a[24:27],v[56:59]
s_mov_b32 vcc_hi,0x22222222
s_add_u32 s88,s88,159744
v_mfma_f32_16x16x32_bf16 v[60:63],v[188:191],a[28:31],v[60:63]
buffer_load_dwordx4 v213,s[8:11],s53 offen lds
s_lshl_b32 s91,s40,2
v_mfma_f32_16x16x32_bf16 v[120:123],v[196:199],v[68:71],v[230:233]
s_lshl_b32 s98,s43,1
s_add_u32 s98,s98,s44
v_mfma_f32_16x16x32_bf16 v[124:127],v[200:203],v[68:71],v[230:233]
s_mul_i32 s99,s3,0x2010102
s_add_u32 s99,s99,0x0e0a0601
v_mfma_f32_16x16x32_bf16 v[234:237],v[192:195],v[192:195],v[234:237]
s_waitcnt lgkmcnt(1)
ds_read_b64_tr_b16 v[176:177],v215 offset:8192
v_mfma_f32_16x16x32_bf16 v[0:3],v[160:163],a[32:35],v[0:3]
buffer_load_dwordx4 v213,s[12:15],s53 offen offset:1024 lds
s_add_u32 m0,s84,69632
v_mfma_f32_16x16x32_bf16 v[4:7],v[160:163],a[36:39],v[4:7]
ds_read_b64_tr_b16 v[178:179],v215 offset:12288
v_cvt_pk_bf16_f32 v204,v120,v121
v_mfma_f32_16x16x32_bf16 v[8:11],v[160:163],a[40:43],v[8:11]
ds_read_b64_tr_b16 v[180:181],v216 offset:8192
v_cvt_pk_bf16_f32 v205,v122,v123
v_mfma_f32_16x16x32_bf16 v[12:15],v[160:163],a[44:47],v[12:15]
ds_read_b64_tr_b16 v[182:183],v216 offset:12288
v_cvt_pk_bf16_f32 v206,v124,v125
v_mfma_f32_16x16x32_bf16 v[16:19],v[164:167],a[32:35],v[16:19]
buffer_load_dwordx4 v214,s[8:11],s53 offen lds
ds_read_b64_tr_b16 v[184:185],v215 offset:9216
v_mfma_f32_16x16x32_bf16 v[20:23],v[164:167],a[36:39],v[20:23]
ds_read_b64_tr_b16 v[186:187],v215 offset:13312
v_cvt_pk_bf16_f32 v207,v126,v127
v_mfma_f32_16x16x32_bf16 v[24:27],v[164:167],a[40:43],v[24:27]
ds_read_b64_tr_b16 v[188:189],v216 offset:9216
v_accvgpr_write_b32 a84,v204
v_mfma_f32_16x16x32_bf16 v[28:31],v[164:167],a[44:47],v[28:31]
ds_read_b64_tr_b16 v[190:191],v216 offset:13312
v_accvgpr_write_b32 a85,v205
v_mfma_f32_16x16x32_bf16 v[32:35],v[168:171],a[32:35],v[32:35]
ds_write_b128 v244,v[204:207] offset:4096
v_accvgpr_write_b32 a86,v206
v_mfma_f32_16x16x32_bf16 v[36:39],v[168:171],a[36:39],v[36:39]
buffer_load_dwordx4 v214,s[12:15],s53 offen offset:1024 lds
s_add_u32 m0,s84,81920
v_mfma_f32_16x16x32_bf16 v[40:43],v[168:171],a[40:43],v[40:43]
v_accvgpr_write_b32 a87,v207
s_add_u32 s66,s98,0
v_mfma_f32_16x16x32_bf16 v[44:47],v[168:171],a[44:47],v[44:47]
s_add_u32 s67,s98,1
s_add_u32 s68,s98,2
v_mfma_f32_16x16x32_bf16 v[48:51],v[172:175],a[32:35],v[48:51]
s_add_u32 s69,s98,3
s_add_u32 s70,s98,4
v_mfma_f32_16x16x32_bf16 v[52:55],v[172:175],a[36:39],v[52:55]
buffer_load_dwordx4 v213,s[8:11],s54 offen lds
s_add_u32 s71,s98,5
v_mfma_f32_16x16x32_bf16 v[56:59],v[172:175],a[40:43],v[56:59]
s_add_u32 s72,s98,6
s_add_u32 s73,s98,7
v_mfma_f32_16x16x32_bf16 v[60:63],v[172:175],a[44:47],v[60:63]
s_add_u32 s98,s44,s43
s_add_u32 s74,s98,0
v_mfma_f32_16x16x32_bf16 v[246:249],v[196:199],v[72:75],v[230:233]
s_and_b32 s74,s74,3
s_lshl_b32 s74,s74,3
v_mfma_f32_16x16x32_bf16 v[250:253],v[200:203],v[72:75],v[230:233]
s_add_u32 s75,s98,1
s_and_b32 s75,s75,3
v_mfma_f32_16x16x32_bf16 v[234:237],v[204:207],v[204:207],v[234:237]
buffer_load_dwordx4 v213,s[12:15],s54 offen offset:1024 lds
s_add_u32 m0,s84,90112
s_waitcnt lgkmcnt(1)
v_mfma_f32_16x16x32_bf16 v[0:3],v[176:179],a[48:51],v[0:3]
s_waitcnt vmcnt(14) lgkmcnt(0)
s_barrier
v_mfma_f32_16x16x32_bf16 v[4:7],v[176:179],a[52:55],v[4:7]
ds_read_b128 a[76:79],v245 offset:0
v_cvt_pk_bf16_f32 v208,v246,v247
v_mfma_f32_16x16x32_bf16 v[8:11],v[176:179],a[56:59],v[8:11]
ds_read_b128 a[92:95],v245 offset:4096
v_cvt_pk_bf16_f32 v209,v248,v249
v_mfma_f32_16x16x32_bf16 v[12:15],v[176:179],a[60:63],v[12:15]
buffer_load_dwordx4 v214,s[8:11],s54 offen lds
ds_read_b64_tr_b16 v[160:161],v215 offset:20480
v_mfma_f32_16x16x32_bf16 v[16:19],v[180:183],a[48:51],v[16:19]
ds_read_b64_tr_b16 v[162:163],v215 offset:24576
v_cvt_pk_bf16_f32 v210,v250,v251
v_mfma_f32_16x16x32_bf16 v[20:23],v[180:183],a[52:55],v[20:23]
ds_read_b64_tr_b16 v[164:165],v216 offset:20480
v_cvt_pk_bf16_f32 v211,v252,v253
v_mfma_f32_16x16x32_bf16 v[24:27],v[180:183],a[56:59],v[24:27]
ds_read_b64_tr_b16 v[166:167],v216 offset:24576
v_accvgpr_write_b32 a100,v208
v_mfma_f32_16x16x32_bf16 v[28:31],v[180:183],a[60:63],v[28:31]
buffer_load_dwordx4 v214,s[12:15],s54 offen offset:1024 lds
s_add_u32 m0,s84,0
v_mfma_f32_16x16x32_bf16 v[32:35],v[184:187],a[48:51],v[32:35]
ds_read_b64_tr_b16 v[168:169],v215 offset:21504
v_accvgpr_write_b32 a101,v209
v_mfma_f32_16x16x32_bf16 v[36:39],v[184:187],a[52:55],v[36:39]
ds_read_b64_tr_b16 v[170:171],v215 offset:25600
v_accvgpr_write_b32 a102,v210
v_mfma_f32_16x16x32_bf16 v[40:43],v[184:187],a[56:59],v[40:43]
ds_read_b64_tr_b16 v[172:173],v216 offset:21504
v_accvgpr_write_b32 a103,v211
v_mfma_f32_16x16x32_bf16 v[44:47],v[184:187],a[60:63],v[44:47]
buffer_load_dwordx4 v213,s[8:11],s55 offen lds
ds_read_b64_tr_b16 v[174:175],v216 offset:25600
v_mfma_f32_16x16x32_bf16 v[48:51],v[188:191],a[48:51],v[48:51]
ds_write_b128 v244,v[208:211] offset:8192
s_lshl_b32 s75,s75,3
v_mfma_f32_16x16x32_bf16 v[52:55],v[188:191],a[52:55],v[52:55]
s_add_u32 s76,s98,2
s_and_b32 s76,s76,3
v_mfma_f32_16x16x32_bf16 v[56:59],v[188:191],a[56:59],v[56:59]
s_lshl_b32 s76,s76,3
s_add_u32 s77,s98,3
v_mfma_f32_16x16x32_bf16 v[60:63],v[188:191],a[60:63],v[60:63]
s_and_b32 s77,s77,3
s_lshl_b32 s77,s77,3
v_mfma_f32_16x16x32_bf16 v[120:123],v[196:199],v[76:79],v[230:233]
buffer_load_dwordx4 v213,s[12:15],s55 offen offset:1024 lds
s_add_u32 m0,s84,8192
v_mfma_f32_16x16x32_bf16 v[124:127],v[200:203],v[76:79],v[230:233]
s_add_u32 s78,s98,0
s_and_b32 s78,s78,3
v_mfma_f32_16x16x32_bf16 v[234:237],v[208:211],v[208:211],v[234:237]
s_waitcnt lgkmcnt(1)
ds_read_b64_tr_b16 v[176:177],v215 offset:28672
v_mfma_f32_16x16x32_bf16 v[0:3],v[160:163],a[64:67],v[0:3]
ds_read_b64_tr_b16 v[178:179],v215 offset:32768
v_cvt_pk_bf16_f32 v192,v120,v121
v_mfma_f32_16x16x32_bf16 v[4:7],v[160:163],a[68:71],v[4:7]
buffer_load_dwordx4 v214,s[8:11],s55 offen lds
ds_read_b64_tr_b16 v[180:181],v216 offset:28672
v_mfma_f32_16x16x32_bf16 v[8:11],v[160:163],a[72:75],v[8:11]
ds_read_b64_tr_b16 v[182:183],v216 offset:32768
v_cvt_pk_bf16_f32 v193,v122,v123
v_mfma_f32_16x16x32_bf16 v[12:15],v[160:163],a[76:79],v[12:15]
ds_read_b64_tr_b16 v[184:185],v215 offset:29696
v_cvt_pk_bf16_f32 v194,v124,v125
v_mfma_f32_16x16x32_bf16 v[16:19],v[164:167],a[64:67],v[16:19]
ds_read_b64_tr_b16 v[186:187],v215 offset:33792
v_subrev_u32 v215,81920,v215
v_mfma_f32_16x16x32_bf16 v[20:23],v[164:167],a[68:71],v[20:23]
buffer_load_dwordx4 v214,s[12:15],s55 offen offset:1024 lds
s_add_u32 m0,s84,102400
v_mfma_f32_16x16x32_bf16 v[24:27],v[164:167],a[72:75],v[24:27]
ds_read_b64_tr_b16 v[188:189],v216 offset:29696
v_cvt_pk_bf16_f32 v195,v126,v127
v_mfma_f32_16x16x32_bf16 v[28:31],v[164:167],a[76:79],v[28:31]
ds_read_b64_tr_b16 v[190:191],v216 offset:33792
v_subrev_u32 v216,81920,v216
v_mfma_f32_16x16x32_bf16 v[32:35],v[168:171],a[64:67],v[32:35]
ds_write_b128 v244,v[192:195] offset:12288
v_accvgpr_write_b32 a116,v192
v_mfma_f32_16x16x32_bf16 v[36:39],v[168:171],a[68:71],v[36:39]
v_accvgpr_write_b32 a117,v193
v_accvgpr_write_b32 a118,v194
v_mfma_f32_16x16x32_bf16 v[40:43],v[168:171],a[72:75],v[40:43]
buffer_load_dwordx4 v213,s[8:11],s56 offen lds
v_accvgpr_write_b32 a119,v195
v_mfma_f32_16x16x32_bf16 v[44:47],v[168:171],a[76:79],v[44:47]
s_lshl_b32 s100,s84,1
s_lshl_b32 s78,s78,3
v_mfma_f32_16x16x32_bf16 v[48:51],v[172:175],a[64:67],v[48:51]
s_add_u32 s79,s98,1
s_and_b32 s79,s79,3
v_mfma_f32_16x16x32_bf16 v[52:55],v[172:175],a[68:71],v[52:55]
s_lshl_b32 s79,s79,3
s_add_u32 s80,s98,2
v_mfma_f32_16x16x32_bf16 v[56:59],v[172:175],a[72:75],v[56:59]
buffer_load_dwordx4 v213,s[12:15],s56 offen offset:1024 lds
s_add_u32 m0,s84,110592
v_mfma_f32_16x16x32_bf16 v[60:63],v[172:175],a[76:79],v[60:63]
s_and_b32 s80,s80,3
s_lshl_b32 s80,s80,3
v_mfma_f32_16x16x32_bf16 v[246:249],v[196:199],v[80:83],v[230:233]
s_add_u32 s81,s98,3
s_and_b32 s81,s81,3
v_mfma_f32_16x16x32_bf16 v[250:253],v[200:203],v[80:83],v[230:233]
s_lshl_b32 s81,s81,3
s_add_u32 s82,s98,0
v_mfma_f32_16x16x32_bf16 v[234:237],v[192:195],v[192:195],v[234:237]
buffer_load_dwordx4 v214,s[8:11],s56 offen lds
s_waitcnt lgkmcnt(1)
v_mfma_f32_16x16x32_bf16 v[0:3],v[176:179],a[80:83],v[0:3]
s_waitcnt vmcnt(19) lgkmcnt(0)
s_barrier
v_mfma_f32_16x16x32_bf16 v[4:7],v[176:179],a[84:87],v[4:7]
ds_read_b128 a[108:111],v245 offset:8192
v_cvt_pk_bf16_f32 v204,v246,v247
v_mfma_f32_16x16x32_bf16 v[8:11],v[176:179],a[88:91],v[8:11]
ds_read_b128 a[124:127],v245 offset:12288
v_cvt_pk_bf16_f32 v205,v248,v249
v_mfma_f32_16x16x32_bf16 v[12:15],v[176:179],a[92:95],v[12:15]
ds_read_b64_tr_b16 v[160:161],v215 offset:0
v_cvt_pk_bf16_f32 v206,v250,v251
v_mfma_f32_16x16x32_bf16 v[16:19],v[180:183],a[80:83],v[16:19]
buffer_load_dwordx4 v214,s[12:15],s56 offen offset:1024 lds
s_add_u32 m0,s100,122880
v_mfma_f32_16x16x32_bf16 v[20:23],v[180:183],a[84:87],v[20:23]
ds_read_b64_tr_b16 v[162:163],v215 offset:4096
v_cvt_pk_bf16_f32 v207,v252,v253
v_mfma_f32_16x16x32_bf16 v[24:27],v[180:183],a[88:91],v[24:27]
ds_read_b64_tr_b16 v[164:165],v216 offset:0
v_accvgpr_write_b32 a132,v204
v_mfma_f32_16x16x32_bf16 v[28:31],v[180:183],a[92:95],v[28:31]
ds_read_b64_tr_b16 v[166:167],v216 offset:4096
v_accvgpr_write_b32 a133,v205
v_mfma_f32_16x16x32_bf16 v[32:35],v[184:187],a[80:83],v[32:35]
buffer_load_dwordx4 v219,s[16:19],s57 offen lds
ds_read_b64_tr_b16 v[168:169],v215 offset:1024
v_mfma_f32_16x16x32_bf16 v[36:39],v[184:187],a[84:87],v[36:39]
ds_read_b64_tr_b16 v[170:171],v215 offset:5120
v_accvgpr_write_b32 a134,v206
v_mfma_f32_16x16x32_bf16 v[40:43],v[184:187],a[88:91],v[40:43]
ds_read_b64_tr_b16 v[172:173],v216 offset:1024
v_accvgpr_write_b32 a135,v207
v_mfma_f32_16x16x32_bf16 v[44:47],v[184:187],a[92:95],v[44:47]
ds_read_b64_tr_b16 v[174:175],v216 offset:5120
s_and_b32 s82,s82,1
v_mfma_f32_16x16x32_bf16 v[48:51],v[188:191],a[80:83],v[48:51]
ds_write_b128 v244,v[204:207] offset:0
s_lshl_b32 s82,s82,3
v_mfma_f32_16x16x32_bf16 v[52:55],v[188:191],a[84:87],v[52:55]
s_add_u32 s83,s98,1
s_and_b32 s83,s83,1
v_mfma_f32_16x16x32_bf16 v[56:59],v[188:191],a[88:91],v[56:59]
s_lshl_b32 s83,s83,3
v_bfe_u32 v240,v226,2,2
v_mfma_f32_16x16x32_bf16 v[60:63],v[188:191],a[92:95],v[60:63]
s_mul_i32 s85,s3,16384
s_add_u32 s85,s85,16384
v_mfma_f32_16x16x32_bf16 v[120:123],v[196:199],v[84:87],v[230:233]
v_mfma_f32_16x16x32_bf16 v[124:127],v[200:203],v[84:87],v[230:233]
v_mfma_f32_16x16x32_bf16 v[234:237],v[204:207],v[204:207],v[234:237]
buffer_load_dwordx4 v220,s[16:19],s57 offen offset:1024 lds
s_waitcnt lgkmcnt(1)
v_mfma_f32_16x16x32_bf16 v[0:3],v[160:163],a[96:99],v[0:3]
ds_read_b64_tr_b16 v[176:177],v215 offset:8192
s_nop 1
v_cvt_pk_bf16_f32 v208,v120,v121
v_mfma_f32_16x16x32_bf16 v[4:7],v[160:163],a[100:103],v[4:7]
ds_read_b64_tr_b16 v[178:179],v215 offset:12288
v_cvt_pk_bf16_f32 v209,v122,v123
v_mfma_f32_16x16x32_bf16 v[8:11],v[160:163],a[104:107],v[8:11]
ds_read_b64_tr_b16 v[180:181],v216 offset:8192
v_cvt_pk_bf16_f32 v210,v124,v125
v_mfma_f32_16x16x32_bf16 v[12:15],v[160:163],a[108:111],v[12:15]
ds_read_b64_tr_b16 v[182:183],v216 offset:12288
v_cvt_pk_bf16_f32 v211,v126,v127
v_mfma_f32_16x16x32_bf16 v[16:19],v[164:167],a[96:99],v[16:19]
ds_read_b64_tr_b16 v[184:185],v215 offset:9216
v_accvgpr_write_b32 a148,v208
v_mfma_f32_16x16x32_bf16 v[20:23],v[164:167],a[100:103],v[20:23]
ds_read_b64_tr_b16 v[186:187],v215 offset:13312
v_accvgpr_write_b32 a149,v209
v_mfma_f32_16x16x32_bf16 v[24:27],v[164:167],a[104:107],v[24:27]
ds_read_b64_tr_b16 v[188:189],v216 offset:9216
v_accvgpr_write_b32 a150,v210
v_mfma_f32_16x16x32_bf16 v[28:31],v[164:167],a[108:111],v[28:31]
ds_read_b64_tr_b16 v[190:191],v216 offset:13312
v_accvgpr_write_b32 a151,v211
v_mfma_f32_16x16x32_bf16 v[32:35],v[168:171],a[96:99],v[32:35]
ds_write_b128 v244,v[208:211] offset:4096
v_mfma_f32_16x16x32_bf16 v[36:39],v[168:171],a[100:103],v[36:39]
buffer_load_dwordx4 v221,s[16:19],s57 offen offset:2048 lds
v_mfma_f32_16x16x32_bf16 v[40:43],v[168:171],a[104:107],v[40:43]
v_mfma_f32_16x16x32_bf16 v[44:47],v[168:171],a[108:111],v[44:47]
s_lshl_b32 s100,s84,1
v_mfma_f32_16x16x32_bf16 v[48:51],v[172:175],a[96:99],v[48:51]
v_mfma_f32_16x16x32_bf16 v[52:55],v[172:175],a[100:103],v[52:55]
v_mfma_f32_16x16x32_bf16 v[56:59],v[172:175],a[104:107],v[56:59]
v_mfma_f32_16x16x32_bf16 v[60:63],v[172:175],a[108:111],v[60:63]
v_mfma_f32_16x16x32_bf16 v[246:249],v[196:199],v[88:91],v[230:233]
v_mfma_f32_16x16x32_bf16 v[250:253],v[200:203],v[88:91],v[230:233]
v_mfma_f32_16x16x32_bf16 v[234:237],v[208:211],v[208:211],v[234:237]
s_waitcnt lgkmcnt(1)
v_mfma_f32_16x16x32_bf16 v[0:3],v[176:179],a[112:115],v[0:3]
buffer_load_dwordx4 v222,s[16:19],s57 offen offset:3072 lds
s_add_u32 m0,s100,20480
s_waitcnt vmcnt(20) lgkmcnt(0)
v_mfma_f32_16x16x32_bf16 v[4:7],v[176:179],a[116:119],v[4:7]
s_barrier
ds_read_b128 a[140:143],v245 offset:0
v_mfma_f32_16x16x32_bf16 v[8:11],v[176:179],a[120:123],v[8:11]
ds_read_b128 a[156:159],v245 offset:4096
v_cvt_pk_bf16_f32 v192,v246,v247
v_mfma_f32_16x16x32_bf16 v[12:15],v[176:179],a[124:127],v[12:15]
ds_read_b64_tr_b16 v[160:161],v215 offset:20480
v_cvt_pk_bf16_f32 v193,v248,v249
v_mfma_f32_16x16x32_bf16 v[16:19],v[180:183],a[112:115],v[16:19]
ds_read_b64_tr_b16 v[162:163],v215 offset:24576
v_cvt_pk_bf16_f32 v194,v250,v251
v_mfma_f32_16x16x32_bf16 v[20:23],v[180:183],a[116:119],v[20:23]
ds_read_b64_tr_b16 v[164:165],v216 offset:20480
v_cvt_pk_bf16_f32 v195,v252,v253
v_mfma_f32_16x16x32_bf16 v[24:27],v[180:183],a[120:123],v[24:27]
ds_read_b64_tr_b16 v[166:167],v216 offset:24576
v_accvgpr_write_b32 a164,v192
v_mfma_f32_16x16x32_bf16 v[28:31],v[180:183],a[124:127],v[28:31]
ds_read_b64_tr_b16 v[168:169],v215 offset:21504
v_accvgpr_write_b32 a165,v193
v_mfma_f32_16x16x32_bf16 v[32:35],v[184:187],a[112:115],v[32:35]
ds_read_b64_tr_b16 v[170:171],v215 offset:25600
v_accvgpr_write_b32 a166,v194
v_mfma_f32_16x16x32_bf16 v[36:39],v[184:187],a[116:119],v[36:39]
ds_read_b64_tr_b16 v[172:173],v216 offset:21504
v_accvgpr_write_b32 a167,v195
v_mfma_f32_16x16x32_bf16 v[40:43],v[184:187],a[120:123],v[40:43]
buffer_load_dwordx4 v219,s[16:19],s58 offen lds
ds_read_b64_tr_b16 v[174:175],v216 offset:25600
v_mfma_f32_16x16x32_bf16 v[44:47],v[184:187],a[124:127],v[44:47]
ds_write_b128 v244,v[192:195] offset:8192
s_add_u32 s57,s44,0
v_mfma_f32_16x16x32_bf16 v[48:51],v[188:191],a[112:115],v[48:51]
s_and_b32 s57,s57,7
s_mul_i32 s57,s57,82944
v_mfma_f32_16x16x32_bf16 v[52:55],v[188:191],a[116:119],v[52:55]
v_mfma_f32_16x16x32_bf16 v[56:59],v[188:191],a[120:123],v[56:59]
v_mfma_f32_16x16x32_bf16 v[60:63],v[188:191],a[124:127],v[60:63]
v_mfma_f32_16x16x32_bf16 v[120:123],v[196:199],v[92:95],v[230:233]
v_mfma_f32_16x16x32_bf16 v[124:127],v[200:203],v[92:95],v[230:233]
v_mfma_f32_16x16x32_bf16 v[234:237],v[192:195],v[192:195],v[234:237]
s_waitcnt lgkmcnt(1)
ds_read_b64_tr_b16 v[176:177],v215 offset:28672
v_mfma_f32_16x16x32_bf16 v[0:3],v[160:163],a[128:131],v[0:3]
ds_read_b64_tr_b16 v[178:179],v215 offset:32768
s_nop 1
v_cvt_pk_bf16_f32 v204,v120,v121
v_mfma_f32_16x16x32_bf16 v[4:7],v[160:163],a[132:135],v[4:7]
buffer_load_dwordx4 v220,s[16:19],s58 offen offset:1024 lds
ds_read_b64_tr_b16 v[180:181],v216 offset:28672
v_mfma_f32_16x16x32_bf16 v[8:11],v[160:163],a[136:139],v[8:11]
ds_read_b64_tr_b16 v[182:183],v216 offset:32768
v_cvt_pk_bf16_f32 v205,v122,v123
v_mfma_f32_16x16x32_bf16 v[12:15],v[160:163],a[140:143],v[12:15]
ds_read_b64_tr_b16 v[184:185],v215 offset:29696
v_cvt_pk_bf16_f32 v206,v124,v125
v_mfma_f32_16x16x32_bf16 v[16:19],v[164:167],a[128:131],v[16:19]
ds_read_b64_tr_b16 v[186:187],v215 offset:33792
v_cvt_pk_bf16_f32 v207,v126,v127
v_mfma_f32_16x16x32_bf16 v[20:23],v[164:167],a[132:135],v[20:23]
ds_read_b64_tr_b16 v[188:189],v216 offset:29696
v_accvgpr_write_b32 a180,v204
v_mfma_f32_16x16x32_bf16 v[24:27],v[164:167],a[136:139],v[24:27]
ds_read_b64_tr_b16 v[190:191],v216 offset:33792
v_accvgpr_write_b32 a181,v205
v_mfma_f32_16x16x32_bf16 v[28:31],v[164:167],a[140:143],v[28:31]
ds_write_b128 v244,v[204:207] offset:12288
v_accvgpr_write_b32 a182,v206
v_mfma_f32_16x16x32_bf16 v[32:35],v[168:171],a[128:131],v[32:35]
v_accvgpr_write_b32 a183,v207
v_mfma_f32_16x16x32_bf16 v[36:39],v[168:171],a[132:135],v[36:39]
v_mfma_f32_16x16x32_bf16 v[40:43],v[168:171],a[136:139],v[40:43]
v_mfma_f32_16x16x32_bf16 v[44:47],v[168:171],a[140:143],v[44:47]
buffer_load_dwordx4 v221,s[16:19],s58 offen offset:2048 lds
s_lshl_b32 s100,s84,1
v_mfma_f32_16x16x32_bf16 v[48:51],v[172:175],a[128:131],v[48:51]
v_mfma_f32_16x16x32_bf16 v[52:55],v[172:175],a[132:135],v[52:55]
v_mfma_f32_16x16x32_bf16 v[56:59],v[172:175],a[136:139],v[56:59]
v_mfma_f32_16x16x32_bf16 v[60:63],v[172:175],a[140:143],v[60:63]
v_mfma_f32_16x16x32_bf16 v[246:249],v[196:199],v[96:99],v[230:233]
v_mfma_f32_16x16x32_bf16 v[250:253],v[200:203],v[96:99],v[230:233]
v_mfma_f32_16x16x32_bf16 v[234:237],v[204:207],v[204:207],v[234:237]
s_waitcnt lgkmcnt(1)
v_mfma_f32_16x16x32_bf16 v[0:3],v[176:179],a[144:147],v[0:3]
s_waitcnt vmcnt(19) lgkmcnt(0)
s_barrier
v_mfma_f32_16x16x32_bf16 v[4:7],v[176:179],a[148:151],v[4:7]
ds_read_b128 a[172:175],v245 offset:8192
v_cvt_pk_bf16_f32 v208,v246,v247
v_mfma_f32_16x16x32_bf16 v[8:11],v[176:179],a[152:155],v[8:11]
buffer_load_dwordx4 v222,s[16:19],s58 offen offset:3072 lds
s_add_u32 m0,s100,40960
v_mfma_f32_16x16x32_bf16 v[12:15],v[176:179],a[156:159],v[12:15]
ds_read_b128 a[188:191],v245 offset:12288
v_cvt_pk_bf16_f32 v209,v248,v249
v_mfma_f32_16x16x32_bf16 v[16:19],v[180:183],a[144:147],v[16:19]
ds_read_b64_tr_b16 v[160:161],v215 offset:40960
v_cvt_pk_bf16_f32 v210,v250,v251
v_mfma_f32_16x16x32_bf16 v[20:23],v[180:183],a[148:151],v[20:23]
ds_read_b64_tr_b16 v[162:163],v215 offset:45056
v_cvt_pk_bf16_f32 v211,v252,v253
v_mfma_f32_16x16x32_bf16 v[24:27],v[180:183],a[152:155],v[24:27]
ds_read_b64_tr_b16 v[164:165],v216 offset:40960
v_accvgpr_write_b32 a196,v208
v_mfma_f32_16x16x32_bf16 v[28:31],v[180:183],a[156:159],v[28:31]
ds_read_b64_tr_b16 v[166:167],v216 offset:45056
v_accvgpr_write_b32 a197,v209
v_mfma_f32_16x16x32_bf16 v[32:35],v[184:187],a[144:147],v[32:35]
ds_read_b64_tr_b16 v[168:169],v215 offset:41984
v_accvgpr_write_b32 a198,v210
v_mfma_f32_16x16x32_bf16 v[36:39],v[184:187],a[148:151],v[36:39]
ds_read_b64_tr_b16 v[170:171],v215 offset:46080
v_accvgpr_write_b32 a199,v211
v_mfma_f32_16x16x32_bf16 v[40:43],v[184:187],a[152:155],v[40:43]
ds_read_b64_tr_b16 v[172:173],v216 offset:41984
v_mfma_f32_16x16x32_bf16 v[44:47],v[184:187],a[156:159],v[44:47]
ds_read_b64_tr_b16 v[174:175],v216 offset:46080
v_mfma_f32_16x16x32_bf16 v[48:51],v[188:191],a[144:147],v[48:51]
buffer_load_dwordx4 v219,s[16:19],s59 offen lds
ds_write_b128 v244,v[208:211] offset:0
v_mfma_f32_16x16x32_bf16 v[52:55],v[188:191],a[148:151],v[52:55]
v_mfma_f32_16x16x32_bf16 v[56:59],v[188:191],a[152:155],v[56:59]
v_mfma_f32_16x16x32_bf16 v[60:63],v[188:191],a[156:159],v[60:63]
v_mfma_f32_16x16x32_bf16 v[120:123],v[196:199],v[100:103],v[230:233]
v_mfma_f32_16x16x32_bf16 v[124:127],v[200:203],v[100:103],v[230:233]
v_mfma_f32_16x16x32_bf16 v[234:237],v[208:211],v[208:211],v[234:237]
s_waitcnt lgkmcnt(1)
ds_read_b64_tr_b16 v[176:177],v215 offset:49152
v_mfma_f32_16x16x32_bf16 v[0:3],v[160:163],a[160:163],v[0:3]
ds_read_b64_tr_b16 v[178:179],v215 offset:53248
s_nop 1
v_cvt_pk_bf16_f32 v192,v120,v121
v_mfma_f32_16x16x32_bf16 v[4:7],v[160:163],a[164:167],v[4:7]
ds_read_b64_tr_b16 v[180:181],v216 offset:49152
v_cvt_pk_bf16_f32 v193,v122,v123
v_mfma_f32_16x16x32_bf16 v[8:11],v[160:163],a[168:171],v[8:11]
ds_read_b64_tr_b16 v[182:183],v216 offset:53248
v_cvt_pk_bf16_f32 v194,v124,v125
v_mfma_f32_16x16x32_bf16 v[12:15],v[160:163],a[172:175],v[12:15]
buffer_load_dwordx4 v220,s[16:19],s59 offen offset:1024 lds
ds_read_b64_tr_b16 v[184:185],v215 offset:50176
v_mfma_f32_16x16x32_bf16 v[16:19],v[164:167],a[160:163],v[16:19]
ds_read_b64_tr_b16 v[186:187],v215 offset:54272
v_add_u32 v215,61440,v215
v_mfma_f32_16x16x32_bf16 v[20:23],v[164:167],a[164:167],v[20:23]
ds_read_b64_tr_b16 v[188:189],v216 offset:50176
v_cvt_pk_bf16_f32 v195,v126,v127
v_mfma_f32_16x16x32_bf16 v[24:27],v[164:167],a[168:171],v[24:27]
ds_read_b64_tr_b16 v[190:191],v216 offset:54272
v_add_u32 v216,61440,v216
v_mfma_f32_16x16x32_bf16 v[28:31],v[164:167],a[172:175],v[28:31]
ds_write_b128 v244,v[192:195] offset:4096
v_accvgpr_write_b32 a212,v192
v_mfma_f32_16x16x32_bf16 v[32:35],v[168:171],a[160:163],v[32:35]
v_accvgpr_write_b32 a213,v193
v_accvgpr_write_b32 a214,v194
v_mfma_f32_16x16x32_bf16 v[36:39],v[168:171],a[164:167],v[36:39]
v_accvgpr_write_b32 a215,v195
v_mfma_f32_16x16x32_bf16 v[40:43],v[168:171],a[168:171],v[40:43]
v_mfma_f32_16x16x32_bf16 v[44:47],v[168:171],a[172:175],v[44:47]
s_lshl_b32 s100,s84,1
v_mfma_f32_16x16x32_bf16 v[48:51],v[172:175],a[160:163],v[48:51]
v_mfma_f32_16x16x32_bf16 v[52:55],v[172:175],a[164:167],v[52:55]
buffer_load_dwordx4 v221,s[16:19],s59 offen offset:2048 lds
v_mfma_f32_16x16x32_bf16 v[56:59],v[172:175],a[168:171],v[56:59]
v_mfma_f32_16x16x32_bf16 v[60:63],v[172:175],a[172:175],v[60:63]
v_mfma_f32_16x16x32_bf16 v[246:249],v[196:199],v[104:107],v[230:233]
v_mfma_f32_16x16x32_bf16 v[250:253],v[200:203],v[104:107],v[230:233]
v_mfma_f32_16x16x32_bf16 v[234:237],v[192:195],v[192:195],v[234:237]
s_waitcnt lgkmcnt(1)
v_mfma_f32_16x16x32_bf16 v[0:3],v[176:179],a[176:179],v[0:3]
s_waitcnt vmcnt(19) lgkmcnt(0)
s_barrier
v_mfma_f32_16x16x32_bf16 v[4:7],v[176:179],a[180:183],v[4:7]
ds_read_b128 a[204:207],v245 offset:0
v_cvt_pk_bf16_f32 v204,v246,v247
v_mfma_f32_16x16x32_bf16 v[8:11],v[176:179],a[184:187],v[8:11]
ds_read_b128 a[220:223],v245 offset:4096
v_cvt_pk_bf16_f32 v205,v248,v249
v_mfma_f32_16x16x32_bf16 v[12:15],v[176:179],a[188:191],v[12:15]
ds_read_b64_tr_b16 v[160:161],v215 offset:0
v_cvt_pk_bf16_f32 v206,v250,v251
v_mfma_f32_16x16x32_bf16 v[16:19],v[180:183],a[176:179],v[16:19]
buffer_load_dwordx4 v222,s[16:19],s59 offen offset:3072 lds
s_add_u32 m0,s100,61440
v_mfma_f32_16x16x32_bf16 v[20:23],v[180:183],a[180:183],v[20:23]
ds_read_b64_tr_b16 v[162:163],v215 offset:4096
v_cvt_pk_bf16_f32 v207,v252,v253
v_mfma_f32_16x16x32_bf16 v[24:27],v[180:183],a[184:187],v[24:27]
ds_read_b64_tr_b16 v[164:165],v216 offset:0
v_accvgpr_write_b32 a228,v204
v_mfma_f32_16x16x32_bf16 v[28:31],v[180:183],a[188:191],v[28:31]
ds_read_b64_tr_b16 v[166:167],v216 offset:4096
v_accvgpr_write_b32 a229,v205
v_mfma_f32_16x16x32_bf16 v[32:35],v[184:187],a[176:179],v[32:35]
ds_read_b64_tr_b16 v[168:169],v215 offset:1024
v_accvgpr_write_b32 a230,v206
v_mfma_f32_16x16x32_bf16 v[36:39],v[184:187],a[180:183],v[36:39]
ds_read_b64_tr_b16 v[170:171],v215 offset:5120
v_accvgpr_write_b32 a231,v207
v_mfma_f32_16x16x32_bf16 v[40:43],v[184:187],a[184:187],v[40:43]
ds_read_b64_tr_b16 v[172:173],v216 offset:1024
s_add_u32 s59,s44,2
v_mfma_f32_16x16x32_bf16 v[44:47],v[184:187],a[188:191],v[44:47]
ds_read_b64_tr_b16 v[174:175],v216 offset:5120
s_and_b32 s59,s59,7
v_mfma_f32_16x16x32_bf16 v[48:51],v[188:191],a[176:179],v[48:51]
ds_write_b128 v244,v[204:207] offset:8192
s_mul_i32 s59,s59,82944
v_mfma_f32_16x16x32_bf16 v[52:55],v[188:191],a[180:183],v[52:55]
v_mfma_f32_16x16x32_bf16 v[56:59],v[188:191],a[184:187],v[56:59]
buffer_load_dwordx4 v219,s[16:19],s60 offen lds
v_mfma_f32_16x16x32_bf16 v[60:63],v[188:191],a[188:191],v[60:63]
v_mfma_f32_16x16x32_bf16 v[120:123],v[196:199],v[108:111],v[230:233]
v_mfma_f32_16x16x32_bf16 v[124:127],v[200:203],v[108:111],v[230:233]
v_mfma_f32_16x16x32_bf16 v[234:237],v[204:207],v[204:207],v[234:237]
s_waitcnt lgkmcnt(1)
ds_read_b64_tr_b16 v[176:177],v215 offset:8192
v_mfma_f32_16x16x32_bf16 v[0:3],v[160:163],a[192:195],v[0:3]
ds_read_b64_tr_b16 v[178:179],v215 offset:12288
s_nop 1
v_cvt_pk_bf16_f32 v208,v120,v121
v_mfma_f32_16x16x32_bf16 v[4:7],v[160:163],a[196:199],v[4:7]
ds_read_b64_tr_b16 v[180:181],v216 offset:8192
v_cvt_pk_bf16_f32 v209,v122,v123
v_mfma_f32_16x16x32_bf16 v[8:11],v[160:163],a[200:203],v[8:11]
ds_read_b64_tr_b16 v[182:183],v216 offset:12288
v_cvt_pk_bf16_f32 v210,v124,v125
v_mfma_f32_16x16x32_bf16 v[12:15],v[160:163],a[204:207],v[12:15]
ds_read_b64_tr_b16 v[184:185],v215 offset:9216
v_cvt_pk_bf16_f32 v211,v126,v127
v_mfma_f32_16x16x32_bf16 v[16:19],v[164:167],a[192:195],v[16:19]
ds_read_b64_tr_b16 v[186:187],v215 offset:13312
v_subrev_u32 v215,81920,v215
v_mfma_f32_16x16x32_bf16 v[20:23],v[164:167],a[196:199],v[20:23]
buffer_load_dwordx4 v220,s[16:19],s60 offen offset:1024 lds
ds_read_b64_tr_b16 v[188:189],v216 offset:9216
v_mfma_f32_16x16x32_bf16 v[24:27],v[164:167],a[200:203],v[24:27]
ds_read_b64_tr_b16 v[190:191],v216 offset:13312
v_subrev_u32 v216,81920,v216
v_mfma_f32_16x16x32_bf16 v[28:31],v[164:167],a[204:207],v[28:31]
ds_write_b128 v244,v[208:211] offset:12288
v_accvgpr_write_b32 a244,v208
v_mfma_f32_16x16x32_bf16 v[32:35],v[168:171],a[192:195],v[32:35]
v_accvgpr_write_b32 a245,v209
v_accvgpr_write_b32 a246,v210
v_mfma_f32_16x16x32_bf16 v[36:39],v[168:171],a[196:199],v[36:39]
v_accvgpr_write_b32 a247,v211
v_mfma_f32_16x16x32_bf16 v[40:43],v[168:171],a[200:203],v[40:43]
v_mfma_f32_16x16x32_bf16 v[44:47],v[168:171],a[204:207],v[44:47]
s_lshl_b32 s100,s84,1
v_mfma_f32_16x16x32_bf16 v[48:51],v[172:175],a[192:195],v[48:51]
v_mfma_f32_16x16x32_bf16 v[52:55],v[172:175],a[196:199],v[52:55]
v_mfma_f32_16x16x32_bf16 v[56:59],v[172:175],a[200:203],v[56:59]
v_mfma_f32_16x16x32_bf16 v[60:63],v[172:175],a[204:207],v[60:63]
buffer_load_dwordx4 v221,s[16:19],s60 offen offset:2048 lds
v_mfma_f32_16x16x32_bf16 v[246:249],v[196:199],v[112:115],v[230:233]
v_mfma_f32_16x16x32_bf16 v[250:253],v[200:203],v[112:115],v[230:233]
v_mfma_f32_16x16x32_bf16 v[234:237],v[208:211],v[208:211],v[234:237]
s_waitcnt lgkmcnt(1)
v_mfma_f32_16x16x32_bf16 v[0:3],v[176:179],a[208:211],v[0:3]
s_waitcnt vmcnt(19) lgkmcnt(0)
s_barrier
v_mfma_f32_16x16x32_bf16 v[4:7],v[176:179],a[212:215],v[4:7]
ds_read_b128 a[236:239],v245 offset:8192
v_cvt_pk_bf16_f32 v192,v246,v247
v_mfma_f32_16x16x32_bf16 v[8:11],v[176:179],a[216:219],v[8:11]
ds_read_b128 a[252:255],v245 offset:12288
v_cvt_pk_bf16_f32 v193,v248,v249
v_mfma_f32_16x16x32_bf16 v[12:15],v[176:179],a[220:223],v[12:15]
ds_read_b64_tr_b16 v[160:161],v215 offset:0
v_cvt_pk_bf16_f32 v194,v250,v251
v_mfma_f32_16x16x32_bf16 v[16:19],v[180:183],a[208:211],v[16:19]
ds_read_b64_tr_b16 v[162:163],v215 offset:4096
v_cvt_pk_bf16_f32 v195,v252,v253
v_mfma_f32_16x16x32_bf16 v[20:23],v[180:183],a[212:215],v[20:23]
ds_read_b64_tr_b16 v[164:165],v216 offset:0
v_mov_b32 v132,v192
v_mfma_f32_16x16x32_bf16 v[24:27],v[180:183],a[216:219],v[24:27]
buffer_load_dwordx4 v222,s[16:19],s60 offen offset:3072 lds
s_add_u32 m0,s100,81920
v_mfma_f32_16x16x32_bf16 v[28:31],v[180:183],a[220:223],v[28:31]
ds_read_b64_tr_b16 v[166:167],v216 offset:4096
v_mov_b32 v133,v193
v_mfma_f32_16x16x32_bf16 v[32:35],v[184:187],a[208:211],v[32:35]
ds_read_b64_tr_b16 v[168:169],v215 offset:1024
v_mov_b32 v134,v194
v_mfma_f32_16x16x32_bf16 v[36:39],v[184:187],a[212:215],v[36:39]
ds_read_b64_tr_b16 v[170:171],v215 offset:5120
v_mov_b32 v135,v195
v_mfma_f32_16x16x32_bf16 v[40:43],v[184:187],a[216:219],v[40:43]
ds_read_b64_tr_b16 v[172:173],v216 offset:1024
v_mov_b32 v246,v238
v_mfma_f32_16x16x32_bf16 v[44:47],v[184:187],a[220:223],v[44:47]
ds_read_b64_tr_b16 v[174:175],v216 offset:5120
v_permlane32_swap_b32 v246,v238
v_mfma_f32_16x16x32_bf16 v[48:51],v[188:191],a[208:211],v[48:51]
ds_write_b128 v244,v[192:195] offset:0
v_add_f32 v238,v246,v238
v_mfma_f32_16x16x32_bf16 v[52:55],v[188:191],a[212:215],v[52:55]
v_mov_b32 v246,v238
v_mov_b32 v248,0x3727c5ac
v_mfma_f32_16x16x32_bf16 v[56:59],v[188:191],a[216:219],v[56:59]
v_permlane16_swap_b32 v246,v238
v_add_f32 v238,v246,v238
v_mfma_f32_16x16x32_bf16 v[60:63],v[188:191],a[220:223],v[60:63]
v_fma_f32 v238,v238,s89,v248
v_and_b32 v247,15,v226
v_mfma_f32_16x16x32_bf16 v[120:123],v[196:199],v[116:119],v[230:233]
buffer_load_dwordx4 v219,s[16:19],s61 offen lds
v_lshl_add_u32 v247,v247,2,s88
v_mfma_f32_16x16x32_bf16 v[124:127],v[200:203],v[116:119],v[230:233]
s_or_b32 s88,s41,s45
s_min_u32 s88,s88,1
v_mfma_f32_16x16x32_bf16 v[234:237],v[192:195],v[192:195],v[234:237]
s_lshl_b32 s88,s88,31
s_waitcnt lgkmcnt(1)
v_mfma_f32_16x16x32_bf16 v[0:3],v[160:163],a[224:227],v[0:3]
ds_read_b64_tr_b16 v[176:177],v215 offset:8192
v_cvt_pk_bf16_f32 v204,v120,v121
v_mfma_f32_16x16x32_bf16 v[4:7],v[160:163],a[228:231],v[4:7]
ds_read_b64_tr_b16 v[178:179],v215 offset:12288
v_cvt_pk_bf16_f32 v205,v122,v123
v_mfma_f32_16x16x32_bf16 v[8:11],v[160:163],a[232:235],v[8:11]
ds_read_b64_tr_b16 v[180:181],v216 offset:8192
v_cvt_pk_bf16_f32 v206,v124,v125
v_mfma_f32_16x16x32_bf16 v[12:15],v[160:163],a[236:239],v[12:15]
ds_read_b64_tr_b16 v[182:183],v216 offset:12288
v_cvt_pk_bf16_f32 v207,v126,v127
v_mfma_f32_16x16x32_bf16 v[16:19],v[164:167],a[224:227],v[16:19]
ds_read_b64_tr_b16 v[184:185],v215 offset:9216
v_mov_b32 v148,v204
v_mfma_f32_16x16x32_bf16 v[20:23],v[164:167],a[228:231],v[20:23]
ds_read_b64_tr_b16 v[186:187],v215 offset:13312
v_add_u32 v215,102400,v215
v_mfma_f32_16x16x32_bf16 v[24:27],v[164:167],a[232:235],v[24:27]
ds_read_b64_tr_b16 v[188:189],v216 offset:9216
v_mov_b32 v149,v205
v_mfma_f32_16x16x32_bf16 v[28:31],v[164:167],a[236:239],v[28:31]
buffer_load_dwordx4 v220,s[16:19],s61 offen offset:1024 lds
ds_read_b64_tr_b16 v[190:191],v216 offset:13312
v_mfma_f32_16x16x32_bf16 v[32:35],v[168:171],a[224:227],v[32:35]
s_lshl_b32 s100,s84,1
v_add_u32 v216,102400,v216
ds_write_b128 v244,v[204:207] offset:4096
v_mfma_f32_16x16x32_bf16 v[36:39],v[168:171],a[228:231],v[36:39]
v_rsq_f32 v238,v238
v_mfma_f32_16x16x32_bf16 v[40:43],v[168:171],a[232:235],v[40:43]
v_mov_b32 v150,v206
v_mov_b32 v151,v207
v_mfma_f32_16x16x32_bf16 v[44:47],v[168:171],a[236:239],v[44:47]
v_or_b32 v252,s88,v212
v_or_b32 v227,s88,v224
v_mfma_f32_16x16x32_bf16 v[48:51],v[172:175],a[224:227],v[48:51]
s_lshl_b32 s88,s40,12
v_mov_b32 v249,0
v_mfma_f32_16x16x32_bf16 v[52:55],v[172:175],a[228:231],v[52:55]
v_mov_b32 v250,0
v_mov_b32 v251,0
v_mfma_f32_16x16x32_bf16 v[56:59],v[172:175],a[232:235],v[56:59]
v_min_u32 v253,1,v226
v_lshrrev_b32 v244,4,v226
v_mfma_f32_16x16x32_bf16 v[60:63],v[172:175],a[236:239],v[60:63]
v_mfma_f32_16x16x32_bf16 v[234:237],v[204:207],v[204:207],v[234:237]
s_waitcnt lgkmcnt(1)
s_waitcnt vmcnt(18) lgkmcnt(0)
v_mfma_f32_16x16x32_bf16 v[0:3],v[176:179],a[240:243],v[0:3]
buffer_load_dwordx4 v221,s[16:19],s61 offen offset:2048 lds
s_barrier
v_mfma_f32_16x16x32_bf16 v[4:7],v[176:179],a[244:247],v[4:7]
ds_read_b128 v[140:143],v245 offset:0
v_mfma_f32_16x16x32_bf16 v[8:11],v[176:179],a[248:251],v[8:11]
ds_read_b128 v[156:159],v245 offset:4096
v_cndmask_b32 v234,v234,v235,vcc
v_mfma_f32_16x16x32_bf16 v[12:15],v[176:179],a[252:255],v[12:15]
ds_read_b64_tr_b16 v[160:161],v215 offset:0
s_mov_b32 vcc_lo,0x44444444
v_mfma_f32_16x16x32_bf16 v[16:19],v[180:183],a[240:243],v[16:19]
ds_read_b64_tr_b16 v[162:163],v215 offset:4096
s_mov_b32 vcc_hi,0x44444444
v_mfma_f32_16x16x32_bf16 v[20:23],v[180:183],a[244:247],v[20:23]
ds_read_b64_tr_b16 v[164:165],v216 offset:0
v_cndmask_b32 v234,v234,v236,vcc
v_mfma_f32_16x16x32_bf16 v[24:27],v[180:183],a[248:251],v[24:27]
ds_read_b64_tr_b16 v[166:167],v216 offset:4096
s_mov_b32 vcc_lo,0x88888888
v_mfma_f32_16x16x32_bf16 v[28:31],v[180:183],a[252:255],v[28:31]
ds_read_b64_tr_b16 v[168:169],v215 offset:1024
s_mov_b32 vcc_hi,0x88888888
v_mfma_f32_16x16x32_bf16 v[32:35],v[184:187],a[240:243],v[32:35]
ds_read_b64_tr_b16 v[170:171],v215 offset:5120
v_cndmask_b32 v234,v234,v237,vcc
v_mfma_f32_16x16x32_bf16 v[36:39],v[184:187],a[244:247],v[36:39]
ds_read_b64_tr_b16 v[172:173],v216 offset:1024
s_mov_b32 vcc_lo,0x00f0000f
v_mfma_f32_16x16x32_bf16 v[40:43],v[184:187],a[248:251],v[40:43]
buffer_load_dwordx4 v222,s[16:19],s61 offen offset:3072 lds
s_add_u32 m0,s100,0
v_mfma_f32_16x16x32_bf16 v[44:47],v[184:187],a[252:255],v[44:47]
ds_read_b64_tr_b16 v[174:175],v216 offset:5120
s_mov_b32 vcc_hi,0xf0000f00
v_mfma_f32_16x16x32_bf16 v[48:51],v[188:191],a[240:243],v[48:51]
v_cndmask_b32 v234,0,v234,vcc
v_mov_b32 v246,v234
v_mfma_f32_16x16x32_bf16 v[52:55],v[188:191],a[244:247],v[52:55]
s_nop 0
v_permlane32_swap_b32 v246,v234
v_add_f32 v234,v246,v234
v_mfma_f32_16x16x32_bf16 v[56:59],v[188:191],a[248:251],v[56:59]
v_mov_b32 v246,v234
ds_write_b32 v247,v238 offset:0
v_mfma_f32_16x16x32_bf16 v[60:63],v[188:191],a[252:255],v[60:63]
s_waitcnt lgkmcnt(1)
ds_read_b64_tr_b16 v[176:177],v215 offset:8192
v_mfma_f32_16x16x32_bf16 v[0:3],v[160:163],v[128:131],v[0:3]
ds_read_b64_tr_b16 v[178:179],v215 offset:12288
v_permlane16_swap_b32 v246,v234
v_mfma_f32_16x16x32_bf16 v[4:7],v[160:163],v[132:135],v[4:7]
ds_read_b64_tr_b16 v[180:181],v216 offset:8192
v_add_f32 v234,v246,v234
v_mfma_f32_16x16x32_bf16 v[8:11],v[160:163],v[136:139],v[8:11]
ds_read_b64_tr_b16 v[182:183],v216 offset:12288
v_fma_f32 v234,v234,s89,v248
v_mfma_f32_16x16x32_bf16 v[12:15],v[160:163],v[140:143],v[12:15]
s_and_b32 s89,s43,1
ds_read_b64_tr_b16 v[184:185],v215 offset:9216
v_mfma_f32_16x16x32_bf16 v[16:19],v[164:167],v[128:131],v[16:19]
buffer_load_dwordx4 v219,s[16:19],s62 offen lds
ds_read_b64_tr_b16 v[186:187],v215 offset:13312
v_mfma_f32_16x16x32_bf16 v[20:23],v[164:167],v[132:135],v[20:23]
ds_read_b64_tr_b16 v[188:189],v216 offset:9216
v_mov_b32 v248,0
v_mfma_f32_16x16x32_bf16 v[24:27],v[164:167],v[136:139],v[24:27]
ds_read_b64_tr_b16 v[190:191],v216 offset:13312
v_subrev_u32 v215,61440,v215
v_mfma_f32_16x16x32_bf16 v[28:31],v[164:167],v[140:143],v[28:31]
v_rsq_f32 v234,v234
v_mfma_f32_16x16x32_bf16 v[32:35],v[168:171],v[128:131],v[32:35]
s_lshl_b32 s100,s84,1
ds_write_b32 v247,v234 offset:64
v_mfma_f32_16x16x32_bf16 v[36:39],v[168:171],v[132:135],v[36:39]
v_subrev_u32 v216,61440,v216
v_cmp_eq_u32 vcc,2,v240
v_mfma_f32_16x16x32_bf16 v[40:43],v[168:171],v[136:139],v[40:43]
v_bfe_u32 v247,v226,4,2
v_lshlrev_b32 v247,1,v247
v_mfma_f32_16x16x32_bf16 v[44:47],v[168:171],v[140:143],v[44:47]
v_mov_b32 v238,0x3f803f80
s_lshl_b32 s61,s101,1
v_mfma_f32_16x16x32_bf16 v[48:51],v[172:175],v[128:131],v[48:51]
s_add_u32 s61,s61,s47
s_lshl_b32 s61,s61,1
v_mfma_f32_16x16x32_bf16 v[52:55],v[172:175],v[132:135],v[52:55]
s_add_u32 s61,s61,s46
s_lshl_b32 s61,s61,13
v_mfma_f32_16x16x32_bf16 v[56:59],v[172:175],v[136:139],v[56:59]
buffer_store_dwordx4 v[248:251],v252,s[24:27],s88 offen sc1
v_mfma_f32_16x16x32_bf16 v[60:63],v[172:175],v[140:143],v[60:63]
buffer_store_dwordx4 v[248:251],v252,s[24:27],s88 offen offset:1024 sc1
s_waitcnt lgkmcnt(1)
v_mfma_f32_16x16x32_bf16 v[0:3],v[176:179],v[144:147],v[0:3]
buffer_store_dwordx4 v[248:251],v252,s[24:27],s88 offen offset:2048 sc1
s_waitcnt vmcnt(16) lgkmcnt(0)
v_mfma_f32_16x16x32_bf16 v[4:7],v[176:179],v[148:151],v[4:7]
buffer_load_dwordx4 v220,s[16:19],s62 offen offset:1024 lds
s_lshl_b32 s88,s45,7
v_mfma_f32_16x16x32_bf16 v[8:11],v[176:179],v[152:155],v[8:11]
s_add_u32 s88,s88,159744
s_barrier
v_mfma_f32_16x16x32_bf16 v[12:15],v[176:179],v[156:159],v[12:15]
ds_read_b64_tr_b16 v[160:161],v218 offset:0
v_and_b32 v248,15,v226
v_mfma_f32_16x16x32_bf16 v[16:19],v[180:183],v[144:147],v[16:19]
ds_read_b64_tr_b16 v[162:163],v218 offset:4096
v_lshl_add_u32 v248,v248,2,s88
v_mfma_f32_16x16x32_bf16 v[20:23],v[180:183],v[148:151],v[20:23]
s_lshl_b32 s88,s44,1
s_add_u32 s88,s88,s89
v_mfma_f32_16x16x32_bf16 v[24:27],v[180:183],v[152:155],v[24:27]
s_lshl_b32 s89,s45,4
s_add_u32 s88,s88,s89
v_mfma_f32_16x16x32_bf16 v[28:31],v[180:183],v[156:159],v[28:31]
ds_read_b64_tr_b16 v[164:165],v228 offset:0
v_lshl_add_u32 v253,v253,6,s88
v_mfma_f32_16x16x32_bf16 v[32:35],v[184:187],v[144:147],v[32:35]
ds_read_b64_tr_b16 v[166:167],v228 offset:4096
v_lshlrev_b32 v253,7,v253
v_mfma_f32_16x16x32_bf16 v[36:39],v[184:187],v[148:151],v[36:39]
ds_read_b64_tr_b16 v[168:169],v229 offset:0
v_add_u32 v253,2048,v253
v_mfma_f32_16x16x32_bf16 v[40:43],v[184:187],v[152:155],v[40:43]
ds_read_b64_tr_b16 v[170:171],v229 offset:4096
s_lshl_b32 s88,s45,7
v_mfma_f32_16x16x32_bf16 v[44:47],v[184:187],v[156:159],v[44:47]
buffer_load_dwordx4 v221,s[16:19],s62 offen offset:2048 lds
ds_read_b64_tr_b16 v[172:173],v223 offset:0
ds_read_b64_tr_b16 v[174:175],v223 offset:4096
v_mfma_f32_16x16x32_bf16 v[48:51],v[188:191],v[144:147],v[48:51]
s_add_u32 s88,s88,159744
s_lshl_b32 s89,s45,9
v_mfma_f32_16x16x32_bf16 v[52:55],v[188:191],v[148:151],v[52:55]
s_add_u32 s89,s89,160256
v_xor_b32 v249,128,v248
v_mfma_f32_16x16x32_bf16 v[56:59],v[188:191],v[152:155],v[56:59]
ds_read_b32 v208,v248 offset:0
v_and_b32 v250,3,v226
v_mfma_f32_16x16x32_bf16 v[60:63],v[188:191],v[156:159],v[60:63]
s_waitcnt lgkmcnt(1)
ds_read_b64_tr_b16 v[176:177],v218 offset:8192
v_mfma_f32_16x16x32_bf16 v[64:67],a[0:3],v[160:163],0
ds_read_b64_tr_b16 v[178:179],v218 offset:12288
v_subrev_u32 v218,102400,v218
v_mfma_f32_16x16x32_bf16 v[68:71],a[4:7],v[160:163],0
ds_read_b64_tr_b16 v[180:181],v228 offset:8192
v_lshlrev_b32 v250,5,v250
v_mfma_f32_16x16x32_bf16 v[72:75],a[8:11],v[160:163],0
ds_read_b64_tr_b16 v[182:183],v228 offset:12288
v_subrev_u32 v228,102400,v228
v_mfma_f32_16x16x32_bf16 v[76:79],a[12:15],v[160:163],0
ds_read_b64_tr_b16 v[184:185],v229 offset:8192
v_lshl_add_u32 v250,v244,3,v250
v_mfma_f32_16x16x32_bf16 v[80:83],a[0:3],v[164:167],0
ds_read_b64_tr_b16 v[186:187],v229 offset:12288
v_subrev_u32 v229,102400,v229
v_mfma_f32_16x16x32_bf16 v[84:87],a[4:7],v[164:167],0
buffer_load_dwordx4 v222,s[16:19],s62 offen offset:3072 lds
s_add_u32 m0,s100,102400
v_mfma_f32_16x16x32_bf16 v[88:91],a[8:11],v[164:167],0
s_bitcmp1_b32 s66,0
s_cselect_b32 s100,s99,0x0d090500
v_mfma_f32_16x16x32_bf16 v[92:95],a[12:15],v[164:167],0
s_and_b32 s66,s66,6
s_lshl_b32 s66,s66,2
v_mfma_f32_16x16x32_bf16 v[192:195],v[168:171],a[0:3],0
s_lshr_b32 s66,s100,s66
ds_read_b64_tr_b16 v[188:189],v223 offset:8192
v_mfma_f32_16x16x32_bf16 v[196:199],v[168:171],a[4:7],0
s_bitcmp1_b32 s67,0
s_cselect_b32 s100,s99,0x0d090500
ds_read_b64_tr_b16 v[190:191],v223 offset:12288
v_mfma_f32_16x16x32_bf16 v[200:203],v[168:171],a[8:11],0
s_and_b32 s67,s67,6
s_lshl_b32 s67,s67,2
v_mfma_f32_16x16x32_bf16 v[204:207],v[168:171],a[12:15],0
s_lshr_b32 s67,s100,s67
v_subrev_u32 v223,102400,v223
v_mfma_f32_16x16x32_bf16 v[112:115],a[0:3],v[172:175],0
s_bitcmp1_b32 s68,0
s_cselect_b32 s100,s99,0x0d090500
v_mfma_f32_16x16x32_bf16 v[116:119],a[4:7],v[172:175],0
s_and_b32 s68,s68,6
s_lshl_b32 s68,s68,2
s_waitcnt lgkmcnt(0)
v_mfma_f32_16x16x32_bf16 v[64:67],a[16:19],v[176:179],v[64:67]
s_lshr_b32 s68,s100,s68
ds_read_b64_tr_b16 v[160:161],v218 offset:0
v_mfma_f32_16x16x32_bf16 v[68:71],a[20:23],v[176:179],v[68:71]
buffer_load_dwordx4 v219,s[16:19],s63 offen lds
ds_read_b64_tr_b16 v[162:163],v218 offset:4096
v_mfma_f32_16x16x32_bf16 v[72:75],a[24:27],v[176:179],v[72:75]
s_bitcmp1_b32 s69,0
s_cselect_b32 s100,s99,0x0d090500
v_mfma_f32_16x16x32_bf16 v[76:79],a[28:31],v[176:179],v[76:79]
s_and_b32 s69,s69,6
s_lshl_b32 s69,s69,2
v_mfma_f32_16x16x32_bf16 v[80:83],a[16:19],v[180:183],v[80:83]
s_lshr_b32 s69,s100,s69
ds_read_b64_tr_b16 v[164:165],v228 offset:0
v_mfma_f32_16x16x32_bf16 v[84:87],a[20:23],v[180:183],v[84:87]
s_bitcmp1_b32 s70,0
s_cselect_b32 s100,s99,0x0d090500
v_mfma_f32_16x16x32_bf16 v[88:91],a[24:27],v[180:183],v[88:91]
s_and_b32 s70,s70,6
s_lshl_b32 s70,s70,2
v_mfma_f32_16x16x32_bf16 v[92:95],a[28:31],v[180:183],v[92:95]
s_lshr_b32 s70,s100,s70
ds_read_b64_tr_b16 v[166:167],v228 offset:4096
v_mfma_f32_16x16x32_bf16 v[192:195],v[184:187],a[16:19],v[192:195]
s_bitcmp1_b32 s71,0
s_cselect_b32 s100,s99,0x0d090500
v_mfma_f32_16x16x32_bf16 v[196:199],v[184:187],a[20:23],v[196:199]
s_and_b32 s71,s71,6
s_lshl_b32 s71,s71,2
ds_read_b64_tr_b16 v[168:169],v229 offset:0
ds_read_b64_tr_b16 v[170:171],v229 offset:4096
ds_read_b64_tr_b16 v[172:173],v223 offset:0
ds_read_b64_tr_b16 v[174:175],v223 offset:4096
v_mfma_f32_16x16x32_bf16 v[200:203],v[184:187],a[24:27],v[200:203]
buffer_load_dwordx4 v220,s[16:19],s63 offen offset:1024 lds
s_lshr_b32 s71,s100,s71
v_mfma_f32_16x16x32_bf16 v[204:207],v[184:187],a[28:31],v[204:207]
s_bitcmp1_b32 s72,0
s_cselect_b32 s100,s99,0x0d090500
v_mfma_f32_16x16x32_bf16 v[112:115],a[16:19],v[188:191],v[112:115]
s_and_b32 s72,s72,6
s_lshl_b32 s72,s72,2
v_mfma_f32_16x16x32_bf16 v[116:119],a[20:23],v[188:191],v[116:119]
s_lshr_b32 s72,s100,s72
s_waitcnt lgkmcnt(0)
v_mfma_f32_16x16x32_bf16 v[64:67],a[32:35],v[160:163],v[64:67]
s_bitcmp1_b32 s73,0
s_cselect_b32 s100,s99,0x0d090500
v_mfma_f32_16x16x32_bf16 v[68:71],a[36:39],v[160:163],v[68:71]
s_and_b32 s73,s73,6
s_lshl_b32 s73,s73,2
v_mfma_f32_16x16x32_bf16 v[72:75],a[40:43],v[160:163],v[72:75]
s_lshr_b32 s73,s100,s73
s_mul_i32 s99,s3,0x2010102
v_mfma_f32_16x16x32_bf16 v[76:79],a[44:47],v[160:163],v[76:79]
s_add_u32 s99,s99,0xf0b0702
s_lshr_b32 s74,s99,s74
v_mfma_f32_16x16x32_bf16 v[80:83],a[32:35],v[164:167],v[80:83]
s_lshr_b32 s75,s99,s75
s_lshr_b32 s76,s99,s76
v_mfma_f32_16x16x32_bf16 v[84:87],a[36:39],v[164:167],v[84:87]
s_lshr_b32 s77,s99,s77
s_mul_i32 s99,s3,0xfdfdfdfe
v_mfma_f32_16x16x32_bf16 v[88:91],a[40:43],v[164:167],v[88:91]
buffer_load_dwordx4 v221,s[16:19],s63 offen offset:2048 lds
s_lshl_b32 s100,s84,1
v_mfma_f32_16x16x32_bf16 v[92:95],a[44:47],v[164:167],v[92:95]
s_add_u32 s99,s99,0x100c0803
s_lshr_b32 s78,s99,s78
v_mfma_f32_16x16x32_bf16 v[192:195],v[168:171],a[32:35],v[192:195]
s_lshr_b32 s79,s99,s79
s_lshr_b32 s80,s99,s80
v_mfma_f32_16x16x32_bf16 v[196:199],v[168:171],a[36:39],v[196:199]
s_lshr_b32 s81,s99,s81
s_mul_i32 s99,s3,0xfffffdfe
ds_read_b64_tr_b16 v[176:177],v218 offset:8192
ds_read_b64_tr_b16 v[178:179],v218 offset:12288
ds_read_b64_tr_b16 v[180:181],v228 offset:8192
ds_read_b64_tr_b16 v[182:183],v228 offset:12288
ds_read_b64_tr_b16 v[184:185],v229 offset:8192
ds_read_b64_tr_b16 v[186:187],v229 offset:12288
ds_read_b64_tr_b16 v[188:189],v223 offset:8192
ds_read_b64_tr_b16 v[190:191],v223 offset:12288
v_mfma_f32_16x16x32_bf16 v[200:203],v[168:171],a[40:43],v[200:203]
s_add_u32 s99,s99,0x1104
s_lshr_b32 s82,s99,s82
v_mfma_f32_16x16x32_bf16 v[204:207],v[168:171],a[44:47],v[204:207]
s_lshr_b32 s83,s99,s83
ds_read_b32 v209,v248 offset:64
v_mfma_f32_16x16x32_bf16 v[112:115],a[32:35],v[172:175],v[112:115]
ds_read_b32 v210,v249 offset:0
v_lshrrev_b32 v248,4,v226
v_mfma_f32_16x16x32_bf16 v[116:119],a[36:39],v[172:175],v[116:119]
s_waitcnt lgkmcnt(2)
ds_read_b32 v211,v249 offset:64
v_mfma_f32_16x16x32_bf16 v[64:67],a[48:51],v[176:179],v[64:67]
s_getpc_b64 s[0:1]
L_cp1_4:
v_min_u32 v254,L_stop_4-L_cp1_4,v253
global_load_dword v255,v254,s[0:1]
s_waitcnt vmcnt(15)
v_mfma_f32_16x16x32_bf16 v[68:71],a[52:55],v[176:179],v[68:71]
s_barrier
ds_read_b64_tr_b16 v[160:161],v218 offset:20480
v_mfma_f32_16x16x32_bf16 v[72:75],a[56:59],v[176:179],v[72:75]
buffer_load_dwordx4 v222,s[16:19],s63 offen offset:3072 lds
s_add_u32 m0,s100,122880
v_mfma_f32_16x16x32_bf16 v[76:79],a[60:63],v[176:179],v[76:79]
s_lshl_b32 s100,s84,1
ds_read_b64_tr_b16 v[162:163],v218 offset:24576
v_mfma_f32_16x16x32_bf16 v[80:83],a[48:51],v[180:183],v[80:83]
ds_read_b64_tr_b16 v[164:165],v228 offset:20480
v_lshl_add_u32 v248,v248,4,s88
v_mfma_f32_16x16x32_bf16 v[84:87],a[52:55],v[180:183],v[84:87]
ds_read_b64_tr_b16 v[166:167],v228 offset:24576
s_mul_i32 s88,s45,3072
v_mfma_f32_16x16x32_bf16 v[88:91],a[56:59],v[180:183],v[88:91]
ds_read_b64_tr_b16 v[168:169],v229 offset:20480
s_add_u32 s88,s88,143360
v_mfma_f32_16x16x32_bf16 v[92:95],a[60:63],v[180:183],v[92:95]
ds_read_b64_tr_b16 v[170:171],v229 offset:24576
s_waitcnt lgkmcnt(6)
v_mfma_f32_16x16x32_bf16 v[192:195],v[184:187],a[48:51],v[192:195]
ds_read_b64_tr_b16 v[172:173],v223 offset:20480
v_mul_f32 v208,0xbfb8aa3b,v208
v_mfma_f32_16x16x32_bf16 v[196:199],v[184:187],a[52:55],v[196:199]
ds_read_b64_tr_b16 v[174:175],v223 offset:24576
v_mul_f32 v0,v208,v0
v_mfma_f32_16x16x32_bf16 v[200:203],v[184:187],a[56:59],v[200:203]
v_exp_f32 v0,v0
v_mfma_f32_16x16x32_bf16 v[204:207],v[184:187],a[60:63],v[204:207]
v_mul_f32 v1,v208,v1
v_mul_f32 v2,v208,v2
v_mfma_f32_16x16x32_bf16 v[112:115],a[48:51],v[188:191],v[112:115]
buffer_load_dwordx4 v219,s[16:19],s64 offen lds
v_mul_f32 v3,v208,v3
v_mfma_f32_16x16x32_bf16 v[116:119],a[52:55],v[188:191],v[116:119]
s_waitcnt lgkmcnt(0)
ds_read_b64_tr_b16 v[176:177],v218 offset:28672
v_mfma_f32_16x16x32_bf16 v[64:67],a[64:67],v[160:163],v[64:67]
ds_read_b64_tr_b16 v[178:179],v218 offset:32768
v_mul_f32 v209,0xbfb8aa3b,v209
v_mfma_f32_16x16x32_bf16 v[68:71],a[68:71],v[160:163],v[68:71]
ds_read_b64_tr_b16 v[180:181],v228 offset:28672
v_add_f32 v0,1.0,v0
v_mfma_f32_16x16x32_bf16 v[72:75],a[72:75],v[160:163],v[72:75]
ds_read_b64_tr_b16 v[182:183],v228 offset:32768
v_mul_f32 v4,v209,v4
v_mfma_f32_16x16x32_bf16 v[76:79],a[76:79],v[160:163],v[76:79]
ds_read_b64_tr_b16 v[184:185],v229 offset:28672
v_mul_f32 v5,v209,v5
v_mfma_f32_16x16x32_bf16 v[80:83],a[64:67],v[164:167],v[80:83]
ds_read_b64_tr_b16 v[186:187],v229 offset:32768
v_mul_f32 v6,v209,v6
v_mfma_f32_16x16x32_bf16 v[84:87],a[68:71],v[164:167],v[84:87]
ds_read_b64_tr_b16 v[188:189],v223 offset:28672
v_mul_f32 v7,v209,v7
v_mfma_f32_16x16x32_bf16 v[88:91],a[72:75],v[164:167],v[88:91]
ds_read_b64_tr_b16 v[190:191],v223 offset:32768
v_mul_f32 v210,0xbfb8aa3b,v210
v_mfma_f32_16x16x32_bf16 v[92:95],a[76:79],v[164:167],v[92:95]
v_exp_f32 v1,v1
v_mfma_f32_16x16x32_bf16 v[192:195],v[168:171],a[64:67],v[192:195]
buffer_load_dwordx4 v220,s[16:19],s64 offen offset:1024 lds
v_add_f32 v1,1.0,v1
v_mfma_f32_16x16x32_bf16 v[196:199],v[168:171],a[68:71],v[196:199]
v_exp_f32 v2,v2
v_mfma_f32_16x16x32_bf16 v[200:203],v[168:171],a[72:75],v[200:203]
v_exp_f32 v3,v3
v_mfma_f32_16x16x32_bf16 v[204:207],v[168:171],a[76:79],v[204:207]
v_rcp_f32 v0,v0
v_mfma_f32_16x16x32_bf16 v[112:115],a[64:67],v[172:175],v[112:115]
v_rcp_f32 v1,v1
v_mfma_f32_16x16x32_bf16 v[116:119],a[68:71],v[172:175],v[116:119]
s_waitcnt lgkmcnt(0)
ds_read_b64_tr_b16 v[160:161],v218 offset:40960
v_mfma_f32_16x16x32_bf16 v[64:67],a[80:83],v[176:179],v[64:67]
ds_read_b64_tr_b16 v[162:163],v218 offset:45056
v_add_f32 v2,1.0,v2
v_mfma_f32_16x16x32_bf16 v[68:71],a[84:87],v[176:179],v[68:71]
ds_read_b64_tr_b16 v[164:165],v228 offset:40960
v_add_f32 v3,1.0,v3
v_mfma_f32_16x16x32_bf16 v[72:75],a[88:91],v[176:179],v[72:75]
ds_read_b64_tr_b16 v[166:167],v228 offset:45056
v_mul_f32 v0,v0,v32
v_mfma_f32_16x16x32_bf16 v[76:79],a[92:95],v[176:179],v[76:79]
ds_read_b64_tr_b16 v[168:169],v229 offset:40960
v_mul_f32 v1,v1,v33
v_mfma_f32_16x16x32_bf16 v[80:83],a[80:83],v[180:183],v[80:83]
buffer_load_dwordx4 v221,s[16:19],s64 offen offset:2048 lds
ds_read_b64_tr_b16 v[170:171],v229 offset:45056
v_mfma_f32_16x16x32_bf16 v[84:87],a[84:87],v[180:183],v[84:87]
ds_read_b64_tr_b16 v[172:173],v223 offset:40960
v_cvt_pk_bf16_f32 v32,v0,v1
v_mfma_f32_16x16x32_bf16 v[88:91],a[88:91],v[180:183],v[88:91]
ds_read_b64_tr_b16 v[174:175],v223 offset:45056
v_mul_f32 v8,v210,v8
v_mfma_f32_16x16x32_bf16 v[92:95],a[92:95],v[180:183],v[92:95]
s_waitcnt vmcnt(11)
buffer_store_dword v225,v227,s[32:35],s91 offen sc1
v_mfma_f32_16x16x32_bf16 v[192:195],v[184:187],a[80:83],v[192:195]
v_rcp_f32 v2,v2
v_mfma_f32_16x16x32_bf16 v[196:199],v[184:187],a[84:87],v[196:199]
v_rcp_f32 v3,v3
v_mfma_f32_16x16x32_bf16 v[200:203],v[184:187],a[88:91],v[200:203]
v_exp_f32 v4,v4
v_mfma_f32_16x16x32_bf16 v[204:207],v[184:187],a[92:95],v[204:207]
v_exp_f32 v5,v5
v_mfma_f32_16x16x32_bf16 v[112:115],a[80:83],v[188:191],v[112:115]
v_exp_f32 v6,v6
v_mfma_f32_16x16x32_bf16 v[116:119],a[84:87],v[188:191],v[116:119]
s_waitcnt lgkmcnt(0)
ds_read_b64_tr_b16 v[176:177],v218 offset:49152
v_mfma_f32_16x16x32_bf16 v[64:67],a[96:99],v[160:163],v[64:67]
buffer_load_dwordx4 v222,s[16:19],s64 offen offset:3072 lds
s_add_u32 m0,s100,20480
v_mfma_f32_16x16x32_bf16 v[68:71],a[100:103],v[160:163],v[68:71]
ds_read_b64_tr_b16 v[178:179],v218 offset:53248
v_add_u32 v218,61440,v218
v_mfma_f32_16x16x32_bf16 v[72:75],a[104:107],v[160:163],v[72:75]
ds_read_b64_tr_b16 v[180:181],v228 offset:49152
v_mul_f32 v2,v2,v34
v_mfma_f32_16x16x32_bf16 v[76:79],a[108:111],v[160:163],v[76:79]
ds_read_b64_tr_b16 v[182:183],v228 offset:53248
v_add_u32 v228,61440,v228
v_mfma_f32_16x16x32_bf16 v[80:83],a[96:99],v[164:167],v[80:83]
ds_read_b64_tr_b16 v[184:185],v229 offset:49152
v_mul_f32 v3,v3,v35
v_mfma_f32_16x16x32_bf16 v[84:87],a[100:103],v[164:167],v[84:87]
ds_read_b64_tr_b16 v[186:187],v229 offset:53248
v_add_u32 v229,61440,v229
v_mfma_f32_16x16x32_bf16 v[88:91],a[104:107],v[164:167],v[88:91]
s_mul_i32 s98,s3,128
s_add_u32 s98,s98,128
s_ashr_i32 s99,s98,31
v_mfma_f32_16x16x32_bf16 v[92:95],a[108:111],v[164:167],v[92:95]
s_add_u32 s8,s8,s98
s_addc_u32 s9,s9,s99
s_sub_u32 s10,s10,s98
v_mfma_f32_16x16x32_bf16 v[192:195],v[168:171],a[96:99],v[192:195]
s_add_u32 s12,s12,s98
s_addc_u32 s13,s13,s99
s_sub_u32 s14,s14,s98
v_mfma_f32_16x16x32_bf16 v[196:199],v[168:171],a[100:103],v[196:199]
ds_read_b64_tr_b16 v[188:189],v223 offset:49152
ds_read_b64_tr_b16 v[190:191],v223 offset:53248
v_mfma_f32_16x16x32_bf16 v[200:203],v[168:171],a[104:107],v[200:203]
buffer_load_dwordx4 v219,s[16:19],s65 offen lds
v_add_u32 v223,61440,v223
v_mfma_f32_16x16x32_bf16 v[204:207],v[168:171],a[108:111],v[204:207]
v_exp_f32 v7,v7
v_mfma_f32_16x16x32_bf16 v[112:115],a[96:99],v[172:175],v[112:115]
v_cvt_pk_bf16_f32 v33,v2,v3
v_add_f32 v4,1.0,v4
v_mfma_f32_16x16x32_bf16 v[116:119],a[100:103],v[172:175],v[116:119]
s_waitcnt lgkmcnt(0)
v_add_f32 v5,1.0,v5
v_mfma_f32_16x16x32_bf16 v[64:67],a[112:115],v[176:179],v[64:67]
s_waitcnt vmcnt(11)
s_barrier
v_mfma_f32_16x16x32_bf16 v[68:71],a[116:119],v[176:179],v[68:71]
ds_read_b64_tr_b16 v[160:161],v218 offset:0
v_add_f32 v6,1.0,v6
v_mfma_f32_16x16x32_bf16 v[72:75],a[120:123],v[176:179],v[72:75]
ds_read_b64_tr_b16 v[162:163],v218 offset:4096
v_add_f32 v7,1.0,v7
v_mfma_f32_16x16x32_bf16 v[76:79],a[124:127],v[176:179],v[76:79]
ds_read_b64_tr_b16 v[164:165],v228 offset:0
v_mul_f32 v9,v210,v9
v_mfma_f32_16x16x32_bf16 v[80:83],a[112:115],v[180:183],v[80:83]
ds_read_b64_tr_b16 v[166:167],v228 offset:4096
v_mul_f32 v10,v210,v10
v_mfma_f32_16x16x32_bf16 v[84:87],a[116:119],v[180:183],v[84:87]
ds_read_b64_tr_b16 v[168:169],v229 offset:0
v_mul_f32 v11,v210,v11
v_mfma_f32_16x16x32_bf16 v[88:91],a[120:123],v[180:183],v[88:91]
buffer_load_dwordx4 v220,s[16:19],s65 offen offset:1024 lds
ds_read_b64_tr_b16 v[170:171],v229 offset:4096
v_mfma_f32_16x16x32_bf16 v[92:95],a[124:127],v[180:183],v[92:95]
ds_read_b64_tr_b16 v[172:173],v223 offset:0
v_mul_f32 v211,0xbfb8aa3b,v211
v_mfma_f32_16x16x32_bf16 v[192:195],v[184:187],a[112:115],v[192:195]
ds_read_b64_tr_b16 v[174:175],v223 offset:4096
v_mul_f32 v12,v211,v12
v_mfma_f32_16x16x32_bf16 v[196:199],v[184:187],a[116:119],v[196:199]
v_rcp_f32 v4,v4
v_mfma_f32_16x16x32_bf16 v[200:203],v[184:187],a[120:123],v[200:203]
v_rcp_f32 v5,v5
v_mfma_f32_16x16x32_bf16 v[204:207],v[184:187],a[124:127],v[204:207]
v_rcp_f32 v6,v6
v_mfma_f32_16x16x32_bf16 v[112:115],a[112:115],v[188:191],v[112:115]
v_rcp_f32 v7,v7
v_mfma_f32_16x16x32_bf16 v[116:119],a[116:119],v[188:191],v[116:119]
s_waitcnt lgkmcnt(0)
ds_read_b64_tr_b16 v[176:177],v218 offset:8192
v_mfma_f32_16x16x32_bf16 v[64:67],a[128:131],v[160:163],v[64:67]
ds_read_b64_tr_b16 v[178:179],v218 offset:12288
v_subrev_u32 v218,81920,v218
v_mfma_f32_16x16x32_bf16 v[68:71],a[132:135],v[160:163],v[68:71]
ds_read_b64_tr_b16 v[180:181],v228 offset:8192
v_mul_f32 v4,v4,v36
v_mfma_f32_16x16x32_bf16 v[72:75],a[136:139],v[160:163],v[72:75]
buffer_load_dwordx4 v221,s[16:19],s65 offen offset:2048 lds
ds_read_b64_tr_b16 v[182:183],v228 offset:12288
v_mfma_f32_16x16x32_bf16 v[76:79],a[140:143],v[160:163],v[76:79]
v_subrev_u32 v228,81920,v228
ds_read_b64_tr_b16 v[184:185],v229 offset:8192
v_mfma_f32_16x16x32_bf16 v[80:83],a[128:131],v[164:167],v[80:83]
ds_read_b64_tr_b16 v[186:187],v229 offset:12288
v_subrev_u32 v229,81920,v229
v_mfma_f32_16x16x32_bf16 v[84:87],a[132:135],v[164:167],v[84:87]
ds_read_b64_tr_b16 v[188:189],v223 offset:8192
v_mul_f32 v5,v5,v37
v_mfma_f32_16x16x32_bf16 v[88:91],a[136:139],v[164:167],v[88:91]
ds_read_b64_tr_b16 v[190:191],v223 offset:12288
v_subrev_u32 v223,81920,v223
v_mfma_f32_16x16x32_bf16 v[92:95],a[140:143],v[164:167],v[92:95]
v_exp_f32 v8,v8
v_mfma_f32_16x16x32_bf16 v[192:195],v[168:171],a[128:131],v[192:195]
v_exp_f32 v9,v9
v_mfma_f32_16x16x32_bf16 v[196:199],v[168:171],a[132:135],v[196:199]
v_exp_f32 v10,v10
v_mfma_f32_16x16x32_bf16 v[200:203],v[168:171],a[136:139],v[200:203]
v_exp_f32 v11,v11
v_mfma_f32_16x16x32_bf16 v[204:207],v[168:171],a[140:143],v[204:207]
v_mul_f32 v6,v6,v38
v_mul_f32 v7,v7,v39
v_mfma_f32_16x16x32_bf16 v[112:115],a[128:131],v[172:175],v[112:115]
buffer_load_dwordx4 v222,s[16:19],s65 offen offset:3072 lds
s_add_u32 m0,s84,40960
v_mfma_f32_16x16x32_bf16 v[116:119],a[132:135],v[172:175],v[116:119]
s_waitcnt lgkmcnt(0)
ds_read_b64_tr_b16 v[160:161],v218 offset:0
v_mfma_f32_16x16x32_bf16 v[64:67],a[144:147],v[176:179],v[64:67]
ds_read_b64_tr_b16 v[162:163],v218 offset:4096
v_cvt_pk_bf16_f32 v36,v4,v5
v_mfma_f32_16x16x32_bf16 v[68:71],a[148:151],v[176:179],v[68:71]
ds_read_b64_tr_b16 v[164:165],v228 offset:0
v_cvt_pk_bf16_f32 v37,v6,v7
v_mfma_f32_16x16x32_bf16 v[72:75],a[152:155],v[176:179],v[72:75]
ds_read_b64_tr_b16 v[166:167],v228 offset:4096
v_add_f32 v8,1.0,v8
v_mfma_f32_16x16x32_bf16 v[76:79],a[156:159],v[176:179],v[76:79]
ds_read_b64_tr_b16 v[168:169],v229 offset:0
v_rcp_f32 v8,v8
v_mfma_f32_16x16x32_bf16 v[80:83],a[144:147],v[180:183],v[80:83]
ds_read_b64_tr_b16 v[170:171],v229 offset:4096
v_add_f32 v9,1.0,v9
v_add_f32 v10,1.0,v10
v_mfma_f32_16x16x32_bf16 v[84:87],a[148:151],v[180:183],v[84:87]
ds_read_b64_tr_b16 v[172:173],v223 offset:0
v_rcp_f32 v9,v9
v_mfma_f32_16x16x32_bf16 v[88:91],a[152:155],v[180:183],v[88:91]
ds_read_b64_tr_b16 v[174:175],v223 offset:4096
v_rcp_f32 v10,v10
v_mfma_f32_16x16x32_bf16 v[92:95],a[156:159],v[180:183],v[92:95]
buffer_load_dwordx4 v213,s[8:11],s48 offen lds
v_add_f32 v11,1.0,v11
v_mul_f32 v13,v211,v13
v_mfma_f32_16x16x32_bf16 v[192:195],v[184:187],a[144:147],v[192:195]
v_rcp_f32 v11,v11
v_mul_f32 v14,v211,v14
v_mfma_f32_16x16x32_bf16 v[196:199],v[184:187],a[148:151],v[196:199]
v_exp_f32 v12,v12
v_mul_f32 v15,v211,v15
v_mfma_f32_16x16x32_bf16 v[200:203],v[184:187],a[152:155],v[200:203]
v_exp_f32 v13,v13
v_mul_f32 v16,v208,v16
v_mfma_f32_16x16x32_bf16 v[204:207],v[184:187],a[156:159],v[204:207]
buffer_load_dwordx4 v213,s[12:15],s48 offen offset:1024 lds
s_add_u32 m0,s84,49152
v_mul_f32 v17,v208,v17
v_mfma_f32_16x16x32_bf16 v[112:115],a[144:147],v[188:191],v[112:115]
v_exp_f32 v14,v14
v_mul_f32 v18,v208,v18
v_mfma_f32_16x16x32_bf16 v[116:119],a[148:151],v[188:191],v[116:119]
s_waitcnt lgkmcnt(0)
ds_read_b64_tr_b16 v[176:177],v218 offset:8192
v_mul_f32 v19,v208,v19
v_mfma_f32_16x16x32_bf16 v[64:67],a[160:163],v[160:163],v[64:67]
ds_read_b64_tr_b16 v[178:179],v218 offset:12288
v_add_u32 v218,102400,v218
v_mul_f32 v8,v8,v40
v_mfma_f32_16x16x32_bf16 v[68:71],a[164:167],v[160:163],v[68:71]
buffer_load_dwordx4 v214,s[8:11],s48 offen lds
ds_read_b64_tr_b16 v[180:181],v228 offset:8192
v_mfma_f32_16x16x32_bf16 v[72:75],a[168:171],v[160:163],v[72:75]
ds_read_b64_tr_b16 v[182:183],v228 offset:12288
v_add_u32 v228,102400,v228
v_mfma_f32_16x16x32_bf16 v[76:79],a[172:175],v[160:163],v[76:79]
ds_read_b64_tr_b16 v[184:185],v229 offset:8192
v_mul_f32 v9,v9,v41
v_mfma_f32_16x16x32_bf16 v[80:83],a[160:163],v[164:167],v[80:83]
ds_read_b64_tr_b16 v[186:187],v229 offset:12288
v_add_u32 v229,102400,v229
v_mfma_f32_16x16x32_bf16 v[84:87],a[164:167],v[164:167],v[84:87]
buffer_load_dwordx4 v214,s[12:15],s48 offen offset:1024 lds
s_add_u32 m0,s84,61440
v_mfma_f32_16x16x32_bf16 v[88:91],a[168:171],v[164:167],v[88:91]
ds_read_b64_tr_b16 v[188:189],v223 offset:8192
v_mul_f32 v10,v10,v42
v_mfma_f32_16x16x32_bf16 v[92:95],a[172:175],v[164:167],v[92:95]
ds_read_b64_tr_b16 v[190:191],v223 offset:12288
v_add_u32 v223,102400,v223
v_mfma_f32_16x16x32_bf16 v[192:195],v[168:171],a[160:163],v[192:195]
v_exp_f32 v15,v15
v_mfma_f32_16x16x32_bf16 v[196:199],v[168:171],a[164:167],v[196:199]
buffer_load_dwordx4 v213,s[8:11],s49 offen lds
v_mul_f32 v11,v11,v43
v_mfma_f32_16x16x32_bf16 v[200:203],v[168:171],a[168:171],v[200:203]
v_exp_f32 v16,v16
v_mfma_f32_16x16x32_bf16 v[204:207],v[168:171],a[172:175],v[204:207]
v_exp_f32 v17,v17
v_mfma_f32_16x16x32_bf16 v[112:115],a[160:163],v[172:175],v[112:115]
v_exp_f32 v18,v18
v_mfma_f32_16x16x32_bf16 v[116:119],a[164:167],v[172:175],v[116:119]
s_waitcnt lgkmcnt(0)
v_cvt_pk_bf16_f32 v40,v8,v9
v_mfma_f32_16x16x32_bf16 v[64:67],a[176:179],v[176:179],v[64:67]
buffer_load_dwordx4 v213,s[12:15],s49 offen offset:1024 lds
s_add_u32 m0,s84,69632
s_waitcnt vmcnt(10)
v_mfma_f32_16x16x32_bf16 v[68:71],a[180:183],v[176:179],v[68:71]
s_barrier
ds_read_b64_tr_b16 v[160:161],v218 offset:0
v_mfma_f32_16x16x32_bf16 v[72:75],a[184:187],v[176:179],v[72:75]
ds_read_b64_tr_b16 v[162:163],v218 offset:4096
v_cvt_pk_bf16_f32 v41,v10,v11
v_mfma_f32_16x16x32_bf16 v[76:79],a[188:191],v[176:179],v[76:79]
ds_read_b64_tr_b16 v[164:165],v228 offset:0
v_add_f32 v12,1.0,v12
v_mfma_f32_16x16x32_bf16 v[80:83],a[176:179],v[180:183],v[80:83]
buffer_load_dwordx4 v214,s[8:11],s49 offen lds
ds_read_b64_tr_b16 v[166:167],v228 offset:4096
v_mfma_f32_16x16x32_bf16 v[84:87],a[180:183],v[180:183],v[84:87]
ds_read_b64_tr_b16 v[168:169],v229 offset:0
v_add_f32 v13,1.0,v13
v_mfma_f32_16x16x32_bf16 v[88:91],a[184:187],v[180:183],v[88:91]
ds_read_b64_tr_b16 v[170:171],v229 offset:4096
v_add_f32 v14,1.0,v14
v_mfma_f32_16x16x32_bf16 v[92:95],a[188:191],v[180:183],v[92:95]
ds_read_b64_tr_b16 v[172:173],v223 offset:0
v_add_f32 v15,1.0,v15
v_mfma_f32_16x16x32_bf16 v[192:195],v[184:187],a[176:179],v[192:195]
buffer_load_dwordx4 v214,s[12:15],s49 offen offset:1024 lds
s_add_u32 m0,s84,81920
v_mfma_f32_16x16x32_bf16 v[196:199],v[184:187],a[180:183],v[196:199]
ds_read_b64_tr_b16 v[174:175],v223 offset:4096
v_add_f32 v16,1.0,v16
v_mfma_f32_16x16x32_bf16 v[200:203],v[184:187],a[184:187],v[200:203]
v_exp_f32 v19,v19
v_mfma_f32_16x16x32_bf16 v[204:207],v[184:187],a[188:191],v[204:207]
v_rcp_f32 v12,v12
v_mfma_f32_16x16x32_bf16 v[112:115],a[176:179],v[188:191],v[112:115]
v_rcp_f32 v13,v13
v_mfma_f32_16x16x32_bf16 v[116:119],a[180:183],v[188:191],v[116:119]
buffer_load_dwordx4 v213,s[8:11],s50 offen lds
s_waitcnt lgkmcnt(0)
v_mfma_f32_16x16x32_bf16 v[64:67],a[192:195],v[160:163],v[64:67]
ds_read_b64_tr_b16 v[176:177],v218 offset:8192
v_add_f32 v17,1.0,v17
v_mfma_f32_16x16x32_bf16 v[68:71],a[196:199],v[160:163],v[68:71]
ds_read_b64_tr_b16 v[178:179],v218 offset:12288
v_add_f32 v18,1.0,v18
v_mfma_f32_16x16x32_bf16 v[72:75],a[200:203],v[160:163],v[72:75]
ds_read_b64_tr_b16 v[180:181],v228 offset:8192
v_add_f32 v19,1.0,v19
v_mfma_f32_16x16x32_bf16 v[76:79],a[204:207],v[160:163],v[76:79]
buffer_load_dwordx4 v213,s[12:15],s50 offen offset:1024 lds
s_add_u32 m0,s84,90112
v_mfma_f32_16x16x32_bf16 v[80:83],a[192:195],v[164:167],v[80:83]
ds_read_b64_tr_b16 v[182:183],v228 offset:12288
v_mul_f32 v20,v209,v20
v_mfma_f32_16x16x32_bf16 v[84:87],a[196:199],v[164:167],v[84:87]
ds_read_b64_tr_b16 v[184:185],v229 offset:8192
v_mul_f32 v21,v209,v21
v_mfma_f32_16x16x32_bf16 v[88:91],a[200:203],v[164:167],v[88:91]
ds_read_b64_tr_b16 v[186:187],v229 offset:12288
v_mul_f32 v22,v209,v22
v_mfma_f32_16x16x32_bf16 v[92:95],a[204:207],v[164:167],v[92:95]
buffer_load_dwordx4 v214,s[8:11],s50 offen lds
ds_read_b64_tr_b16 v[188:189],v223 offset:8192
v_mfma_f32_16x16x32_bf16 v[192:195],v[168:171],a[192:195],v[192:195]
ds_read_b64_tr_b16 v[190:191],v223 offset:12288
v_mul_f32 v23,v209,v23
v_mfma_f32_16x16x32_bf16 v[196:199],v[168:171],a[196:199],v[196:199]
v_rcp_f32 v14,v14
v_mfma_f32_16x16x32_bf16 v[200:203],v[168:171],a[200:203],v[200:203]
v_rcp_f32 v15,v15
v_mfma_f32_16x16x32_bf16 v[204:207],v[168:171],a[204:207],v[204:207]
v_rcp_f32 v16,v16
v_mfma_f32_16x16x32_bf16 v[112:115],a[192:195],v[172:175],v[112:115]
buffer_load_dwordx4 v214,s[12:15],s50 offen offset:1024 lds
s_add_u32 m0,s84,0
v_mfma_f32_16x16x32_bf16 v[116:119],a[196:199],v[172:175],v[116:119]
s_waitcnt lgkmcnt(0)
ds_read_b64_tr_b16 v[160:161],v218 offset:20480
v_mfma_f32_16x16x32_bf16 v[64:67],a[208:211],v[176:179],v[64:67]
ds_read_b64_tr_b16 v[162:163],v218 offset:24576
v_mul_f32 v12,v12,v44
v_mfma_f32_16x16x32_bf16 v[68:71],a[212:215],v[176:179],v[68:71]
ds_read_b64_tr_b16 v[164:165],v228 offset:20480
v_mul_f32 v13,v13,v45
v_mfma_f32_16x16x32_bf16 v[72:75],a[216:219],v[176:179],v[72:75]
buffer_load_dwordx4 v213,s[8:11],s51 offen lds
ds_read_b64_tr_b16 v[166:167],v228 offset:24576
v_mfma_f32_16x16x32_bf16 v[76:79],a[220:223],v[176:179],v[76:79]
ds_read_b64_tr_b16 v[168:169],v229 offset:20480
v_mul_f32 v14,v14,v46
v_mfma_f32_16x16x32_bf16 v[80:83],a[208:211],v[180:183],v[80:83]
ds_read_b64_tr_b16 v[170:171],v229 offset:24576
v_mul_f32 v15,v15,v47
v_mfma_f32_16x16x32_bf16 v[84:87],a[212:215],v[180:183],v[84:87]
ds_read_b64_tr_b16 v[172:173],v223 offset:20480
v_cvt_pk_bf16_f32 v44,v12,v13
v_mfma_f32_16x16x32_bf16 v[88:91],a[216:219],v[180:183],v[88:91]
buffer_load_dwordx4 v213,s[12:15],s51 offen offset:1024 lds
s_add_u32 m0,s84,8192
v_mfma_f32_16x16x32_bf16 v[92:95],a[220:223],v[180:183],v[92:95]
ds_read_b64_tr_b16 v[174:175],v223 offset:24576
v_cvt_pk_bf16_f32 v45,v14,v15
v_mfma_f32_16x16x32_bf16 v[192:195],v[184:187],a[208:211],v[192:195]
v_rcp_f32 v17,v17
v_mfma_f32_16x16x32_bf16 v[196:199],v[184:187],a[212:215],v[196:199]
v_rcp_f32 v18,v18
v_mfma_f32_16x16x32_bf16 v[200:203],v[184:187],a[216:219],v[200:203]
v_rcp_f32 v19,v19
v_mfma_f32_16x16x32_bf16 v[204:207],v[184:187],a[220:223],v[204:207]
buffer_load_dwordx4 v214,s[8:11],s51 offen lds
v_mul_f32 v16,v16,v48
v_mfma_f32_16x16x32_bf16 v[112:115],a[208:211],v[188:191],v[112:115]
v_exp_f32 v20,v20
v_mul_f32 v17,v17,v49
v_mfma_f32_16x16x32_bf16 v[116:119],a[212:215],v[188:191],v[116:119]
s_waitcnt lgkmcnt(0)
ds_read_b64_tr_b16 v[176:177],v218 offset:28672
v_mul_f32 v18,v18,v50
v_mfma_f32_16x16x32_bf16 v[64:67],a[224:227],v[160:163],v[64:67]
ds_read_b64_tr_b16 v[178:179],v218 offset:32768
v_subrev_u32 v218,81920,v218
v_mul_f32 v19,v19,v51
v_mfma_f32_16x16x32_bf16 v[68:71],a[228:231],v[160:163],v[68:71]
buffer_load_dwordx4 v214,s[12:15],s51 offen offset:1024 lds
ds_read_b64_tr_b16 v[180:181],v228 offset:28672
v_mfma_f32_16x16x32_bf16 v[72:75],a[232:235],v[160:163],v[72:75]
ds_read_b64_tr_b16 v[182:183],v228 offset:32768
v_subrev_u32 v228,81920,v228
v_mfma_f32_16x16x32_bf16 v[76:79],a[236:239],v[160:163],v[76:79]
ds_read_b64_tr_b16 v[184:185],v229 offset:28672
v_exp_f32 v21,v21
v_mfma_f32_16x16x32_bf16 v[80:83],a[224:227],v[164:167],v[80:83]
ds_read_b64_tr_b16 v[186:187],v229 offset:32768
v_subrev_u32 v229,81920,v229
v_cvt_pk_bf16_f32 v34,v16,v17
v_mfma_f32_16x16x32_bf16 v[84:87],a[228:231],v[164:167],v[84:87]
ds_read_b64_tr_b16 v[188:189],v223 offset:28672
v_cvt_pk_bf16_f32 v35,v18,v19
v_mfma_f32_16x16x32_bf16 v[88:91],a[232:235],v[164:167],v[88:91]
buffer_store_dwordx4 v[32:35],v212,s[24:27],s86 offen sc1
s_add_u32 m0,s84,102400
v_mfma_f32_16x16x32_bf16 v[92:95],a[236:239],v[164:167],v[92:95]
ds_read_b64_tr_b16 v[190:191],v223 offset:32768
v_subrev_u32 v223,81920,v223
v_mfma_f32_16x16x32_bf16 v[192:195],v[168:171],a[224:227],v[192:195]
v_exp_f32 v22,v22
v_mfma_f32_16x16x32_bf16 v[196:199],v[168:171],a[228:231],v[196:199]
v_exp_f32 v23,v23
v_mfma_f32_16x16x32_bf16 v[200:203],v[168:171],a[232:235],v[200:203]
v_add_f32 v20,1.0,v20
v_add_f32 v21,1.0,v21
v_mfma_f32_16x16x32_bf16 v[204:207],v[168:171],a[236:239],v[204:207]
v_rcp_f32 v20,v20
v_mfma_f32_16x16x32_bf16 v[112:115],a[224:227],v[172:175],v[112:115]
v_rcp_f32 v21,v21
v_mfma_f32_16x16x32_bf16 v[116:119],a[228:231],v[172:175],v[116:119]
s_waitcnt lgkmcnt(0)
v_add_f32 v22,1.0,v22
v_mfma_f32_16x16x32_bf16 v[64:67],a[240:243],v[176:179],v[64:67]
s_waitcnt vmcnt(13)
s_barrier
v_mfma_f32_16x16x32_bf16 v[68:71],a[244:247],v[176:179],v[68:71]
ds_read_b64_tr_b16 v[160:161],v218 offset:0
v_add_f32 v23,1.0,v23
v_mfma_f32_16x16x32_bf16 v[72:75],a[248:251],v[176:179],v[72:75]
buffer_load_dwordx4 v213,s[8:11],s52 offen lds
ds_read_b64_tr_b16 v[162:163],v218 offset:4096
v_mfma_f32_16x16x32_bf16 v[76:79],a[252:255],v[176:179],v[76:79]
ds_read_b64_tr_b16 v[164:165],v228 offset:0
v_mul_f32 v24,v210,v24
v_mfma_f32_16x16x32_bf16 v[80:83],a[240:243],v[180:183],v[80:83]
ds_read_b64_tr_b16 v[166:167],v228 offset:4096
v_mul_f32 v25,v210,v25
v_mfma_f32_16x16x32_bf16 v[84:87],a[244:247],v[180:183],v[84:87]
ds_read_b64_tr_b16 v[168:169],v229 offset:0
v_mul_f32 v26,v210,v26
v_mfma_f32_16x16x32_bf16 v[88:91],a[248:251],v[180:183],v[88:91]
buffer_load_dwordx4 v213,s[12:15],s52 offen offset:1024 lds
s_add_u32 m0,s84,110592
v_mfma_f32_16x16x32_bf16 v[92:95],a[252:255],v[180:183],v[92:95]
ds_read_b64_tr_b16 v[170:171],v229 offset:4096
v_mul_f32 v27,v210,v27
v_mfma_f32_16x16x32_bf16 v[192:195],v[184:187],a[240:243],v[192:195]
ds_read_b64_tr_b16 v[172:173],v223 offset:0
v_mul_f32 v20,v20,v52
v_mfma_f32_16x16x32_bf16 v[196:199],v[184:187],a[244:247],v[196:199]
ds_read_b64_tr_b16 v[174:175],v223 offset:4096
v_mul_f32 v21,v21,v53
v_mfma_f32_16x16x32_bf16 v[200:203],v[184:187],a[248:251],v[200:203]
v_rcp_f32 v22,v22
v_mfma_f32_16x16x32_bf16 v[204:207],v[184:187],a[252:255],v[204:207]
buffer_load_dwordx4 v214,s[8:11],s52 offen lds
v_mul_f32 v22,v22,v54
v_mfma_f32_16x16x32_bf16 v[112:115],a[240:243],v[188:191],v[112:115]
v_rcp_f32 v23,v23
v_mfma_f32_16x16x32_bf16 v[116:119],a[244:247],v[188:191],v[116:119]
s_waitcnt lgkmcnt(0)
ds_read_b64_tr_b16 v[176:177],v218 offset:8192
v_mfma_f32_16x16x32_bf16 v[64:67],v[128:131],v[160:163],v[64:67]
ds_read_b64_tr_b16 v[178:179],v218 offset:12288
v_mul_f32 v23,v23,v55
v_mfma_f32_16x16x32_bf16 v[68:71],v[132:135],v[160:163],v[68:71]
buffer_load_dwordx4 v214,s[12:15],s52 offen offset:1024 lds
s_add_u32 m0,s84,122880
ds_read_b64_tr_b16 v[180:181],v228 offset:8192
v_mfma_f32_16x16x32_bf16 v[72:75],v[136:139],v[160:163],v[72:75]
ds_read_b64_tr_b16 v[182:183],v228 offset:12288
v_exp_f32 v24,v24
v_mfma_f32_16x16x32_bf16 v[76:79],v[140:143],v[160:163],v[76:79]
ds_read_b64_tr_b16 v[184:185],v229 offset:8192
v_exp_f32 v25,v25
v_mfma_f32_16x16x32_bf16 v[80:83],v[128:131],v[164:167],v[80:83]
ds_read_b64_tr_b16 v[186:187],v229 offset:12288
v_exp_f32 v26,v26
v_mfma_f32_16x16x32_bf16 v[84:87],v[132:135],v[164:167],v[84:87]
buffer_load_dwordx4 v213,s[8:11],s53 offen lds
ds_read_b64_tr_b16 v[188:189],v223 offset:8192
v_cvt_pk_bf16_f32 v38,v20,v21
v_mfma_f32_16x16x32_bf16 v[88:91],v[136:139],v[164:167],v[88:91]
ds_read_b64_tr_b16 v[190:191],v223 offset:12288
v_cvt_pk_bf16_f32 v39,v22,v23
v_mfma_f32_16x16x32_bf16 v[92:95],v[140:143],v[164:167],v[92:95]
v_exp_f32 v27,v27
v_add_f32 v24,1.0,v24
v_mfma_f32_16x16x32_bf16 v[192:195],v[168:171],v[128:131],v[192:195]
v_rcp_f32 v24,v24
v_add_f32 v25,1.0,v25
v_mfma_f32_16x16x32_bf16 v[196:199],v[168:171],v[132:135],v[196:199]
buffer_store_dwordx4 v[36:39],v212,s[24:27],s86 offen offset:1024 sc1
v_add_f32 v26,1.0,v26
v_mfma_f32_16x16x32_bf16 v[200:203],v[168:171],v[136:139],v[200:203]
v_rcp_f32 v25,v25
v_mfma_f32_16x16x32_bf16 v[204:207],v[168:171],v[140:143],v[204:207]
v_rcp_f32 v26,v26
v_mfma_f32_16x16x32_bf16 v[112:115],v[128:131],v[172:175],v[112:115]
v_add_f32 v27,1.0,v27
v_mul_f32 v28,v211,v28
v_mfma_f32_16x16x32_bf16 v[116:119],v[132:135],v[172:175],v[116:119]
s_waitcnt lgkmcnt(0)
ds_read_b64_tr_b16 v[160:161],v215 offset:0
v_mfma_f32_16x16x32_bf16 v[64:67],v[144:147],v[176:179],v[64:67]
ds_read_b64_tr_b16 v[162:163],v215 offset:4096
v_mul_f32 v29,v211,v29
v_mfma_f32_16x16x32_bf16 v[68:71],v[148:151],v[176:179],v[68:71]
ds_read_b64_tr_b16 v[164:165],v216 offset:0
v_mul_f32 v30,v211,v30
v_mfma_f32_16x16x32_bf16 v[72:75],v[152:155],v[176:179],v[72:75]
ds_read_b64_tr_b16 v[166:167],v216 offset:4096
v_mul_f32 v31,v211,v31
v_mfma_f32_16x16x32_bf16 v[76:79],v[156:159],v[176:179],v[76:79]
ds_read_b64_tr_b16 v[168:169],v215 offset:1024
v_mul_f32 v24,v24,v56
v_mfma_f32_16x16x32_bf16 v[80:83],v[144:147],v[180:183],v[80:83]
ds_read_b64_tr_b16 v[170:171],v215 offset:5120
v_rcp_f32 v27,v27
v_mfma_f32_16x16x32_bf16 v[84:87],v[148:151],v[180:183],v[84:87]
ds_read_b64_tr_b16 v[172:173],v216 offset:1024
v_mul_f32 v25,v25,v57
v_mfma_f32_16x16x32_bf16 v[88:91],v[152:155],v[180:183],v[88:91]
buffer_load_dwordx4 v213,s[12:15],s53 offen offset:1024 lds
s_add_u32 m0,s84,131072
v_mfma_f32_16x16x32_bf16 v[92:95],v[156:159],v[180:183],v[92:95]
ds_read_b64_tr_b16 v[174:175],v216 offset:5120
v_mul_f32 v26,v26,v58
v_mfma_f32_16x16x32_bf16 v[192:195],v[184:187],v[144:147],v[192:195]
v_exp_f32 v28,v28
v_mfma_f32_16x16x32_bf16 v[196:199],v[184:187],v[148:151],v[196:199]
v_exp_f32 v29,v29
v_mul_f32 v27,v27,v59
v_mfma_f32_16x16x32_bf16 v[200:203],v[184:187],v[152:155],v[200:203]
buffer_load_dwordx4 v214,s[8:11],s53 offen lds
v_exp_f32 v30,v30
v_mfma_f32_16x16x32_bf16 v[204:207],v[184:187],v[156:159],v[204:207]
v_exp_f32 v31,v31
v_mfma_f32_16x16x32_bf16 v[112:115],v[144:147],v[188:191],v[112:115]
v_cvt_pk_bf16_f32 v42,v24,v25
v_cvt_pk_bf16_f32 v43,v26,v27
v_add_f32 v28,1.0,v28
v_mfma_f32_16x16x32_bf16 v[116:119],v[148:151],v[188:191],v[116:119]
s_waitcnt lgkmcnt(0)
ds_read_b64_tr_b16 v[176:177],v215 offset:8192
v_mfma_f32_16x16x32_bf16 v[0:3],v[160:163],a[0:3],0
buffer_store_dwordx4 v[40:43],v212,s[24:27],s87 offen sc1
ds_read_b64_tr_b16 v[178:179],v215 offset:12288
v_mfma_f32_16x16x32_bf16 v[4:7],v[160:163],a[4:7],0
ds_read_b64_tr_b16 v[180:181],v216 offset:8192
v_add_f32 v29,1.0,v29
v_mfma_f32_16x16x32_bf16 v[8:11],v[160:163],a[8:11],0
ds_read_b64_tr_b16 v[182:183],v216 offset:12288
v_add_f32 v30,1.0,v30
v_mfma_f32_16x16x32_bf16 v[12:15],v[160:163],a[12:15],0
ds_read_b64_tr_b16 v[184:185],v215 offset:9216
v_rcp_f32 v28,v28
v_mfma_f32_16x16x32_bf16 v[16:19],v[164:167],a[0:3],0
ds_read_b64_tr_b16 v[186:187],v215 offset:13312
v_add_f32 v31,1.0,v31
v_mfma_f32_16x16x32_bf16 v[20:23],v[164:167],a[4:7],0
ds_read_b64_tr_b16 v[188:189],v216 offset:9216
v_rcp_f32 v29,v29
v_rcp_f32 v30,v30
v_rcp_f32 v31,v31
v_mfma_f32_16x16x32_bf16 v[24:27],v[164:167],a[8:11],0
ds_read_b64_tr_b16 v[190:191],v216 offset:13312
v_mul_f32 v28,v28,v60
v_mul_f32 v29,v29,v61
v_mul_f32 v30,v30,v62
v_mul_f32 v31,v31,v63
v_cvt_pk_bf16_f32 v46,v28,v29
v_cvt_pk_bf16_f32 v47,v30,v31
v_mfma_f32_16x16x32_bf16 v[28:31],v[164:167],a[12:15],0
ds_read_b128 v[228:231],v248 offset:0
s_lshl_b32 s100,s45,3
v_mfma_f32_16x16x32_bf16 v[32:35],v[168:171],a[0:3],0
ds_read_b128 v[232:235],v248 offset:64
v_add_u32 v250,s89,v250
v_mfma_f32_16x16x32_bf16 v[36:39],v[168:171],a[4:7],0
buffer_store_dwordx4 v[44:47],v212,s[24:27],s87 offen offset:1024 sc1
s_xor_b32 s89,s45,1
v_mfma_f32_16x16x32_bf16 v[40:43],v[168:171],a[8:11],0
s_mul_i32 s89,s89,3072
s_add_u32 s89,s89,143360
v_mfma_f32_16x16x32_bf16 v[44:47],v[168:171],a[12:15],0
v_lshlrev_b32 v244,3,v226
v_add_u32 v244,162304,v244
v_mfma_f32_16x16x32_bf16 v[48:51],v[172:175],a[0:3],0
v_cndmask_b32 v250,v244,v250,vcc
v_add_u32 v236,s88,v212
v_mfma_f32_16x16x32_bf16 v[52:55],v[172:175],a[4:7],0
s_xor_b32 s91,s45,2
s_mul_i32 s91,s91,3072
v_mfma_f32_16x16x32_bf16 v[56:59],v[172:175],a[8:11],0
s_waitcnt lgkmcnt(0)
v_mul_f32 v112,v228,v112
v_mfma_f32_16x16x32_bf16 v[60:63],v[172:175],a[12:15],0
v_mul_f32 v113,v229,v113
v_mfma_f32_16x16x32_bf16 v[0:3],v[176:179],a[16:19],v[0:3]
s_waitcnt vmcnt(15)
s_barrier
v_mfma_f32_16x16x32_bf16 v[4:7],v[176:179],a[20:23],v[4:7]
ds_read_b64_tr_b16 v[160:161],v215 offset:20480
v_mul_f32 v114,v230,v114
v_mfma_f32_16x16x32_bf16 v[8:11],v[176:179],a[24:27],v[8:11]
ds_read_b64_tr_b16 v[162:163],v215 offset:24576
v_mul_f32 v115,v231,v115
v_mfma_f32_16x16x32_bf16 v[12:15],v[176:179],a[28:31],v[12:15]
ds_read_b64_tr_b16 v[164:165],v216 offset:20480
v_mul_f32 v240,0x3fb8aa3b,v112
v_mfma_f32_16x16x32_bf16 v[16:19],v[180:183],a[16:19],v[16:19]
ds_read_b64_tr_b16 v[166:167],v216 offset:24576
v_mul_f32 v241,0x3fb8aa3b,v113
v_mfma_f32_16x16x32_bf16 v[20:23],v[180:183],a[20:23],v[20:23]
buffer_load_dwordx4 v214,s[12:15],s53 offen offset:1024 lds
s_add_u32 m0,s84,20480
v_mfma_f32_16x16x32_bf16 v[24:27],v[180:183],a[24:27],v[24:27]
ds_read_b64_tr_b16 v[168:169],v215 offset:21504
v_mul_f32 v242,0x3fb8aa3b,v114
v_mfma_f32_16x16x32_bf16 v[28:31],v[180:183],a[28:31],v[28:31]
ds_read_b64_tr_b16 v[170:171],v215 offset:25600
v_mul_f32 v243,0x3fb8aa3b,v115
v_mfma_f32_16x16x32_bf16 v[32:35],v[184:187],a[16:19],v[32:35]
ds_read_b64_tr_b16 v[172:173],v216 offset:21504
v_cvt_pk_bf16_f32 v96,v112,v113
v_mfma_f32_16x16x32_bf16 v[36:39],v[184:187],a[20:23],v[36:39]
buffer_load_dwordx4 v213,s[8:11],s54 offen lds
ds_read_b64_tr_b16 v[174:175],v216 offset:25600
v_mfma_f32_16x16x32_bf16 v[40:43],v[184:187],a[24:27],v[40:43]
v_exp_f32 v240,v240 clamp
v_mfma_f32_16x16x32_bf16 v[44:47],v[184:187],a[28:31],v[44:47]
v_exp_f32 v241,v241 clamp
v_mfma_f32_16x16x32_bf16 v[48:51],v[188:191],a[16:19],v[48:51]
v_exp_f32 v242,v242 clamp
v_mfma_f32_16x16x32_bf16 v[52:55],v[188:191],a[20:23],v[52:55]
v_exp_f32 v243,v243 clamp
v_mfma_f32_16x16x32_bf16 v[56:59],v[188:191],a[24:27],v[56:59]
buffer_load_dwordx4 v213,s[12:15],s54 offen offset:1024 lds
s_add_u32 m0,s84,28672
v_mfma_f32_16x16x32_bf16 v[60:63],v[188:191],a[28:31],v[60:63]
s_waitcnt lgkmcnt(0)
ds_read_b64_tr_b16 v[176:177],v215 offset:28672
v_mfma_f32_16x16x32_bf16 v[0:3],v[160:163],a[32:35],v[0:3]
ds_read_b64_tr_b16 v[178:179],v215 offset:32768
v_cvt_pk_bf16_f32 v97,v114,v115
v_mfma_f32_16x16x32_bf16 v[4:7],v[160:163],a[36:39],v[4:7]
ds_read_b64_tr_b16 v[180:181],v216 offset:28672
v_max_f32 v112,0,v112
v_mfma_f32_16x16x32_bf16 v[8:11],v[160:163],a[40:43],v[8:11]
buffer_load_dwordx4 v214,s[8:11],s54 offen lds
ds_read_b64_tr_b16 v[182:183],v216 offset:32768
v_mfma_f32_16x16x32_bf16 v[12:15],v[160:163],a[44:47],v[12:15]
ds_read_b64_tr_b16 v[184:185],v215 offset:29696
v_add_f32 v112,0x358637bd,v112
v_mfma_f32_16x16x32_bf16 v[16:19],v[164:167],a[32:35],v[16:19]
ds_read_b64_tr_b16 v[186:187],v215 offset:33792
v_add_f32 v112,v112,v240
v_mfma_f32_16x16x32_bf16 v[20:23],v[164:167],a[36:39],v[20:23]
ds_read_b64_tr_b16 v[188:189],v216 offset:29696
v_max_f32 v113,0,v113
v_mfma_f32_16x16x32_bf16 v[24:27],v[164:167],a[40:43],v[24:27]
buffer_load_dwordx4 v214,s[12:15],s54 offen offset:1024 lds
s_add_u32 m0,s84,40960
v_mfma_f32_16x16x32_bf16 v[28:31],v[164:167],a[44:47],v[28:31]
ds_read_b64_tr_b16 v[190:191],v216 offset:33792
v_add_f32 v113,0x358637bd,v113
v_mfma_f32_16x16x32_bf16 v[32:35],v[168:171],a[32:35],v[32:35]
v_add_f32 v113,v113,v241
v_max_f32 v114,0,v114
v_mfma_f32_16x16x32_bf16 v[36:39],v[168:171],a[36:39],v[36:39]
v_add_f32 v114,0x358637bd,v114
v_add_f32 v114,v114,v242
v_mfma_f32_16x16x32_bf16 v[40:43],v[168:171],a[40:43],v[40:43]
v_max_f32 v115,0,v115
v_add_f32 v115,0x358637bd,v115
v_mfma_f32_16x16x32_bf16 v[44:47],v[168:171],a[44:47],v[44:47]
buffer_load_dwordx4 v213,s[8:11],s55 offen lds
v_add_f32 v115,v115,v243
v_mfma_f32_16x16x32_bf16 v[48:51],v[172:175],a[32:35],v[48:51]
v_mul_f32 v116,v232,v116
v_mul_f32 v117,v233,v117
v_mfma_f32_16x16x32_bf16 v[52:55],v[172:175],a[36:39],v[52:55]
v_mul_f32 v118,v234,v118
v_mul_f32 v119,v235,v119
v_mfma_f32_16x16x32_bf16 v[56:59],v[172:175],a[40:43],v[56:59]
v_mul_f32 v240,0x3fb8aa3b,v116
v_mul_f32 v241,0x3fb8aa3b,v117
v_mfma_f32_16x16x32_bf16 v[60:63],v[172:175],a[44:47],v[60:63]
s_getpc_b64 s[0:1]
L_cp2_4:
v_min_u32 v254,L_stop_4-L_cp2_4,v253
global_load_dword v255,v254,s[0:1]
s_waitcnt lgkmcnt(0)
v_mfma_f32_16x16x32_bf16 v[0:3],v[176:179],a[48:51],v[0:3]
ds_read_b64_tr_b16 v[160:161],v215 offset:40960
v_mul_f32 v242,0x3fb8aa3b,v118
v_mfma_f32_16x16x32_bf16 v[4:7],v[176:179],a[52:55],v[4:7]
buffer_load_dwordx4 v213,s[12:15],s55 offen offset:1024 lds
s_add_u32 m0,s84,49152
v_mfma_f32_16x16x32_bf16 v[8:11],v[176:179],a[56:59],v[8:11]
ds_read_b64_tr_b16 v[162:163],v215 offset:45056
v_mul_f32 v243,0x3fb8aa3b,v119
v_mfma_f32_16x16x32_bf16 v[12:15],v[176:179],a[60:63],v[12:15]
ds_read_b64_tr_b16 v[164:165],v216 offset:40960
v_cvt_pk_bf16_f32 v112,v112,v113
v_mfma_f32_16x16x32_bf16 v[16:19],v[180:183],a[48:51],v[16:19]
ds_read_b64_tr_b16 v[166:167],v216 offset:45056
v_cvt_pk_bf16_f32 v113,v114,v115
v_mfma_f32_16x16x32_bf16 v[20:23],v[180:183],a[52:55],v[20:23]
buffer_load_dwordx4 v214,s[8:11],s55 offen lds
ds_read_b64_tr_b16 v[168:169],v215 offset:41984
v_mfma_f32_16x16x32_bf16 v[24:27],v[180:183],a[56:59],v[24:27]
ds_read_b64_tr_b16 v[170:171],v215 offset:46080
v_cvt_pk_bf16_f32 v98,v116,v117
v_mfma_f32_16x16x32_bf16 v[28:31],v[180:183],a[60:63],v[28:31]
ds_read_b64_tr_b16 v[172:173],v216 offset:41984
v_cvt_pk_bf16_f32 v99,v118,v119
v_mfma_f32_16x16x32_bf16 v[32:35],v[184:187],a[48:51],v[32:35]
ds_read_b64_tr_b16 v[174:175],v216 offset:46080
v_max_f32 v116,0,v116
v_mfma_f32_16x16x32_bf16 v[36:39],v[184:187],a[52:55],v[36:39]
v_exp_f32 v240,v240 clamp
v_mfma_f32_16x16x32_bf16 v[40:43],v[184:187],a[56:59],v[40:43]
buffer_load_dwordx4 v214,s[12:15],s55 offen offset:1024 lds
v_add_f32 v116,0x358637bd,v116
v_mfma_f32_16x16x32_bf16 v[44:47],v[184:187],a[60:63],v[44:47]
v_exp_f32 v241,v241 clamp
v_mfma_f32_16x16x32_bf16 v[48:51],v[188:191],a[48:51],v[48:51]
v_exp_f32 v242,v242 clamp
v_mfma_f32_16x16x32_bf16 v[52:55],v[188:191],a[52:55],v[52:55]
v_exp_f32 v243,v243 clamp
v_mfma_f32_16x16x32_bf16 v[56:59],v[188:191],a[56:59],v[56:59]
v_add_f32 v116,v116,v240
v_max_f32 v117,0,v117
v_mfma_f32_16x16x32_bf16 v[60:63],v[188:191],a[60:63],v[60:63]
s_waitcnt lgkmcnt(0)
ds_read_b64_tr_b16 v[176:177],v215 offset:49152
v_mfma_f32_16x16x32_bf16 v[0:3],v[160:163],a[64:67],v[0:3]
ds_read_b64_tr_b16 v[178:179],v215 offset:53248
v_add_f32 v117,0x358637bd,v117
v_mfma_f32_16x16x32_bf16 v[4:7],v[160:163],a[68:71],v[4:7]
ds_read_b64_tr_b16 v[180:181],v216 offset:49152
v_add_f32 v117,v117,v241
v_mfma_f32_16x16x32_bf16 v[8:11],v[160:163],a[72:75],v[8:11]
ds_read_b64_tr_b16 v[182:183],v216 offset:53248
v_max_f32 v118,0,v118
v_mfma_f32_16x16x32_bf16 v[12:15],v[160:163],a[76:79],v[12:15]
ds_read_b64_tr_b16 v[184:185],v215 offset:50176
v_add_f32 v118,0x358637bd,v118
v_mfma_f32_16x16x32_bf16 v[16:19],v[164:167],a[64:67],v[16:19]
ds_read_b64_tr_b16 v[186:187],v215 offset:54272
v_subrev_u32 v215,40960,v215
v_mfma_f32_16x16x32_bf16 v[20:23],v[164:167],a[68:71],v[20:23]
ds_read_b64_tr_b16 v[188:189],v216 offset:50176
v_add_f32 v118,v118,v242
v_mfma_f32_16x16x32_bf16 v[24:27],v[164:167],a[72:75],v[24:27]
ds_read_b64_tr_b16 v[190:191],v216 offset:54272
v_subrev_u32 v216,40960,v216
v_mfma_f32_16x16x32_bf16 v[28:31],v[164:167],a[76:79],v[28:31]
v_max_f32 v119,0,v119
v_add_f32 v119,0x358637bd,v119
v_mfma_f32_16x16x32_bf16 v[32:35],v[168:171],a[64:67],v[32:35]
s_add_u32 m0,s84,61440
v_add_f32 v119,v119,v243
v_mfma_f32_16x16x32_bf16 v[36:39],v[168:171],a[68:71],v[36:39]
v_cvt_pk_bf16_f32 v114,v116,v117
v_cvt_pk_bf16_f32 v115,v118,v119
v_mfma_f32_16x16x32_bf16 v[40:43],v[168:171],a[72:75],v[40:43]
ds_write_b128 v236,v[112:115] offset:0
s_add_u32 s91,s91,143360
v_mfma_f32_16x16x32_bf16 v[44:47],v[168:171],a[76:79],v[44:47]
ds_write_b128 v236,v[96:99] offset:1024
s_lshl_b32 s16,s41,1
v_mfma_f32_16x16x32_bf16 v[48:51],v[172:175],a[64:67],v[48:51]
ds_write_b64 v250,v[112:113] offset:0
s_add_u32 s16,s16,s47
v_mfma_f32_16x16x32_bf16 v[52:55],v[172:175],a[68:71],v[52:55]
ds_write_b64 v250,v[114:115] offset:128
s_lshl_b32 s16,s16,4
v_mfma_f32_16x16x32_bf16 v[56:59],v[172:175],a[72:75],v[56:59]
s_add_u32 s16,s16,s40
s_lshl_b32 s16,s16,10
v_mfma_f32_16x16x32_bf16 v[60:63],v[172:175],a[76:79],v[60:63]
s_waitcnt lgkmcnt(4)
s_add_u32 s16,s16,131072
v_mfma_f32_16x16x32_bf16 v[0:3],v[176:179],a[80:83],v[0:3]
s_waitcnt vmcnt(16)
s_barrier
v_mfma_f32_16x16x32_bf16 v[4:7],v[176:179],a[84:87],v[4:7]
buffer_load_dwordx4 v213,s[8:11],s56 offen lds
ds_read_b64_tr_b16 v[160:161],v215 offset:0
v_mfma_f32_16x16x32_bf16 v[8:11],v[176:179],a[88:91],v[8:11]
buffer_load_dwordx4 v213,s[12:15],s56 offen offset:1024 lds
s_add_u32 m0,s84,69632
v_mfma_f32_16x16x32_bf16 v[12:15],v[176:179],a[92:95],v[12:15]
ds_read_b64_tr_b16 v[162:163],v215 offset:4096
s_lshl_b32 s17,s46,31
v_mfma_f32_16x16x32_bf16 v[16:19],v[180:183],a[80:83],v[16:19]
ds_read_b64_tr_b16 v[164:165],v216 offset:0
v_add_u32 v237,s89,v212
v_mfma_f32_16x16x32_bf16 v[20:23],v[180:183],a[84:87],v[20:23]
s_mul_i32 s89,s45,3072
s_add_u32 s89,s89,143360
v_mfma_f32_16x16x32_bf16 v[24:27],v[180:183],a[88:91],v[24:27]
ds_read_b64_tr_b16 v[166:167],v216 offset:4096
v_lshrrev_b32 v227,3,v226
v_mfma_f32_16x16x32_bf16 v[28:31],v[180:183],a[92:95],v[28:31]
buffer_load_dwordx4 v214,s[8:11],s56 offen lds
ds_read_b64_tr_b16 v[168:169],v215 offset:1024
v_mfma_f32_16x16x32_bf16 v[32:35],v[184:187],a[80:83],v[32:35]
s_add_u32 s8,s8,128
s_addc_u32 s9,s9,0
s_sub_u32 s10,s10,128
v_mfma_f32_16x16x32_bf16 v[36:39],v[184:187],a[84:87],v[36:39]
ds_read_b64_tr_b16 v[170:171],v215 offset:5120
v_add_u32 v227,s100,v227
v_mfma_f32_16x16x32_bf16 v[40:43],v[184:187],a[88:91],v[40:43]
ds_read_b64_tr_b16 v[172:173],v216 offset:1024
s_lshl_b32 s100,s45,4
v_mfma_f32_16x16x32_bf16 v[44:47],v[184:187],a[92:95],v[44:47]
buffer_load_dwordx4 v214,s[12:15],s56 offen offset:1024 lds
s_add_u32 m0,s84,81920
ds_read_b64_tr_b16 v[174:175],v216 offset:5120
v_mfma_f32_16x16x32_bf16 v[48:51],v[188:191],a[80:83],v[48:51]
s_add_u32 s12,s12,128
s_addc_u32 s13,s13,0
s_sub_u32 s14,s14,128
v_mfma_f32_16x16x32_bf16 v[52:55],v[188:191],a[84:87],v[52:55]
v_mul_u32_u24 v227,1152,v227
v_and_b32 v219,7,v226
v_mfma_f32_16x16x32_bf16 v[56:59],v[188:191],a[88:91],v[56:59]
v_xor_b32 v247,v247,v219
v_lshl_add_u32 v227,v247,4,v227
v_mfma_f32_16x16x32_bf16 v[60:63],v[188:191],a[92:95],v[60:63]
buffer_load_dwordx4 v213,s[8:11],s48 offen lds
s_waitcnt lgkmcnt(0)
v_mfma_f32_16x16x32_bf16 v[0:3],v[160:163],a[96:99],v[0:3]
ds_read_b64_tr_b16 v[176:177],v215 offset:8192
v_add_u32 v219,1024,v227
v_mfma_f32_16x16x32_bf16 v[4:7],v[160:163],a[100:103],v[4:7]
ds_read_b64_tr_b16 v[178:179],v215 offset:12288
v_add_u32 v220,128,v227
v_mfma_f32_16x16x32_bf16 v[8:11],v[160:163],a[104:107],v[8:11]
ds_read_b64_tr_b16 v[180:181],v216 offset:8192
v_add_u32 v221,37888,v227
v_mfma_f32_16x16x32_bf16 v[12:15],v[160:163],a[108:111],v[12:15]
buffer_load_dwordx4 v213,s[12:15],s48 offen offset:1024 lds
s_add_u32 m0,s84,90112
v_mfma_f32_16x16x32_bf16 v[16:19],v[164:167],a[96:99],v[16:19]
ds_read_b64_tr_b16 v[182:183],v216 offset:12288
v_add_u32 v222,36992,v227
v_mfma_f32_16x16x32_bf16 v[20:23],v[164:167],a[100:103],v[20:23]
ds_read_b64_tr_b16 v[184:185],v215 offset:9216
v_lshrrev_b32 v227,2,v226
v_mfma_f32_16x16x32_bf16 v[24:27],v[164:167],a[104:107],v[24:27]
ds_read_b64_tr_b16 v[186:187],v215 offset:13312
v_add_u32 v215,102400,v215
v_mfma_f32_16x16x32_bf16 v[28:31],v[164:167],a[108:111],v[28:31]
ds_read_b64_tr_b16 v[188:189],v216 offset:9216
v_add_u32 v227,s100,v227
v_mfma_f32_16x16x32_bf16 v[32:35],v[168:171],a[96:99],v[32:35]
buffer_load_dwordx4 v214,s[8:11],s48 offen lds
ds_read_b64_tr_b16 v[190:191],v216 offset:13312
v_mfma_f32_16x16x32_bf16 v[36:39],v[168:171],a[100:103],v[36:39]
v_add_u32 v216,102400,v216
s_mul_i32 s100,s43,-320
v_mfma_f32_16x16x32_bf16 v[40:43],v[168:171],a[104:107],v[40:43]
s_add_u32 s100,s100,1600
v_mul_u32_u24 v227,1152,v227
v_mfma_f32_16x16x32_bf16 v[44:47],v[168:171],a[108:111],v[44:47]
v_bfe_u32 v247,v226,4,1
v_lshlrev_b32 v247,1,v247
v_mfma_f32_16x16x32_bf16 v[48:51],v[172:175],a[96:99],v[48:51]
buffer_load_dwordx4 v214,s[12:15],s48 offen offset:1024 lds
v_and_b32 v223,3,v226
v_mfma_f32_16x16x32_bf16 v[52:55],v[172:175],a[100:103],v[52:55]
v_xor_b32 v247,v247,v223
v_lshl_add_u32 v227,v247,4,v227
v_mfma_f32_16x16x32_bf16 v[56:59],v[172:175],a[104:107],v[56:59]
v_add_u32 v223,s100,v227
s_add_u32 s86,s86,s85
v_mfma_f32_16x16x32_bf16 v[60:63],v[172:175],a[108:111],v[60:63]
s_waitcnt lgkmcnt(0)
ds_read_b64_tr_b16 v[160:161],v215 offset:0
v_mfma_f32_16x16x32_bf16 v[0:3],v[176:179],a[112:115],v[0:3]
ds_read_b64_tr_b16 v[162:163],v215 offset:4096
s_mov_b32 s19,0x358637bd
v_mfma_f32_16x16x32_bf16 v[4:7],v[176:179],a[116:119],v[4:7]
ds_read_b64_tr_b16 v[164:165],v216 offset:0
v_xor_b32 v249,128,v248
v_mfma_f32_16x16x32_bf16 v[8:11],v[176:179],a[120:123],v[8:11]
ds_read_b64_tr_b16 v[166:167],v216 offset:4096
v_fma_f32 v64,v228,v64,s19
v_mfma_f32_16x16x32_bf16 v[12:15],v[176:179],a[124:127],v[12:15]
ds_read_b64_tr_b16 v[168:169],v215 offset:1024
v_mul_f32 v80,v228,v80
v_mfma_f32_16x16x32_bf16 v[16:19],v[180:183],a[112:115],v[16:19]
ds_read_b64_tr_b16 v[170:171],v215 offset:5120
v_fma_f32 v65,v229,v65,s19
v_mfma_f32_16x16x32_bf16 v[20:23],v[180:183],a[116:119],v[20:23]
ds_read_b64_tr_b16 v[172:173],v216 offset:1024
v_mul_f32 v81,v229,v81
v_mfma_f32_16x16x32_bf16 v[24:27],v[180:183],a[120:123],v[24:27]
ds_read_b64_tr_b16 v[174:175],v216 offset:5120
v_fma_f32 v66,v230,v66,s19
v_mfma_f32_16x16x32_bf16 v[28:31],v[180:183],a[124:127],v[28:31]
v_mul_f32 v82,v230,v82
v_fma_f32 v67,v231,v67,s19
v_mfma_f32_16x16x32_bf16 v[32:35],v[184:187],a[112:115],v[32:35]
v_mul_f32 v83,v231,v83
ds_read_b128 v[228:231],v249 offset:0
v_mfma_f32_16x16x32_bf16 v[36:39],v[184:187],a[116:119],v[36:39]
v_fma_f32 v68,v232,v68,s19
v_mul_f32 v84,v232,v84
v_mfma_f32_16x16x32_bf16 v[40:43],v[184:187],a[120:123],v[40:43]
v_fma_f32 v69,v233,v69,s19
v_mul_f32 v85,v233,v85
v_mfma_f32_16x16x32_bf16 v[44:47],v[184:187],a[124:127],v[44:47]
v_fma_f32 v70,v234,v70,s19
v_mul_f32 v86,v234,v86
v_mfma_f32_16x16x32_bf16 v[48:51],v[188:191],a[112:115],v[48:51]
v_fma_f32 v71,v235,v71,s19
v_mul_f32 v87,v235,v87
v_mfma_f32_16x16x32_bf16 v[52:55],v[188:191],a[116:119],v[52:55]
ds_read_b128 v[232:235],v249 offset:64
v_mul_f32 v240,0x3fb8aa3b,v64
v_mfma_f32_16x16x32_bf16 v[56:59],v[188:191],a[120:123],v[56:59]
v_exp_f32 v240,v240 clamp
v_mfma_f32_16x16x32_bf16 v[60:63],v[188:191],a[124:127],v[60:63]
s_waitcnt lgkmcnt(2)
ds_read_b64_tr_b16 v[176:177],v215 offset:8192
v_mfma_f32_16x16x32_bf16 v[0:3],v[160:163],a[128:131],v[0:3]
ds_read_b64_tr_b16 v[178:179],v215 offset:12288
v_mul_f32 v241,0x3fb8aa3b,v65
v_mfma_f32_16x16x32_bf16 v[4:7],v[160:163],a[132:135],v[4:7]
ds_read_b64_tr_b16 v[180:181],v216 offset:8192
v_mul_f32 v242,0x3fb8aa3b,v66
v_mfma_f32_16x16x32_bf16 v[8:11],v[160:163],a[136:139],v[8:11]
ds_read_b64_tr_b16 v[182:183],v216 offset:12288
v_mul_f32 v243,0x3fb8aa3b,v67
v_mfma_f32_16x16x32_bf16 v[12:15],v[160:163],a[140:143],v[12:15]
ds_read_b64_tr_b16 v[184:185],v215 offset:9216
v_max_f32 v64,s19,v64
v_mfma_f32_16x16x32_bf16 v[16:19],v[164:167],a[128:131],v[16:19]
ds_read_b64_tr_b16 v[186:187],v215 offset:13312
v_add_f32 v64,v64,v240
v_mfma_f32_16x16x32_bf16 v[20:23],v[164:167],a[132:135],v[20:23]
ds_read_b64_tr_b16 v[188:189],v216 offset:9216
v_max_f32 v65,s19,v65
v_mfma_f32_16x16x32_bf16 v[24:27],v[164:167],a[136:139],v[24:27]
ds_read_b64_tr_b16 v[190:191],v216 offset:13312
v_max_f32 v66,s19,v66
v_mfma_f32_16x16x32_bf16 v[28:31],v[164:167],a[140:143],v[28:31]
v_exp_f32 v241,v241 clamp
v_mfma_f32_16x16x32_bf16 v[32:35],v[168:171],a[128:131],v[32:35]
s_add_u32 m0,s84,0
v_add_f32 v65,v65,v241
v_mfma_f32_16x16x32_bf16 v[36:39],v[168:171],a[132:135],v[36:39]
v_exp_f32 v242,v242 clamp
v_mfma_f32_16x16x32_bf16 v[40:43],v[168:171],a[136:139],v[40:43]
v_exp_f32 v243,v243 clamp
v_mfma_f32_16x16x32_bf16 v[44:47],v[168:171],a[140:143],v[44:47]
v_add_f32 v66,v66,v242
v_max_f32 v67,s19,v67
v_mfma_f32_16x16x32_bf16 v[48:51],v[172:175],a[128:131],v[48:51]
v_add_f32 v67,v67,v243
v_mul_f32 v240,0x3fb8aa3b,v68
v_mfma_f32_16x16x32_bf16 v[52:55],v[172:175],a[132:135],v[52:55]
v_exp_f32 v240,v240 clamp
v_mfma_f32_16x16x32_bf16 v[56:59],v[172:175],a[136:139],v[56:59]
v_mul_f32 v241,0x3fb8aa3b,v69
v_mul_f32 v242,0x3fb8aa3b,v70
v_mfma_f32_16x16x32_bf16 v[60:63],v[172:175],a[140:143],v[60:63]
s_waitcnt lgkmcnt(0)
v_mul_f32 v243,0x3fb8aa3b,v71
v_mfma_f32_16x16x32_bf16 v[0:3],v[176:179],a[144:147],v[0:3]
s_waitcnt vmcnt(13)
s_barrier
v_mfma_f32_16x16x32_bf16 v[4:7],v[176:179],a[148:151],v[4:7]
buffer_load_dwordx4 v213,s[8:11],s49 offen lds
ds_read_b128 v[120:123],v237 offset:0
v_mfma_f32_16x16x32_bf16 v[8:11],v[176:179],a[152:155],v[8:11]
buffer_load_dwordx4 v213,s[12:15],s49 offen offset:1024 lds
s_add_u32 m0,s84,8192
v_mfma_f32_16x16x32_bf16 v[12:15],v[176:179],a[156:159],v[12:15]
ds_read_b128 v[100:103],v237 offset:1024
v_cvt_pk_bf16_f32 v64,v64,v65
v_mfma_f32_16x16x32_bf16 v[16:19],v[180:183],a[144:147],v[16:19]
ds_read_b64_tr_b16 v[160:161],v215 offset:20480
v_cvt_pk_bf16_f32 v65,v66,v67
v_mfma_f32_16x16x32_bf16 v[20:23],v[180:183],a[148:151],v[20:23]
ds_read_b64_tr_b16 v[162:163],v215 offset:24576
v_cvt_pk_bf16_f32 v80,v80,v81
v_mfma_f32_16x16x32_bf16 v[24:27],v[180:183],a[152:155],v[24:27]
ds_read_b64_tr_b16 v[164:165],v216 offset:20480
v_cvt_pk_bf16_f32 v81,v82,v83
v_mfma_f32_16x16x32_bf16 v[28:31],v[180:183],a[156:159],v[28:31]
buffer_load_dwordx4 v214,s[8:11],s49 offen lds
ds_read_b64_tr_b16 v[166:167],v216 offset:24576
v_mfma_f32_16x16x32_bf16 v[32:35],v[184:187],a[144:147],v[32:35]
ds_read_b64_tr_b16 v[168:169],v215 offset:21504
v_max_f32 v68,s19,v68
v_mfma_f32_16x16x32_bf16 v[36:39],v[184:187],a[148:151],v[36:39]
ds_read_b64_tr_b16 v[170:171],v215 offset:25600
v_add_f32 v68,v68,v240
v_mfma_f32_16x16x32_bf16 v[40:43],v[184:187],a[152:155],v[40:43]
ds_read_b64_tr_b16 v[172:173],v216 offset:21504
v_max_f32 v69,s19,v69
v_mfma_f32_16x16x32_bf16 v[44:47],v[184:187],a[156:159],v[44:47]
buffer_load_dwordx4 v214,s[12:15],s49 offen offset:1024 lds
s_add_u32 m0,s84,102400
ds_read_b64_tr_b16 v[174:175],v216 offset:25600
v_mfma_f32_16x16x32_bf16 v[48:51],v[188:191],a[144:147],v[48:51]
v_exp_f32 v241,v241 clamp
v_mfma_f32_16x16x32_bf16 v[52:55],v[188:191],a[148:151],v[52:55]
v_exp_f32 v242,v242 clamp
v_mfma_f32_16x16x32_bf16 v[56:59],v[188:191],a[152:155],v[56:59]
v_exp_f32 v243,v243 clamp
v_mfma_f32_16x16x32_bf16 v[60:63],v[188:191],a[156:159],v[60:63]
buffer_load_dwordx4 v213,s[8:11],s50 offen lds
s_waitcnt lgkmcnt(0)
v_mfma_f32_16x16x32_bf16 v[0:3],v[160:163],a[160:163],v[0:3]
ds_read_b64_tr_b16 v[176:177],v215 offset:28672
v_add_f32 v69,v69,v241
v_mfma_f32_16x16x32_bf16 v[4:7],v[160:163],a[164:167],v[4:7]
ds_read_b64_tr_b16 v[178:179],v215 offset:32768
v_max_f32 v70,s19,v70
v_mfma_f32_16x16x32_bf16 v[8:11],v[160:163],a[168:171],v[8:11]
ds_read_b64_tr_b16 v[180:181],v216 offset:28672
v_add_f32 v70,v70,v242
v_mfma_f32_16x16x32_bf16 v[12:15],v[160:163],a[172:175],v[12:15]
ds_read_b64_tr_b16 v[182:183],v216 offset:32768
v_max_f32 v71,s19,v71
v_mfma_f32_16x16x32_bf16 v[16:19],v[164:167],a[160:163],v[16:19]
buffer_load_dwordx4 v213,s[12:15],s50 offen offset:1024 lds
s_add_u32 m0,s84,110592
v_mfma_f32_16x16x32_bf16 v[20:23],v[164:167],a[164:167],v[20:23]
ds_read_b64_tr_b16 v[184:185],v215 offset:29696
v_add_f32 v71,v71,v243
v_mfma_f32_16x16x32_bf16 v[24:27],v[164:167],a[168:171],v[24:27]
ds_read_b64_tr_b16 v[186:187],v215 offset:33792
v_subrev_u32 v215,81920,v215
v_mfma_f32_16x16x32_bf16 v[28:31],v[164:167],a[172:175],v[28:31]
ds_read_b64_tr_b16 v[188:189],v216 offset:29696
v_cvt_pk_bf16_f32 v66,v68,v69
v_mfma_f32_16x16x32_bf16 v[32:35],v[168:171],a[160:163],v[32:35]
buffer_load_dwordx4 v214,s[8:11],s50 offen lds
ds_read_b64_tr_b16 v[190:191],v216 offset:33792
v_mfma_f32_16x16x32_bf16 v[36:39],v[168:171],a[164:167],v[36:39]
v_subrev_u32 v216,81920,v216
v_cvt_pk_bf16_f32 v67,v70,v71
v_mfma_f32_16x16x32_bf16 v[40:43],v[168:171],a[168:171],v[40:43]
v_cvt_pk_bf16_f32 v82,v84,v85
v_cvt_pk_bf16_f32 v83,v86,v87
v_mfma_f32_16x16x32_bf16 v[44:47],v[168:171],a[172:175],v[44:47]
v_fma_f32 v72,v228,v72,s19
v_mfma_f32_16x16x32_bf16 v[48:51],v[172:175],a[160:163],v[48:51]
buffer_load_dwordx4 v214,s[12:15],s50 offen offset:1024 lds
v_mul_f32 v88,v228,v88
v_mfma_f32_16x16x32_bf16 v[52:55],v[172:175],a[164:167],v[52:55]
v_fma_f32 v73,v229,v73,s19
v_mul_f32 v89,v229,v89
v_mfma_f32_16x16x32_bf16 v[56:59],v[172:175],a[168:171],v[56:59]
v_fma_f32 v74,v230,v74,s19
v_mul_f32 v90,v230,v90
v_mfma_f32_16x16x32_bf16 v[60:63],v[172:175],a[172:175],v[60:63]
s_waitcnt lgkmcnt(0)
ds_read_b64_tr_b16 v[160:161],v215 offset:0
v_mfma_f32_16x16x32_bf16 v[0:3],v[176:179],a[176:179],v[0:3]
ds_read_b64_tr_b16 v[162:163],v215 offset:4096
v_fma_f32 v75,v231,v75,s19
v_mfma_f32_16x16x32_bf16 v[4:7],v[176:179],a[180:183],v[4:7]
ds_read_b64_tr_b16 v[164:165],v216 offset:0
v_mul_f32 v91,v231,v91
v_mfma_f32_16x16x32_bf16 v[8:11],v[176:179],a[184:187],v[8:11]
ds_read_b64_tr_b16 v[166:167],v216 offset:4096
v_mfma_f32_16x16x32_bf16 v[12:15],v[176:179],a[188:191],v[12:15]
ds_read_b64_tr_b16 v[168:169],v215 offset:1024
v_cndmask_b32 v96,v96,v238,s[94:95]
v_mfma_f32_16x16x32_bf16 v[16:19],v[180:183],a[176:179],v[16:19]
ds_read_b64_tr_b16 v[170:171],v215 offset:5120
v_cndmask_b32 v97,v97,v238,s[94:95]
v_mfma_f32_16x16x32_bf16 v[20:23],v[180:183],a[180:183],v[20:23]
ds_read_b64_tr_b16 v[172:173],v216 offset:1024
v_cndmask_b32 v98,v98,v238,s[94:95]
v_mfma_f32_16x16x32_bf16 v[24:27],v[180:183],a[184:187],v[24:27]
ds_read_b64_tr_b16 v[174:175],v216 offset:5120
v_cndmask_b32 v99,v99,v238,s[94:95]
v_mfma_f32_16x16x32_bf16 v[28:31],v[180:183],a[188:191],v[28:31]
v_mul_f32 v240,0x3fb8aa3b,v72
v_mul_f32 v241,0x3fb8aa3b,v73
v_mfma_f32_16x16x32_bf16 v[32:35],v[184:187],a[176:179],v[32:35]
v_exp_f32 v240,v240 clamp
v_mfma_f32_16x16x32_bf16 v[36:39],v[184:187],a[180:183],v[36:39]
v_exp_f32 v241,v241 clamp
v_mfma_f32_16x16x32_bf16 v[40:43],v[184:187],a[184:187],v[40:43]
v_mul_f32 v242,0x3fb8aa3b,v74
v_mul_f32 v243,0x3fb8aa3b,v75
v_mfma_f32_16x16x32_bf16 v[44:47],v[184:187],a[188:191],v[44:47]
v_exp_f32 v242,v242 clamp
v_mfma_f32_16x16x32_bf16 v[48:51],v[188:191],a[176:179],v[48:51]
v_exp_f32 v243,v243 clamp
v_mfma_f32_16x16x32_bf16 v[52:55],v[188:191],a[180:183],v[52:55]
v_fma_f32 v76,v232,v76,s19
v_mfma_f32_16x16x32_bf16 v[56:59],v[188:191],a[184:187],v[56:59]
v_mul_f32 v92,v232,v92
v_fma_f32 v77,v233,v77,s19
v_mfma_f32_16x16x32_bf16 v[60:63],v[188:191],a[188:191],v[60:63]
s_waitcnt lgkmcnt(0)
ds_read_b64_tr_b16 v[176:177],v215 offset:8192
v_mfma_f32_16x16x32_bf16 v[0:3],v[160:163],a[192:195],v[0:3]
ds_read_b64_tr_b16 v[178:179],v215 offset:12288
v_mul_f32 v93,v233,v93
v_mfma_f32_16x16x32_bf16 v[4:7],v[160:163],a[196:199],v[4:7]
ds_read_b64_tr_b16 v[180:181],v216 offset:8192
v_fma_f32 v78,v234,v78,s19
v_mfma_f32_16x16x32_bf16 v[8:11],v[160:163],a[200:203],v[8:11]
ds_read_b64_tr_b16 v[182:183],v216 offset:12288
v_mul_f32 v94,v234,v94
v_mfma_f32_16x16x32_bf16 v[12:15],v[160:163],a[204:207],v[12:15]
ds_read_b64_tr_b16 v[184:185],v215 offset:9216
v_fma_f32 v79,v235,v79,s19
v_mfma_f32_16x16x32_bf16 v[16:19],v[164:167],a[192:195],v[16:19]
ds_read_b64_tr_b16 v[186:187],v215 offset:13312
v_mul_f32 v95,v235,v95
v_mfma_f32_16x16x32_bf16 v[20:23],v[164:167],a[196:199],v[20:23]
ds_read_b64_tr_b16 v[188:189],v216 offset:9216
v_max_f32 v72,s19,v72
v_mfma_f32_16x16x32_bf16 v[24:27],v[164:167],a[200:203],v[24:27]
ds_read_b64_tr_b16 v[190:191],v216 offset:13312
v_add_f32 v72,v72,v240
v_mfma_f32_16x16x32_bf16 v[28:31],v[164:167],a[204:207],v[28:31]
v_max_f32 v73,s19,v73
v_add_f32 v73,v73,v241
v_mfma_f32_16x16x32_bf16 v[32:35],v[168:171],a[192:195],v[32:35]
s_add_u32 m0,s84,122880
v_max_f32 v74,s19,v74
v_mfma_f32_16x16x32_bf16 v[36:39],v[168:171],a[196:199],v[36:39]
v_add_f32 v74,v74,v242
v_max_f32 v75,s19,v75
v_mfma_f32_16x16x32_bf16 v[40:43],v[168:171],a[200:203],v[40:43]
v_add_f32 v75,v75,v243
v_mul_f32 v240,0x3fb8aa3b,v76
v_mfma_f32_16x16x32_bf16 v[44:47],v[168:171],a[204:207],v[44:47]
v_exp_f32 v240,v240 clamp
v_mfma_f32_16x16x32_bf16 v[48:51],v[172:175],a[192:195],v[48:51]
v_mul_f32 v241,0x3fb8aa3b,v77
v_mul_f32 v242,0x3fb8aa3b,v78
v_mfma_f32_16x16x32_bf16 v[52:55],v[172:175],a[196:199],v[52:55]
v_exp_f32 v241,v241 clamp
v_mfma_f32_16x16x32_bf16 v[56:59],v[172:175],a[200:203],v[56:59]
v_exp_f32 v242,v242 clamp
v_mfma_f32_16x16x32_bf16 v[60:63],v[172:175],a[204:207],v[60:63]
s_waitcnt lgkmcnt(0)
v_mul_f32 v243,0x3fb8aa3b,v79
v_mfma_f32_16x16x32_bf16 v[0:3],v[176:179],a[208:211],v[0:3]
s_waitcnt vmcnt(12)
s_barrier
v_mfma_f32_16x16x32_bf16 v[4:7],v[176:179],a[212:215],v[4:7]
buffer_load_dwordx4 v213,s[8:11],s51 offen lds
ds_read_b64_tr_b16 v[160:161],v215 offset:20480
v_mfma_f32_16x16x32_bf16 v[8:11],v[176:179],a[216:219],v[8:11]
buffer_load_dwordx4 v213,s[12:15],s51 offen offset:1024 lds
s_add_u32 m0,s84,131072
v_mfma_f32_16x16x32_bf16 v[12:15],v[176:179],a[220:223],v[12:15]
ds_read_b64_tr_b16 v[162:163],v215 offset:24576
v_cndmask_b32 v100,v100,v238,s[94:95]
v_mfma_f32_16x16x32_bf16 v[16:19],v[180:183],a[208:211],v[16:19]
ds_read_b64_tr_b16 v[164:165],v216 offset:20480
v_cndmask_b32 v101,v101,v238,s[94:95]
v_mfma_f32_16x16x32_bf16 v[20:23],v[180:183],a[212:215],v[20:23]
ds_read_b64_tr_b16 v[166:167],v216 offset:24576
v_cndmask_b32 v102,v102,v238,s[94:95]
v_mfma_f32_16x16x32_bf16 v[24:27],v[180:183],a[216:219],v[24:27]
ds_read_b64_tr_b16 v[168:169],v215 offset:21504
v_cndmask_b32 v103,v103,v238,s[94:95]
v_mfma_f32_16x16x32_bf16 v[28:31],v[180:183],a[220:223],v[28:31]
buffer_load_dwordx4 v214,s[8:11],s51 offen lds
ds_read_b64_tr_b16 v[170:171],v215 offset:25600
v_mfma_f32_16x16x32_bf16 v[32:35],v[184:187],a[208:211],v[32:35]
ds_read_b64_tr_b16 v[172:173],v216 offset:21504
s_add_u32 s87,s87,s85
v_mfma_f32_16x16x32_bf16 v[36:39],v[184:187],a[212:215],v[36:39]
ds_read_b64_tr_b16 v[174:175],v216 offset:25600
v_cvt_pk_bf16_f32 v72,v72,v73
v_mfma_f32_16x16x32_bf16 v[40:43],v[184:187],a[216:219],v[40:43]
v_exp_f32 v243,v243 clamp
v_mfma_f32_16x16x32_bf16 v[44:47],v[184:187],a[220:223],v[44:47]
buffer_load_dwordx4 v214,s[12:15],s51 offen offset:1024 lds
s_add_u32 m0,s84,20480
v_mfma_f32_16x16x32_bf16 v[48:51],v[188:191],a[208:211],v[48:51]
v_cvt_pk_bf16_f32 v73,v74,v75
v_cvt_pk_bf16_f32 v88,v88,v89
v_mfma_f32_16x16x32_bf16 v[52:55],v[188:191],a[212:215],v[52:55]
v_cvt_pk_bf16_f32 v89,v90,v91
v_max_f32 v76,s19,v76
v_mfma_f32_16x16x32_bf16 v[56:59],v[188:191],a[216:219],v[56:59]
v_add_f32 v76,v76,v240
v_max_f32 v77,s19,v77
v_mfma_f32_16x16x32_bf16 v[60:63],v[188:191],a[220:223],v[60:63]
buffer_load_dwordx4 v213,s[8:11],s52 offen lds
s_waitcnt lgkmcnt(0)
v_mfma_f32_16x16x32_bf16 v[0:3],v[160:163],a[224:227],v[0:3]
ds_read_b64_tr_b16 v[176:177],v215 offset:28672
v_add_f32 v77,v77,v241
v_mfma_f32_16x16x32_bf16 v[4:7],v[160:163],a[228:231],v[4:7]
ds_read_b64_tr_b16 v[178:179],v215 offset:32768
v_max_f32 v78,s19,v78
v_mfma_f32_16x16x32_bf16 v[8:11],v[160:163],a[232:235],v[8:11]
ds_read_b64_tr_b16 v[180:181],v216 offset:28672
v_add_f32 v78,v78,v242
v_mfma_f32_16x16x32_bf16 v[12:15],v[160:163],a[236:239],v[12:15]
ds_read_b64_tr_b16 v[182:183],v216 offset:32768
v_max_f32 v79,s19,v79
v_mfma_f32_16x16x32_bf16 v[16:19],v[164:167],a[224:227],v[16:19]
buffer_load_dwordx4 v213,s[12:15],s52 offen offset:1024 lds
s_add_u32 m0,s84,28672
v_mfma_f32_16x16x32_bf16 v[20:23],v[164:167],a[228:231],v[20:23]
ds_read_b64_tr_b16 v[184:185],v215 offset:29696
v_add_f32 v79,v79,v243
v_mfma_f32_16x16x32_bf16 v[24:27],v[164:167],a[232:235],v[24:27]
ds_read_b64_tr_b16 v[186:187],v215 offset:33792
v_cvt_pk_bf16_f32 v74,v76,v77
v_mfma_f32_16x16x32_bf16 v[28:31],v[164:167],a[236:239],v[28:31]
ds_read_b64_tr_b16 v[188:189],v216 offset:29696
v_cvt_pk_bf16_f32 v75,v78,v79
v_mfma_f32_16x16x32_bf16 v[32:35],v[168:171],a[224:227],v[32:35]
buffer_load_dwordx4 v214,s[8:11],s52 offen lds
ds_read_b64_tr_b16 v[190:191],v216 offset:33792
v_mfma_f32_16x16x32_bf16 v[36:39],v[168:171],a[228:231],v[36:39]
v_cvt_pk_bf16_f32 v90,v92,v93
v_cvt_pk_bf16_f32 v91,v94,v95
v_mfma_f32_16x16x32_bf16 v[40:43],v[168:171],a[232:235],v[40:43]
v_add_u32 v245,s89,v212
v_add_u32 v246,s91,v212
v_mfma_f32_16x16x32_bf16 v[44:47],v[168:171],a[236:239],v[44:47]
s_lshr_b32 s62,s61,3
s_add_u32 s62,s62,1048576
v_mfma_f32_16x16x32_bf16 v[48:51],v[172:175],a[224:227],v[48:51]
buffer_load_dwordx4 v214,s[12:15],s52 offen offset:1024 lds
s_and_b32 s66,s66,0xff
v_mfma_f32_16x16x32_bf16 v[52:55],v[172:175],a[228:231],v[52:55]
s_lshl_b32 s66,s66,14
s_add_u32 s61,s61,131072
v_mfma_f32_16x16x32_bf16 v[56:59],v[172:175],a[232:235],v[56:59]
s_and_b32 s67,s67,0xff
s_lshl_b32 s67,s67,14
v_mfma_f32_16x16x32_bf16 v[60:63],v[172:175],a[236:239],v[60:63]
s_waitcnt lgkmcnt(0)
ds_read_b64_tr_b16 v[160:161],v215 offset:40960
v_mfma_f32_16x16x32_bf16 v[0:3],v[176:179],a[240:243],v[0:3]
ds_read_b64_tr_b16 v[162:163],v215 offset:45056
s_and_b32 s68,s68,0xff
v_mfma_f32_16x16x32_bf16 v[4:7],v[176:179],a[244:247],v[4:7]
ds_read_b64_tr_b16 v[164:165],v216 offset:40960
s_lshl_b32 s68,s68,14
v_mfma_f32_16x16x32_bf16 v[8:11],v[176:179],a[248:251],v[8:11]
ds_read_b64_tr_b16 v[166:167],v216 offset:45056
s_mul_i32 s88,s45,3072
v_mfma_f32_16x16x32_bf16 v[12:15],v[176:179],a[252:255],v[12:15]
ds_read_b64_tr_b16 v[168:169],v215 offset:41984
s_add_u32 s88,s88,143360
v_mfma_f32_16x16x32_bf16 v[16:19],v[180:183],a[240:243],v[16:19]
ds_read_b64_tr_b16 v[170:171],v215 offset:46080
s_and_b32 s69,s69,0xff
v_mfma_f32_16x16x32_bf16 v[20:23],v[180:183],a[244:247],v[20:23]
ds_read_b64_tr_b16 v[172:173],v216 offset:41984
s_lshl_b32 s69,s69,14
v_mfma_f32_16x16x32_bf16 v[24:27],v[180:183],a[248:251],v[24:27]
ds_read_b64_tr_b16 v[174:175],v216 offset:46080
s_and_b32 s70,s70,0xff
v_mfma_f32_16x16x32_bf16 v[28:31],v[180:183],a[252:255],v[28:31]
s_lshl_b32 s70,s70,14
v_mul_f32 v244,0xbf317218,v208
v_mfma_f32_16x16x32_bf16 v[32:35],v[184:187],a[240:243],v[32:35]
v_fma_f32 v192,v244,v192,s19
v_mul_f32 v249,0x3fb8aa3b,v192
v_mfma_f32_16x16x32_bf16 v[36:39],v[184:187],a[244:247],v[36:39]
v_exp_f32 v249,v249 clamp
v_mfma_f32_16x16x32_bf16 v[40:43],v[184:187],a[248:251],v[40:43]
v_max_f32 v192,s19,v192
v_add_f32 v192,v192,v249
v_mfma_f32_16x16x32_bf16 v[44:47],v[184:187],a[252:255],v[44:47]
v_fma_f32 v194,v244,v194,s19
v_mul_f32 v249,0x3fb8aa3b,v194
v_mfma_f32_16x16x32_bf16 v[48:51],v[188:191],a[240:243],v[48:51]
v_exp_f32 v249,v249 clamp
v_mfma_f32_16x16x32_bf16 v[52:55],v[188:191],a[244:247],v[52:55]
v_fma_f32 v193,v244,v193,s19
v_max_f32 v194,s19,v194
v_mfma_f32_16x16x32_bf16 v[56:59],v[188:191],a[248:251],v[56:59]
v_add_f32 v194,v194,v249
v_fma_f32 v195,v244,v195,s19
v_mfma_f32_16x16x32_bf16 v[60:63],v[188:191],a[252:255],v[60:63]
v_mul_f32 v244,0xbf317218,v209
v_fma_f32 v196,v244,v196,s19
v_mfma_f32_16x16x32_bf16 v[228:231],v[64:67],v[80:83],0
v_mul_f32 v249,0x3fb8aa3b,v196
v_max_f32 v196,s19,v196
v_mfma_f32_16x16x32_bf16 v[232:235],v[64:67],v[96:99],0
v_exp_f32 v249,v249 clamp
v_mfma_f32_16x16x32_bf16 v[236:239],v[112:115],v[80:83],0
v_add_f32 v196,v196,v249
v_fma_f32 v198,v244,v198,s19
v_mfma_f32_16x16x32_bf16 v[240:243],v[112:115],v[96:99],0
v_mul_f32 v249,0x3fb8aa3b,v198
v_fma_f32 v197,v244,v197,s19
v_mfma_f32_16x16x32_bf16 v[228:231],v[72:75],v[88:91],v[228:231]
v_exp_f32 v249,v249 clamp
v_mfma_f32_16x16x32_bf16 v[232:235],v[72:75],v[100:103],v[232:235]
v_max_f32 v198,s19,v198
v_add_f32 v198,v198,v249
v_mfma_f32_16x16x32_bf16 v[236:239],v[120:123],v[88:91],v[236:239]
v_fma_f32 v199,v244,v199,s19
v_mul_f32 v244,0xbf317218,v210
v_mfma_f32_16x16x32_bf16 v[240:243],v[120:123],v[100:103],v[240:243]
s_waitcnt lgkmcnt(0)
ds_read_b64_tr_b16 v[176:177],v215 offset:49152
v_mfma_f32_16x16x32_bf16 v[0:3],v[160:163],v[128:131],v[0:3]
ds_read_b64_tr_b16 v[178:179],v215 offset:53248
v_fma_f32 v200,v244,v200,s19
v_mfma_f32_16x16x32_bf16 v[4:7],v[160:163],v[132:135],v[4:7]
ds_read_b64_tr_b16 v[180:181],v216 offset:49152
v_cndmask_b32 v236,v236,v238,s[92:93]
v_mfma_f32_16x16x32_bf16 v[8:11],v[160:163],v[136:139],v[8:11]
ds_read_b64_tr_b16 v[182:183],v216 offset:53248
v_cndmask_b32 v237,v237,v239,s[92:93]
v_mfma_f32_16x16x32_bf16 v[12:15],v[160:163],v[140:143],v[12:15]
ds_read_b64_tr_b16 v[184:185],v215 offset:50176
v_cndmask_b32 v238,v240,v242,s[92:93]
v_mfma_f32_16x16x32_bf16 v[16:19],v[164:167],v[128:131],v[16:19]
ds_read_b64_tr_b16 v[186:187],v215 offset:54272
v_add_u32 v215,61440,v215
v_mfma_f32_16x16x32_bf16 v[20:23],v[164:167],v[132:135],v[20:23]
ds_read_b64_tr_b16 v[188:189],v216 offset:50176
v_cndmask_b32 v239,v241,v243,s[92:93]
v_mfma_f32_16x16x32_bf16 v[24:27],v[164:167],v[136:139],v[24:27]
ds_read_b64_tr_b16 v[190:191],v216 offset:54272
v_add_u32 v216,61440,v216
v_mfma_f32_16x16x32_bf16 v[28:31],v[164:167],v[140:143],v[28:31]
ds_write_b128 v245,v[228:231] offset:0
v_mul_f32 v249,0x3fb8aa3b,v200
v_mfma_f32_16x16x32_bf16 v[32:35],v[168:171],v[128:131],v[32:35]
s_add_u32 m0,s84,40960
ds_write_b128 v245,v[232:235] offset:1024
v_mfma_f32_16x16x32_bf16 v[36:39],v[168:171],v[132:135],v[36:39]
ds_write_b128 v245,v[236:239] offset:2048
v_or_b32 v245,s17,v212
v_mfma_f32_16x16x32_bf16 v[40:43],v[168:171],v[136:139],v[40:43]
v_exp_f32 v249,v249 clamp
v_mfma_f32_16x16x32_bf16 v[44:47],v[168:171],v[140:143],v[44:47]
v_mul_f32 v250,0x3fb8aa3b,v193
v_max_f32 v200,s19,v200
v_mfma_f32_16x16x32_bf16 v[48:51],v[172:175],v[128:131],v[48:51]
v_exp_f32 v250,v250 clamp
v_mfma_f32_16x16x32_bf16 v[52:55],v[172:175],v[132:135],v[52:55]
v_add_f32 v200,v200,v249
v_fma_f32 v202,v244,v202,s19
v_mfma_f32_16x16x32_bf16 v[56:59],v[172:175],v[136:139],v[56:59]
v_mul_f32 v249,0x3fb8aa3b,v202
v_max_f32 v193,s19,v193
v_mfma_f32_16x16x32_bf16 v[60:63],v[172:175],v[140:143],v[60:63]
s_waitcnt lgkmcnt(3)
v_add_f32 v193,v193,v250
v_mfma_f32_16x16x32_bf16 v[0:3],v[176:179],v[144:147],v[0:3]
s_waitcnt vmcnt(12) lgkmcnt(0)
s_barrier
v_mfma_f32_16x16x32_bf16 v[4:7],v[176:179],v[148:151],v[4:7]
buffer_load_dwordx4 v213,s[8:11],s53 offen lds
ds_read_b64_tr_b16 v[160:161],v215 offset:0
v_mfma_f32_16x16x32_bf16 v[8:11],v[176:179],v[152:155],v[8:11]
buffer_load_dwordx4 v213,s[12:15],s53 offen offset:1024 lds
s_add_u32 m0,s84,49152
v_mfma_f32_16x16x32_bf16 v[12:15],v[176:179],v[156:159],v[12:15]
ds_read_b64_tr_b16 v[162:163],v215 offset:4096
v_mul_f32 v0,v208,v0
v_mfma_f32_16x16x32_bf16 v[16:19],v[180:183],v[144:147],v[16:19]
ds_read_b64_tr_b16 v[164:165],v216 offset:0
v_mul_f32 v1,v208,v1
v_mfma_f32_16x16x32_bf16 v[20:23],v[180:183],v[148:151],v[20:23]
ds_read_b64_tr_b16 v[166:167],v216 offset:4096
v_mul_f32 v2,v208,v2
v_mfma_f32_16x16x32_bf16 v[24:27],v[180:183],v[152:155],v[24:27]
ds_read_b64_tr_b16 v[168:169],v215 offset:1024
v_mul_f32 v3,v208,v3
v_mfma_f32_16x16x32_bf16 v[28:31],v[180:183],v[156:159],v[28:31]
buffer_load_dwordx4 v214,s[8:11],s53 offen lds
ds_read_b64_tr_b16 v[170:171],v215 offset:5120
v_mfma_f32_16x16x32_bf16 v[32:35],v[184:187],v[144:147],v[32:35]
ds_read_b64_tr_b16 v[172:173],v216 offset:1024
v_mul_f32 v16,v208,v16
v_mfma_f32_16x16x32_bf16 v[36:39],v[184:187],v[148:151],v[36:39]
ds_read_b64_tr_b16 v[174:175],v216 offset:5120
v_mul_f32 v17,v208,v17
v_mfma_f32_16x16x32_bf16 v[40:43],v[184:187],v[152:155],v[40:43]
ds_read_b128 v[240:243],v246 offset:0
v_mul_f32 v18,v208,v18
v_mfma_f32_16x16x32_bf16 v[44:47],v[184:187],v[156:159],v[44:47]
buffer_load_dwordx4 v214,s[12:15],s53 offen offset:1024 lds
s_add_u32 m0,s84,61440
v_mfma_f32_16x16x32_bf16 v[48:51],v[188:191],v[144:147],v[48:51]
v_exp_f32 v0,v0
v_mfma_f32_16x16x32_bf16 v[52:55],v[188:191],v[148:151],v[52:55]
v_exp_f32 v1,v1
v_mfma_f32_16x16x32_bf16 v[56:59],v[188:191],v[152:155],v[56:59]
v_exp_f32 v2,v2
v_mfma_f32_16x16x32_bf16 v[60:63],v[188:191],v[156:159],v[60:63]
buffer_load_dwordx4 v213,s[8:11],s54 offen lds
s_waitcnt lgkmcnt(1)
v_mfma_f32_16x16x32_bf16 v[64:67],v[160:163],a[0:3],0
ds_read_b64_tr_b16 v[176:177],v215 offset:8192
s_waitcnt lgkmcnt(1)
v_mfma_f32_16x16x32_bf16 v[68:71],v[160:163],a[4:7],0
ds_read_b64_tr_b16 v[178:179],v215 offset:12288
v_and_b32 v227,15,v226
v_mfma_f32_16x16x32_bf16 v[72:75],v[160:163],a[8:11],0
ds_read_b64_tr_b16 v[180:181],v216 offset:8192
v_mul_u32_u24 v227,4,v227
v_mfma_f32_16x16x32_bf16 v[76:79],v[160:163],a[12:15],0
ds_read_b64_tr_b16 v[182:183],v216 offset:12288
v_add_f32 v228,v228,v240
v_mfma_f32_16x16x32_bf16 v[80:83],v[164:167],a[0:3],0
buffer_load_dwordx4 v213,s[12:15],s54 offen offset:1024 lds
s_add_u32 m0,s84,69632
v_mfma_f32_16x16x32_bf16 v[84:87],v[164:167],a[4:7],0
ds_read_b64_tr_b16 v[184:185],v215 offset:9216
v_add_f32 v229,v229,v241
v_mfma_f32_16x16x32_bf16 v[88:91],v[164:167],a[8:11],0
ds_read_b64_tr_b16 v[186:187],v215 offset:13312
v_subrev_u32 v215,81920,v215
v_mfma_f32_16x16x32_bf16 v[92:95],v[164:167],a[12:15],0
ds_read_b64_tr_b16 v[188:189],v216 offset:9216
v_add_f32 v230,v230,v242
v_mfma_f32_16x16x32_bf16 v[96:99],v[168:171],a[0:3],0
buffer_load_dwordx4 v214,s[8:11],s54 offen lds
ds_read_b64_tr_b16 v[190:191],v216 offset:13312
v_mfma_f32_16x16x32_bf16 v[100:103],v[168:171],a[4:7],0
v_subrev_u32 v216,81920,v216
v_add_f32 v231,v231,v243
v_mfma_f32_16x16x32_bf16 v[104:107],v[168:171],a[8:11],0
ds_read_b128 v[240:243],v246 offset:1024
v_cvt_pk_bf16_f32 v228,v228,v229
v_mfma_f32_16x16x32_bf16 v[108:111],v[168:171],a[12:15],0
v_cvt_pk_bf16_f32 v229,v230,v231
v_mul_f32 v19,v208,v19
v_mfma_f32_16x16x32_bf16 v[112:115],v[172:175],a[0:3],0
buffer_load_dwordx4 v214,s[12:15],s54 offen offset:1024 lds
v_add_f32 v0,1.0,v0
v_mfma_f32_16x16x32_bf16 v[116:119],v[172:175],a[4:7],0
v_exp_f32 v3,v3
v_mfma_f32_16x16x32_bf16 v[120:123],v[172:175],a[8:11],0
v_exp_f32 v16,v16
v_mfma_f32_16x16x32_bf16 v[124:127],v[172:175],a[12:15],0
s_waitcnt lgkmcnt(1)
ds_read_b64_tr_b16 v[160:161],v215 offset:0
v_mfma_f32_16x16x32_bf16 v[64:67],v[176:179],a[16:19],v[64:67]
ds_read_b64_tr_b16 v[162:163],v215 offset:4096
s_waitcnt lgkmcnt(2)
v_mfma_f32_16x16x32_bf16 v[68:71],v[176:179],a[20:23],v[68:71]
ds_read_b64_tr_b16 v[164:165],v216 offset:0
v_add_f32 v232,v232,v240
v_mfma_f32_16x16x32_bf16 v[72:75],v[176:179],a[24:27],v[72:75]
ds_read_b64_tr_b16 v[166:167],v216 offset:4096
v_add_f32 v233,v233,v241
v_mfma_f32_16x16x32_bf16 v[76:79],v[176:179],a[28:31],v[76:79]
ds_read_b64_tr_b16 v[168:169],v215 offset:1024
v_add_f32 v234,v234,v242
v_mfma_f32_16x16x32_bf16 v[80:83],v[180:183],a[16:19],v[80:83]
ds_read_b64_tr_b16 v[170:171],v215 offset:5120
v_add_f32 v235,v235,v243
v_mfma_f32_16x16x32_bf16 v[84:87],v[180:183],a[20:23],v[84:87]
ds_read_b64_tr_b16 v[172:173],v216 offset:1024
v_cvt_pk_bf16_f32 v230,v232,v233
v_mfma_f32_16x16x32_bf16 v[88:91],v[180:183],a[24:27],v[88:91]
ds_read_b64_tr_b16 v[174:175],v216 offset:5120
v_cvt_pk_bf16_f32 v231,v234,v235
v_mfma_f32_16x16x32_bf16 v[92:95],v[180:183],a[28:31],v[92:95]
buffer_store_dwordx4 v[228:231],v245,s[24:27],s16 offen sc1
ds_read_b128 v[240:243],v246 offset:2048
v_mfma_f32_16x16x32_bf16 v[96:99],v[184:187],a[16:19],v[96:99]
v_lshrrev_b32 v246,4,v226
v_min_u32 v246,1,v246
v_mfma_f32_16x16x32_bf16 v[100:103],v[184:187],a[20:23],v[100:103]
v_lshlrev_b32 v246,31,v246
v_lshl_or_b32 v246,v226,3,v246
v_mfma_f32_16x16x32_bf16 v[104:107],v[184:187],a[24:27],v[104:107]
v_or_b32 v246,s17,v246
s_lshr_b32 s17,s16,3
v_mfma_f32_16x16x32_bf16 v[108:111],v[184:187],a[28:31],v[108:111]
s_add_u32 s17,s17,1032192
v_add_f32 v1,1.0,v1
v_mfma_f32_16x16x32_bf16 v[112:115],v[188:191],a[16:19],v[112:115]
v_exp_f32 v17,v17
v_mfma_f32_16x16x32_bf16 v[116:119],v[188:191],a[20:23],v[116:119]
s_waitcnt lgkmcnt(0)
v_add_f32 v236,v236,v240
v_mfma_f32_16x16x32_bf16 v[120:123],v[188:191],a[24:27],v[120:123]
v_add_f32 v237,v237,v241
v_add_f32 v238,v238,v242
v_mfma_f32_16x16x32_bf16 v[124:127],v[188:191],a[28:31],v[124:127]
ds_read_b64_tr_b16 v[176:177],v215 offset:8192
v_mfma_f32_16x16x32_bf16 v[64:67],v[160:163],a[32:35],v[64:67]
ds_read_b64_tr_b16 v[178:179],v215 offset:12288
buffer_load_dword v247,v227,s[32:35],0 offen sc1
v_mfma_f32_16x16x32_bf16 v[68:71],v[160:163],a[36:39],v[68:71]
ds_read_b64_tr_b16 v[180:181],v216 offset:8192
v_add_f32 v239,v239,v243
v_mfma_f32_16x16x32_bf16 v[72:75],v[160:163],a[40:43],v[72:75]
ds_read_b64_tr_b16 v[182:183],v216 offset:12288
v_cvt_pk_bf16_f32 v232,v236,v237
v_mfma_f32_16x16x32_bf16 v[76:79],v[160:163],a[44:47],v[76:79]
ds_read_b64_tr_b16 v[184:185],v215 offset:9216
v_cvt_pk_bf16_f32 v233,v238,v239
v_mfma_f32_16x16x32_bf16 v[80:83],v[164:167],a[32:35],v[80:83]
buffer_store_dwordx2 v[232:233],v246,s[24:27],s17 offen sc1
ds_read_b64_tr_b16 v[186:187],v215 offset:13312
v_mfma_f32_16x16x32_bf16 v[84:87],v[164:167],a[36:39],v[84:87]
v_add_u32 v215,102400,v215
ds_read_b64_tr_b16 v[188:189],v216 offset:9216
v_mfma_f32_16x16x32_bf16 v[88:91],v[164:167],a[40:43],v[88:91]
ds_read_b64_tr_b16 v[190:191],v216 offset:13312
v_add_u32 v216,102400,v216
v_mfma_f32_16x16x32_bf16 v[92:95],v[164:167],a[44:47],v[92:95]
v_exp_f32 v18,v18
v_mfma_f32_16x16x32_bf16 v[96:99],v[168:171],a[32:35],v[96:99]
s_add_u32 m0,s84,81920
v_exp_f32 v19,v19
v_mfma_f32_16x16x32_bf16 v[100:103],v[168:171],a[36:39],v[100:103]
v_rcp_f32 v0,v0
v_add_f32 v2,1.0,v2
v_mfma_f32_16x16x32_bf16 v[104:107],v[168:171],a[40:43],v[104:107]
v_rcp_f32 v1,v1
v_add_f32 v3,1.0,v3
v_mfma_f32_16x16x32_bf16 v[108:111],v[168:171],a[44:47],v[108:111]
v_rcp_f32 v2,v2
v_add_f32 v16,1.0,v16
v_mfma_f32_16x16x32_bf16 v[112:115],v[172:175],a[32:35],v[112:115]
v_rcp_f32 v3,v3
v_add_f32 v17,1.0,v17
v_mfma_f32_16x16x32_bf16 v[116:119],v[172:175],a[36:39],v[116:119]
v_rcp_f32 v16,v16
v_add_f32 v18,1.0,v18
v_mfma_f32_16x16x32_bf16 v[120:123],v[172:175],a[40:43],v[120:123]
v_rcp_f32 v17,v17
v_add_f32 v19,1.0,v19
v_mfma_f32_16x16x32_bf16 v[124:127],v[172:175],a[44:47],v[124:127]
s_getpc_b64 s[0:1]
L_cp3_4:
v_min_u32 v254,L_stop_4-L_cp3_4,v253
global_load_dword v255,v254,s[0:1]
s_waitcnt lgkmcnt(0)
v_mfma_f32_16x16x32_bf16 v[64:67],v[176:179],a[48:51],v[64:67]
s_waitcnt vmcnt(16)
s_barrier
buffer_load_dwordx4 v213,s[8:11],s55 offen lds
v_mfma_f32_16x16x32_bf16 v[68:71],v[176:179],a[52:55],v[68:71]
ds_read_b64_tr_b16 v[160:161],v215 offset:0
v_rcp_f32 v18,v18
v_mfma_f32_16x16x32_bf16 v[72:75],v[176:179],a[56:59],v[72:75]
buffer_load_dwordx4 v213,s[12:15],s55 offen offset:1024 lds
s_add_u32 m0,s84,90112
ds_read_b64_tr_b16 v[162:163],v215 offset:4096
v_mfma_f32_16x16x32_bf16 v[76:79],v[176:179],a[60:63],v[76:79]
ds_read_b64_tr_b16 v[164:165],v216 offset:0
v_rcp_f32 v19,v19
v_mfma_f32_16x16x32_bf16 v[80:83],v[180:183],a[48:51],v[80:83]
ds_read_b64_tr_b16 v[166:167],v216 offset:4096
v_mul_f32 v0,v0,v32
v_mul_f32 v1,v1,v33
v_mfma_f32_16x16x32_bf16 v[84:87],v[180:183],a[52:55],v[84:87]
ds_read_b64_tr_b16 v[168:169],v215 offset:1024
v_mul_f32 v2,v2,v34
v_mul_f32 v3,v3,v35
v_mfma_f32_16x16x32_bf16 v[88:91],v[180:183],a[56:59],v[88:91]
buffer_load_dwordx4 v214,s[8:11],s55 offen lds
ds_read_b64_tr_b16 v[170:171],v215 offset:5120
v_mul_f32 v16,v16,v48
v_mfma_f32_16x16x32_bf16 v[92:95],v[180:183],a[60:63],v[92:95]
ds_read_b64_tr_b16 v[172:173],v216 offset:1024
v_mul_f32 v17,v17,v49
v_mul_f32 v18,v18,v50
v_mfma_f32_16x16x32_bf16 v[96:99],v[184:187],a[48:51],v[96:99]
ds_read_b64_tr_b16 v[174:175],v216 offset:5120
v_mul_f32 v19,v19,v51
v_cvt_pk_bf16_f32 v32,v0,v1
v_mfma_f32_16x16x32_bf16 v[100:103],v[184:187],a[52:55],v[100:103]
v_cvt_pk_bf16_f32 v33,v2,v3
v_cvt_pk_bf16_f32 v34,v16,v17
v_cvt_pk_bf16_f32 v35,v18,v19
v_mfma_f32_16x16x32_bf16 v[104:107],v[184:187],a[56:59],v[104:107]
buffer_load_dwordx4 v214,s[12:15],s55 offen offset:1024 lds
s_add_u32 m0,s84,0
v_mul_f32 v4,v209,v4
v_mfma_f32_16x16x32_bf16 v[108:111],v[184:187],a[60:63],v[108:111]
v_exp_f32 v4,v4
v_mul_f32 v5,v209,v5
v_mfma_f32_16x16x32_bf16 v[112:115],v[188:191],a[48:51],v[112:115]
v_exp_f32 v5,v5
v_mul_f32 v6,v209,v6
v_mfma_f32_16x16x32_bf16 v[116:119],v[188:191],a[52:55],v[116:119]
buffer_store_dwordx4 v[32:35],v212,s[24:27],s86 offen sc1
v_exp_f32 v6,v6
v_mfma_f32_16x16x32_bf16 v[120:123],v[188:191],a[56:59],v[120:123]
v_mul_f32 v7,v209,v7
v_exp_f32 v7,v7
v_mfma_f32_16x16x32_bf16 v[124:127],v[188:191],a[60:63],v[124:127]
s_waitcnt lgkmcnt(0)
ds_read_b64_tr_b16 v[176:177],v215 offset:8192
v_mul_f32 v20,v209,v20
v_mfma_f32_16x16x32_bf16 v[64:67],v[160:163],a[64:67],v[64:67]
ds_read_b64_tr_b16 v[178:179],v215 offset:12288
v_exp_f32 v20,v20
v_mfma_f32_16x16x32_bf16 v[68:71],v[160:163],a[68:71],v[68:71]
ds_read_b64_tr_b16 v[180:181],v216 offset:8192
v_mul_f32 v21,v209,v21
v_mul_f32 v22,v209,v22
v_mfma_f32_16x16x32_bf16 v[72:75],v[160:163],a[72:75],v[72:75]
ds_read_b64_tr_b16 v[182:183],v216 offset:12288
v_exp_f32 v21,v21
v_mfma_f32_16x16x32_bf16 v[76:79],v[160:163],a[76:79],v[76:79]
ds_read_b64_tr_b16 v[184:185],v215 offset:9216
v_exp_f32 v22,v22
v_mfma_f32_16x16x32_bf16 v[80:83],v[164:167],a[64:67],v[80:83]
ds_read_b64_tr_b16 v[186:187],v215 offset:13312
v_mul_f32 v23,v209,v23
v_add_f32 v4,1.0,v4
v_mfma_f32_16x16x32_bf16 v[84:87],v[164:167],a[68:71],v[84:87]
ds_read_b64_tr_b16 v[188:189],v216 offset:9216
v_exp_f32 v23,v23
v_mfma_f32_16x16x32_bf16 v[88:91],v[164:167],a[72:75],v[88:91]
ds_read_b64_tr_b16 v[190:191],v216 offset:13312
v_add_f32 v5,1.0,v5
v_mfma_f32_16x16x32_bf16 v[92:95],v[164:167],a[76:79],v[92:95]
v_rcp_f32 v4,v4
v_mfma_f32_16x16x32_bf16 v[96:99],v[168:171],a[64:67],v[96:99]
buffer_load_dwordx4 v213,s[8:11],s56 offen lds
v_add_f32 v6,1.0,v6
v_mfma_f32_16x16x32_bf16 v[100:103],v[168:171],a[68:71],v[100:103]
v_rcp_f32 v5,v5
v_mfma_f32_16x16x32_bf16 v[104:107],v[168:171],a[72:75],v[104:107]
v_rcp_f32 v6,v6
v_mfma_f32_16x16x32_bf16 v[108:111],v[168:171],a[76:79],v[108:111]
v_add_f32 v7,1.0,v7
v_add_f32 v20,1.0,v20
v_mfma_f32_16x16x32_bf16 v[112:115],v[172:175],a[64:67],v[112:115]
buffer_load_dwordx4 v213,s[12:15],s56 offen offset:1024 lds
s_add_u32 m0,s84,8192
v_mfma_f32_16x16x32_bf16 v[116:119],v[172:175],a[68:71],v[116:119]
v_rcp_f32 v7,v7
v_mfma_f32_16x16x32_bf16 v[120:123],v[172:175],a[72:75],v[120:123]
v_rcp_f32 v20,v20
v_mfma_f32_16x16x32_bf16 v[124:127],v[172:175],a[76:79],v[124:127]
s_waitcnt lgkmcnt(0)
ds_read_b64_tr_b16 v[160:161],v215 offset:20480
v_mfma_f32_16x16x32_bf16 v[64:67],v[176:179],a[80:83],v[64:67]
buffer_load_dwordx4 v214,s[8:11],s56 offen lds
ds_read_b64_tr_b16 v[162:163],v215 offset:24576
v_mfma_f32_16x16x32_bf16 v[68:71],v[176:179],a[84:87],v[68:71]
ds_read_b64_tr_b16 v[164:165],v216 offset:20480
v_add_f32 v21,1.0,v21
v_mfma_f32_16x16x32_bf16 v[72:75],v[176:179],a[88:91],v[72:75]
ds_read_b64_tr_b16 v[166:167],v216 offset:24576
v_add_f32 v22,1.0,v22
v_mfma_f32_16x16x32_bf16 v[76:79],v[176:179],a[92:95],v[76:79]
ds_read_b64_tr_b16 v[168:169],v215 offset:21504
v_add_f32 v23,1.0,v23
v_mfma_f32_16x16x32_bf16 v[80:83],v[180:183],a[80:83],v[80:83]
ds_read_b64_tr_b16 v[170:171],v215 offset:25600
v_mul_f32 v4,v4,v36
v_mfma_f32_16x16x32_bf16 v[84:87],v[180:183],a[84:87],v[84:87]
buffer_load_dwordx4 v214,s[12:15],s56 offen offset:1024 lds
ds_read_b64_tr_b16 v[172:173],v216 offset:21504
v_mfma_f32_16x16x32_bf16 v[88:91],v[180:183],a[88:91],v[88:91]
ds_read_b64_tr_b16 v[174:175],v216 offset:25600
v_mul_f32 v5,v5,v37
v_mfma_f32_16x16x32_bf16 v[92:95],v[180:183],a[92:95],v[92:95]
v_rcp_f32 v21,v21
v_mfma_f32_16x16x32_bf16 v[96:99],v[184:187],a[80:83],v[96:99]
v_rcp_f32 v22,v22
v_mfma_f32_16x16x32_bf16 v[100:103],v[184:187],a[84:87],v[100:103]
v_rcp_f32 v23,v23
v_mfma_f32_16x16x32_bf16 v[104:107],v[184:187],a[88:91],v[104:107]
v_mul_f32 v6,v6,v38
v_mul_f32 v7,v7,v39
v_mfma_f32_16x16x32_bf16 v[108:111],v[184:187],a[92:95],v[108:111]
s_waitcnt vmcnt(11)
v_mul_f32 v20,v20,v52
v_mfma_f32_16x16x32_bf16 v[112:115],v[188:191],a[80:83],v[112:115]
v_cmp_ne_u32 vcc,1,v247
s_cbranch_vccnz L_slow_clr_4
L_back_clr_4:
v_mfma_f32_16x16x32_bf16 v[116:119],v[188:191],a[84:87],v[116:119]
v_mul_f32 v21,v21,v53
v_mul_f32 v22,v22,v54
v_mfma_f32_16x16x32_bf16 v[120:123],v[188:191],a[88:91],v[120:123]
v_mul_f32 v23,v23,v55
v_cvt_pk_bf16_f32 v36,v4,v5
v_mfma_f32_16x16x32_bf16 v[124:127],v[188:191],a[92:95],v[124:127]
s_waitcnt lgkmcnt(0)
ds_read_b64_tr_b16 v[176:177],v215 offset:28672
v_mfma_f32_16x16x32_bf16 v[64:67],v[160:163],a[96:99],v[64:67]
ds_read_b64_tr_b16 v[178:179],v215 offset:32768
v_cvt_pk_bf16_f32 v37,v6,v7
v_mfma_f32_16x16x32_bf16 v[68:71],v[160:163],a[100:103],v[68:71]
ds_read_b64_tr_b16 v[180:181],v216 offset:28672
v_cvt_pk_bf16_f32 v38,v20,v21
v_mfma_f32_16x16x32_bf16 v[72:75],v[160:163],a[104:107],v[72:75]
ds_read_b64_tr_b16 v[182:183],v216 offset:32768
v_cvt_pk_bf16_f32 v39,v22,v23
v_mfma_f32_16x16x32_bf16 v[76:79],v[160:163],a[108:111],v[76:79]
buffer_store_dwordx4 v[36:39],v212,s[24:27],s86 offen offset:1024 sc1
ds_read_b64_tr_b16 v[184:185],v215 offset:29696
v_mfma_f32_16x16x32_bf16 v[80:83],v[164:167],a[96:99],v[80:83]
ds_read_b64_tr_b16 v[186:187],v215 offset:33792
v_subrev_u32 v215,81920,v215
v_mfma_f32_16x16x32_bf16 v[84:87],v[164:167],a[100:103],v[84:87]
ds_read_b64_tr_b16 v[188:189],v216 offset:29696
v_mul_f32 v8,v210,v8
v_mfma_f32_16x16x32_bf16 v[88:91],v[164:167],a[104:107],v[88:91]
ds_read_b64_tr_b16 v[190:191],v216 offset:33792
v_subrev_u32 v216,81920,v216
v_mfma_f32_16x16x32_bf16 v[92:95],v[164:167],a[108:111],v[92:95]
v_exp_f32 v8,v8
v_mfma_f32_16x16x32_bf16 v[96:99],v[168:171],a[96:99],v[96:99]
s_add_u32 m0,s84,102400
v_mul_f32 v9,v210,v9
v_mfma_f32_16x16x32_bf16 v[100:103],v[168:171],a[100:103],v[100:103]
s_mul_i32 s98,s3,-384
s_add_u32 s98,s98,128
s_ashr_i32 s99,s98,31
v_mfma_f32_16x16x32_bf16 v[104:107],v[168:171],a[104:107],v[104:107]
s_add_u32 s8,s8,s98
s_addc_u32 s9,s9,s99
s_sub_u32 s10,s10,s98
v_mfma_f32_16x16x32_bf16 v[108:111],v[168:171],a[108:111],v[108:111]
s_add_u32 s12,s12,s98
s_addc_u32 s13,s13,s99
s_sub_u32 s14,s14,s98
v_mfma_f32_16x16x32_bf16 v[112:115],v[172:175],a[96:99],v[112:115]
v_exp_f32 v9,v9
v_mul_f32 v10,v210,v10
v_mfma_f32_16x16x32_bf16 v[116:119],v[172:175],a[100:103],v[116:119]
v_exp_f32 v10,v10
v_mul_f32 v11,v210,v11
v_mfma_f32_16x16x32_bf16 v[120:123],v[172:175],a[104:107],v[120:123]
v_exp_f32 v11,v11
v_mul_f32 v24,v210,v24
v_mfma_f32_16x16x32_bf16 v[124:127],v[172:175],a[108:111],v[124:127]
s_waitcnt lgkmcnt(0)
v_exp_f32 v24,v24
v_mfma_f32_16x16x32_bf16 v[64:67],v[176:179],a[112:115],v[64:67]
s_barrier
buffer_load_dwordx4 v213,s[8:11],s48 offen lds
v_mfma_f32_16x16x32_bf16 v[68:71],v[176:179],a[116:119],v[68:71]
buffer_load_dwordx4 v213,s[12:15],s48 offen offset:1024 lds
s_add_u32 m0,s84,110592
ds_read_b64_tr_b16 v[160:161],v215 offset:0
v_mfma_f32_16x16x32_bf16 v[72:75],v[176:179],a[120:123],v[72:75]
ds_read_b64_tr_b16 v[162:163],v215 offset:4096
v_mul_f32 v25,v210,v25
v_mul_f32 v26,v210,v26
v_mfma_f32_16x16x32_bf16 v[76:79],v[176:179],a[124:127],v[76:79]
ds_read_b64_tr_b16 v[164:165],v216 offset:0
v_exp_f32 v25,v25
v_mfma_f32_16x16x32_bf16 v[80:83],v[180:183],a[112:115],v[80:83]
ds_read_b64_tr_b16 v[166:167],v216 offset:4096
v_exp_f32 v26,v26
v_mfma_f32_16x16x32_bf16 v[84:87],v[180:183],a[116:119],v[84:87]
buffer_load_dwordx4 v214,s[8:11],s48 offen lds
ds_read_b64_tr_b16 v[168:169],v215 offset:1024
v_mul_f32 v27,v210,v27
v_mfma_f32_16x16x32_bf16 v[88:91],v[180:183],a[120:123],v[88:91]
ds_read_b64_tr_b16 v[170:171],v215 offset:5120
v_exp_f32 v27,v27
v_mfma_f32_16x16x32_bf16 v[92:95],v[180:183],a[124:127],v[92:95]
ds_read_b64_tr_b16 v[172:173],v216 offset:1024
v_add_f32 v8,1.0,v8
v_add_f32 v9,1.0,v9
v_mfma_f32_16x16x32_bf16 v[96:99],v[184:187],a[112:115],v[96:99]
ds_read_b64_tr_b16 v[174:175],v216 offset:5120
v_rcp_f32 v8,v8
v_mfma_f32_16x16x32_bf16 v[100:103],v[184:187],a[116:119],v[100:103]
buffer_load_dwordx4 v214,s[12:15],s48 offen offset:1024 lds
s_add_u32 m0,s84,122880
v_mfma_f32_16x16x32_bf16 v[104:107],v[184:187],a[120:123],v[104:107]
v_rcp_f32 v9,v9
v_mfma_f32_16x16x32_bf16 v[108:111],v[184:187],a[124:127],v[108:111]
v_add_f32 v10,1.0,v10
v_rcp_f32 v10,v10
v_mfma_f32_16x16x32_bf16 v[112:115],v[188:191],a[112:115],v[112:115]
v_add_f32 v11,1.0,v11
v_rcp_f32 v11,v11
v_mfma_f32_16x16x32_bf16 v[116:119],v[188:191],a[116:119],v[116:119]
buffer_load_dwordx4 v213,s[8:11],s49 offen lds
v_add_f32 v24,1.0,v24
v_mfma_f32_16x16x32_bf16 v[120:123],v[188:191],a[120:123],v[120:123]
v_rcp_f32 v24,v24
v_mfma_f32_16x16x32_bf16 v[124:127],v[188:191],a[124:127],v[124:127]
s_waitcnt lgkmcnt(0)
ds_read_b64_tr_b16 v[176:177],v215 offset:8192
v_mfma_f32_16x16x32_bf16 v[64:67],v[160:163],a[128:131],v[64:67]
ds_read_b64_tr_b16 v[178:179],v215 offset:12288
v_add_f32 v25,1.0,v25
v_mfma_f32_16x16x32_bf16 v[68:71],v[160:163],a[132:135],v[68:71]
buffer_load_dwordx4 v213,s[12:15],s49 offen offset:1024 lds
s_add_u32 m0,s84,131072
v_mfma_f32_16x16x32_bf16 v[72:75],v[160:163],a[136:139],v[72:75]
ds_read_b64_tr_b16 v[180:181],v216 offset:8192
v_add_f32 v26,1.0,v26
v_mfma_f32_16x16x32_bf16 v[76:79],v[160:163],a[140:143],v[76:79]
ds_read_b64_tr_b16 v[182:183],v216 offset:12288
v_add_f32 v27,1.0,v27
v_mfma_f32_16x16x32_bf16 v[80:83],v[164:167],a[128:131],v[80:83]
ds_read_b64_tr_b16 v[184:185],v215 offset:9216
v_mul_f32 v8,v8,v40
v_mfma_f32_16x16x32_bf16 v[84:87],v[164:167],a[132:135],v[84:87]
ds_read_b64_tr_b16 v[186:187],v215 offset:13312
v_mul_f32 v9,v9,v41
v_mfma_f32_16x16x32_bf16 v[88:91],v[164:167],a[136:139],v[88:91]
buffer_load_dwordx4 v214,s[8:11],s49 offen lds
ds_read_b64_tr_b16 v[188:189],v216 offset:9216
v_mfma_f32_16x16x32_bf16 v[92:95],v[164:167],a[140:143],v[92:95]
ds_read_b64_tr_b16 v[190:191],v216 offset:13312
v_mul_f32 v10,v10,v42
v_mfma_f32_16x16x32_bf16 v[96:99],v[168:171],a[128:131],v[96:99]
s_lshl_b32 s18,s41,5
s_add_u32 s18,s18,21
v_mfma_f32_16x16x32_bf16 v[100:103],v[168:171],a[132:135],v[100:103]
s_lshl_b32 s18,s18,5
s_add_u32 s18,s18,s40
s_lshl_b32 s18,s18,2
v_mfma_f32_16x16x32_bf16 v[104:107],v[168:171],a[136:139],v[104:107]
buffer_load_dwordx4 v214,s[12:15],s49 offen offset:1024 lds
v_rcp_f32 v25,v25
v_mfma_f32_16x16x32_bf16 v[108:111],v[168:171],a[140:143],v[108:111]
v_rcp_f32 v26,v26
v_mul_f32 v11,v11,v43
v_mfma_f32_16x16x32_bf16 v[112:115],v[172:175],a[128:131],v[112:115]
v_rcp_f32 v27,v27
v_mul_f32 v24,v24,v56
v_mfma_f32_16x16x32_bf16 v[116:119],v[172:175],a[132:135],v[116:119]
v_mul_f32 v25,v25,v57
v_mul_f32 v26,v26,v58
v_mul_f32 v27,v27,v59
v_mfma_f32_16x16x32_bf16 v[120:123],v[172:175],a[136:139],v[120:123]
v_cvt_pk_bf16_f32 v40,v8,v9
v_cvt_pk_bf16_f32 v41,v10,v11
v_cvt_pk_bf16_f32 v42,v24,v25
v_mfma_f32_16x16x32_bf16 v[124:127],v[172:175],a[140:143],v[124:127]
s_waitcnt lgkmcnt(0)
ds_read_b64_tr_b16 v[160:161],v215 offset:20480
v_cvt_pk_bf16_f32 v43,v26,v27
v_mfma_f32_16x16x32_bf16 v[64:67],v[176:179],a[144:147],v[64:67]
buffer_store_dwordx4 v[40:43],v212,s[24:27],s87 offen sc1
ds_read_b64_tr_b16 v[162:163],v215 offset:24576
v_mul_f32 v12,v211,v12
v_mfma_f32_16x16x32_bf16 v[68:71],v[176:179],a[148:151],v[68:71]
ds_read_b64_tr_b16 v[164:165],v216 offset:20480
v_exp_f32 v12,v12
v_mfma_f32_16x16x32_bf16 v[72:75],v[176:179],a[152:155],v[72:75]
ds_read_b64_tr_b16 v[166:167],v216 offset:24576
v_mul_f32 v13,v211,v13
v_mul_f32 v14,v211,v14
v_mfma_f32_16x16x32_bf16 v[76:79],v[176:179],a[156:159],v[76:79]
ds_read_b64_tr_b16 v[168:169],v215 offset:21504
v_exp_f32 v13,v13
v_mfma_f32_16x16x32_bf16 v[80:83],v[180:183],a[144:147],v[80:83]
ds_read_b64_tr_b16 v[170:171],v215 offset:25600
v_exp_f32 v14,v14
v_mfma_f32_16x16x32_bf16 v[84:87],v[180:183],a[148:151],v[84:87]
ds_read_b64_tr_b16 v[172:173],v216 offset:21504
v_mul_f32 v15,v211,v15
v_mul_f32 v28,v211,v28
v_mfma_f32_16x16x32_bf16 v[88:91],v[180:183],a[152:155],v[88:91]
ds_read_b64_tr_b16 v[174:175],v216 offset:25600
v_mul_f32 v29,v211,v29
v_mfma_f32_16x16x32_bf16 v[92:95],v[180:183],a[156:159],v[92:95]
v_exp_f32 v15,v15
v_mfma_f32_16x16x32_bf16 v[96:99],v[184:187],a[144:147],v[96:99]
v_exp_f32 v28,v28
v_mfma_f32_16x16x32_bf16 v[100:103],v[184:187],a[148:151],v[100:103]
v_exp_f32 v29,v29
v_mfma_f32_16x16x32_bf16 v[104:107],v[184:187],a[152:155],v[104:107]
v_mul_f32 v30,v211,v30
v_exp_f32 v30,v30
v_mfma_f32_16x16x32_bf16 v[108:111],v[184:187],a[156:159],v[108:111]
v_mul_f32 v31,v211,v31
v_exp_f32 v31,v31
v_mfma_f32_16x16x32_bf16 v[112:115],v[188:191],a[144:147],v[112:115]
v_add_f32 v12,1.0,v12
v_rcp_f32 v12,v12
v_mfma_f32_16x16x32_bf16 v[116:119],v[188:191],a[148:151],v[116:119]
v_add_f32 v13,1.0,v13
v_rcp_f32 v13,v13
v_mfma_f32_16x16x32_bf16 v[120:123],v[188:191],a[152:155],v[120:123]
v_add_f32 v14,1.0,v14
v_rcp_f32 v14,v14
v_mfma_f32_16x16x32_bf16 v[124:127],v[188:191],a[156:159],v[124:127]
s_waitcnt lgkmcnt(0)
ds_read_b64_tr_b16 v[176:177],v215 offset:28672
v_add_f32 v15,1.0,v15
v_mfma_f32_16x16x32_bf16 v[64:67],v[160:163],a[160:163],v[64:67]
ds_read_b64_tr_b16 v[178:179],v215 offset:32768
v_rcp_f32 v15,v15
v_mfma_f32_16x16x32_bf16 v[68:71],v[160:163],a[164:167],v[68:71]
ds_read_b64_tr_b16 v[180:181],v216 offset:28672
v_add_f32 v28,1.0,v28
v_mfma_f32_16x16x32_bf16 v[72:75],v[160:163],a[168:171],v[72:75]
ds_read_b64_tr_b16 v[182:183],v216 offset:32768
v_rcp_f32 v28,v28
v_mfma_f32_16x16x32_bf16 v[76:79],v[160:163],a[172:175],v[76:79]
ds_read_b64_tr_b16 v[184:185],v215 offset:29696
v_add_f32 v29,1.0,v29
v_add_f32 v30,1.0,v30
v_mfma_f32_16x16x32_bf16 v[80:83],v[164:167],a[160:163],v[80:83]
ds_read_b64_tr_b16 v[186:187],v215 offset:33792
v_rcp_f32 v29,v29
v_mfma_f32_16x16x32_bf16 v[84:87],v[164:167],a[164:167],v[84:87]
ds_read_b64_tr_b16 v[188:189],v216 offset:29696
v_rcp_f32 v30,v30
v_mfma_f32_16x16x32_bf16 v[88:91],v[164:167],a[168:171],v[88:91]
ds_read_b64_tr_b16 v[190:191],v216 offset:33792
v_add_f32 v31,1.0,v31
v_mfma_f32_16x16x32_bf16 v[92:95],v[164:167],a[172:175],v[92:95]
v_rcp_f32 v31,v31
v_mfma_f32_16x16x32_bf16 v[96:99],v[168:171],a[160:163],v[96:99]
s_add_u32 m0,s84,20480
v_mul_f32 v12,v12,v44
v_mfma_f32_16x16x32_bf16 v[100:103],v[168:171],a[164:167],v[100:103]
v_mul_f32 v13,v13,v45
v_mul_f32 v14,v14,v46
v_mfma_f32_16x16x32_bf16 v[104:107],v[168:171],a[168:171],v[104:107]
v_mul_f32 v15,v15,v47
v_mul_f32 v28,v28,v60
v_mul_f32 v29,v29,v61
v_mul_f32 v30,v30,v62
v_mul_f32 v31,v31,v63
v_cvt_pk_bf16_f32 v44,v12,v13
v_cvt_pk_bf16_f32 v45,v14,v15
v_cvt_pk_bf16_f32 v46,v28,v29
v_cvt_pk_bf16_f32 v47,v30,v31
buffer_store_dwordx4 v[44:47],v212,s[24:27],s87 offen offset:1024 sc1
v_mfma_f32_16x16x32_bf16 v[108:111],v[168:171],a[172:175],v[108:111]
s_add_u32 s86,s86,16384
s_add_u32 s87,s87,16384
v_mfma_f32_16x16x32_bf16 v[112:115],v[172:175],a[160:163],v[112:115]
v_exp_f32 v249,v249 clamp
v_mfma_f32_16x16x32_bf16 v[116:119],v[172:175],a[164:167],v[116:119]
v_mul_f32 v250,0x3fb8aa3b,v195
v_fma_f32 v201,v244,v201,s19
v_mfma_f32_16x16x32_bf16 v[120:123],v[172:175],a[168:171],v[120:123]
v_exp_f32 v250,v250 clamp
v_mfma_f32_16x16x32_bf16 v[124:127],v[172:175],a[172:175],v[124:127]
s_waitcnt lgkmcnt(0)
v_max_f32 v202,s19,v202
v_mfma_f32_16x16x32_bf16 v[64:67],v[176:179],a[176:179],v[64:67]
s_waitcnt vmcnt(16)
s_barrier
v_mfma_f32_16x16x32_bf16 v[68:71],v[176:179],a[180:183],v[68:71]
buffer_load_dwordx4 v213,s[8:11],s50 offen lds
ds_read_b64_tr_b16 v[160:161],v215 offset:40960
v_mfma_f32_16x16x32_bf16 v[72:75],v[176:179],a[184:187],v[72:75]
ds_read_b64_tr_b16 v[162:163],v215 offset:45056
buffer_store_dword v225,v224,s[24:27],s18 offen sc1
v_mfma_f32_16x16x32_bf16 v[76:79],v[176:179],a[188:191],v[76:79]
ds_read_b64_tr_b16 v[164:165],v216 offset:40960
v_add_f32 v202,v202,v249
v_mfma_f32_16x16x32_bf16 v[80:83],v[180:183],a[176:179],v[80:83]
ds_read_b64_tr_b16 v[166:167],v216 offset:45056
v_fma_f32 v203,v244,v203,s19
v_mfma_f32_16x16x32_bf16 v[84:87],v[180:183],a[180:183],v[84:87]
buffer_load_dwordx4 v213,s[12:15],s50 offen offset:1024 lds
s_add_u32 m0,s84,28672
v_mfma_f32_16x16x32_bf16 v[88:91],v[180:183],a[184:187],v[88:91]
ds_read_b64_tr_b16 v[168:169],v215 offset:41984
v_mul_f32 v244,0xbf317218,v211
v_mfma_f32_16x16x32_bf16 v[92:95],v[180:183],a[188:191],v[92:95]
ds_read_b64_tr_b16 v[170:171],v215 offset:46080
v_fma_f32 v204,v244,v204,s19
v_mfma_f32_16x16x32_bf16 v[96:99],v[184:187],a[176:179],v[96:99]
ds_read_b64_tr_b16 v[172:173],v216 offset:41984
v_mul_f32 v249,0x3fb8aa3b,v204
v_mfma_f32_16x16x32_bf16 v[100:103],v[184:187],a[180:183],v[100:103]
buffer_load_dwordx4 v214,s[8:11],s50 offen lds
ds_read_b64_tr_b16 v[174:175],v216 offset:46080
v_mfma_f32_16x16x32_bf16 v[104:107],v[184:187],a[184:187],v[104:107]
v_exp_f32 v249,v249 clamp
v_mfma_f32_16x16x32_bf16 v[108:111],v[184:187],a[188:191],v[108:111]
v_max_f32 v195,s19,v195
v_add_f32 v195,v195,v250
v_mfma_f32_16x16x32_bf16 v[112:115],v[188:191],a[176:179],v[112:115]
v_mul_f32 v250,0x3fb8aa3b,v197
v_max_f32 v204,s19,v204
v_mfma_f32_16x16x32_bf16 v[116:119],v[188:191],a[180:183],v[116:119]
v_exp_f32 v250,v250 clamp
v_mfma_f32_16x16x32_bf16 v[120:123],v[188:191],a[184:187],v[120:123]
buffer_load_dwordx4 v214,s[12:15],s50 offen offset:1024 lds
s_add_u32 m0,s84,40960
v_mfma_f32_16x16x32_bf16 v[124:127],v[188:191],a[188:191],v[124:127]
s_waitcnt lgkmcnt(0)
ds_read_b64_tr_b16 v[176:177],v215 offset:49152
v_mfma_f32_16x16x32_bf16 v[64:67],v[160:163],a[192:195],v[64:67]
ds_read_b64_tr_b16 v[178:179],v215 offset:53248
v_add_f32 v204,v204,v249
v_mfma_f32_16x16x32_bf16 v[68:71],v[160:163],a[196:199],v[68:71]
ds_read_b64_tr_b16 v[180:181],v216 offset:49152
v_fma_f32 v206,v244,v206,s19
v_mfma_f32_16x16x32_bf16 v[72:75],v[160:163],a[200:203],v[72:75]
buffer_load_dwordx4 v213,s[8:11],s51 offen lds
ds_read_b64_tr_b16 v[182:183],v216 offset:53248
v_mfma_f32_16x16x32_bf16 v[76:79],v[160:163],a[204:207],v[76:79]
ds_read_b64_tr_b16 v[184:185],v215 offset:50176
v_mul_f32 v249,0x3fb8aa3b,v206
v_mfma_f32_16x16x32_bf16 v[80:83],v[164:167],a[192:195],v[80:83]
ds_read_b64_tr_b16 v[186:187],v215 offset:54272
v_add_u32 v215,61440,v215
v_mfma_f32_16x16x32_bf16 v[84:87],v[164:167],a[196:199],v[84:87]
ds_read_b64_tr_b16 v[188:189],v216 offset:50176
v_max_f32 v197,s19,v197
v_mfma_f32_16x16x32_bf16 v[88:91],v[164:167],a[200:203],v[88:91]
buffer_load_dwordx4 v213,s[12:15],s51 offen offset:1024 lds
s_add_u32 m0,s84,49152
v_mfma_f32_16x16x32_bf16 v[92:95],v[164:167],a[204:207],v[92:95]
ds_read_b64_tr_b16 v[190:191],v216 offset:54272
v_add_u32 v216,61440,v216
v_mfma_f32_16x16x32_bf16 v[96:99],v[168:171],a[192:195],v[96:99]
s_lshl_b32 s58,s40,5
s_add_u32 s58,s58,s42
v_mfma_f32_16x16x32_bf16 v[100:103],v[168:171],a[196:199],v[100:103]
s_lshl_b32 s58,s58,5
s_add_u32 s58,s58,s43
v_mfma_f32_16x16x32_bf16 v[104:107],v[168:171],a[200:203],v[104:107]
s_lshl_b32 s58,s58,2
v_add_f32 v197,v197,v250
v_mfma_f32_16x16x32_bf16 v[108:111],v[168:171],a[204:207],v[108:111]
buffer_load_dwordx4 v214,s[8:11],s51 offen lds
v_mul_f32 v250,0x3fb8aa3b,v199
v_mfma_f32_16x16x32_bf16 v[112:115],v[172:175],a[192:195],v[112:115]
v_exp_f32 v249,v249 clamp
v_mfma_f32_16x16x32_bf16 v[116:119],v[172:175],a[196:199],v[116:119]
v_exp_f32 v250,v250 clamp
v_mfma_f32_16x16x32_bf16 v[120:123],v[172:175],a[200:203],v[120:123]
v_max_f32 v206,s19,v206
v_add_f32 v206,v206,v249
v_mfma_f32_16x16x32_bf16 v[124:127],v[172:175],a[204:207],v[124:127]
buffer_load_dwordx4 v214,s[12:15],s51 offen offset:1024 lds
s_waitcnt lgkmcnt(0)
v_mfma_f32_16x16x32_bf16 v[64:67],v[176:179],a[208:211],v[64:67]
ds_read_b64_tr_b16 v[160:161],v215 offset:0
v_and_b32 v252,15,v226
v_mfma_f32_16x16x32_bf16 v[68:71],v[176:179],a[212:215],v[68:71]
ds_read_b64_tr_b16 v[162:163],v215 offset:4096
v_lshlrev_b32 v252,3,v252
v_mfma_f32_16x16x32_bf16 v[72:75],v[176:179],a[216:219],v[72:75]
ds_read_b64_tr_b16 v[164:165],v216 offset:0
v_lshrrev_b32 v248,4,v226
v_mfma_f32_16x16x32_bf16 v[76:79],v[176:179],a[220:223],v[76:79]
ds_read_b64_tr_b16 v[166:167],v216 offset:4096
v_lshl_add_u32 v252,v248,8,v252
v_mfma_f32_16x16x32_bf16 v[80:83],v[180:183],a[208:211],v[80:83]
ds_read_b64_tr_b16 v[168:169],v215 offset:1024
v_max_f32 v199,s19,v199
v_mfma_f32_16x16x32_bf16 v[84:87],v[180:183],a[212:215],v[84:87]
ds_read_b64_tr_b16 v[170:171],v215 offset:5120
v_add_f32 v199,v199,v250
v_mfma_f32_16x16x32_bf16 v[88:91],v[180:183],a[216:219],v[88:91]
ds_read_b64_tr_b16 v[172:173],v216 offset:1024
v_mul_f32 v250,0x3fb8aa3b,v201
v_mfma_f32_16x16x32_bf16 v[92:95],v[180:183],a[220:223],v[92:95]
ds_read_b64_tr_b16 v[174:175],v216 offset:5120
v_max_f32 v201,s19,v201
v_mfma_f32_16x16x32_bf16 v[96:99],v[184:187],a[208:211],v[96:99]
v_exp_f32 v250,v250 clamp
v_mfma_f32_16x16x32_bf16 v[100:103],v[184:187],a[212:215],v[100:103]
v_add_f32 v201,v201,v250
v_mul_f32 v250,0x3fb8aa3b,v203
v_mfma_f32_16x16x32_bf16 v[104:107],v[184:187],a[216:219],v[104:107]
v_exp_f32 v250,v250 clamp
v_mfma_f32_16x16x32_bf16 v[108:111],v[184:187],a[220:223],v[108:111]
v_max_f32 v203,s19,v203
v_add_f32 v203,v203,v250
v_mfma_f32_16x16x32_bf16 v[112:115],v[188:191],a[208:211],v[112:115]
v_fma_f32 v205,v244,v205,s19
v_mul_f32 v250,0x3fb8aa3b,v205
v_mfma_f32_16x16x32_bf16 v[116:119],v[188:191],a[212:215],v[116:119]
v_exp_f32 v250,v250 clamp
v_mfma_f32_16x16x32_bf16 v[120:123],v[188:191],a[216:219],v[120:123]
v_max_f32 v205,s19,v205
v_add_f32 v205,v205,v250
v_mfma_f32_16x16x32_bf16 v[124:127],v[188:191],a[220:223],v[124:127]
s_waitcnt lgkmcnt(0)
ds_read_b64_tr_b16 v[176:177],v215 offset:8192
v_mfma_f32_16x16x32_bf16 v[64:67],v[160:163],a[224:227],v[64:67]
ds_read_b64_tr_b16 v[178:179],v215 offset:12288
v_fma_f32 v207,v244,v207,s19
v_mfma_f32_16x16x32_bf16 v[68:71],v[160:163],a[228:231],v[68:71]
ds_read_b64_tr_b16 v[180:181],v216 offset:8192
v_mul_f32 v250,0x3fb8aa3b,v207
v_mfma_f32_16x16x32_bf16 v[72:75],v[160:163],a[232:235],v[72:75]
ds_read_b64_tr_b16 v[182:183],v216 offset:12288
v_max_f32 v207,s19,v207
v_mfma_f32_16x16x32_bf16 v[76:79],v[160:163],a[236:239],v[76:79]
ds_read_b64_tr_b16 v[184:185],v215 offset:9216
s_and_b32 s71,s71,0xff
v_mfma_f32_16x16x32_bf16 v[80:83],v[164:167],a[224:227],v[80:83]
ds_read_b64_tr_b16 v[186:187],v215 offset:13312
v_subrev_u32 v215,81920,v215
v_mfma_f32_16x16x32_bf16 v[84:87],v[164:167],a[228:231],v[84:87]
ds_read_b64_tr_b16 v[188:189],v216 offset:9216
s_lshl_b32 s71,s71,14
v_mfma_f32_16x16x32_bf16 v[88:91],v[164:167],a[232:235],v[88:91]
ds_read_b64_tr_b16 v[190:191],v216 offset:13312
v_subrev_u32 v216,81920,v216
v_mfma_f32_16x16x32_bf16 v[92:95],v[164:167],a[236:239],v[92:95]
v_exp_f32 v250,v250 clamp
v_mfma_f32_16x16x32_bf16 v[96:99],v[168:171],a[224:227],v[96:99]
s_add_u32 m0,s84,61440
v_add_f32 v207,v207,v250
v_mfma_f32_16x16x32_bf16 v[100:103],v[168:171],a[228:231],v[100:103]
s_and_b32 s72,s72,0xff
s_lshl_b32 s72,s72,14
v_mfma_f32_16x16x32_bf16 v[104:107],v[168:171],a[232:235],v[104:107]
v_and_b32 v246,15,v226
v_lshrrev_b32 v240,4,v226
v_mfma_f32_16x16x32_bf16 v[108:111],v[168:171],a[236:239],v[108:111]
v_lshlrev_b32 v240,2,v240
v_sub_u32 v246,v246,v240
v_mfma_f32_16x16x32_bf16 v[112:115],v[172:175],a[224:227],v[112:115]
v_and_b32 v240,1,v246
v_lshrrev_b32 v246,1,v246
v_mfma_f32_16x16x32_bf16 v[116:119],v[172:175],a[228:231],v[116:119]
v_lshlrev_b32 v240,4,v240
v_mov_b32 v241,0x3f80
v_mfma_f32_16x16x32_bf16 v[120:123],v[172:175],a[232:235],v[120:123]
v_lshlrev_b32 v241,v240,v241
v_mov_b32 v237,0x3f80
v_mfma_f32_16x16x32_bf16 v[124:127],v[172:175],a[236:239],v[124:127]
s_waitcnt lgkmcnt(0)
s_xor_b32 s89,s45,2
v_mfma_f32_16x16x32_bf16 v[64:67],v[176:179],a[240:243],v[64:67]
s_waitcnt vmcnt(9)
s_barrier
v_mfma_f32_16x16x32_bf16 v[68:71],v[176:179],a[244:247],v[68:71]
buffer_load_dwordx4 v213,s[8:11],s52 offen lds
ds_read_b64_tr_b16 v[160:161],v215 offset:0
v_mfma_f32_16x16x32_bf16 v[72:75],v[176:179],a[248:251],v[72:75]
buffer_load_dwordx4 v213,s[12:15],s52 offen offset:1024 lds
s_add_u32 m0,s84,69632
buffer_store_dword v225,v224,s[24:27],s58 offen sc1
v_mfma_f32_16x16x32_bf16 v[76:79],v[176:179],a[252:255],v[76:79]
ds_read_b64_tr_b16 v[162:163],v215 offset:4096
s_mul_i32 s89,s89,3072
v_mfma_f32_16x16x32_bf16 v[80:83],v[180:183],a[240:243],v[80:83]
ds_read_b64_tr_b16 v[164:165],v216 offset:0
s_add_u32 s89,s89,143360
v_mfma_f32_16x16x32_bf16 v[84:87],v[180:183],a[244:247],v[84:87]
ds_read_b64_tr_b16 v[166:167],v216 offset:4096
s_mul_i32 s85,s3,-49152
v_mfma_f32_16x16x32_bf16 v[88:91],v[180:183],a[248:251],v[88:91]
ds_read_b64_tr_b16 v[168:169],v215 offset:1024
s_add_u32 s85,s85,16384
v_mfma_f32_16x16x32_bf16 v[92:95],v[180:183],a[252:255],v[92:95]
buffer_load_dwordx4 v214,s[8:11],s52 offen lds
ds_read_b64_tr_b16 v[170:171],v215 offset:5120
v_mfma_f32_16x16x32_bf16 v[96:99],v[184:187],a[240:243],v[96:99]
ds_read_b64_tr_b16 v[172:173],v216 offset:1024
v_mov_b32 v244,0
v_mfma_f32_16x16x32_bf16 v[100:103],v[184:187],a[244:247],v[100:103]
ds_read_b64_tr_b16 v[174:175],v216 offset:5120
v_mov_b32 v245,0
v_mfma_f32_16x16x32_bf16 v[104:107],v[184:187],a[248:251],v[104:107]
v_mov_b32 v240,0
s_lshl_b32 s18,s45,9
v_mfma_f32_16x16x32_bf16 v[108:111],v[184:187],a[252:255],v[108:111]
buffer_load_dwordx4 v214,s[12:15],s52 offen offset:1024 lds
s_add_u32 m0,s84,81920
v_mfma_f32_16x16x32_bf16 v[112:115],v[188:191],a[240:243],v[112:115]
s_lshl_b32 s60,s45,12
s_add_u32 s60,s60,s96
v_mfma_f32_16x16x32_bf16 v[116:119],v[188:191],a[244:247],v[116:119]
v_add_u32 v218,s60,v212
s_add_u32 s18,s18,160256
v_mfma_f32_16x16x32_bf16 v[120:123],v[188:191],a[248:251],v[120:123]
s_and_b32 s73,s73,0xff
s_lshl_b32 s73,s73,14
v_mfma_f32_16x16x32_bf16 v[124:127],v[188:191],a[252:255],v[124:127]
buffer_load_dwordx4 v213,s[8:11],s53 offen lds
s_waitcnt lgkmcnt(0)
v_mfma_f32_16x16x32_bf16 v[64:67],v[160:163],v[128:131],v[64:67]
ds_read_b64_tr_b16 v[176:177],v215 offset:8192
s_and_b32 s74,s74,0xff
v_mfma_f32_16x16x32_bf16 v[68:71],v[160:163],v[132:135],v[68:71]
ds_read_b64_tr_b16 v[178:179],v215 offset:12288
s_lshl_b32 s74,s74,14
v_mfma_f32_16x16x32_bf16 v[72:75],v[160:163],v[136:139],v[72:75]
ds_read_b64_tr_b16 v[180:181],v216 offset:8192
s_lshl_b32 s91,s101,1
v_mfma_f32_16x16x32_bf16 v[76:79],v[160:163],v[140:143],v[76:79]
ds_read_b64_tr_b16 v[182:183],v216 offset:12288
s_add_u32 s91,s91,s47
v_mfma_f32_16x16x32_bf16 v[80:83],v[164:167],v[128:131],v[80:83]
buffer_load_dwordx4 v213,s[12:15],s53 offen offset:1024 lds
s_add_u32 m0,s84,90112
v_mfma_f32_16x16x32_bf16 v[84:87],v[164:167],v[132:135],v[84:87]
ds_read_b64_tr_b16 v[184:185],v215 offset:9216
s_and_b32 s75,s75,0xff
v_mfma_f32_16x16x32_bf16 v[88:91],v[164:167],v[136:139],v[88:91]
ds_read_b64_tr_b16 v[186:187],v215 offset:13312
v_add_u32 v215,102400,v215
v_mfma_f32_16x16x32_bf16 v[92:95],v[164:167],v[140:143],v[92:95]
ds_read_b64_tr_b16 v[188:189],v216 offset:9216
s_lshl_b32 s75,s75,14
v_mfma_f32_16x16x32_bf16 v[96:99],v[168:171],v[128:131],v[96:99]
buffer_load_dwordx4 v214,s[8:11],s53 offen lds
ds_read_b64_tr_b16 v[190:191],v216 offset:13312
v_mfma_f32_16x16x32_bf16 v[100:103],v[168:171],v[132:135],v[100:103]
v_add_u32 v216,102400,v216
s_xor_b32 s16,s45,1
v_mfma_f32_16x16x32_bf16 v[104:107],v[168:171],v[136:139],v[104:107]
s_lshl_b32 s17,s40,2
s_add_u32 s16,s16,s17
v_mfma_f32_16x16x32_bf16 v[108:111],v[168:171],v[140:143],v[108:111]
s_lshl_b32 s17,s16,6
s_and_b32 s76,s76,0xff
v_mfma_f32_16x16x32_bf16 v[112:115],v[172:175],v[128:131],v[112:115]
buffer_load_dwordx4 v214,s[12:15],s53 offen offset:1024 lds
s_lshl_b32 s76,s76,14
v_mfma_f32_16x16x32_bf16 v[116:119],v[172:175],v[132:135],v[116:119]
s_lshl_b32 s16,s16,5
s_and_b32 s77,s77,0xff
v_mfma_f32_16x16x32_bf16 v[120:123],v[172:175],v[136:139],v[120:123]
s_lshl_b32 s77,s77,14
v_cvt_pk_bf16_f32 v192,v192,v193
v_mfma_f32_16x16x32_bf16 v[124:127],v[172:175],v[140:143],v[124:127]
s_waitcnt lgkmcnt(0)
ds_read_b64_tr_b16 v[160:161],v215 offset:0
v_mfma_f32_16x16x32_bf16 v[64:67],v[176:179],v[144:147],v[64:67]
ds_read_b64_tr_b16 v[162:163],v215 offset:4096
v_cvt_pk_bf16_f32 v193,v194,v195
v_mfma_f32_16x16x32_bf16 v[68:71],v[176:179],v[148:151],v[68:71]
ds_read_b64_tr_b16 v[164:165],v216 offset:0
s_lshl_b32 s90,s40,5
v_mfma_f32_16x16x32_bf16 v[72:75],v[176:179],v[152:155],v[72:75]
ds_read_b64_tr_b16 v[166:167],v216 offset:4096
s_add_u32 s90,s90,s42
v_mfma_f32_16x16x32_bf16 v[76:79],v[176:179],v[156:159],v[76:79]
ds_read_b64_tr_b16 v[168:169],v215 offset:1024
s_lshl_b32 s90,s90,7
v_mfma_f32_16x16x32_bf16 v[80:83],v[180:183],v[144:147],v[80:83]
ds_read_b64_tr_b16 v[170:171],v215 offset:5120
v_and_b32 v227,3,v226
v_mfma_f32_16x16x32_bf16 v[84:87],v[180:183],v[148:151],v[84:87]
ds_read_b64_tr_b16 v[172:173],v216 offset:1024
v_mul_u32_u24 v227,4,v227
v_mfma_f32_16x16x32_bf16 v[88:91],v[180:183],v[152:155],v[88:91]
ds_read_b64_tr_b16 v[174:175],v216 offset:5120
v_mul_f32 v64,v208,v64
v_mfma_f32_16x16x32_bf16 v[92:95],v[180:183],v[156:159],v[92:95]
v_exp_f32 v64,v64
v_mfma_f32_16x16x32_bf16 v[96:99],v[184:187],v[144:147],v[96:99]
v_mul_f32 v65,v208,v65
v_mul_f32 v66,v208,v66
v_mfma_f32_16x16x32_bf16 v[100:103],v[184:187],v[148:151],v[100:103]
v_exp_f32 v65,v65
v_mfma_f32_16x16x32_bf16 v[104:107],v[184:187],v[152:155],v[104:107]
v_exp_f32 v66,v66
v_mfma_f32_16x16x32_bf16 v[108:111],v[184:187],v[156:159],v[108:111]
v_mul_f32 v67,v208,v67
v_mul_f32 v80,v208,v80
v_mfma_f32_16x16x32_bf16 v[112:115],v[188:191],v[144:147],v[112:115]
v_exp_f32 v67,v67
v_mfma_f32_16x16x32_bf16 v[116:119],v[188:191],v[148:151],v[116:119]
v_exp_f32 v80,v80
v_mfma_f32_16x16x32_bf16 v[120:123],v[188:191],v[152:155],v[120:123]
v_mul_f32 v81,v208,v81
v_mul_f32 v82,v208,v82
v_mfma_f32_16x16x32_bf16 v[124:127],v[188:191],v[156:159],v[124:127]
s_waitcnt lgkmcnt(0)
ds_read_b64_tr_b16 v[176:177],v215 offset:8192
v_mfma_f32_16x16x32_bf16 v[0:3],v[160:163],a[0:3],0
ds_read_b64_tr_b16 v[178:179],v215 offset:12288
v_mul_f32 v83,v208,v83
v_mfma_f32_16x16x32_bf16 v[4:7],v[160:163],a[4:7],0
ds_read_b64_tr_b16 v[180:181],v216 offset:8192
v_add_f32 v64,1.0,v64
v_mfma_f32_16x16x32_bf16 v[8:11],v[160:163],a[8:11],0
ds_read_b64_tr_b16 v[182:183],v216 offset:12288
v_add_f32 v65,1.0,v65
v_mfma_f32_16x16x32_bf16 v[12:15],v[160:163],a[12:15],0
ds_read_b64_tr_b16 v[184:185],v215 offset:9216
v_add_f32 v66,1.0,v66
v_mfma_f32_16x16x32_bf16 v[16:19],v[164:167],a[0:3],0
ds_read_b64_tr_b16 v[186:187],v215 offset:13312
v_add_f32 v67,1.0,v67
v_mfma_f32_16x16x32_bf16 v[20:23],v[164:167],a[4:7],0
ds_read_b64_tr_b16 v[188:189],v216 offset:9216
v_add_f32 v80,1.0,v80
v_mfma_f32_16x16x32_bf16 v[24:27],v[164:167],a[8:11],0
ds_read_b64_tr_b16 v[190:191],v216 offset:13312
v_mul_f32 v68,v209,v68
v_mfma_f32_16x16x32_bf16 v[28:31],v[164:167],a[12:15],0
v_exp_f32 v81,v81
v_mfma_f32_16x16x32_bf16 v[32:35],v[168:171],a[0:3],0
s_add_u32 m0,s84,0
v_add_f32 v81,1.0,v81
v_mfma_f32_16x16x32_bf16 v[36:39],v[168:171],a[4:7],0
v_exp_f32 v82,v82
v_mfma_f32_16x16x32_bf16 v[40:43],v[168:171],a[8:11],0
v_exp_f32 v83,v83
v_mfma_f32_16x16x32_bf16 v[44:47],v[168:171],a[12:15],0
v_rcp_f32 v64,v64
v_mfma_f32_16x16x32_bf16 v[48:51],v[172:175],a[0:3],0
v_rcp_f32 v65,v65
v_mfma_f32_16x16x32_bf16 v[52:55],v[172:175],a[4:7],0
v_rcp_f32 v66,v66
v_mfma_f32_16x16x32_bf16 v[56:59],v[172:175],a[8:11],0
v_rcp_f32 v67,v67
v_mfma_f32_16x16x32_bf16 v[60:63],v[172:175],a[12:15],0
s_waitcnt lgkmcnt(0)
buffer_load_dword v247,v227,s[24:27],s90 offen sc1
v_mfma_f32_16x16x32_bf16 v[0:3],v[176:179],a[16:19],v[0:3]
s_waitcnt vmcnt(14)
s_barrier
v_mfma_f32_16x16x32_bf16 v[4:7],v[176:179],a[20:23],v[4:7]
buffer_load_dwordx4 v213,s[8:11],s54 offen lds
ds_read_b64_tr_b16 v[160:161],v215 offset:20480
v_mfma_f32_16x16x32_bf16 v[8:11],v[176:179],a[24:27],v[8:11]
buffer_load_dwordx4 v213,s[12:15],s54 offen offset:1024 lds
s_add_u32 m0,s84,8192
v_mfma_f32_16x16x32_bf16 v[12:15],v[176:179],a[28:31],v[12:15]
ds_read_b64_tr_b16 v[162:163],v215 offset:24576
v_add_f32 v82,1.0,v82
v_mfma_f32_16x16x32_bf16 v[16:19],v[180:183],a[16:19],v[16:19]
ds_read_b64_tr_b16 v[164:165],v216 offset:20480
v_add_f32 v83,1.0,v83
v_mfma_f32_16x16x32_bf16 v[20:23],v[180:183],a[20:23],v[20:23]
ds_read_b64_tr_b16 v[166:167],v216 offset:24576
v_mul_f32 v64,v64,v96
v_mfma_f32_16x16x32_bf16 v[24:27],v[180:183],a[24:27],v[24:27]
ds_read_b64_tr_b16 v[168:169],v215 offset:21504
v_mul_f32 v65,v65,v97
v_mfma_f32_16x16x32_bf16 v[28:31],v[180:183],a[28:31],v[28:31]
buffer_load_dwordx4 v214,s[8:11],s54 offen lds
ds_read_b64_tr_b16 v[170:171],v215 offset:25600
v_mfma_f32_16x16x32_bf16 v[32:35],v[184:187],a[16:19],v[32:35]
ds_read_b64_tr_b16 v[172:173],v216 offset:21504
v_mul_f32 v66,v66,v98
v_mfma_f32_16x16x32_bf16 v[36:39],v[184:187],a[20:23],v[36:39]
ds_read_b64_tr_b16 v[174:175],v216 offset:25600
v_mul_f32 v67,v67,v99
v_mfma_f32_16x16x32_bf16 v[40:43],v[184:187],a[24:27],v[40:43]
v_rcp_f32 v80,v80
v_mfma_f32_16x16x32_bf16 v[44:47],v[184:187],a[28:31],v[44:47]
buffer_load_dwordx4 v214,s[12:15],s54 offen offset:1024 lds
s_add_u32 m0,s84,102400
v_mfma_f32_16x16x32_bf16 v[48:51],v[188:191],a[16:19],v[48:51]
v_rcp_f32 v81,v81
v_mfma_f32_16x16x32_bf16 v[52:55],v[188:191],a[20:23],v[52:55]
v_rcp_f32 v82,v82
v_mfma_f32_16x16x32_bf16 v[56:59],v[188:191],a[24:27],v[56:59]
v_rcp_f32 v83,v83
v_mfma_f32_16x16x32_bf16 v[60:63],v[188:191],a[28:31],v[60:63]
buffer_load_dwordx4 v213,s[8:11],s55 offen lds
s_waitcnt lgkmcnt(0)
v_mfma_f32_16x16x32_bf16 v[0:3],v[160:163],a[32:35],v[0:3]
ds_read_b64_tr_b16 v[176:177],v215 offset:28672
v_mul_f32 v80,v80,v112
v_mfma_f32_16x16x32_bf16 v[4:7],v[160:163],a[36:39],v[4:7]
ds_read_b64_tr_b16 v[178:179],v215 offset:32768
v_mul_f32 v81,v81,v113
v_mfma_f32_16x16x32_bf16 v[8:11],v[160:163],a[40:43],v[8:11]
ds_read_b64_tr_b16 v[180:181],v216 offset:28672
v_mul_f32 v82,v82,v114
v_mfma_f32_16x16x32_bf16 v[12:15],v[160:163],a[44:47],v[12:15]
ds_read_b64_tr_b16 v[182:183],v216 offset:32768
v_mul_f32 v83,v83,v115
v_mfma_f32_16x16x32_bf16 v[16:19],v[164:167],a[32:35],v[16:19]
buffer_load_dwordx4 v213,s[12:15],s55 offen offset:1024 lds
s_add_u32 m0,s84,110592
v_mfma_f32_16x16x32_bf16 v[20:23],v[164:167],a[36:39],v[20:23]
ds_read_b64_tr_b16 v[184:185],v215 offset:29696
v_cvt_pk_bf16_f32 v96,v64,v65
v_mfma_f32_16x16x32_bf16 v[24:27],v[164:167],a[40:43],v[24:27]
ds_read_b64_tr_b16 v[186:187],v215 offset:33792
v_subrev_u32 v215,81920,v215
v_mfma_f32_16x16x32_bf16 v[28:31],v[164:167],a[44:47],v[28:31]
ds_read_b64_tr_b16 v[188:189],v216 offset:29696
v_cvt_pk_bf16_f32 v97,v66,v67
v_mfma_f32_16x16x32_bf16 v[32:35],v[168:171],a[32:35],v[32:35]
buffer_load_dwordx4 v214,s[8:11],s55 offen lds
ds_read_b64_tr_b16 v[190:191],v216 offset:33792
v_mfma_f32_16x16x32_bf16 v[36:39],v[168:171],a[36:39],v[36:39]
v_subrev_u32 v216,81920,v216
v_cvt_pk_bf16_f32 v98,v80,v81
v_mfma_f32_16x16x32_bf16 v[40:43],v[168:171],a[40:43],v[40:43]
v_cvt_pk_bf16_f32 v99,v82,v83
v_mul_f32 v69,v209,v69
v_mfma_f32_16x16x32_bf16 v[44:47],v[168:171],a[44:47],v[44:47]
v_exp_f32 v68,v68
v_mfma_f32_16x16x32_bf16 v[48:51],v[172:175],a[32:35],v[48:51]
buffer_load_dwordx4 v214,s[12:15],s55 offen offset:1024 lds
v_mul_f32 v70,v209,v70
v_mfma_f32_16x16x32_bf16 v[52:55],v[172:175],a[36:39],v[52:55]
v_exp_f32 v69,v69
v_mfma_f32_16x16x32_bf16 v[56:59],v[172:175],a[40:43],v[56:59]
v_exp_f32 v70,v70
v_mfma_f32_16x16x32_bf16 v[60:63],v[172:175],a[44:47],v[60:63]
s_waitcnt lgkmcnt(0)
ds_read_b64_tr_b16 v[160:161],v215 offset:0
v_mfma_f32_16x16x32_bf16 v[0:3],v[176:179],a[48:51],v[0:3]
ds_read_b64_tr_b16 v[162:163],v215 offset:4096
v_mul_f32 v71,v209,v71
v_mfma_f32_16x16x32_bf16 v[4:7],v[176:179],a[52:55],v[4:7]
s_getpc_b64 s[0:1]
L_cp4_4:
v_min_u32 v254,L_stop_4-L_cp4_4,v253
global_load_dword v255,v254,s[0:1]
v_mfma_f32_16x16x32_bf16 v[8:11],v[176:179],a[56:59],v[8:11]
ds_read_b64_tr_b16 v[164:165],v216 offset:0
v_mul_f32 v84,v209,v84
v_mfma_f32_16x16x32_bf16 v[12:15],v[176:179],a[60:63],v[12:15]
buffer_store_dwordx4 v[96:99],v212,s[24:27],s86 offen sc1
ds_read_b64_tr_b16 v[166:167],v216 offset:4096
v_mfma_f32_16x16x32_bf16 v[16:19],v[180:183],a[48:51],v[16:19]
ds_read_b64_tr_b16 v[168:169],v215 offset:1024
v_mul_f32 v85,v209,v85
v_mfma_f32_16x16x32_bf16 v[20:23],v[180:183],a[52:55],v[20:23]
ds_read_b64_tr_b16 v[170:171],v215 offset:5120
v_mul_f32 v86,v209,v86
v_mfma_f32_16x16x32_bf16 v[24:27],v[180:183],a[56:59],v[24:27]
ds_read_b64_tr_b16 v[172:173],v216 offset:1024
v_mul_f32 v87,v209,v87
v_mfma_f32_16x16x32_bf16 v[28:31],v[180:183],a[60:63],v[28:31]
ds_read_b64_tr_b16 v[174:175],v216 offset:5120
s_waitcnt vmcnt(10)
v_mfma_f32_16x16x32_bf16 v[32:35],v[184:187],a[48:51],v[32:35]
v_cmp_ne_u32 vcc,1,v247
s_cbranch_vccnz L_slow_ha_4
L_back_ha_4:
v_mfma_f32_16x16x32_bf16 v[36:39],v[184:187],a[52:55],v[36:39]
v_exp_f32 v71,v71
v_mfma_f32_16x16x32_bf16 v[40:43],v[184:187],a[56:59],v[40:43]
v_exp_f32 v84,v84
v_mfma_f32_16x16x32_bf16 v[44:47],v[184:187],a[60:63],v[44:47]
v_exp_f32 v85,v85
v_mfma_f32_16x16x32_bf16 v[48:51],v[188:191],a[48:51],v[48:51]
v_exp_f32 v86,v86
v_mfma_f32_16x16x32_bf16 v[52:55],v[188:191],a[52:55],v[52:55]
v_exp_f32 v87,v87
v_mfma_f32_16x16x32_bf16 v[56:59],v[188:191],a[56:59],v[56:59]
v_add_f32 v68,1.0,v68
v_add_f32 v69,1.0,v69
v_mfma_f32_16x16x32_bf16 v[60:63],v[188:191],a[60:63],v[60:63]
buffer_load_dwordx4 a[0:3],v218,s[24:27],s66 offen sc1
s_waitcnt lgkmcnt(0)
v_mfma_f32_16x16x32_bf16 v[0:3],v[160:163],a[64:67],v[0:3]
ds_read_b64_tr_b16 v[176:177],v215 offset:8192
v_add_f32 v70,1.0,v70
v_mfma_f32_16x16x32_bf16 v[4:7],v[160:163],a[68:71],v[4:7]
ds_read_b64_tr_b16 v[178:179],v215 offset:12288
v_add_f32 v71,1.0,v71
v_mfma_f32_16x16x32_bf16 v[8:11],v[160:163],a[72:75],v[8:11]
buffer_load_dwordx4 a[4:7],v218,s[24:27],s66 offen offset:1024 sc1
ds_read_b64_tr_b16 v[180:181],v216 offset:8192
v_mfma_f32_16x16x32_bf16 v[12:15],v[160:163],a[76:79],v[12:15]
ds_read_b64_tr_b16 v[182:183],v216 offset:12288
v_add_f32 v84,1.0,v84
v_mfma_f32_16x16x32_bf16 v[16:19],v[164:167],a[64:67],v[16:19]
ds_read_b64_tr_b16 v[184:185],v215 offset:9216
v_add_f32 v85,1.0,v85
v_mfma_f32_16x16x32_bf16 v[20:23],v[164:167],a[68:71],v[20:23]
ds_read_b64_tr_b16 v[186:187],v215 offset:13312
v_add_f32 v86,1.0,v86
v_mfma_f32_16x16x32_bf16 v[24:27],v[164:167],a[72:75],v[24:27]
ds_read_b64_tr_b16 v[188:189],v216 offset:9216
v_add_f32 v87,1.0,v87
v_mfma_f32_16x16x32_bf16 v[28:31],v[164:167],a[76:79],v[28:31]
buffer_load_dwordx4 a[8:11],v218,s[24:27],s66 offen offset:2048 sc1
ds_read_b64_tr_b16 v[190:191],v216 offset:13312
v_mfma_f32_16x16x32_bf16 v[32:35],v[168:171],a[64:67],v[32:35]
s_add_u32 m0,s84,122880
s_mul_i32 s98,s66,9
v_mfma_f32_16x16x32_bf16 v[36:39],v[168:171],a[68:71],v[36:39]
s_lshr_b32 s98,s98,1
s_lshr_b32 s99,s84,1
v_mfma_f32_16x16x32_bf16 v[40:43],v[168:171],a[72:75],v[40:43]
v_rcp_f32 v68,v68
v_mfma_f32_16x16x32_bf16 v[44:47],v[168:171],a[76:79],v[44:47]
buffer_load_dwordx4 a[12:15],v218,s[24:27],s66 offen offset:3072 sc1
v_mul_f32 v68,v68,v100
v_mfma_f32_16x16x32_bf16 v[48:51],v[172:175],a[64:67],v[48:51]
v_rcp_f32 v69,v69
v_mfma_f32_16x16x32_bf16 v[52:55],v[172:175],a[68:71],v[52:55]
v_rcp_f32 v70,v70
v_mfma_f32_16x16x32_bf16 v[56:59],v[172:175],a[72:75],v[56:59]
v_rcp_f32 v71,v71
v_mfma_f32_16x16x32_bf16 v[60:63],v[172:175],a[76:79],v[60:63]
buffer_load_dwordx4 a[16:19],v218,s[24:27],s67 offen sc1
s_waitcnt lgkmcnt(0)
v_mfma_f32_16x16x32_bf16 v[0:3],v[176:179],a[80:83],v[0:3]
s_barrier
v_mfma_f32_16x16x32_bf16 v[4:7],v[176:179],a[84:87],v[4:7]
ds_read_b64_tr_b16 v[160:161],v215 offset:20480
s_lshl_b32 s90,s101,5
v_mfma_f32_16x16x32_bf16 v[8:11],v[176:179],a[88:91],v[8:11]
ds_read_b64_tr_b16 v[162:163],v215 offset:24576
s_add_u32 s90,s90,21
v_mfma_f32_16x16x32_bf16 v[12:15],v[176:179],a[92:95],v[12:15]
buffer_load_dwordx4 v213,s[8:11],s56 offen lds
ds_read_b64_tr_b16 v[164:165],v216 offset:20480
v_mfma_f32_16x16x32_bf16 v[16:19],v[180:183],a[80:83],v[16:19]
ds_read_b64_tr_b16 v[166:167],v216 offset:24576
s_lshl_b32 s90,s90,7
v_mfma_f32_16x16x32_bf16 v[20:23],v[180:183],a[84:87],v[20:23]
ds_read_b64_tr_b16 v[168:169],v215 offset:21504
v_and_b32 v227,15,v226
v_mfma_f32_16x16x32_bf16 v[24:27],v[180:183],a[88:91],v[24:27]
ds_read_b64_tr_b16 v[170:171],v215 offset:25600
v_mul_u32_u24 v227,4,v227
v_mfma_f32_16x16x32_bf16 v[28:31],v[180:183],a[92:95],v[28:31]
buffer_load_dwordx4 v213,s[12:15],s56 offen offset:1024 lds
s_add_u32 m0,s84,131072
v_mfma_f32_16x16x32_bf16 v[32:35],v[184:187],a[80:83],v[32:35]
ds_read_b64_tr_b16 v[172:173],v216 offset:21504
v_mul_f32 v69,v69,v101
v_mfma_f32_16x16x32_bf16 v[36:39],v[184:187],a[84:87],v[36:39]
ds_read_b64_tr_b16 v[174:175],v216 offset:25600
v_mul_f32 v70,v70,v102
v_mfma_f32_16x16x32_bf16 v[40:43],v[184:187],a[88:91],v[40:43]
v_rcp_f32 v84,v84
v_mfma_f32_16x16x32_bf16 v[44:47],v[184:187],a[92:95],v[44:47]
v_rcp_f32 v85,v85
v_mfma_f32_16x16x32_bf16 v[48:51],v[188:191],a[80:83],v[48:51]
buffer_load_dwordx4 v214,s[8:11],s56 offen lds
v_mul_f32 v71,v71,v103
v_mfma_f32_16x16x32_bf16 v[52:55],v[188:191],a[84:87],v[52:55]
v_rcp_f32 v86,v86
v_mfma_f32_16x16x32_bf16 v[56:59],v[188:191],a[88:91],v[56:59]
v_rcp_f32 v87,v87
v_mfma_f32_16x16x32_bf16 v[60:63],v[188:191],a[92:95],v[60:63]
s_waitcnt lgkmcnt(0)
ds_read_b64_tr_b16 v[176:177],v215 offset:28672
v_mfma_f32_16x16x32_bf16 v[0:3],v[160:163],a[96:99],v[0:3]
buffer_load_dwordx4 v214,s[12:15],s56 offen offset:1024 lds
s_add_u32 m0,s84,20480
v_mfma_f32_16x16x32_bf16 v[4:7],v[160:163],a[100:103],v[4:7]
ds_read_b64_tr_b16 v[178:179],v215 offset:32768
v_mul_f32 v84,v84,v116
v_mfma_f32_16x16x32_bf16 v[8:11],v[160:163],a[104:107],v[8:11]
ds_read_b64_tr_b16 v[180:181],v216 offset:28672
v_mul_f32 v85,v85,v117
v_mfma_f32_16x16x32_bf16 v[12:15],v[160:163],a[108:111],v[12:15]
ds_read_b64_tr_b16 v[182:183],v216 offset:32768
v_mul_f32 v86,v86,v118
v_mfma_f32_16x16x32_bf16 v[16:19],v[164:167],a[96:99],v[16:19]
buffer_load_dwordx4 v219,s[20:23],s98 offen lds
ds_read_b64_tr_b16 v[184:185],v215 offset:29696
v_mfma_f32_16x16x32_bf16 v[20:23],v[164:167],a[100:103],v[20:23]
ds_read_b64_tr_b16 v[186:187],v215 offset:33792
v_mul_f32 v87,v87,v119
v_mfma_f32_16x16x32_bf16 v[24:27],v[164:167],a[104:107],v[24:27]
ds_read_b64_tr_b16 v[188:189],v216 offset:29696
v_cvt_pk_bf16_f32 v100,v68,v69
v_mfma_f32_16x16x32_bf16 v[28:31],v[164:167],a[108:111],v[28:31]
ds_read_b64_tr_b16 v[190:191],v216 offset:33792
v_cvt_pk_bf16_f32 v101,v70,v71
v_mfma_f32_16x16x32_bf16 v[32:35],v[168:171],a[96:99],v[32:35]
v_cvt_pk_bf16_f32 v102,v84,v85
v_cvt_pk_bf16_f32 v103,v86,v87
v_mfma_f32_16x16x32_bf16 v[36:39],v[168:171],a[100:103],v[36:39]
buffer_store_dwordx4 v[100:103],v212,s[24:27],s86 offen offset:1024 sc1
v_mul_f32 v72,v210,v72
v_mfma_f32_16x16x32_bf16 v[40:43],v[168:171],a[104:107],v[40:43]
v_exp_f32 v72,v72
v_mfma_f32_16x16x32_bf16 v[44:47],v[168:171],a[108:111],v[44:47]
v_mul_f32 v73,v210,v73
v_mul_f32 v74,v210,v74
v_mfma_f32_16x16x32_bf16 v[48:51],v[172:175],a[96:99],v[48:51]
v_exp_f32 v73,v73
v_mfma_f32_16x16x32_bf16 v[52:55],v[172:175],a[100:103],v[52:55]
v_exp_f32 v74,v74
v_mfma_f32_16x16x32_bf16 v[56:59],v[172:175],a[104:107],v[56:59]
v_mul_f32 v75,v210,v75
v_mul_f32 v88,v210,v88
v_mfma_f32_16x16x32_bf16 v[60:63],v[172:175],a[108:111],v[60:63]
s_waitcnt lgkmcnt(0)
ds_read_b64_tr_b16 v[160:161],v215 offset:40960
v_mfma_f32_16x16x32_bf16 v[0:3],v[176:179],a[112:115],v[0:3]
ds_read_b64_tr_b16 v[162:163],v215 offset:45056
buffer_load_dword v247,v227,s[24:27],s90 offen sc1
v_mfma_f32_16x16x32_bf16 v[4:7],v[176:179],a[116:119],v[4:7]
ds_read_b64_tr_b16 v[164:165],v216 offset:40960
v_mul_f32 v89,v210,v89
v_mfma_f32_16x16x32_bf16 v[8:11],v[176:179],a[120:123],v[8:11]
ds_read_b64_tr_b16 v[166:167],v216 offset:45056
v_mul_f32 v90,v210,v90
v_mfma_f32_16x16x32_bf16 v[12:15],v[176:179],a[124:127],v[12:15]
ds_read_b64_tr_b16 v[168:169],v215 offset:41984
v_mul_f32 v91,v210,v91
v_mfma_f32_16x16x32_bf16 v[16:19],v[180:183],a[112:115],v[16:19]
buffer_load_dwordx4 v220,s[20:23],s98 offen offset:1024 lds
s_add_u32 m0,s84,28672
v_mfma_f32_16x16x32_bf16 v[20:23],v[180:183],a[116:119],v[20:23]
ds_read_b64_tr_b16 v[170:171],v215 offset:46080
v_add_f32 v72,1.0,v72
v_mfma_f32_16x16x32_bf16 v[24:27],v[180:183],a[120:123],v[24:27]
ds_read_b64_tr_b16 v[172:173],v216 offset:41984
v_add_f32 v73,1.0,v73
v_mfma_f32_16x16x32_bf16 v[28:31],v[180:183],a[124:127],v[28:31]
ds_read_b64_tr_b16 v[174:175],v216 offset:46080
v_add_f32 v74,1.0,v74
v_mfma_f32_16x16x32_bf16 v[32:35],v[184:187],a[112:115],v[32:35]
buffer_load_dwordx4 v221,s[20:23],s98 offen lds
v_mul_f32 v76,v211,v76
v_mfma_f32_16x16x32_bf16 v[36:39],v[184:187],a[116:119],v[36:39]
v_exp_f32 v75,v75
v_mfma_f32_16x16x32_bf16 v[40:43],v[184:187],a[120:123],v[40:43]
v_exp_f32 v88,v88
v_mfma_f32_16x16x32_bf16 v[44:47],v[184:187],a[124:127],v[44:47]
v_exp_f32 v89,v89
v_mfma_f32_16x16x32_bf16 v[48:51],v[188:191],a[112:115],v[48:51]
v_exp_f32 v90,v90
v_mfma_f32_16x16x32_bf16 v[52:55],v[188:191],a[116:119],v[52:55]
buffer_load_dwordx4 v222,s[20:23],s98 offen offset:1024 lds
s_add_u32 m0,s99,36864
v_mfma_f32_16x16x32_bf16 v[56:59],v[188:191],a[120:123],v[56:59]
v_exp_f32 v91,v91
v_mfma_f32_16x16x32_bf16 v[60:63],v[188:191],a[124:127],v[60:63]
s_waitcnt lgkmcnt(0)
ds_read_b64_tr_b16 v[176:177],v215 offset:49152
v_mfma_f32_16x16x32_bf16 v[0:3],v[160:163],a[128:131],v[0:3]
ds_read_b64_tr_b16 v[178:179],v215 offset:53248
v_add_f32 v75,1.0,v75
v_mfma_f32_16x16x32_bf16 v[4:7],v[160:163],a[132:135],v[4:7]
buffer_load_dwordx4 v223,s[20:23],s98 offen lds
ds_read_b64_tr_b16 v[180:181],v216 offset:49152
v_mfma_f32_16x16x32_bf16 v[8:11],v[160:163],a[136:139],v[8:11]
ds_read_b64_tr_b16 v[182:183],v216 offset:53248
v_add_f32 v88,1.0,v88
v_mfma_f32_16x16x32_bf16 v[12:15],v[160:163],a[140:143],v[12:15]
ds_read_b64_tr_b16 v[184:185],v215 offset:50176
v_add_f32 v89,1.0,v89
v_mfma_f32_16x16x32_bf16 v[16:19],v[164:167],a[128:131],v[16:19]
ds_read_b64_tr_b16 v[186:187],v215 offset:54272
v_add_u32 v215,61440,v215
v_mfma_f32_16x16x32_bf16 v[20:23],v[164:167],a[132:135],v[20:23]
ds_read_b64_tr_b16 v[188:189],v216 offset:50176
v_add_f32 v90,1.0,v90
v_mfma_f32_16x16x32_bf16 v[24:27],v[164:167],a[136:139],v[24:27]
ds_read_b64_tr_b16 v[190:191],v216 offset:54272
v_add_u32 v216,61440,v216
v_mfma_f32_16x16x32_bf16 v[28:31],v[164:167],a[140:143],v[28:31]
v_rcp_f32 v72,v72
v_mfma_f32_16x16x32_bf16 v[32:35],v[168:171],a[128:131],v[32:35]
s_add_u32 m0,s84,40960
s_mul_i32 s98,s67,9
v_mfma_f32_16x16x32_bf16 v[36:39],v[168:171],a[132:135],v[36:39]
s_lshr_b32 s98,s98,1
s_lshr_b32 s99,s84,1
v_mfma_f32_16x16x32_bf16 v[40:43],v[168:171],a[136:139],v[40:43]
buffer_load_dwordx4 a[20:23],v218,s[24:27],s67 offen offset:1024 sc1
v_add_f32 v91,1.0,v91
v_mfma_f32_16x16x32_bf16 v[44:47],v[168:171],a[140:143],v[44:47]
v_rcp_f32 v73,v73
v_mul_f32 v72,v72,v104
v_mfma_f32_16x16x32_bf16 v[48:51],v[172:175],a[128:131],v[48:51]
v_rcp_f32 v74,v74
v_mfma_f32_16x16x32_bf16 v[52:55],v[172:175],a[132:135],v[52:55]
v_rcp_f32 v75,v75
v_mfma_f32_16x16x32_bf16 v[56:59],v[172:175],a[136:139],v[56:59]
buffer_load_dwordx4 a[24:27],v218,s[24:27],s67 offen offset:2048 sc1
v_mul_f32 v73,v73,v105
v_mfma_f32_16x16x32_bf16 v[60:63],v[172:175],a[140:143],v[60:63]
s_waitcnt lgkmcnt(0)
v_mul_f32 v74,v74,v106
v_mfma_f32_16x16x32_bf16 v[0:3],v[176:179],a[144:147],v[0:3]
s_waitcnt vmcnt(24)
s_barrier
v_mfma_f32_16x16x32_bf16 v[4:7],v[176:179],a[148:151],v[4:7]
ds_read_b64_tr_b16 v[160:161],v215 offset:0
v_mul_f32 v75,v75,v107
v_mfma_f32_16x16x32_bf16 v[8:11],v[176:179],a[152:155],v[8:11]
buffer_load_dwordx4 v219,s[20:23],s98 offen lds
ds_read_b64_tr_b16 v[162:163],v215 offset:4096
v_mfma_f32_16x16x32_bf16 v[12:15],v[176:179],a[156:159],v[12:15]
ds_read_b64_tr_b16 v[164:165],v216 offset:0
v_cvt_pk_bf16_f32 v104,v72,v73
v_mfma_f32_16x16x32_bf16 v[16:19],v[180:183],a[144:147],v[16:19]
ds_read_b64_tr_b16 v[166:167],v216 offset:4096
v_cvt_pk_bf16_f32 v105,v74,v75
v_mfma_f32_16x16x32_bf16 v[20:23],v[180:183],a[148:151],v[20:23]
ds_read_b64_tr_b16 v[168:169],v215 offset:1024
v_mul_f32 v77,v211,v77
v_mfma_f32_16x16x32_bf16 v[24:27],v[180:183],a[152:155],v[24:27]
ds_read_b64_tr_b16 v[170:171],v215 offset:5120
v_mul_f32 v78,v211,v78
v_mfma_f32_16x16x32_bf16 v[28:31],v[180:183],a[156:159],v[28:31]
buffer_load_dwordx4 v220,s[20:23],s98 offen offset:1024 lds
s_add_u32 m0,s84,49152
v_mfma_f32_16x16x32_bf16 v[32:35],v[184:187],a[144:147],v[32:35]
ds_read_b64_tr_b16 v[172:173],v216 offset:1024
s_waitcnt vmcnt(8)
v_mfma_f32_16x16x32_bf16 v[36:39],v[184:187],a[148:151],v[36:39]
ds_read_b64_tr_b16 v[174:175],v216 offset:5120
v_mul_f32 v79,v211,v79
v_mfma_f32_16x16x32_bf16 v[40:43],v[184:187],a[152:155],v[40:43]
v_cmp_ne_u32 vcc,1,v247
s_cbranch_vccnz L_slow_kv_4
L_back_kv_4:
v_mfma_f32_16x16x32_bf16 v[44:47],v[184:187],a[156:159],v[44:47]
buffer_load_dwordx2 v[248:249],v252,s[24:27],s62 offen sc1
v_mul_f32 v92,v211,v92
v_mfma_f32_16x16x32_bf16 v[48:51],v[188:191],a[144:147],v[48:51]
v_rcp_f32 v88,v88
v_mfma_f32_16x16x32_bf16 v[52:55],v[188:191],a[148:151],v[52:55]
buffer_load_dwordx2 v[250:251],v252,s[24:27],s62 offen offset:128 sc1
v_mul_f32 v88,v88,v120
v_mfma_f32_16x16x32_bf16 v[56:59],v[188:191],a[152:155],v[56:59]
v_rcp_f32 v89,v89
v_mfma_f32_16x16x32_bf16 v[60:63],v[188:191],a[156:159],v[60:63]
s_waitcnt lgkmcnt(0)
ds_read_b64_tr_b16 v[176:177],v215 offset:8192
v_mfma_f32_16x16x32_bf16 v[0:3],v[160:163],a[160:163],v[0:3]
buffer_load_dwordx4 v[96:99],v212,s[24:27],s61 offen sc1
ds_read_b64_tr_b16 v[178:179],v215 offset:12288
v_mfma_f32_16x16x32_bf16 v[4:7],v[160:163],a[164:167],v[4:7]
ds_read_b64_tr_b16 v[180:181],v216 offset:8192
v_mul_f32 v89,v89,v121
v_mfma_f32_16x16x32_bf16 v[8:11],v[160:163],a[168:171],v[8:11]
ds_read_b64_tr_b16 v[182:183],v216 offset:12288
v_cvt_pk_bf16_f32 v106,v88,v89
v_mfma_f32_16x16x32_bf16 v[12:15],v[160:163],a[172:175],v[12:15]
ds_read_b64_tr_b16 v[184:185],v215 offset:9216
v_mul_f32 v93,v211,v93
v_mfma_f32_16x16x32_bf16 v[16:19],v[164:167],a[160:163],v[16:19]
ds_read_b64_tr_b16 v[186:187],v215 offset:13312
v_subrev_u32 v215,81920,v215
v_mfma_f32_16x16x32_bf16 v[20:23],v[164:167],a[164:167],v[20:23]
buffer_load_dwordx4 v[100:103],v212,s[24:27],s61 offen offset:1024 sc1
ds_read_b64_tr_b16 v[188:189],v216 offset:9216
v_mfma_f32_16x16x32_bf16 v[24:27],v[164:167],a[168:171],v[24:27]
ds_read_b64_tr_b16 v[190:191],v216 offset:13312
v_subrev_u32 v216,81920,v216
v_mfma_f32_16x16x32_bf16 v[28:31],v[164:167],a[172:175],v[28:31]
v_rcp_f32 v90,v90
v_mfma_f32_16x16x32_bf16 v[32:35],v[168:171],a[160:163],v[32:35]
v_rcp_f32 v91,v91
v_mfma_f32_16x16x32_bf16 v[36:39],v[168:171],a[164:167],v[36:39]
v_mul_f32 v90,v90,v122
v_mul_f32 v91,v91,v123
v_mfma_f32_16x16x32_bf16 v[40:43],v[168:171],a[168:171],v[40:43]
buffer_load_dwordx4 v221,s[20:23],s98 offen lds
v_cvt_pk_bf16_f32 v107,v90,v91
v_mul_f32 v94,v211,v94
v_mfma_f32_16x16x32_bf16 v[44:47],v[168:171],a[172:175],v[44:47]
v_exp_f32 v76,v76
v_mul_f32 v95,v211,v95
v_mfma_f32_16x16x32_bf16 v[48:51],v[172:175],a[160:163],v[48:51]
v_exp_f32 v77,v77
v_add_f32 v76,1.0,v76
v_mfma_f32_16x16x32_bf16 v[52:55],v[172:175],a[164:167],v[52:55]
v_exp_f32 v78,v78
v_add_f32 v77,1.0,v77
v_mfma_f32_16x16x32_bf16 v[56:59],v[172:175],a[168:171],v[56:59]
buffer_store_dwordx4 v[104:107],v212,s[24:27],s87 offen sc1
v_add_f32 v78,1.0,v78
v_mfma_f32_16x16x32_bf16 v[60:63],v[172:175],a[172:175],v[60:63]
s_waitcnt lgkmcnt(0)
ds_read_b64_tr_b16 v[160:161],v215 offset:0
v_mfma_f32_16x16x32_bf16 v[0:3],v[176:179],a[176:179],v[0:3]
ds_read_b64_tr_b16 v[162:163],v215 offset:4096
v_cmp_eq_u32 vcc,0,v246
v_mfma_f32_16x16x32_bf16 v[4:7],v[176:179],a[180:183],v[4:7]
ds_read_b64_tr_b16 v[164:165],v216 offset:0
v_cndmask_b32 v242,0,v241,vcc
v_mfma_f32_16x16x32_bf16 v[8:11],v[176:179],a[184:187],v[8:11]
ds_read_b64_tr_b16 v[166:167],v216 offset:4096
v_cmp_eq_u32 vcc,1,v246
v_mfma_f32_16x16x32_bf16 v[12:15],v[176:179],a[188:191],v[12:15]
ds_read_b64_tr_b16 v[168:169],v215 offset:1024
v_cndmask_b32 v243,0,v241,vcc
v_mfma_f32_16x16x32_bf16 v[16:19],v[180:183],a[176:179],v[16:19]
ds_read_b64_tr_b16 v[170:171],v215 offset:5120
v_and_b32 v246,15,v226
v_mfma_f32_16x16x32_bf16 v[20:23],v[180:183],a[180:183],v[20:23]
ds_read_b64_tr_b16 v[172:173],v216 offset:1024
v_and_b32 v236,1,v246
v_mfma_f32_16x16x32_bf16 v[24:27],v[180:183],a[184:187],v[24:27]
ds_read_b64_tr_b16 v[174:175],v216 offset:5120
v_lshrrev_b32 v246,1,v246
v_mfma_f32_16x16x32_bf16 v[28:31],v[180:183],a[188:191],v[28:31]
v_exp_f32 v79,v79
v_mfma_f32_16x16x32_bf16 v[32:35],v[184:187],a[176:179],v[32:35]
v_exp_f32 v92,v92
v_mfma_f32_16x16x32_bf16 v[36:39],v[184:187],a[180:183],v[36:39]
buffer_load_dwordx4 v[104:107],v212,s[24:27],s61 offen offset:2048 sc1
v_add_f32 v79,1.0,v79
v_mfma_f32_16x16x32_bf16 v[40:43],v[184:187],a[184:187],v[40:43]
v_exp_f32 v93,v93
v_add_f32 v92,1.0,v92
v_mfma_f32_16x16x32_bf16 v[44:47],v[184:187],a[188:191],v[44:47]
v_exp_f32 v94,v94
v_add_f32 v93,1.0,v93
v_mfma_f32_16x16x32_bf16 v[48:51],v[188:191],a[176:179],v[48:51]
v_exp_f32 v95,v95
v_add_f32 v94,1.0,v94
v_mfma_f32_16x16x32_bf16 v[52:55],v[188:191],a[180:183],v[52:55]
v_rcp_f32 v76,v76
v_add_f32 v95,1.0,v95
v_mfma_f32_16x16x32_bf16 v[56:59],v[188:191],a[184:187],v[56:59]
buffer_load_dwordx4 v222,s[20:23],s98 offen offset:1024 lds
s_add_u32 m0,s99,57344
s_lshr_b32 s99,s84,1
v_mfma_f32_16x16x32_bf16 v[60:63],v[188:191],a[188:191],v[60:63]
s_waitcnt lgkmcnt(0)
ds_read_b64_tr_b16 v[176:177],v215 offset:8192
v_mul_f32 v76,v76,v108
v_mfma_f32_16x16x32_bf16 v[0:3],v[160:163],a[192:195],v[0:3]
ds_read_b64_tr_b16 v[178:179],v215 offset:12288
v_rcp_f32 v77,v77
v_mfma_f32_16x16x32_bf16 v[4:7],v[160:163],a[196:199],v[4:7]
ds_read_b64_tr_b16 v[180:181],v216 offset:8192
v_mul_f32 v77,v77,v109
v_mfma_f32_16x16x32_bf16 v[8:11],v[160:163],a[200:203],v[8:11]
buffer_load_dwordx4 v223,s[20:23],s98 offen lds
s_add_u32 m0,s84,61440
s_mul_i32 s98,s68,9
v_mfma_f32_16x16x32_bf16 v[12:15],v[160:163],a[204:207],v[12:15]
s_lshr_b32 s98,s98,1
ds_read_b64_tr_b16 v[182:183],v216 offset:12288
v_rcp_f32 v78,v78
v_mfma_f32_16x16x32_bf16 v[16:19],v[164:167],a[192:195],v[16:19]
ds_read_b64_tr_b16 v[184:185],v215 offset:9216
v_rcp_f32 v79,v79
v_mfma_f32_16x16x32_bf16 v[20:23],v[164:167],a[196:199],v[20:23]
ds_read_b64_tr_b16 v[186:187],v215 offset:13312
v_add_u32 v215,102400,v215
v_mul_f32 v78,v78,v110
v_mfma_f32_16x16x32_bf16 v[24:27],v[164:167],a[200:203],v[24:27]
ds_read_b64_tr_b16 v[188:189],v216 offset:9216
v_rcp_f32 v92,v92
v_mfma_f32_16x16x32_bf16 v[28:31],v[164:167],a[204:207],v[28:31]
ds_read_b64_tr_b16 v[190:191],v216 offset:13312
v_add_u32 v216,102400,v216
v_mfma_f32_16x16x32_bf16 v[32:35],v[168:171],a[192:195],v[32:35]
v_rcp_f32 v93,v93
v_mfma_f32_16x16x32_bf16 v[36:39],v[168:171],a[196:199],v[36:39]
v_rcp_f32 v94,v94
v_rcp_f32 v95,v95
v_mfma_f32_16x16x32_bf16 v[40:43],v[168:171],a[200:203],v[40:43]
buffer_load_dwordx4 a[28:31],v218,s[24:27],s67 offen offset:3072 sc1
v_mul_f32 v79,v79,v111
v_mul_f32 v92,v92,v124
v_mul_f32 v93,v93,v125
v_mul_f32 v94,v94,v126
v_mul_f32 v95,v95,v127
v_cvt_pk_bf16_f32 v108,v76,v77
v_cvt_pk_bf16_f32 v109,v78,v79
v_cvt_pk_bf16_f32 v110,v92,v93
v_cvt_pk_bf16_f32 v111,v94,v95
buffer_store_dwordx4 v[108:111],v212,s[24:27],s87 offen offset:1024 sc1
v_mfma_f32_16x16x32_bf16 v[44:47],v[168:171],a[204:207],v[44:47]
v_cmp_eq_u32 vcc,0,v246
v_lshlrev_b32 v236,4,v236
v_mfma_f32_16x16x32_bf16 v[48:51],v[172:175],a[192:195],v[48:51]
v_lshlrev_b32 v237,v236,v237
v_cndmask_b32 v232,0,v237,vcc
v_mfma_f32_16x16x32_bf16 v[52:55],v[172:175],a[196:199],v[52:55]
v_cmp_eq_u32 vcc,1,v246
s_add_u32 s86,s86,s85
v_mfma_f32_16x16x32_bf16 v[56:59],v[172:175],a[200:203],v[56:59]
v_cndmask_b32 v233,0,v237,vcc
v_mov_b32 v234,v232
v_mfma_f32_16x16x32_bf16 v[60:63],v[172:175],a[204:207],v[60:63]
s_waitcnt lgkmcnt(0)
v_mov_b32 v235,v233
v_mfma_f32_16x16x32_bf16 v[0:3],v[176:179],a[208:211],v[0:3]
s_barrier
v_mfma_f32_16x16x32_bf16 v[4:7],v[176:179],a[212:215],v[4:7]
ds_read_b64_tr_b16 v[160:161],v215 offset:0
v_mov_b32 v241,0
v_mfma_f32_16x16x32_bf16 v[8:11],v[176:179],a[216:219],v[8:11]
ds_read_b64_tr_b16 v[162:163],v215 offset:4096
s_add_u32 s87,s87,s85
v_mfma_f32_16x16x32_bf16 v[12:15],v[176:179],a[220:223],v[12:15]
ds_read_b64_tr_b16 v[164:165],v216 offset:0
v_lshrrev_b32 v252,2,v226
v_mfma_f32_16x16x32_bf16 v[16:19],v[180:183],a[208:211],v[16:19]
ds_read_b64_tr_b16 v[166:167],v216 offset:4096
v_lshlrev_b32 v252,6,v252
v_mfma_f32_16x16x32_bf16 v[20:23],v[180:183],a[212:215],v[20:23]
ds_read_b64_tr_b16 v[168:169],v215 offset:1024
v_bfe_u32 v214,v226,4,1
v_mfma_f32_16x16x32_bf16 v[24:27],v[180:183],a[216:219],v[24:27]
ds_read_b64_tr_b16 v[170:171],v215 offset:5120
v_lshl_add_u32 v252,v214,5,v252
v_mfma_f32_16x16x32_bf16 v[28:31],v[180:183],a[220:223],v[28:31]
buffer_load_dwordx4 v[108:111],v212,s[24:27],s61 offen offset:3072 sc1
s_add_u32 s61,s61,4096
v_mfma_f32_16x16x32_bf16 v[32:35],v[184:187],a[208:211],v[32:35]
ds_read_b64_tr_b16 v[172:173],v216 offset:1024
v_and_b32 v214,3,v226
v_mfma_f32_16x16x32_bf16 v[36:39],v[184:187],a[212:215],v[36:39]
ds_read_b64_tr_b16 v[174:175],v216 offset:5120
v_lshl_add_u32 v214,v214,3,v252
v_mfma_f32_16x16x32_bf16 v[40:43],v[184:187],a[216:219],v[40:43]
v_xor_b32 v252,32,v214
v_add_u32 v246,s89,v212
v_mfma_f32_16x16x32_bf16 v[44:47],v[184:187],a[220:223],v[44:47]
s_lshl_b32 s89,s40,2
v_cvt_pk_bf16_f32 v196,v196,v197
v_mfma_f32_16x16x32_bf16 v[48:51],v[188:191],a[208:211],v[48:51]
buffer_load_dwordx4 v[112:115],v212,s[24:27],s61 offen sc1
v_cvt_pk_bf16_f32 v197,v198,v199
v_mfma_f32_16x16x32_bf16 v[52:55],v[188:191],a[212:215],v[52:55]
v_cvt_pk_bf16_f32 v200,v200,v201
v_cvt_pk_bf16_f32 v201,v202,v203
v_mfma_f32_16x16x32_bf16 v[56:59],v[188:191],a[216:219],v[56:59]
v_cvt_pk_bf16_f32 v204,v204,v205
v_cvt_pk_bf16_f32 v205,v206,v207
v_mfma_f32_16x16x32_bf16 v[60:63],v[188:191],a[220:223],v[60:63]
s_waitcnt lgkmcnt(0)
ds_read_b64_tr_b16 v[176:177],v215 offset:8192
v_mfma_f32_16x16x32_bf16 v[0:3],v[160:163],a[224:227],v[0:3]
ds_read_b64_tr_b16 v[178:179],v215 offset:12288
s_and_b32 s34,s92,0xffff
v_mfma_f32_16x16x32_bf16 v[4:7],v[160:163],a[228:231],v[4:7]
buffer_load_dwordx4 v[116:119],v212,s[24:27],s61 offen offset:1024 sc1
ds_read_b64_tr_b16 v[180:181],v216 offset:8192
v_mfma_f32_16x16x32_bf16 v[8:11],v[160:163],a[232:235],v[8:11]
ds_read_b64_tr_b16 v[182:183],v216 offset:12288
s_mov_b32 s35,0
v_mfma_f32_16x16x32_bf16 v[12:15],v[160:163],a[236:239],v[12:15]
ds_read_b64_tr_b16 v[184:185],v215 offset:9216
s_xor_b32 s32,s34,0xffff
v_mfma_f32_16x16x32_bf16 v[16:19],v[164:167],a[224:227],v[16:19]
ds_read_b64_tr_b16 v[186:187],v215 offset:13312
s_mov_b32 s33,0
v_mfma_f32_16x16x32_bf16 v[20:23],v[164:167],a[228:231],v[20:23]
ds_read_b64_tr_b16 v[188:189],v216 offset:9216
s_and_b32 s78,s78,0xff
v_mfma_f32_16x16x32_bf16 v[24:27],v[164:167],a[232:235],v[24:27]
buffer_load_dwordx4 v[120:123],v212,s[24:27],s61 offen offset:2048 sc1
ds_read_b64_tr_b16 v[190:191],v216 offset:13312
v_mfma_f32_16x16x32_bf16 v[28:31],v[164:167],a[236:239],v[28:31]
s_lshl_b32 s63,s47,6
s_lshl_b32 s78,s78,14
v_mfma_f32_16x16x32_bf16 v[32:35],v[168:171],a[224:227],v[32:35]
s_lshl_b32 s64,s40,5
s_add_u32 s64,s64,s42
v_mfma_f32_16x16x32_bf16 v[36:39],v[168:171],a[228:231],v[36:39]
s_add_u32 s64,s64,4
s_lshl_b32 s64,s64,5
v_mfma_f32_16x16x32_bf16 v[40:43],v[168:171],a[232:235],v[40:43]
s_add_u32 s64,s64,s43
s_lshl_b32 s64,s64,2
v_mfma_f32_16x16x32_bf16 v[44:47],v[168:171],a[236:239],v[44:47]
s_and_b32 s79,s79,0xff
s_lshl_b32 s79,s79,14
v_mfma_f32_16x16x32_bf16 v[48:51],v[172:175],a[224:227],v[48:51]
buffer_load_dwordx4 v[124:127],v212,s[24:27],s61 offen offset:3072 sc1
s_and_b32 s80,s80,0xff
v_mfma_f32_16x16x32_bf16 v[52:55],v[172:175],a[228:231],v[52:55]
s_lshl_b32 s80,s80,14
s_and_b32 s81,s81,0xff
v_mfma_f32_16x16x32_bf16 v[56:59],v[172:175],a[232:235],v[56:59]
s_lshl_b32 s81,s81,14
s_and_b32 s82,s82,0xff
v_mfma_f32_16x16x32_bf16 v[60:63],v[172:175],a[236:239],v[60:63]
s_waitcnt lgkmcnt(0)
ds_read_b64_tr_b16 v[160:161],v215 offset:20480
v_mfma_f32_16x16x32_bf16 v[0:3],v[176:179],a[240:243],v[0:3]
ds_read_b64_tr_b16 v[162:163],v215 offset:24576
s_lshl_b32 s82,s82,14
v_mfma_f32_16x16x32_bf16 v[4:7],v[176:179],a[244:247],v[4:7]
buffer_load_dwordx4 v219,s[20:23],s98 offen lds
ds_read_b64_tr_b16 v[164:165],v216 offset:20480
v_mfma_f32_16x16x32_bf16 v[8:11],v[176:179],a[248:251],v[8:11]
ds_read_b64_tr_b16 v[166:167],v216 offset:24576
s_and_b32 s83,s83,0xff
v_mfma_f32_16x16x32_bf16 v[12:15],v[176:179],a[252:255],v[12:15]
ds_read_b64_tr_b16 v[168:169],v215 offset:21504
s_lshl_b32 s83,s83,14
v_mfma_f32_16x16x32_bf16 v[16:19],v[180:183],a[240:243],v[16:19]
ds_read_b64_tr_b16 v[170:171],v215 offset:25600
s_mul_i32 s65,s47,136
v_mfma_f32_16x16x32_bf16 v[20:23],v[180:183],a[244:247],v[20:23]
buffer_load_dwordx4 v220,s[20:23],s98 offen offset:1024 lds
s_add_u32 m0,s84,69632
v_mfma_f32_16x16x32_bf16 v[24:27],v[180:183],a[248:251],v[24:27]
ds_read_b64_tr_b16 v[172:173],v216 offset:21504
s_lshl_b32 s100,s46,4
v_mfma_f32_16x16x32_bf16 v[28:31],v[180:183],a[252:255],v[28:31]
ds_read_b64_tr_b16 v[174:175],v216 offset:25600
s_add_u32 s65,s65,s100
v_mfma_f32_16x16x32_bf16 v[32:35],v[184:187],a[240:243],v[32:35]
s_mul_i32 s85,s46,252
s_mul_i32 s100,s47,20
v_mfma_f32_16x16x32_bf16 v[36:39],v[184:187],a[244:247],v[36:39]
buffer_load_dwordx4 v221,s[20:23],s98 offen lds
s_add_u32 s85,s85,s100
v_mfma_f32_16x16x32_bf16 v[40:43],v[184:187],a[248:251],v[40:43]
s_add_u32 s58,s44,1
s_and_b32 s58,s58,7
v_mfma_f32_16x16x32_bf16 v[44:47],v[184:187],a[252:255],v[44:47]
s_mul_i32 s58,s58,82944
s_add_u32 s60,s44,3
v_mfma_f32_16x16x32_bf16 v[48:51],v[188:191],a[240:243],v[48:51]
s_and_b32 s60,s60,7
s_mul_i32 s60,s60,82944
v_mfma_f32_16x16x32_bf16 v[52:55],v[188:191],a[244:247],v[52:55]
s_add_u32 s61,s44,4
s_and_b32 s61,s61,7
v_mfma_f32_16x16x32_bf16 v[56:59],v[188:191],a[248:251],v[56:59]
buffer_load_dwordx4 a[32:35],v218,s[24:27],s68 offen sc1
s_mul_i32 s61,s61,82944
v_mfma_f32_16x16x32_bf16 v[60:63],v[188:191],a[252:255],v[60:63]
s_waitcnt lgkmcnt(0)
ds_read_b64_tr_b16 v[176:177],v215 offset:28672
v_mfma_f32_16x16x32_bf16 v[0:3],v[160:163],v[128:131],v[0:3]
ds_read_b64_tr_b16 v[178:179],v215 offset:32768
s_add_u32 s62,s44,5
v_mfma_f32_16x16x32_bf16 v[4:7],v[160:163],v[132:135],v[4:7]
ds_read_b64_tr_b16 v[180:181],v216 offset:28672
s_and_b32 s62,s62,7
v_mfma_f32_16x16x32_bf16 v[8:11],v[160:163],v[136:139],v[8:11]
buffer_load_dwordx4 v222,s[20:23],s98 offen offset:1024 lds
s_add_u32 m0,s99,77824
v_mfma_f32_16x16x32_bf16 v[12:15],v[160:163],v[140:143],v[12:15]
s_lshr_b32 s99,s84,1
ds_read_b64_tr_b16 v[182:183],v216 offset:32768
v_mfma_f32_16x16x32_bf16 v[16:19],v[164:167],v[128:131],v[16:19]
ds_read_b64_tr_b16 v[184:185],v215 offset:29696
s_mul_i32 s62,s62,82944
v_mfma_f32_16x16x32_bf16 v[20:23],v[164:167],v[132:135],v[20:23]
ds_read_b64_tr_b16 v[186:187],v215 offset:33792
v_xor_b32 v215,s63,v215
v_mfma_f32_16x16x32_bf16 v[24:27],v[164:167],v[136:139],v[24:27]
buffer_load_dwordx4 a[36:39],v218,s[24:27],s68 offen offset:1024 sc1
v_xor_b32 v217,64,v215
v_mfma_f32_16x16x32_bf16 v[28:31],v[164:167],v[140:143],v[28:31]
ds_read_b64_tr_b16 v[188:189],v216 offset:29696
s_add_u32 s65,s65,16
v_mfma_f32_16x16x32_bf16 v[32:35],v[168:171],v[128:131],v[32:35]
ds_read_b64_tr_b16 v[190:191],v216 offset:33792
v_xor_b32 v216,s63,v216
v_mfma_f32_16x16x32_bf16 v[36:39],v[168:171],v[132:135],v[36:39]
v_xor_b32 v213,64,v216
s_add_u32 s63,s44,6
v_mfma_f32_16x16x32_bf16 v[40:43],v[168:171],v[136:139],v[40:43]
buffer_load_dwordx4 v223,s[20:23],s98 offen lds
s_add_u32 m0,s84,81920
v_mfma_f32_16x16x32_bf16 v[44:47],v[168:171],v[140:143],v[44:47]
s_mul_i32 s98,s69,9
s_lshr_b32 s98,s98,1
v_mfma_f32_16x16x32_bf16 v[48:51],v[172:175],v[128:131],v[48:51]
s_and_b32 s63,s63,7
s_mul_i32 s63,s63,82944
v_mfma_f32_16x16x32_bf16 v[52:55],v[172:175],v[132:135],v[52:55]
s_mul_i32 s65,s65,1152
s_add_u32 s85,s85,16
v_mfma_f32_16x16x32_bf16 v[56:59],v[172:175],v[136:139],v[56:59]
s_mul_i32 s85,s85,1152
v_mfma_f32_16x16x32_bf16 v[60:63],v[172:175],v[140:143],v[60:63]
s_waitcnt lgkmcnt(0)
v_mfma_f32_16x16x32_bf16 v[0:3],v[176:179],v[144:147],v[0:3]
v_subrev_u32 v215,81920,v215
v_subrev_u32 v216,81920,v216
s_waitcnt vmcnt(12)
v_mfma_f32_16x16x32_bf16 v[4:7],v[176:179],v[148:151],v[4:7]
s_barrier
v_subrev_u32 v217,81920,v217
v_mfma_f32_16x16x32_bf16 v[8:11],v[176:179],v[152:155],v[8:11]
v_subrev_u32 v213,81920,v213
buffer_store_dword v225,v224,s[24:27],s64 offen sc1
v_mfma_f32_16x16x32_bf16 v[12:15],v[176:179],v[156:159],v[12:15]
buffer_load_dwordx4 a[40:43],v218,s[24:27],s68 offen offset:2048 sc1
ds_read_b64_tr_b16 v[160:161],v215 offset:0
v_mfma_f32_16x16x32_bf16 v[16:19],v[180:183],v[144:147],v[16:19]
ds_read_b64_tr_b16 v[162:163],v215 offset:4096
v_mul_f32 v0,v208,v0
v_mfma_f32_16x16x32_bf16 v[20:23],v[180:183],v[148:151],v[20:23]
ds_read_b64_tr_b16 v[164:165],v216 offset:0
v_mul_f32 v1,v208,v1
v_mfma_f32_16x16x32_bf16 v[24:27],v[180:183],v[152:155],v[24:27]
ds_read_b64_tr_b16 v[166:167],v216 offset:4096
v_mul_f32 v2,v208,v2
v_mfma_f32_16x16x32_bf16 v[28:31],v[180:183],v[156:159],v[28:31]
buffer_load_dwordx4 a[44:47],v218,s[24:27],s68 offen offset:3072 sc1
ds_read_b64_tr_b16 v[168:169],v217 offset:0
v_mfma_f32_16x16x32_bf16 v[32:35],v[184:187],v[144:147],v[32:35]
ds_read_b64_tr_b16 v[170:171],v217 offset:4096
v_mul_f32 v3,v208,v3
v_mfma_f32_16x16x32_bf16 v[36:39],v[184:187],v[148:151],v[36:39]
ds_read_b64_tr_b16 v[172:173],v213 offset:0
v_mul_f32 v16,v208,v16
v_mfma_f32_16x16x32_bf16 v[40:43],v[184:187],v[152:155],v[40:43]
ds_read_b64_tr_b16 v[174:175],v213 offset:4096
v_mul_f32 v17,v208,v17
v_mfma_f32_16x16x32_bf16 v[44:47],v[184:187],v[156:159],v[44:47]
v_exp_f32 v0,v0
v_mfma_f32_16x16x32_bf16 v[48:51],v[188:191],v[144:147],v[48:51]
buffer_load_dwordx4 v219,s[20:23],s98 offen lds
v_mul_f32 v18,v208,v18
v_mfma_f32_16x16x32_bf16 v[52:55],v[188:191],v[148:151],v[52:55]
v_exp_f32 v1,v1
v_mfma_f32_16x16x32_bf16 v[56:59],v[188:191],v[152:155],v[56:59]
v_exp_f32 v2,v2
v_mfma_f32_16x16x32_bf16 v[60:63],v[188:191],v[156:159],v[60:63]
s_waitcnt vmcnt(11)
v_mul_f32 v19,v208,v19
v_mfma_f32_16x16x32_bf16 v[236:239],v[232:235],v[248:251],0
buffer_load_dwordx4 v220,s[20:23],s98 offen offset:1024 lds
s_add_u32 m0,s84,90112
v_mfma_f32_16x16x32_bf16 v[228:231],v[242:245],v[96:99],0
v_exp_f32 v3,v3
v_mfma_f32_16x16x32_bf16 v[232:235],v[240:243],v[96:99],0
v_exp_f32 v16,v16
v_mfma_f32_16x16x32_bf16 v[228:231],v[242:245],v[100:103],v[228:231]
v_exp_f32 v17,v17
v_mfma_f32_16x16x32_bf16 v[232:235],v[240:243],v[100:103],v[232:235]
buffer_load_dwordx4 v221,s[20:23],s98 offen lds
v_add_f32 v0,1.0,v0
v_mfma_f32_16x16x32_bf16 v[228:231],v[242:245],v[104:107],v[228:231]
v_exp_f32 v18,v18
v_mfma_f32_16x16x32_bf16 v[232:235],v[240:243],v[104:107],v[232:235]
v_exp_f32 v19,v19
v_mfma_f32_16x16x32_bf16 v[228:231],v[242:245],v[108:111],v[228:231]
v_rcp_f32 v0,v0
v_mfma_f32_16x16x32_bf16 v[232:235],v[240:243],v[108:111],v[232:235]
v_add_f32 v1,1.0,v1
v_add_f32 v2,1.0,v2
v_mfma_f32_16x16x32_bf16 v[228:231],v[242:245],v[112:115],v[228:231]
buffer_load_dwordx4 a[48:51],v218,s[24:27],s69 offen sc1
v_add_f32 v3,1.0,v3
v_mfma_f32_16x16x32_bf16 v[232:235],v[240:243],v[112:115],v[232:235]
v_rcp_f32 v1,v1
v_mfma_f32_16x16x32_bf16 v[228:231],v[242:245],v[116:119],v[228:231]
v_rcp_f32 v2,v2
v_mfma_f32_16x16x32_bf16 v[232:235],v[240:243],v[116:119],v[232:235]
v_rcp_f32 v3,v3
v_mfma_f32_16x16x32_bf16 v[228:231],v[242:245],v[120:123],v[228:231]
buffer_load_dwordx4 v222,s[20:23],s98 offen offset:1024 lds
s_add_u32 m0,s99,98304
v_mfma_f32_16x16x32_bf16 v[232:235],v[240:243],v[120:123],v[232:235]
s_lshr_b32 s99,s84,1
v_add_f32 v16,1.0,v16
v_mfma_f32_16x16x32_bf16 v[228:231],v[242:245],v[124:127],v[228:231]
v_add_u32 v245,s88,v212
ds_write_b128 v245,v[236:239] offset:2048
v_mfma_f32_16x16x32_bf16 v[232:235],v[240:243],v[124:127],v[232:235]
ds_read_b64_tr_b16 v[176:177],v215 offset:1024
s_waitcnt lgkmcnt(2)
v_mfma_f32_16x16x32_bf16 v[64:67],v[160:163],a[0:3],0
s_getpc_b64 s[0:1]
L_cp5_4:
v_min_u32 v254,L_stop_4-L_cp5_4,v253
global_load_dword v255,v254,s[0:1]
v_mfma_f32_16x16x32_bf16 v[68:71],v[160:163],a[4:7],0
ds_read_b64_tr_b16 v[178:179],v215 offset:5120
ds_read_b64_tr_b16 v[180:181],v216 offset:1024
v_mfma_f32_16x16x32_bf16 v[72:75],v[164:167],a[0:3],0
buffer_load_dwordx4 a[52:55],v218,s[24:27],s69 offen offset:1024 sc1
ds_read_b64_tr_b16 v[182:183],v216 offset:5120
v_mfma_f32_16x16x32_bf16 v[76:79],v[164:167],a[4:7],0
ds_read_b64_tr_b16 v[184:185],v217 offset:1024
ds_read_b64_tr_b16 v[186:187],v217 offset:5120
v_mfma_f32_16x16x32_bf16 v[80:83],v[168:171],a[0:3],0
ds_read_b64_tr_b16 v[188:189],v213 offset:1024
ds_read_b64_tr_b16 v[190:191],v213 offset:5120
v_mfma_f32_16x16x32_bf16 v[84:87],v[168:171],a[4:7],0
ds_read_b64_tr_b16 v[160:161],v214 offset:36864
ds_read_b64_tr_b16 v[162:163],v214 offset:37888
v_mfma_f32_16x16x32_bf16 v[88:91],v[172:175],a[0:3],0
buffer_load_dwordx4 v223,s[20:23],s98 offen lds
s_add_u32 m0,s84,0
v_mfma_f32_16x16x32_bf16 v[92:95],v[172:175],a[4:7],0
s_mul_i32 s98,s70,9
s_lshr_b32 s98,s98,1
s_waitcnt lgkmcnt(2)
v_mfma_f32_16x16x32_bf16 v[96:99],v[176:179],a[0:3],0
ds_read_b64_tr_b16 v[164:165],v252 offset:36864
ds_read_b64_tr_b16 v[166:167],v252 offset:37888
v_mfma_f32_16x16x32_bf16 v[100:103],v[176:179],a[4:7],0
ds_read_b64_tr_b16 v[168:169],v215 offset:8192
ds_read_b64_tr_b16 v[170:171],v215 offset:12288
v_mfma_f32_16x16x32_bf16 v[104:107],v[180:183],a[0:3],0
ds_read_b64_tr_b16 v[172:173],v216 offset:8192
ds_read_b64_tr_b16 v[174:175],v216 offset:12288
v_mfma_f32_16x16x32_bf16 v[108:111],v[180:183],a[4:7],0
ds_read_b64_tr_b16 v[176:177],v217 offset:8192
ds_read_b64_tr_b16 v[178:179],v217 offset:12288
v_mfma_f32_16x16x32_bf16 v[112:115],v[184:187],a[0:3],0
ds_write_b128 v245,v[228:231] offset:0
ds_write_b128 v245,v[232:235] offset:1024
v_mfma_f32_16x16x32_bf16 v[116:119],v[184:187],a[4:7],0
ds_read_b64_tr_b16 v[180:181],v213 offset:8192
ds_read_b64_tr_b16 v[182:183],v213 offset:12288
v_mfma_f32_16x16x32_bf16 v[120:123],v[188:191],a[0:3],0
s_xor_b32 s88,s45,0
s_add_u32 s88,s88,s89
v_mfma_f32_16x16x32_bf16 v[124:127],v[188:191],a[4:7],0
buffer_load_dwordx4 a[56:59],v218,s[24:27],s69 offen offset:2048 sc1
ds_read_b64_tr_b16 v[184:185],v215 offset:9216
s_waitcnt lgkmcnt(7)
v_mfma_f32_16x16x32_bf16 v[128:131],v[160:163],a[0:3],0
ds_read_b64_tr_b16 v[186:187],v215 offset:13312
s_lshl_b32 s89,s88,6
v_mfma_f32_16x16x32_bf16 v[132:135],v[160:163],a[4:7],0
ds_read_b64_tr_b16 v[188:189],v216 offset:9216
ds_read_b64_tr_b16 v[190:191],v216 offset:13312
v_mfma_f32_16x16x32_bf16 v[136:139],v[164:167],a[0:3],0
s_lshl_b32 s88,s88,5
s_add_u32 s88,s88,s91
v_mfma_f32_16x16x32_bf16 v[140:143],v[164:167],a[4:7],0
buffer_load_dwordx4 a[60:63],v218,s[24:27],s69 offen offset:3072 sc1
ds_read_b64_tr_b16 v[160:161],v217 offset:9216
v_mfma_f32_16x16x32_bf16 v[64:67],v[168:171],a[8:11],v[64:67]
ds_read_b64_tr_b16 v[162:163],v217 offset:13312
s_lshl_b32 s88,s88,10
v_mfma_f32_16x16x32_bf16 v[68:71],v[168:171],a[12:15],v[68:71]
ds_read_b64_tr_b16 v[164:165],v213 offset:9216
ds_read_b64_tr_b16 v[166:167],v213 offset:13312
v_mfma_f32_16x16x32_bf16 v[72:75],v[172:175],a[8:11],v[72:75]
s_add_u32 s88,s88,3145728
s_add_u32 s89,s89,s91
v_mfma_f32_16x16x32_bf16 v[76:79],v[172:175],a[12:15],v[76:79]
buffer_load_dwordx4 v219,s[20:23],s98 offen lds
ds_read_b64_tr_b16 v[168:169],v214 offset:38912
s_waitcnt lgkmcnt(5)
v_mfma_f32_16x16x32_bf16 v[80:83],v[176:179],a[8:11],v[80:83]
ds_read_b64_tr_b16 v[170:171],v214 offset:39936
s_lshl_b32 s89,s89,6
v_mfma_f32_16x16x32_bf16 v[84:87],v[176:179],a[12:15],v[84:87]
ds_read_b64_tr_b16 v[172:173],v252 offset:38912
ds_read_b64_tr_b16 v[174:175],v252 offset:39936
v_mfma_f32_16x16x32_bf16 v[88:91],v[180:183],a[8:11],v[88:91]
s_add_u32 s89,s89,2097152
v_add_f32 v17,1.0,v17
v_mfma_f32_16x16x32_bf16 v[92:95],v[180:183],a[12:15],v[92:95]
buffer_load_dwordx4 v220,s[20:23],s98 offen offset:1024 lds
s_add_u32 m0,s84,8192
v_mfma_f32_16x16x32_bf16 v[96:99],v[184:187],a[8:11],v[96:99]
s_barrier
ds_read_b64_tr_b16 v[176:177],v215 offset:20480
v_mfma_f32_16x16x32_bf16 v[100:103],v[184:187],a[12:15],v[100:103]
ds_read_b64_tr_b16 v[178:179],v215 offset:24576
ds_read_b64_tr_b16 v[180:181],v216 offset:20480
v_mfma_f32_16x16x32_bf16 v[104:107],v[188:191],a[8:11],v[104:107]
ds_read_b64_tr_b16 v[182:183],v216 offset:24576
ds_read_b128 v[248:251],v246 offset:0
v_mfma_f32_16x16x32_bf16 v[108:111],v[188:191],a[12:15],v[108:111]
ds_read_b64_tr_b16 v[184:185],v217 offset:20480
ds_read_b64_tr_b16 v[186:187],v217 offset:24576
s_waitcnt lgkmcnt(7)
v_mfma_f32_16x16x32_bf16 v[112:115],v[160:163],a[8:11],v[112:115]
buffer_load_dwordx4 v221,s[20:23],s98 offen lds
v_add_f32 v18,1.0,v18
v_mfma_f32_16x16x32_bf16 v[116:119],v[160:163],a[12:15],v[116:119]
ds_read_b64_tr_b16 v[188:189],v213 offset:20480
ds_read_b64_tr_b16 v[190:191],v213 offset:24576
v_mfma_f32_16x16x32_bf16 v[120:123],v[164:167],a[8:11],v[120:123]
v_rcp_f32 v16,v16
v_mfma_f32_16x16x32_bf16 v[124:127],v[164:167],a[12:15],v[124:127]
ds_read_b64_tr_b16 v[160:161],v215 offset:21504
ds_read_b64_tr_b16 v[162:163],v215 offset:25600
v_mfma_f32_16x16x32_bf16 v[128:131],v[168:171],a[8:11],v[128:131]
buffer_load_dwordx4 a[64:67],v218,s[24:27],s70 offen sc1
v_add_f32 v19,1.0,v19
v_mfma_f32_16x16x32_bf16 v[132:135],v[168:171],a[12:15],v[132:135]
ds_read_b64_tr_b16 v[164:165],v216 offset:21504
ds_read_b64_tr_b16 v[166:167],v216 offset:25600
v_mfma_f32_16x16x32_bf16 v[136:139],v[172:175],a[8:11],v[136:139]
v_rcp_f32 v17,v17
v_mfma_f32_16x16x32_bf16 v[140:143],v[172:175],a[12:15],v[140:143]
ds_read_b64_tr_b16 v[168:169],v217 offset:21504
ds_read_b64_tr_b16 v[170:171],v217 offset:25600
s_waitcnt lgkmcnt(6)
v_mfma_f32_16x16x32_bf16 v[64:67],v[176:179],a[16:19],v[64:67]
buffer_load_dwordx4 v222,s[20:23],s98 offen offset:1024 lds
s_add_u32 m0,s99,16384
v_mfma_f32_16x16x32_bf16 v[68:71],v[176:179],a[20:23],v[68:71]
s_lshr_b32 s99,s84,1
ds_read_b64_tr_b16 v[172:173],v213 offset:21504
v_mfma_f32_16x16x32_bf16 v[72:75],v[180:183],a[16:19],v[72:75]
ds_read_b64_tr_b16 v[174:175],v213 offset:25600
v_mul_f32 v0,v0,v32
v_mfma_f32_16x16x32_bf16 v[76:79],v[180:183],a[20:23],v[76:79]
ds_read_b64_tr_b16 v[176:177],v214 offset:57344
ds_read_b64_tr_b16 v[178:179],v214 offset:58368
v_mfma_f32_16x16x32_bf16 v[80:83],v[184:187],a[16:19],v[80:83]
buffer_load_dwordx4 a[68:71],v218,s[24:27],s70 offen offset:1024 sc1
v_mul_f32 v1,v1,v33
v_mfma_f32_16x16x32_bf16 v[84:87],v[184:187],a[20:23],v[84:87]
ds_read_b64_tr_b16 v[180:181],v252 offset:57344
ds_read_b64_tr_b16 v[182:183],v252 offset:58368
v_mfma_f32_16x16x32_bf16 v[88:91],v[188:191],a[16:19],v[88:91]
v_rcp_f32 v18,v18
v_mfma_f32_16x16x32_bf16 v[92:95],v[188:191],a[20:23],v[92:95]
ds_read_b64_tr_b16 v[184:185],v215 offset:28672
ds_read_b64_tr_b16 v[186:187],v215 offset:32768
s_waitcnt lgkmcnt(6)
v_mfma_f32_16x16x32_bf16 v[96:99],v[160:163],a[16:19],v[96:99]
buffer_load_dwordx4 v223,s[20:23],s98 offen lds
s_add_u32 m0,s84,102400
v_mfma_f32_16x16x32_bf16 v[100:103],v[160:163],a[20:23],v[100:103]
s_mul_i32 s98,s71,9
s_lshr_b32 s98,s98,1
v_mfma_f32_16x16x32_bf16 v[104:107],v[164:167],a[16:19],v[104:107]
ds_read_b64_tr_b16 v[188:189],v216 offset:28672
ds_read_b64_tr_b16 v[190:191],v216 offset:32768
v_mfma_f32_16x16x32_bf16 v[108:111],v[164:167],a[20:23],v[108:111]
ds_read_b64_tr_b16 v[160:161],v217 offset:28672
ds_read_b64_tr_b16 v[162:163],v217 offset:32768
v_mfma_f32_16x16x32_bf16 v[112:115],v[168:171],a[16:19],v[112:115]
s_lshl_b32 s90,s40,5
s_add_u32 s90,s90,s42
v_mfma_f32_16x16x32_bf16 v[116:119],v[168:171],a[20:23],v[116:119]
ds_read_b64_tr_b16 v[164:165],v213 offset:28672
ds_read_b64_tr_b16 v[166:167],v213 offset:32768
v_mfma_f32_16x16x32_bf16 v[120:123],v[172:175],a[16:19],v[120:123]
s_add_u32 s90,s90,4
s_lshl_b32 s90,s90,7
v_mfma_f32_16x16x32_bf16 v[124:127],v[172:175],a[20:23],v[124:127]
ds_read_b64_tr_b16 v[168:169],v215 offset:29696
ds_read_b64_tr_b16 v[170:171],v215 offset:33792
s_waitcnt lgkmcnt(6)
v_mfma_f32_16x16x32_bf16 v[128:131],v[176:179],a[16:19],v[128:131]
v_and_b32 v227,3,v226
v_mul_u32_u24 v227,4,v227
v_mfma_f32_16x16x32_bf16 v[132:135],v[176:179],a[20:23],v[132:135]
buffer_load_dwordx4 a[72:75],v218,s[24:27],s70 offen offset:2048 sc1
ds_read_b64_tr_b16 v[172:173],v216 offset:29696
v_mfma_f32_16x16x32_bf16 v[136:139],v[180:183],a[16:19],v[136:139]
ds_read_b64_tr_b16 v[174:175],v216 offset:33792
v_mul_f32 v2,v2,v34
v_mfma_f32_16x16x32_bf16 v[140:143],v[180:183],a[20:23],v[140:143]
ds_read_b64_tr_b16 v[176:177],v217 offset:29696
ds_read_b64_tr_b16 v[178:179],v217 offset:33792
v_mfma_f32_16x16x32_bf16 v[64:67],v[184:187],a[24:27],v[64:67]
v_rcp_f32 v19,v19
v_mul_f32 v3,v3,v35
v_mfma_f32_16x16x32_bf16 v[68:71],v[184:187],a[28:31],v[68:71]
buffer_load_dwordx4 a[76:79],v218,s[24:27],s70 offen offset:3072 sc1
ds_read_b64_tr_b16 v[180:181],v213 offset:29696
ds_read_b64_tr_b16 v[182:183],v213 offset:33792
v_mfma_f32_16x16x32_bf16 v[72:75],v[188:191],a[24:27],v[72:75]
v_mul_f32 v16,v16,v48
v_mul_f32 v17,v17,v49
v_mul_f32 v18,v18,v50
v_mfma_f32_16x16x32_bf16 v[76:79],v[188:191],a[28:31],v[76:79]
ds_read_b64_tr_b16 v[184:185],v214 offset:59392
ds_read_b64_tr_b16 v[186:187],v214 offset:60416
s_waitcnt lgkmcnt(6)
v_mfma_f32_16x16x32_bf16 v[80:83],v[160:163],a[24:27],v[80:83]
v_mul_f32 v19,v19,v51
v_cvt_pk_bf16_f32 v32,v0,v1
v_cvt_pk_bf16_f32 v33,v2,v3
v_mfma_f32_16x16x32_bf16 v[84:87],v[160:163],a[28:31],v[84:87]
buffer_load_dwordx4 v219,s[20:23],s98 offen lds
ds_read_b64_tr_b16 v[188:189],v252 offset:59392
ds_read_b64_tr_b16 v[190:191],v252 offset:60416
v_mfma_f32_16x16x32_bf16 v[88:91],v[164:167],a[24:27],v[88:91]
v_cvt_pk_bf16_f32 v34,v16,v17
v_cvt_pk_bf16_f32 v35,v18,v19
v_mfma_f32_16x16x32_bf16 v[92:95],v[164:167],a[28:31],v[92:95]
s_waitcnt vmcnt(23)
s_barrier
ds_read_b64_tr_b16 v[160:161],v215 offset:40960
v_mfma_f32_16x16x32_bf16 v[96:99],v[168:171],a[24:27],v[96:99]
buffer_load_dwordx4 v220,s[20:23],s98 offen offset:1024 lds
s_add_u32 m0,s84,110592
ds_read_b64_tr_b16 v[162:163],v215 offset:45056
v_mfma_f32_16x16x32_bf16 v[100:103],v[168:171],a[28:31],v[100:103]
ds_read_b64_tr_b16 v[164:165],v216 offset:40960
ds_read_b64_tr_b16 v[166:167],v216 offset:45056
v_add_f32 v228,v228,v248
v_mfma_f32_16x16x32_bf16 v[104:107],v[172:175],a[24:27],v[104:107]
v_add_f32 v229,v229,v249
v_add_f32 v230,v230,v250
v_add_f32 v231,v231,v251
v_mfma_f32_16x16x32_bf16 v[108:111],v[172:175],a[28:31],v[108:111]
ds_read_b64_tr_b16 v[168:169],v217 offset:40960
ds_read_b64_tr_b16 v[170:171],v217 offset:45056
s_waitcnt lgkmcnt(6)
v_mfma_f32_16x16x32_bf16 v[112:115],v[176:179],a[24:27],v[112:115]
buffer_load_dwordx4 v221,s[20:23],s98 offen lds
ds_read_b128 v[248:251],v246 offset:1024
v_mul_f32 v4,v209,v4
v_mfma_f32_16x16x32_bf16 v[116:119],v[176:179],a[28:31],v[116:119]
ds_read_b64_tr_b16 v[172:173],v213 offset:40960
ds_read_b64_tr_b16 v[174:175],v213 offset:45056
v_mul_f32 v5,v209,v5
v_mfma_f32_16x16x32_bf16 v[120:123],v[180:183],a[24:27],v[120:123]
v_exp_f32 v4,v4
v_mul_f32 v6,v209,v6
v_mfma_f32_16x16x32_bf16 v[124:127],v[180:183],a[28:31],v[124:127]
ds_read_b64_tr_b16 v[176:177],v215 offset:41984
ds_read_b64_tr_b16 v[178:179],v215 offset:46080
v_mul_f32 v7,v209,v7
v_mfma_f32_16x16x32_bf16 v[128:131],v[184:187],a[24:27],v[128:131]
buffer_load_dwordx4 v222,s[20:23],s98 offen offset:1024 lds
s_add_u32 m0,s99,118784
s_lshr_b32 s99,s84,1
v_mul_f32 v20,v209,v20
v_mfma_f32_16x16x32_bf16 v[132:135],v[184:187],a[28:31],v[132:135]
ds_read_b64_tr_b16 v[180:181],v216 offset:41984
ds_read_b64_tr_b16 v[182:183],v216 offset:46080
v_exp_f32 v5,v5
v_mfma_f32_16x16x32_bf16 v[136:139],v[188:191],a[24:27],v[136:139]
v_exp_f32 v6,v6
v_exp_f32 v7,v7
v_mfma_f32_16x16x32_bf16 v[140:143],v[188:191],a[28:31],v[140:143]
buffer_load_dwordx4 v223,s[20:23],s98 offen lds
s_add_u32 m0,s84,122880
s_mul_i32 s98,s72,9
s_lshr_b32 s98,s98,1
s_waitcnt lgkmcnt(4)
s_waitcnt vmcnt(24)
v_mfma_f32_16x16x32_bf16 v[64:67],v[160:163],a[32:35],v[64:67]
ds_read_b64_tr_b16 v[184:185],v217 offset:41984
ds_read_b64_tr_b16 v[186:187],v217 offset:46080
buffer_load_dword v247,v227,s[24:27],s90 offen sc1
v_mfma_f32_16x16x32_bf16 v[68:71],v[160:163],a[36:39],v[68:71]
ds_read_b64_tr_b16 v[188:189],v213 offset:41984
ds_read_b64_tr_b16 v[190:191],v213 offset:46080
v_mul_f32 v21,v209,v21
v_mfma_f32_16x16x32_bf16 v[72:75],v[164:167],a[32:35],v[72:75]
v_exp_f32 v20,v20
v_mul_f32 v22,v209,v22
v_mfma_f32_16x16x32_bf16 v[76:79],v[164:167],a[36:39],v[76:79]
v_add_u32 v214,61440,v214
ds_read_b64_tr_b16 v[160:161],v214 offset:16384
ds_read_b64_tr_b16 v[162:163],v214 offset:17408
v_mfma_f32_16x16x32_bf16 v[80:83],v[168:171],a[32:35],v[80:83]
v_exp_f32 v21,v21
v_mul_f32 v23,v209,v23
v_mfma_f32_16x16x32_bf16 v[84:87],v[168:171],a[36:39],v[84:87]
v_add_u32 v252,61440,v252
ds_read_b64_tr_b16 v[164:165],v252 offset:16384
ds_read_b64_tr_b16 v[166:167],v252 offset:17408
v_mfma_f32_16x16x32_bf16 v[88:91],v[172:175],a[32:35],v[88:91]
v_exp_f32 v22,v22
v_add_f32 v4,1.0,v4
v_mfma_f32_16x16x32_bf16 v[92:95],v[172:175],a[36:39],v[92:95]
buffer_load_dwordx4 a[80:83],v218,s[24:27],s71 offen sc1
ds_read_b64_tr_b16 v[168:169],v215 offset:49152
ds_read_b64_tr_b16 v[170:171],v215 offset:53248
s_waitcnt lgkmcnt(6)
v_mfma_f32_16x16x32_bf16 v[96:99],v[176:179],a[32:35],v[96:99]
v_exp_f32 v23,v23
v_add_f32 v5,1.0,v5
v_mfma_f32_16x16x32_bf16 v[100:103],v[176:179],a[36:39],v[100:103]
ds_read_b64_tr_b16 v[172:173],v216 offset:49152
ds_read_b64_tr_b16 v[174:175],v216 offset:53248
v_add_f32 v6,1.0,v6
v_mfma_f32_16x16x32_bf16 v[104:107],v[180:183],a[32:35],v[104:107]
buffer_load_dwordx4 a[84:87],v218,s[24:27],s71 offen offset:1024 sc1
v_rcp_f32 v4,v4
v_mfma_f32_16x16x32_bf16 v[108:111],v[180:183],a[36:39],v[108:111]
ds_read_b64_tr_b16 v[176:177],v217 offset:49152
ds_read_b64_tr_b16 v[178:179],v217 offset:53248
v_add_f32 v7,1.0,v7
v_mfma_f32_16x16x32_bf16 v[112:115],v[184:187],a[32:35],v[112:115]
v_rcp_f32 v5,v5
v_add_f32 v20,1.0,v20
v_mfma_f32_16x16x32_bf16 v[116:119],v[184:187],a[36:39],v[116:119]
ds_read_b64_tr_b16 v[180:181],v213 offset:49152
ds_read_b64_tr_b16 v[182:183],v213 offset:53248
v_add_f32 v21,1.0,v21
v_mfma_f32_16x16x32_bf16 v[120:123],v[188:191],a[32:35],v[120:123]
buffer_load_dwordx4 a[88:91],v218,s[24:27],s71 offen offset:2048 sc1
v_rcp_f32 v6,v6
v_mfma_f32_16x16x32_bf16 v[124:127],v[188:191],a[36:39],v[124:127]
ds_read_b64_tr_b16 v[184:185],v215 offset:50176
ds_read_b64_tr_b16 v[186:187],v215 offset:54272
s_waitcnt lgkmcnt(6)
v_mfma_f32_16x16x32_bf16 v[128:131],v[160:163],a[32:35],v[128:131]
v_rcp_f32 v7,v7
v_add_f32 v22,1.0,v22
v_mfma_f32_16x16x32_bf16 v[132:135],v[160:163],a[36:39],v[132:135]
buffer_load_dwordx4 a[92:95],v218,s[24:27],s71 offen offset:3072 sc1
ds_read_b64_tr_b16 v[188:189],v216 offset:50176
ds_read_b64_tr_b16 v[190:191],v216 offset:54272
v_mfma_f32_16x16x32_bf16 v[136:139],v[164:167],a[32:35],v[136:139]
v_rcp_f32 v20,v20
v_add_f32 v23,1.0,v23
v_mfma_f32_16x16x32_bf16 v[140:143],v[164:167],a[36:39],v[140:143]
ds_read_b64_tr_b16 v[160:161],v217 offset:50176
ds_read_b64_tr_b16 v[162:163],v217 offset:54272
v_mul_f32 v4,v4,v36
v_mfma_f32_16x16x32_bf16 v[64:67],v[168:171],a[40:43],v[64:67]
v_rcp_f32 v21,v21
v_mul_f32 v5,v5,v37
v_mfma_f32_16x16x32_bf16 v[68:71],v[168:171],a[44:47],v[68:71]
buffer_load_dwordx4 v219,s[20:23],s98 offen lds
ds_read_b64_tr_b16 v[164:165],v213 offset:50176
ds_read_b64_tr_b16 v[166:167],v213 offset:54272
v_mfma_f32_16x16x32_bf16 v[72:75],v[172:175],a[40:43],v[72:75]
v_rcp_f32 v22,v22
v_mul_f32 v6,v6,v38
v_mfma_f32_16x16x32_bf16 v[76:79],v[172:175],a[44:47],v[76:79]
ds_read_b64_tr_b16 v[168:169],v214 offset:18432
ds_read_b64_tr_b16 v[170:171],v214 offset:19456
s_waitcnt lgkmcnt(6)
v_mfma_f32_16x16x32_bf16 v[80:83],v[176:179],a[40:43],v[80:83]
v_rcp_f32 v23,v23
v_mul_f32 v7,v7,v39
v_mfma_f32_16x16x32_bf16 v[84:87],v[176:179],a[44:47],v[84:87]
buffer_load_dwordx4 v220,s[20:23],s98 offen offset:1024 lds
s_add_u32 m0,s84,131072
ds_read_b64_tr_b16 v[172:173],v252 offset:18432
v_mfma_f32_16x16x32_bf16 v[88:91],v[180:183],a[40:43],v[88:91]
ds_read_b64_tr_b16 v[174:175],v252 offset:19456
v_mul_f32 v20,v20,v52
v_mul_f32 v21,v21,v53
v_mfma_f32_16x16x32_bf16 v[92:95],v[180:183],a[44:47],v[92:95]
v_add_u32 v215,61440,v215
s_waitcnt vmcnt(23)
s_barrier
v_mfma_f32_16x16x32_bf16 v[96:99],v[184:187],a[40:43],v[96:99]
buffer_load_dwordx4 v221,s[20:23],s98 offen lds
ds_read_b64_tr_b16 v[176:177],v215 offset:0
ds_read_b64_tr_b16 v[178:179],v215 offset:4096
v_mfma_f32_16x16x32_bf16 v[100:103],v[184:187],a[44:47],v[100:103]
v_add_u32 v216,61440,v216
ds_read_b64_tr_b16 v[180:181],v216 offset:0
ds_read_b64_tr_b16 v[182:183],v216 offset:4096
v_mfma_f32_16x16x32_bf16 v[104:107],v[188:191],a[40:43],v[104:107]
v_mul_f32 v22,v22,v54
v_mul_f32 v23,v23,v55
v_cvt_pk_bf16_f32 v36,v4,v5
v_mfma_f32_16x16x32_bf16 v[108:111],v[188:191],a[44:47],v[108:111]
v_add_u32 v217,61440,v217
ds_read_b64_tr_b16 v[184:185],v217 offset:0
ds_read_b64_tr_b16 v[186:187],v217 offset:4096
s_waitcnt lgkmcnt(6)
v_mfma_f32_16x16x32_bf16 v[112:115],v[160:163],a[40:43],v[112:115]
buffer_load_dwordx4 a[96:99],v218,s[24:27],s72 offen sc1
v_cvt_pk_bf16_f32 v37,v6,v7
v_cvt_pk_bf16_f32 v38,v20,v21
v_mfma_f32_16x16x32_bf16 v[116:119],v[160:163],a[44:47],v[116:119]
v_add_u32 v213,61440,v213
ds_read_b64_tr_b16 v[188:189],v213 offset:0
ds_read_b64_tr_b16 v[190:191],v213 offset:4096
v_mfma_f32_16x16x32_bf16 v[120:123],v[164:167],a[40:43],v[120:123]
v_cvt_pk_bf16_f32 v39,v22,v23
v_add_f32 v232,v232,v248
v_mfma_f32_16x16x32_bf16 v[124:127],v[164:167],a[44:47],v[124:127]
ds_read_b64_tr_b16 v[160:161],v215 offset:1024
ds_read_b64_tr_b16 v[162:163],v215 offset:5120
v_add_f32 v233,v233,v249
v_mfma_f32_16x16x32_bf16 v[128:131],v[168:171],a[40:43],v[128:131]
buffer_load_dwordx4 v222,s[20:23],s98 offen offset:1024 lds
s_add_u32 m0,s99,139264
s_lshr_b32 s99,s84,1
v_mfma_f32_16x16x32_bf16 v[132:135],v[168:171],a[44:47],v[132:135]
ds_read_b64_tr_b16 v[164:165],v216 offset:1024
ds_read_b64_tr_b16 v[166:167],v216 offset:5120
v_add_f32 v234,v234,v250
v_mfma_f32_16x16x32_bf16 v[136:139],v[172:175],a[40:43],v[136:139]
v_add_f32 v235,v235,v251
ds_read_b128 v[248:251],v246 offset:2048
v_and_b32 v244,15,v226
v_mfma_f32_16x16x32_bf16 v[140:143],v[172:175],a[44:47],v[140:143]
buffer_store_dwordx4 v[32:35],v212,s[24:27],s86 offen sc1
ds_read_b64_tr_b16 v[168:169],v217 offset:1024
ds_read_b64_tr_b16 v[170:171],v217 offset:5120
s_waitcnt lgkmcnt(7)
s_waitcnt vmcnt(25)
v_mfma_f32_16x16x32_bf16 v[64:67],v[176:179],a[48:51],v[64:67]
s_waitcnt vmcnt(10)
v_cmp_ne_u32 vcc,1,v247
s_cbranch_vccnz L_slow_hb_4
L_back_hb_4:
v_mfma_f32_16x16x32_bf16 v[68:71],v[176:179],a[52:55],v[68:71]
ds_read_b64_tr_b16 v[172:173],v213 offset:1024
ds_read_b64_tr_b16 v[174:175],v213 offset:5120
v_lshl_add_u32 v244,v244,3,s18
v_mfma_f32_16x16x32_bf16 v[72:75],v[180:183],a[48:51],v[72:75]
s_mul_i32 s18,s47,-1024
s_add_u32 s18,s18,512
v_add_u32 v245,s18,v244
v_mfma_f32_16x16x32_bf16 v[76:79],v[180:183],a[52:55],v[76:79]
s_lshl_b32 s18,s101,1
s_add_u32 s18,s18,s47
s_add_u32 s17,s17,s18
v_mfma_f32_16x16x32_bf16 v[80:83],v[184:187],a[48:51],v[80:83]
s_lshl_b32 s17,s17,6
s_add_u32 s17,s17,2097152
ds_read_b64_tr_b16 v[176:177],v214 offset:36864
v_mfma_f32_16x16x32_bf16 v[84:87],v[184:187],a[52:55],v[84:87]
ds_read_b64_tr_b16 v[178:179],v214 offset:37888
ds_read_b64_tr_b16 v[180:181],v252 offset:36864
ds_read_b64_tr_b16 v[182:183],v252 offset:37888
v_mfma_f32_16x16x32_bf16 v[88:91],v[188:191],a[48:51],v[88:91]
s_add_u32 s16,s16,s18
s_lshl_b32 s16,s16,10
s_add_u32 s16,s16,3145728
v_mfma_f32_16x16x32_bf16 v[92:95],v[188:191],a[52:55],v[92:95]
ds_read_b64_tr_b16 v[184:185],v215 offset:8192
ds_read_b64_tr_b16 v[186:187],v215 offset:12288
s_waitcnt lgkmcnt(6)
v_mfma_f32_16x16x32_bf16 v[96:99],v[160:163],a[48:51],v[96:99]
ds_read_b64_tr_b16 v[194:195],v244 offset:0
ds_read_b64_tr_b16 v[198:199],v244 offset:128
ds_read_b64_tr_b16 v[202:203],v245 offset:0
v_mfma_f32_16x16x32_bf16 v[100:103],v[160:163],a[52:55],v[100:103]
buffer_load_dwordx4 a[100:103],v218,s[24:27],s72 offen offset:1024 sc1
ds_read_b64_tr_b16 v[188:189],v216 offset:8192
ds_read_b64_tr_b16 v[190:191],v216 offset:12288
v_mfma_f32_16x16x32_bf16 v[104:107],v[164:167],a[48:51],v[104:107]
ds_read_b64_tr_b16 v[206:207],v245 offset:128
v_mul_f32 v8,v210,v8
v_mul_f32 v9,v210,v9
v_mfma_f32_16x16x32_bf16 v[108:111],v[164:167],a[52:55],v[108:111]
ds_read_b64_tr_b16 v[160:161],v217 offset:8192
ds_read_b64_tr_b16 v[162:163],v217 offset:12288
v_mul_f32 v10,v210,v10
v_mfma_f32_16x16x32_bf16 v[112:115],v[168:171],a[48:51],v[112:115]
v_exp_f32 v8,v8
v_mul_f32 v11,v210,v11
v_mfma_f32_16x16x32_bf16 v[116:119],v[168:171],a[52:55],v[116:119]
buffer_load_dwordx4 v223,s[20:23],s98 offen lds
s_add_u32 m0,s84,20480
s_mul_i32 s98,s73,9
v_mfma_f32_16x16x32_bf16 v[120:123],v[172:175],a[48:51],v[120:123]
s_lshr_b32 s98,s98,1
ds_read_b64_tr_b16 v[164:165],v213 offset:8192
ds_read_b64_tr_b16 v[166:167],v213 offset:12288
v_mfma_f32_16x16x32_bf16 v[124:127],v[172:175],a[52:55],v[124:127]
ds_read_b64_tr_b16 v[168:169],v215 offset:9216
ds_read_b64_tr_b16 v[170:171],v215 offset:13312
s_waitcnt lgkmcnt(7)
v_mfma_f32_16x16x32_bf16 v[128:131],v[176:179],a[48:51],v[128:131]
v_exp_f32 v9,v9
v_mul_f32 v24,v210,v24
v_mfma_f32_16x16x32_bf16 v[132:135],v[176:179],a[52:55],v[132:135]
ds_read_b64_tr_b16 v[172:173],v216 offset:9216
ds_read_b64_tr_b16 v[174:175],v216 offset:13312
v_mul_f32 v25,v210,v25
v_mfma_f32_16x16x32_bf16 v[136:139],v[180:183],a[48:51],v[136:139]
v_exp_f32 v10,v10
v_mul_f32 v26,v210,v26
v_mfma_f32_16x16x32_bf16 v[140:143],v[180:183],a[52:55],v[140:143]
ds_read_b64_tr_b16 v[176:177],v217 offset:9216
ds_read_b64_tr_b16 v[178:179],v217 offset:13312
v_mul_f32 v27,v210,v27
v_mfma_f32_16x16x32_bf16 v[64:67],v[184:187],a[56:59],v[64:67]
v_exp_f32 v11,v11
v_exp_f32 v24,v24
v_mfma_f32_16x16x32_bf16 v[68:71],v[184:187],a[60:63],v[68:71]
buffer_store_dwordx4 v[36:39],v212,s[24:27],s86 offen offset:1024 sc1
ds_read_b64_tr_b16 v[180:181],v213 offset:9216
ds_read_b64_tr_b16 v[182:183],v213 offset:13312
v_add_f32 v8,1.0,v8
v_mfma_f32_16x16x32_bf16 v[72:75],v[188:191],a[56:59],v[72:75]
v_exp_f32 v25,v25
v_exp_f32 v26,v26
v_mfma_f32_16x16x32_bf16 v[76:79],v[188:191],a[60:63],v[76:79]
ds_read_b64_tr_b16 v[184:185],v214 offset:38912
ds_read_b64_tr_b16 v[186:187],v214 offset:39936
s_waitcnt lgkmcnt(6)
v_mfma_f32_16x16x32_bf16 v[80:83],v[160:163],a[56:59],v[80:83]
v_exp_f32 v27,v27
v_add_f32 v9,1.0,v9
v_mfma_f32_16x16x32_bf16 v[84:87],v[160:163],a[60:63],v[84:87]
ds_read_b64_tr_b16 v[188:189],v252 offset:38912
ds_read_b64_tr_b16 v[190:191],v252 offset:39936
v_add_f32 v10,1.0,v10
v_mfma_f32_16x16x32_bf16 v[88:91],v[164:167],a[56:59],v[88:91]
v_rcp_f32 v8,v8
v_add_f32 v11,1.0,v11
v_mfma_f32_16x16x32_bf16 v[92:95],v[164:167],a[60:63],v[92:95]
v_subrev_u32 v215,81920,v215
s_barrier
v_mfma_f32_16x16x32_bf16 v[96:99],v[168:171],a[56:59],v[96:99]
ds_read_b64_tr_b16 v[160:161],v215 offset:0
ds_read_b64_tr_b16 v[162:163],v215 offset:4096
v_add_f32 v24,1.0,v24
v_mfma_f32_16x16x32_bf16 v[100:103],v[168:171],a[60:63],v[100:103]
v_subrev_u32 v216,81920,v216
ds_read_b64_tr_b16 v[164:165],v216 offset:0
ds_read_b64_tr_b16 v[166:167],v216 offset:4096
v_mfma_f32_16x16x32_bf16 v[104:107],v[172:175],a[56:59],v[104:107]
buffer_load_dwordx4 a[104:107],v218,s[24:27],s72 offen offset:2048 sc1
v_rcp_f32 v9,v9
v_mfma_f32_16x16x32_bf16 v[108:111],v[172:175],a[60:63],v[108:111]
v_subrev_u32 v217,81920,v217
ds_read_b64_tr_b16 v[168:169],v217 offset:0
ds_read_b64_tr_b16 v[170:171],v217 offset:4096
s_waitcnt lgkmcnt(6)
v_mfma_f32_16x16x32_bf16 v[112:115],v[176:179],a[56:59],v[112:115]
v_rcp_f32 v10,v10
v_add_f32 v25,1.0,v25
v_mfma_f32_16x16x32_bf16 v[116:119],v[176:179],a[60:63],v[116:119]
buffer_load_dwordx4 a[108:111],v218,s[24:27],s72 offen offset:3072 sc1
v_subrev_u32 v213,81920,v213
ds_read_b64_tr_b16 v[172:173],v213 offset:0
v_mfma_f32_16x16x32_bf16 v[120:123],v[180:183],a[56:59],v[120:123]
ds_read_b64_tr_b16 v[174:175],v213 offset:4096
v_rcp_f32 v11,v11
v_mfma_f32_16x16x32_bf16 v[124:127],v[180:183],a[60:63],v[124:127]
ds_read_b64_tr_b16 v[176:177],v215 offset:1024
ds_read_b64_tr_b16 v[178:179],v215 offset:5120
v_add_f32 v26,1.0,v26
v_mfma_f32_16x16x32_bf16 v[128:131],v[184:187],a[56:59],v[128:131]
v_rcp_f32 v24,v24
v_add_f32 v27,1.0,v27
v_mfma_f32_16x16x32_bf16 v[132:135],v[184:187],a[60:63],v[132:135]
buffer_load_dwordx4 v219,s[20:23],s98 offen lds
ds_read_b64_tr_b16 v[180:181],v216 offset:1024
ds_read_b64_tr_b16 v[182:183],v216 offset:5120
v_mfma_f32_16x16x32_bf16 v[136:139],v[188:191],a[56:59],v[136:139]
v_rcp_f32 v25,v25
v_mul_f32 v8,v8,v40
v_mfma_f32_16x16x32_bf16 v[140:143],v[188:191],a[60:63],v[140:143]
ds_read_b64_tr_b16 v[184:185],v217 offset:1024
ds_read_b64_tr_b16 v[186:187],v217 offset:5120
s_waitcnt lgkmcnt(6)
v_mfma_f32_16x16x32_bf16 v[64:67],v[160:163],a[64:67],v[64:67]
v_rcp_f32 v26,v26
v_mul_f32 v9,v9,v41
v_mfma_f32_16x16x32_bf16 v[68:71],v[160:163],a[68:71],v[68:71]
buffer_load_dwordx4 v220,s[20:23],s98 offen offset:1024 lds
s_add_u32 m0,s84,28672
ds_read_b64_tr_b16 v[188:189],v213 offset:1024
v_mfma_f32_16x16x32_bf16 v[72:75],v[164:167],a[64:67],v[72:75]
ds_read_b64_tr_b16 v[190:191],v213 offset:5120
v_rcp_f32 v27,v27
v_mfma_f32_16x16x32_bf16 v[76:79],v[164:167],a[68:71],v[76:79]
v_subrev_u32 v214,61440,v214
ds_read_b64_tr_b16 v[160:161],v214 offset:16384
ds_read_b64_tr_b16 v[162:163],v214 offset:17408
v_mfma_f32_16x16x32_bf16 v[80:83],v[168:171],a[64:67],v[80:83]
buffer_load_dwordx4 v221,s[20:23],s98 offen lds
v_mul_f32 v10,v10,v42
v_mul_f32 v11,v11,v43
v_mfma_f32_16x16x32_bf16 v[84:87],v[168:171],a[68:71],v[84:87]
v_subrev_u32 v252,61440,v252
ds_read_b64_tr_b16 v[164:165],v252 offset:16384
ds_read_b64_tr_b16 v[166:167],v252 offset:17408
v_mfma_f32_16x16x32_bf16 v[88:91],v[172:175],a[64:67],v[88:91]
v_mul_f32 v24,v24,v56
v_mul_f32 v25,v25,v57
v_mul_f32 v26,v26,v58
v_mfma_f32_16x16x32_bf16 v[92:95],v[172:175],a[68:71],v[92:95]
ds_read_b64_tr_b16 v[168:169],v215 offset:8192
ds_read_b64_tr_b16 v[170:171],v215 offset:12288
s_waitcnt lgkmcnt(6)
v_mfma_f32_16x16x32_bf16 v[96:99],v[176:179],a[64:67],v[96:99]
buffer_load_dwordx4 a[112:115],v218,s[24:27],s73 offen sc1
v_mul_f32 v27,v27,v59
v_cvt_pk_bf16_f32 v40,v8,v9
v_mfma_f32_16x16x32_bf16 v[100:103],v[176:179],a[68:71],v[100:103]
ds_read_b64_tr_b16 v[172:173],v216 offset:8192
ds_read_b64_tr_b16 v[174:175],v216 offset:12288
v_cvt_pk_bf16_f32 v41,v10,v11
v_mfma_f32_16x16x32_bf16 v[104:107],v[180:183],a[64:67],v[104:107]
v_cvt_pk_bf16_f32 v42,v24,v25
v_cvt_pk_bf16_f32 v43,v26,v27
v_mfma_f32_16x16x32_bf16 v[108:111],v[180:183],a[68:71],v[108:111]
ds_read_b64_tr_b16 v[176:177],v217 offset:8192
ds_read_b64_tr_b16 v[178:179],v217 offset:12288
v_add_f32 v236,v236,v248
v_mfma_f32_16x16x32_bf16 v[112:115],v[184:187],a[64:67],v[112:115]
buffer_store_dwordx4 v[40:43],v212,s[24:27],s87 offen sc1
v_add_f32 v237,v237,v249
v_add_f32 v238,v238,v250
v_add_f32 v239,v239,v251
v_mfma_f32_16x16x32_bf16 v[116:119],v[184:187],a[68:71],v[116:119]
ds_read_b64_tr_b16 v[180:181],v213 offset:8192
ds_read_b64_tr_b16 v[182:183],v213 offset:12288
v_cvt_pk_bf16_f32 v240,v228,v229
v_cvt_pk_bf16_f32 v241,v230,v231
v_mfma_f32_16x16x32_bf16 v[120:123],v[188:191],a[64:67],v[120:123]
v_cvt_pk_bf16_f32 v243,v236,v237
v_cndmask_b32 v242,0,v243,s[32:33]
v_cndmask_b32 v243,0,v243,s[34:35]
v_mfma_f32_16x16x32_bf16 v[124:127],v[188:191],a[68:71],v[124:127]
ds_read_b64_tr_b16 v[184:185],v215 offset:9216
ds_read_b64_tr_b16 v[186:187],v215 offset:13312
s_waitcnt lgkmcnt(6)
v_mfma_f32_16x16x32_bf16 v[128:131],v[160:163],a[64:67],v[128:131]
v_cvt_pk_bf16_f32 v228,v232,v233
v_cvt_pk_bf16_f32 v229,v234,v235
v_cvt_pk_bf16_f32 v231,v238,v239
v_mfma_f32_16x16x32_bf16 v[132:135],v[160:163],a[68:71],v[132:135]
ds_read_b64_tr_b16 v[188:189],v216 offset:9216
ds_read_b64_tr_b16 v[190:191],v216 offset:13312
v_cndmask_b32 v230,0,v231,s[32:33]
v_mfma_f32_16x16x32_bf16 v[136:139],v[164:167],a[64:67],v[136:139]
v_cndmask_b32 v231,0,v231,s[34:35]
v_mul_f32 v12,v211,v12
v_mfma_f32_16x16x32_bf16 v[140:143],v[164:167],a[68:71],v[140:143]
ds_read_b64_tr_b16 v[160:161],v217 offset:9216
ds_read_b64_tr_b16 v[162:163],v217 offset:13312
v_mul_f32 v13,v211,v13
v_mfma_f32_16x16x32_bf16 v[64:67],v[168:171],a[72:75],v[64:67]
v_exp_f32 v12,v12
v_mul_f32 v14,v211,v14
v_mfma_f32_16x16x32_bf16 v[68:71],v[168:171],a[76:79],v[68:71]
buffer_load_dwordx4 v222,s[20:23],s98 offen offset:1024 lds
s_add_u32 m0,s99,36864
s_lshr_b32 s99,s84,1
v_mfma_f32_16x16x32_bf16 v[72:75],v[172:175],a[72:75],v[72:75]
ds_read_b64_tr_b16 v[164:165],v213 offset:9216
ds_read_b64_tr_b16 v[166:167],v213 offset:13312
v_mul_f32 v15,v211,v15
v_mfma_f32_16x16x32_bf16 v[76:79],v[172:175],a[76:79],v[76:79]
ds_read_b64_tr_b16 v[168:169],v214 offset:18432
ds_read_b64_tr_b16 v[170:171],v214 offset:19456
s_waitcnt lgkmcnt(6)
v_mfma_f32_16x16x32_bf16 v[80:83],v[176:179],a[72:75],v[80:83]
v_exp_f32 v13,v13
v_add_f32 v12,1.0,v12
v_mfma_f32_16x16x32_bf16 v[84:87],v[176:179],a[76:79],v[84:87]
buffer_load_dwordx4 a[116:119],v218,s[24:27],s73 offen offset:1024 sc1
ds_read_b64_tr_b16 v[172:173],v252 offset:18432
ds_read_b64_tr_b16 v[174:175],v252 offset:19456
v_mfma_f32_16x16x32_bf16 v[88:91],v[180:183],a[72:75],v[88:91]
v_exp_f32 v14,v14
v_add_f32 v13,1.0,v13
v_mfma_f32_16x16x32_bf16 v[92:95],v[180:183],a[76:79],v[92:95]
v_add_u32 v215,102400,v215
s_barrier
v_mfma_f32_16x16x32_bf16 v[96:99],v[184:187],a[72:75],v[96:99]
ds_read_b64_tr_b16 v[176:177],v215 offset:0
ds_read_b64_tr_b16 v[178:179],v215 offset:4096
v_exp_f32 v15,v15
v_mfma_f32_16x16x32_bf16 v[100:103],v[184:187],a[76:79],v[100:103]
buffer_load_dwordx4 v223,s[20:23],s98 offen lds
s_add_u32 m0,s84,40960
s_mul_i32 s98,s74,9
s_lshr_b32 s98,s98,1
v_mfma_f32_16x16x32_bf16 v[104:107],v[188:191],a[72:75],v[104:107]
v_add_u32 v216,102400,v216
ds_read_b64_tr_b16 v[180:181],v216 offset:0
ds_read_b64_tr_b16 v[182:183],v216 offset:4096
v_add_f32 v14,1.0,v14
v_mfma_f32_16x16x32_bf16 v[108:111],v[188:191],a[76:79],v[108:111]
v_add_u32 v217,102400,v217
s_waitcnt lgkmcnt(4)
ds_read_b64_tr_b16 v[184:185],v217 offset:0
ds_read_b64_tr_b16 v[186:187],v217 offset:4096
v_mfma_f32_16x16x32_bf16 v[112:115],v[160:163],a[72:75],v[112:115]
v_rcp_f32 v12,v12
v_add_f32 v15,1.0,v15
v_mfma_f32_16x16x32_bf16 v[116:119],v[160:163],a[76:79],v[116:119]
v_add_u32 v213,102400,v213
ds_read_b64_tr_b16 v[188:189],v213 offset:0
ds_read_b64_tr_b16 v[190:191],v213 offset:4096
v_mfma_f32_16x16x32_bf16 v[120:123],v[164:167],a[72:75],v[120:123]
v_rcp_f32 v13,v13
v_mul_f32 v12,v12,v44
v_mfma_f32_16x16x32_bf16 v[124:127],v[164:167],a[76:79],v[124:127]
v_rcp_f32 v14,v14
v_mul_f32 v13,v13,v45
v_mfma_f32_16x16x32_bf16 v[128:131],v[168:171],a[72:75],v[128:131]
buffer_load_dwordx4 a[120:123],v218,s[24:27],s73 offen offset:2048 sc1
v_rcp_f32 v15,v15
v_mul_f32 v14,v14,v46
v_mfma_f32_16x16x32_bf16 v[132:135],v[168:171],a[76:79],v[132:135]
v_mul_f32 v15,v15,v47
v_cvt_pk_bf16_f32 v44,v12,v13
v_cvt_pk_bf16_f32 v45,v14,v15
ds_read_b64_tr_b16 v[160:161],v215 offset:1024
v_mfma_f32_16x16x32_bf16 v[136:139],v[172:175],a[72:75],v[136:139]
ds_read_b64_tr_b16 v[162:163],v215 offset:5120
ds_read_b64_tr_b16 v[164:165],v216 offset:1024
ds_read_b64_tr_b16 v[166:167],v216 offset:5120
v_mul_f32 v28,v211,v28
v_mfma_f32_16x16x32_bf16 v[140:143],v[172:175],a[76:79],v[140:143]
buffer_load_dwordx4 a[124:127],v218,s[24:27],s73 offen offset:3072 sc1
ds_read_b64_tr_b16 v[168:169],v217 offset:1024
ds_read_b64_tr_b16 v[170:171],v217 offset:5120
v_mul_f32 v29,v211,v29
v_mfma_f32_16x16x32_bf16 v[0:3],v[240:243],v[192:195],0
v_exp_f32 v28,v28
v_exp_f32 v29,v29
v_mfma_f32_16x16x32_bf16 v[4:7],v[228:231],v[192:195],0
v_mul_f32 v30,v211,v30
v_exp_f32 v30,v30
v_mfma_f32_16x16x32_bf16 v[8:11],v[240:243],v[196:199],0
buffer_load_dwordx4 v219,s[20:23],s98 offen lds
v_mul_f32 v31,v211,v31
v_add_f32 v28,1.0,v28
v_mfma_f32_16x16x32_bf16 v[12:15],v[228:231],v[196:199],0
v_exp_f32 v31,v31
v_add_f32 v29,1.0,v29
v_mfma_f32_16x16x32_bf16 v[16:19],v[240:243],v[200:203],0
v_rcp_f32 v28,v28
v_rcp_f32 v29,v29
v_add_f32 v30,1.0,v30
v_rcp_f32 v30,v30
v_add_f32 v31,1.0,v31
v_rcp_f32 v31,v31
v_mfma_f32_16x16x32_bf16 v[20:23],v[228:231],v[200:203],0
buffer_load_dwordx4 v220,s[20:23],s98 offen offset:1024 lds
s_add_u32 m0,s84,49152
v_mul_f32 v28,v28,v60
v_mul_f32 v29,v29,v61
v_mul_f32 v30,v30,v62
v_mul_f32 v31,v31,v63
v_cvt_pk_bf16_f32 v46,v28,v29
v_cvt_pk_bf16_f32 v47,v30,v31
buffer_store_dwordx4 v[44:47],v212,s[24:27],s87 offen offset:1024 sc1
v_mfma_f32_16x16x32_bf16 v[24:27],v[240:243],v[204:207],0
v_lshrrev_b32 v246,4,v226
v_cmp_eq_u32 vcc,1,v246
v_cndmask_b32 v246,v6,v4,s[92:93]
v_mfma_f32_16x16x32_bf16 v[28:31],v[228:231],v[204:207],0
s_waitcnt lgkmcnt(6)
s_waitcnt vmcnt(24)
v_cndmask_b32 v4,v4,v6,s[92:93]
v_mfma_f32_16x16x32_bf16 v[64:67],v[176:179],a[80:83],v[64:67]
v_add_f32 v6,0x358637bd,v246
v_rcp_f32 v6,v6
v_mfma_f32_16x16x32_bf16 v[68:71],v[176:179],a[84:87],v[68:71]
ds_read_b64_tr_b16 v[172:173],v213 offset:1024
ds_read_b64_tr_b16 v[174:175],v213 offset:5120
v_cndmask_b32 v246,v14,v12,s[92:93]
v_mfma_f32_16x16x32_bf16 v[72:75],v[180:183],a[80:83],v[72:75]
v_cndmask_b32 v12,v12,v14,s[92:93]
v_add_f32 v14,0x358637bd,v246
v_mul_f32 v0,v6,v0
v_mfma_f32_16x16x32_bf16 v[76:79],v[180:183],a[84:87],v[76:79]
v_add_u32 v214,102400,v214
ds_read_b64_tr_b16 v[176:177],v214 offset:16384
ds_read_b64_tr_b16 v[178:179],v214 offset:17408
v_mfma_f32_16x16x32_bf16 v[80:83],v[184:187],a[80:83],v[80:83]
v_rcp_f32 v14,v14
v_mul_f32 v1,v6,v1
v_mfma_f32_16x16x32_bf16 v[84:87],v[184:187],a[84:87],v[84:87]
v_add_u32 v252,102400,v252
ds_read_b64_tr_b16 v[180:181],v252 offset:16384
ds_read_b64_tr_b16 v[182:183],v252 offset:17408
v_mfma_f32_16x16x32_bf16 v[88:91],v[188:191],a[80:83],v[88:91]
v_mul_f32 v2,v6,v2
v_mul_f32 v3,v6,v3
v_cvt_pk_bf16_f32 v0,v0,v1
v_mfma_f32_16x16x32_bf16 v[92:95],v[188:191],a[84:87],v[92:95]
ds_read_b64_tr_b16 v[184:185],v215 offset:8192
ds_read_b64_tr_b16 v[186:187],v215 offset:12288
s_waitcnt lgkmcnt(6)
v_mfma_f32_16x16x32_bf16 v[96:99],v[160:163],a[80:83],v[96:99]
v_cvt_pk_bf16_f32 v1,v2,v3
v_mul_f32 v8,v14,v8
v_mul_f32 v9,v14,v9
v_mfma_f32_16x16x32_bf16 v[100:103],v[160:163],a[84:87],v[100:103]
buffer_load_dwordx4 v221,s[20:23],s98 offen lds
ds_read_b64_tr_b16 v[188:189],v216 offset:8192
v_mfma_f32_16x16x32_bf16 v[104:107],v[164:167],a[80:83],v[104:107]
ds_read_b64_tr_b16 v[190:191],v216 offset:12288
v_mul_f32 v10,v14,v10
v_mfma_f32_16x16x32_bf16 v[108:111],v[164:167],a[84:87],v[108:111]
ds_read_b64_tr_b16 v[160:161],v217 offset:8192
ds_read_b64_tr_b16 v[162:163],v217 offset:12288
v_mfma_f32_16x16x32_bf16 v[112:115],v[168:171],a[80:83],v[112:115]
v_mul_f32 v11,v14,v11
v_cvt_pk_bf16_f32 v2,v8,v9
v_cvt_pk_bf16_f32 v3,v10,v11
v_mfma_f32_16x16x32_bf16 v[116:119],v[168:171],a[84:87],v[116:119]
buffer_load_dwordx4 a[128:131],v218,s[24:27],s74 offen sc1
ds_read_b64_tr_b16 v[164:165],v213 offset:8192
v_mfma_f32_16x16x32_bf16 v[120:123],v[172:175],a[80:83],v[120:123]
ds_read_b64_tr_b16 v[166:167],v213 offset:12288
v_and_b32 v244,15,v226
v_mfma_f32_16x16x32_bf16 v[124:127],v[172:175],a[84:87],v[124:127]
ds_read_b64_tr_b16 v[168:169],v215 offset:9216
ds_read_b64_tr_b16 v[170:171],v215 offset:13312
s_waitcnt lgkmcnt(6)
v_mfma_f32_16x16x32_bf16 v[128:131],v[176:179],a[80:83],v[128:131]
v_lshlrev_b32 v244,2,v244
v_mov_b32 v245,2147483648
v_mfma_f32_16x16x32_bf16 v[132:135],v[176:179],a[84:87],v[132:135]
buffer_load_dwordx4 v222,s[20:23],s98 offen offset:1024 lds
s_add_u32 m0,s99,57344
v_mfma_f32_16x16x32_bf16 v[136:139],v[180:183],a[80:83],v[136:139]
s_lshr_b32 s99,s84,1
ds_read_b64_tr_b16 v[172:173],v216 offset:9216
v_mfma_f32_16x16x32_bf16 v[140:143],v[180:183],a[84:87],v[140:143]
ds_read_b64_tr_b16 v[174:175],v216 offset:13312
ds_read_b64_tr_b16 v[176:177],v217 offset:9216
v_mfma_f32_16x16x32_bf16 v[64:67],v[184:187],a[88:91],v[64:67]
ds_read_b64_tr_b16 v[178:179],v217 offset:13312
v_cndmask_b32 v244,v245,v244,vcc
v_mfma_f32_16x16x32_bf16 v[68:71],v[184:187],a[92:95],v[68:71]
ds_read_b64_tr_b16 v[180:181],v213 offset:9216
ds_read_b64_tr_b16 v[182:183],v213 offset:13312
v_mfma_f32_16x16x32_bf16 v[72:75],v[188:191],a[88:91],v[72:75]
buffer_load_dwordx4 a[132:135],v218,s[24:27],s74 offen offset:1024 sc1
v_cndmask_b32 v5,v5,v7,s[92:93]
v_mfma_f32_16x16x32_bf16 v[76:79],v[188:191],a[92:95],v[76:79]
ds_read_b64_tr_b16 v[184:185],v214 offset:18432
ds_read_b64_tr_b16 v[186:187],v214 offset:19456
s_waitcnt lgkmcnt(6)
v_mfma_f32_16x16x32_bf16 v[80:83],v[160:163],a[88:91],v[80:83]
v_mul_f32 v4,v6,v4
v_mul_f32 v5,v6,v5
v_mfma_f32_16x16x32_bf16 v[84:87],v[160:163],a[92:95],v[84:87]
ds_read_b64_tr_b16 v[188:189],v252 offset:18432
ds_read_b64_tr_b16 v[190:191],v252 offset:19456
v_mfma_f32_16x16x32_bf16 v[88:91],v[164:167],a[88:91],v[88:91]
buffer_load_dwordx4 v223,s[20:23],s98 offen lds
s_add_u32 m0,s84,61440
v_mfma_f32_16x16x32_bf16 v[92:95],v[164:167],a[92:95],v[92:95]
s_mul_i32 s98,s75,9
s_lshr_b32 s98,s98,1
s_waitcnt vmcnt(21)
v_mfma_f32_16x16x32_bf16 v[96:99],v[168:171],a[88:91],v[96:99]
s_barrier
ds_read_b64_tr_b16 v[160:161],v215 offset:20480
v_mfma_f32_16x16x32_bf16 v[100:103],v[168:171],a[92:95],v[100:103]
ds_read_b64_tr_b16 v[162:163],v215 offset:24576
ds_read_b64_tr_b16 v[164:165],v216 offset:20480
v_mfma_f32_16x16x32_bf16 v[104:107],v[172:175],a[88:91],v[104:107]
ds_read_b64_tr_b16 v[166:167],v216 offset:24576
v_cvt_pk_bf16_f32 v4,v4,v5
v_mfma_f32_16x16x32_bf16 v[108:111],v[172:175],a[92:95],v[108:111]
ds_read_b64_tr_b16 v[168:169],v217 offset:20480
ds_read_b64_tr_b16 v[170:171],v217 offset:24576
s_waitcnt lgkmcnt(6)
v_mfma_f32_16x16x32_bf16 v[112:115],v[176:179],a[88:91],v[112:115]
v_cndmask_b32 v13,v13,v15,s[92:93]
v_mul_f32 v12,v14,v12
v_mfma_f32_16x16x32_bf16 v[116:119],v[176:179],a[92:95],v[116:119]
ds_read_b64_tr_b16 v[172:173],v213 offset:20480
ds_read_b64_tr_b16 v[174:175],v213 offset:24576
v_mfma_f32_16x16x32_bf16 v[120:123],v[180:183],a[88:91],v[120:123]
buffer_load_dwordx4 a[136:139],v218,s[24:27],s74 offen offset:2048 sc1
v_mul_f32 v13,v14,v13
v_mfma_f32_16x16x32_bf16 v[124:127],v[180:183],a[92:95],v[124:127]
ds_read_b64_tr_b16 v[176:177],v215 offset:21504
ds_read_b64_tr_b16 v[178:179],v215 offset:25600
v_mfma_f32_16x16x32_bf16 v[128:131],v[184:187],a[88:91],v[128:131]
v_cvt_pk_bf16_f32 v12,v12,v13
v_cndmask_b32 v246,v22,v20,s[92:93]
v_mfma_f32_16x16x32_bf16 v[132:135],v[184:187],a[92:95],v[132:135]
ds_read_b64_tr_b16 v[180:181],v216 offset:21504
ds_read_b64_tr_b16 v[182:183],v216 offset:25600
v_mfma_f32_16x16x32_bf16 v[136:139],v[188:191],a[88:91],v[136:139]
v_cndmask_b32 v20,v20,v22,s[92:93]
v_add_f32 v22,0x358637bd,v246
v_mfma_f32_16x16x32_bf16 v[140:143],v[188:191],a[92:95],v[140:143]
buffer_store_dwordx4 v[0:3],v212,s[24:27],s88 offen sc1
ds_read_b64_tr_b16 v[184:185],v217 offset:21504
s_waitcnt lgkmcnt(5)
s_waitcnt vmcnt(20)
v_mfma_f32_16x16x32_bf16 v[64:67],v[160:163],a[96:99],v[64:67]
ds_read_b64_tr_b16 v[186:187],v217 offset:25600
s_lshl_b32 s88,s40,5
v_mfma_f32_16x16x32_bf16 v[68:71],v[160:163],a[100:103],v[68:71]
ds_read_b64_tr_b16 v[188:189],v213 offset:21504
ds_read_b64_tr_b16 v[190:191],v213 offset:25600
v_mfma_f32_16x16x32_bf16 v[72:75],v[164:167],a[96:99],v[72:75]
s_add_u32 s88,s88,s42
s_add_u32 s88,s88,8
v_mfma_f32_16x16x32_bf16 v[76:79],v[164:167],a[100:103],v[76:79]
ds_read_b64_tr_b16 v[160:161],v214 offset:36864
ds_read_b64_tr_b16 v[162:163],v214 offset:37888
v_mfma_f32_16x16x32_bf16 v[80:83],v[168:171],a[96:99],v[80:83]
s_lshl_b32 s88,s88,5
s_add_u32 s88,s88,s43
v_mfma_f32_16x16x32_bf16 v[84:87],v[168:171],a[100:103],v[84:87]
ds_read_b64_tr_b16 v[164:165],v252 offset:36864
ds_read_b64_tr_b16 v[166:167],v252 offset:37888
v_mfma_f32_16x16x32_bf16 v[88:91],v[172:175],a[96:99],v[88:91]
s_lshl_b32 s88,s88,2
v_cndmask_b32 v21,v21,v23,s[92:93]
v_mfma_f32_16x16x32_bf16 v[92:95],v[172:175],a[100:103],v[92:95]
ds_read_b64_tr_b16 v[168:169],v215 offset:28672
ds_read_b64_tr_b16 v[170:171],v215 offset:32768
s_waitcnt lgkmcnt(6)
v_mfma_f32_16x16x32_bf16 v[96:99],v[176:179],a[96:99],v[96:99]
v_rcp_f32 v22,v22
v_mfma_f32_16x16x32_bf16 v[100:103],v[176:179],a[100:103],v[100:103]
buffer_load_dwordx4 a[140:143],v218,s[24:27],s74 offen offset:3072 sc1
ds_read_b64_tr_b16 v[172:173],v216 offset:28672
v_mfma_f32_16x16x32_bf16 v[104:107],v[180:183],a[96:99],v[104:107]
ds_read_b64_tr_b16 v[174:175],v216 offset:32768
v_mul_f32 v20,v22,v20
v_mfma_f32_16x16x32_bf16 v[108:111],v[180:183],a[100:103],v[108:111]
ds_read_b64_tr_b16 v[176:177],v217 offset:28672
ds_read_b64_tr_b16 v[178:179],v217 offset:32768
v_mfma_f32_16x16x32_bf16 v[112:115],v[184:187],a[96:99],v[112:115]
v_mul_f32 v21,v22,v21
v_cvt_pk_bf16_f32 v20,v20,v21
v_mfma_f32_16x16x32_bf16 v[116:119],v[184:187],a[100:103],v[116:119]
ds_read_b64_tr_b16 v[180:181],v213 offset:28672
ds_read_b64_tr_b16 v[182:183],v213 offset:32768
v_mfma_f32_16x16x32_bf16 v[120:123],v[188:191],a[96:99],v[120:123]
buffer_load_dwordx4 v219,s[20:23],s98 offen lds
v_cndmask_b32 v246,v30,v28,s[92:93]
v_mfma_f32_16x16x32_bf16 v[124:127],v[188:191],a[100:103],v[124:127]
ds_read_b64_tr_b16 v[184:185],v215 offset:29696
ds_read_b64_tr_b16 v[186:187],v215 offset:33792
s_waitcnt lgkmcnt(6)
v_mfma_f32_16x16x32_bf16 v[128:131],v[160:163],a[96:99],v[128:131]
v_cndmask_b32 v28,v28,v30,s[92:93]
v_add_f32 v30,0x358637bd,v246
v_mfma_f32_16x16x32_bf16 v[132:135],v[160:163],a[100:103],v[132:135]
ds_read_b64_tr_b16 v[188:189],v216 offset:29696
ds_read_b64_tr_b16 v[190:191],v216 offset:33792
v_mfma_f32_16x16x32_bf16 v[136:139],v[164:167],a[96:99],v[136:139]
buffer_store_dword v4,v244,s[24:27],s89 offen sc1
v_cndmask_b32 v29,v29,v31,s[92:93]
v_mfma_f32_16x16x32_bf16 v[140:143],v[164:167],a[100:103],v[140:143]
buffer_load_dwordx4 v220,s[20:23],s98 offen offset:1024 lds
s_add_u32 m0,s84,69632
v_mfma_f32_16x16x32_bf16 v[64:67],v[168:171],a[104:107],v[64:67]
ds_read_b64_tr_b16 v[160:161],v217 offset:29696
ds_read_b64_tr_b16 v[162:163],v217 offset:33792
v_mfma_f32_16x16x32_bf16 v[68:71],v[168:171],a[108:111],v[68:71]
ds_read_b64_tr_b16 v[164:165],v213 offset:29696
ds_read_b64_tr_b16 v[166:167],v213 offset:33792
v_mfma_f32_16x16x32_bf16 v[72:75],v[172:175],a[104:107],v[72:75]
v_rcp_f32 v30,v30
v_mfma_f32_16x16x32_bf16 v[76:79],v[172:175],a[108:111],v[76:79]
buffer_load_dwordx4 v221,s[20:23],s98 offen lds
ds_read_b64_tr_b16 v[168:169],v214 offset:38912
s_waitcnt lgkmcnt(5)
v_mfma_f32_16x16x32_bf16 v[80:83],v[176:179],a[104:107],v[80:83]
ds_read_b64_tr_b16 v[170:171],v214 offset:39936
v_mul_f32 v28,v30,v28
v_mfma_f32_16x16x32_bf16 v[84:87],v[176:179],a[108:111],v[84:87]
ds_read_b64_tr_b16 v[172:173],v252 offset:38912
ds_read_b64_tr_b16 v[174:175],v252 offset:39936
v_mfma_f32_16x16x32_bf16 v[88:91],v[180:183],a[104:107],v[88:91]
v_mul_f32 v29,v30,v29
v_cvt_pk_bf16_f32 v28,v28,v29
v_mfma_f32_16x16x32_bf16 v[92:95],v[180:183],a[108:111],v[92:95]
buffer_store_dword v12,v244,s[24:27],s89 offen offset:2048 sc1
v_subrev_u32 v215,81920,v215
s_waitcnt vmcnt(13)
v_mfma_f32_16x16x32_bf16 v[96:99],v[184:187],a[104:107],v[96:99]
buffer_load_dwordx4 a[144:147],v218,s[24:27],s75 offen sc1
s_barrier
v_mfma_f32_16x16x32_bf16 v[100:103],v[184:187],a[108:111],v[100:103]
v_subrev_u32 v216,81920,v216
ds_read_b64_tr_b16 v[176:177],v215 offset:0
buffer_store_dword v225,v224,s[24:27],s88 offen sc1
v_mfma_f32_16x16x32_bf16 v[104:107],v[188:191],a[104:107],v[104:107]
ds_read_b64_tr_b16 v[178:179],v215 offset:4096
ds_read_b64_tr_b16 v[180:181],v216 offset:0
v_mfma_f32_16x16x32_bf16 v[108:111],v[188:191],a[108:111],v[108:111]
v_subrev_u32 v217,81920,v217
ds_read_b64_tr_b16 v[182:183],v216 offset:4096
s_waitcnt lgkmcnt(4)
v_mfma_f32_16x16x32_bf16 v[112:115],v[160:163],a[104:107],v[112:115]
buffer_load_dwordx4 v222,s[20:23],s98 offen offset:1024 lds
s_add_u32 m0,s99,77824
v_mfma_f32_16x16x32_bf16 v[116:119],v[160:163],a[108:111],v[116:119]
s_lshr_b32 s99,s84,1
v_subrev_u32 v213,81920,v213
v_mfma_f32_16x16x32_bf16 v[120:123],v[164:167],a[104:107],v[120:123]
ds_read_b64_tr_b16 v[184:185],v217 offset:0
ds_read_b64_tr_b16 v[186:187],v217 offset:4096
v_mfma_f32_16x16x32_bf16 v[124:127],v[164:167],a[108:111],v[124:127]
ds_read_b64_tr_b16 v[188:189],v213 offset:0
ds_read_b64_tr_b16 v[190:191],v213 offset:4096
v_mfma_f32_16x16x32_bf16 v[128:131],v[168:171],a[104:107],v[128:131]
ds_read_b64_tr_b16 v[160:161],v215 offset:1024
ds_read_b64_tr_b16 v[162:163],v215 offset:5120
v_mfma_f32_16x16x32_bf16 v[132:135],v[168:171],a[108:111],v[132:135]
buffer_load_dwordx4 a[148:151],v218,s[24:27],s75 offen offset:1024 sc1
ds_read_b64_tr_b16 v[164:165],v216 offset:1024
v_mfma_f32_16x16x32_bf16 v[136:139],v[172:175],a[104:107],v[136:139]
ds_read_b64_tr_b16 v[166:167],v216 offset:5120
v_mul_f32 v16,v22,v16
v_mfma_f32_16x16x32_bf16 v[140:143],v[172:175],a[108:111],v[140:143]
ds_read_b64_tr_b16 v[168:169],v217 offset:1024
ds_read_b64_tr_b16 v[170:171],v217 offset:5120
s_waitcnt lgkmcnt(6)
v_mfma_f32_16x16x32_bf16 v[64:67],v[176:179],a[112:115],v[64:67]
buffer_load_dwordx4 v223,s[20:23],s98 offen lds
s_add_u32 m0,s84,81920
v_mfma_f32_16x16x32_bf16 v[68:71],v[176:179],a[116:119],v[68:71]
s_mul_i32 s98,s76,9
s_lshr_b32 s98,s98,1
v_mfma_f32_16x16x32_bf16 v[72:75],v[180:183],a[112:115],v[72:75]
ds_read_b64_tr_b16 v[172:173],v213 offset:1024
ds_read_b64_tr_b16 v[174:175],v213 offset:5120
v_mfma_f32_16x16x32_bf16 v[76:79],v[180:183],a[116:119],v[76:79]
v_subrev_u32 v214,81920,v214
ds_read_b64_tr_b16 v[176:177],v214 offset:16384
v_mfma_f32_16x16x32_bf16 v[80:83],v[184:187],a[112:115],v[80:83]
ds_read_b64_tr_b16 v[178:179],v214 offset:17408
v_mul_f32 v17,v22,v17
v_mfma_f32_16x16x32_bf16 v[84:87],v[184:187],a[116:119],v[84:87]
v_subrev_u32 v252,81920,v252
ds_read_b64_tr_b16 v[180:181],v252 offset:16384
v_mfma_f32_16x16x32_bf16 v[88:91],v[188:191],a[112:115],v[88:91]
ds_read_b64_tr_b16 v[182:183],v252 offset:17408
v_mul_f32 v18,v22,v18
v_mfma_f32_16x16x32_bf16 v[92:95],v[188:191],a[116:119],v[92:95]
ds_read_b64_tr_b16 v[184:185],v215 offset:8192
ds_read_b64_tr_b16 v[186:187],v215 offset:12288
s_waitcnt lgkmcnt(6)
v_mfma_f32_16x16x32_bf16 v[96:99],v[160:163],a[112:115],v[96:99]
v_mul_f32 v19,v22,v19
v_cvt_pk_bf16_f32 v16,v16,v17
v_mfma_f32_16x16x32_bf16 v[100:103],v[160:163],a[116:119],v[100:103]
buffer_store_dword v20,v244,s[24:27],s17 offen sc1
ds_read_b64_tr_b16 v[188:189],v216 offset:8192
v_mfma_f32_16x16x32_bf16 v[104:107],v[164:167],a[112:115],v[104:107]
buffer_load_dwordx4 a[152:155],v218,s[24:27],s75 offen offset:2048 sc1
ds_read_b64_tr_b16 v[190:191],v216 offset:12288
v_mfma_f32_16x16x32_bf16 v[108:111],v[164:167],a[116:119],v[108:111]
ds_read_b64_tr_b16 v[160:161],v217 offset:8192
ds_read_b64_tr_b16 v[162:163],v217 offset:12288
v_mfma_f32_16x16x32_bf16 v[112:115],v[168:171],a[112:115],v[112:115]
v_cvt_pk_bf16_f32 v17,v18,v19
v_mul_f32 v24,v30,v24
v_mfma_f32_16x16x32_bf16 v[116:119],v[168:171],a[116:119],v[116:119]
ds_read_b64_tr_b16 v[164:165],v213 offset:8192
ds_read_b64_tr_b16 v[166:167],v213 offset:12288
v_mfma_f32_16x16x32_bf16 v[120:123],v[172:175],a[112:115],v[120:123]
v_mul_f32 v25,v30,v25
v_mul_f32 v26,v30,v26
v_mfma_f32_16x16x32_bf16 v[124:127],v[172:175],a[116:119],v[124:127]
buffer_load_dwordx4 a[156:159],v218,s[24:27],s75 offen offset:3072 sc1
ds_read_b64_tr_b16 v[168:169],v215 offset:9216
s_waitcnt lgkmcnt(5)
v_mfma_f32_16x16x32_bf16 v[128:131],v[176:179],a[112:115],v[128:131]
ds_read_b64_tr_b16 v[170:171],v215 offset:13312
v_mul_f32 v27,v30,v27
v_mfma_f32_16x16x32_bf16 v[132:135],v[176:179],a[116:119],v[132:135]
ds_read_b64_tr_b16 v[172:173],v216 offset:9216
ds_read_b64_tr_b16 v[174:175],v216 offset:13312
v_mfma_f32_16x16x32_bf16 v[136:139],v[180:183],a[112:115],v[136:139]
v_cvt_pk_bf16_f32 v18,v24,v25
v_cvt_pk_bf16_f32 v19,v26,v27
v_mfma_f32_16x16x32_bf16 v[140:143],v[180:183],a[116:119],v[140:143]
buffer_store_dword v28,v244,s[24:27],s17 offen offset:2048 sc1
ds_read_b64_tr_b16 v[176:177],v217 offset:9216
v_mfma_f32_16x16x32_bf16 v[64:67],v[184:187],a[120:123],v[64:67]
buffer_load_dwordx4 v219,s[20:23],s98 offen lds
ds_read_b64_tr_b16 v[178:179],v217 offset:13312
v_mfma_f32_16x16x32_bf16 v[68:71],v[184:187],a[124:127],v[68:71]
ds_read_b64_tr_b16 v[180:181],v213 offset:9216
ds_read_b64_tr_b16 v[182:183],v213 offset:13312
v_mfma_f32_16x16x32_bf16 v[72:75],v[188:191],a[120:123],v[72:75]
s_lshl_b32 s90,s40,5
s_add_u32 s90,s90,s42
v_mfma_f32_16x16x32_bf16 v[76:79],v[188:191],a[124:127],v[76:79]
ds_read_b64_tr_b16 v[184:185],v214 offset:18432
ds_read_b64_tr_b16 v[186:187],v214 offset:19456
s_waitcnt lgkmcnt(6)
v_mfma_f32_16x16x32_bf16 v[80:83],v[160:163],a[120:123],v[80:83]
buffer_store_dwordx4 v[16:19],v212,s[24:27],s16 offen sc1
s_add_u32 s90,s90,8
v_mfma_f32_16x16x32_bf16 v[84:87],v[160:163],a[124:127],v[84:87]
ds_read_b64_tr_b16 v[188:189],v252 offset:18432
ds_read_b64_tr_b16 v[190:191],v252 offset:19456
v_mfma_f32_16x16x32_bf16 v[88:91],v[164:167],a[120:123],v[88:91]
s_lshl_b32 s90,s90,7
v_and_b32 v227,3,v226
v_mfma_f32_16x16x32_bf16 v[92:95],v[164:167],a[124:127],v[92:95]
s_waitcnt vmcnt(19)
s_barrier
v_mfma_f32_16x16x32_bf16 v[96:99],v[168:171],a[120:123],v[96:99]
ds_read_b64_tr_b16 v[160:161],v215 offset:20480
ds_read_b64_tr_b16 v[162:163],v215 offset:24576
v_mfma_f32_16x16x32_bf16 v[100:103],v[168:171],a[124:127],v[100:103]
ds_read_b64_tr_b16 v[164:165],v216 offset:20480
ds_read_b64_tr_b16 v[166:167],v216 offset:24576
v_mfma_f32_16x16x32_bf16 v[104:107],v[172:175],a[120:123],v[104:107]
v_mul_u32_u24 v227,4,v227
s_add_u32 s86,s86,16384
v_mfma_f32_16x16x32_bf16 v[108:111],v[172:175],a[124:127],v[108:111]
ds_read_b64_tr_b16 v[168:169],v217 offset:20480
ds_read_b64_tr_b16 v[170:171],v217 offset:24576
s_waitcnt lgkmcnt(6)
v_mfma_f32_16x16x32_bf16 v[112:115],v[176:179],a[120:123],v[112:115]
s_add_u32 s87,s87,16384
s_lshl_b32 s86,s40,2
v_mfma_f32_16x16x32_bf16 v[116:119],v[176:179],a[124:127],v[116:119]
ds_read_b64_tr_b16 v[172:173],v213 offset:20480
ds_read_b64_tr_b16 v[174:175],v213 offset:24576
v_mfma_f32_16x16x32_bf16 v[120:123],v[180:183],a[120:123],v[120:123]
s_add_u32 s86,s86,s43
s_lshl_b32 s86,s86,2
v_mfma_f32_16x16x32_bf16 v[124:127],v[180:183],a[124:127],v[124:127]
buffer_load_dwordx4 v220,s[20:23],s98 offen offset:1024 lds
s_add_u32 m0,s84,90112
v_mfma_f32_16x16x32_bf16 v[128:131],v[184:187],a[120:123],v[128:131]
ds_read_b64_tr_b16 v[176:177],v215 offset:21504
ds_read_b64_tr_b16 v[178:179],v215 offset:25600
v_mfma_f32_16x16x32_bf16 v[132:135],v[184:187],a[124:127],v[132:135]
ds_read_b64_tr_b16 v[180:181],v216 offset:21504
ds_read_b64_tr_b16 v[182:183],v216 offset:25600
v_mfma_f32_16x16x32_bf16 v[136:139],v[188:191],a[120:123],v[136:139]
s_add_u32 s86,s86,s45
s_lshl_b32 s86,s86,2
v_mfma_f32_16x16x32_bf16 v[140:143],v[188:191],a[124:127],v[140:143]
ds_read_b64_tr_b16 v[184:185],v217 offset:21504
ds_read_b64_tr_b16 v[186:187],v217 offset:25600
s_waitcnt lgkmcnt(6)
s_waitcnt vmcnt(17)
v_mfma_f32_16x16x32_bf16 v[64:67],v[160:163],a[128:131],v[64:67]
buffer_load_dwordx4 v221,s[20:23],s98 offen lds
s_add_u32 s86,s86,s42
v_mfma_f32_16x16x32_bf16 v[68:71],v[160:163],a[132:135],v[68:71]
ds_read_b64_tr_b16 v[188:189],v213 offset:21504
ds_read_b64_tr_b16 v[190:191],v213 offset:25600
v_mfma_f32_16x16x32_bf16 v[72:75],v[164:167],a[128:131],v[72:75]
buffer_load_dword v247,v227,s[24:27],s90 offen sc1
s_mul_i32 s86,s86,10240
v_mfma_f32_16x16x32_bf16 v[76:79],v[164:167],a[132:135],v[76:79]
ds_read_b64_tr_b16 v[160:161],v214 offset:36864
ds_read_b64_tr_b16 v[162:163],v214 offset:37888
v_mfma_f32_16x16x32_bf16 v[80:83],v[168:171],a[128:131],v[80:83]
s_getpc_b64 s[0:1]
L_cp6_4:
v_min_u32 v254,L_stop_4-L_cp6_4,v253
global_load_dword v255,v254,s[0:1]
v_mfma_f32_16x16x32_bf16 v[84:87],v[168:171],a[132:135],v[84:87]
ds_read_b64_tr_b16 v[164:165],v252 offset:36864
ds_read_b64_tr_b16 v[166:167],v252 offset:37888
v_mfma_f32_16x16x32_bf16 v[88:91],v[172:175],a[128:131],v[88:91]
buffer_load_dwordx4 a[160:163],v218,s[24:27],s76 offen sc1
s_add_u32 s86,s86,5242880
v_mfma_f32_16x16x32_bf16 v[92:95],v[172:175],a[132:135],v[92:95]
ds_read_b64_tr_b16 v[168:169],v215 offset:28672
ds_read_b64_tr_b16 v[170:171],v215 offset:32768
s_waitcnt lgkmcnt(6)
v_mfma_f32_16x16x32_bf16 v[96:99],v[176:179],a[128:131],v[96:99]
s_add_u32 s87,s86,4096
s_add_u32 s48,s86,8192
v_mfma_f32_16x16x32_bf16 v[100:103],v[176:179],a[132:135],v[100:103]
ds_read_b64_tr_b16 v[172:173],v216 offset:28672
ds_read_b64_tr_b16 v[174:175],v216 offset:32768
v_mfma_f32_16x16x32_bf16 v[104:107],v[180:183],a[128:131],v[104:107]
buffer_load_dwordx4 v222,s[20:23],s98 offen offset:1024 lds
s_add_u32 m0,s99,98304
v_mfma_f32_16x16x32_bf16 v[108:111],v[180:183],a[132:135],v[108:111]
s_lshr_b32 s99,s84,1
ds_read_b64_tr_b16 v[176:177],v217 offset:28672
v_mfma_f32_16x16x32_bf16 v[112:115],v[184:187],a[128:131],v[112:115]
ds_read_b64_tr_b16 v[178:179],v217 offset:32768
s_add_u32 s64,s44,7
v_mfma_f32_16x16x32_bf16 v[116:119],v[184:187],a[132:135],v[116:119]
ds_read_b64_tr_b16 v[180:181],v213 offset:28672
ds_read_b64_tr_b16 v[182:183],v213 offset:32768
v_mfma_f32_16x16x32_bf16 v[120:123],v[188:191],a[128:131],v[120:123]
buffer_load_dwordx4 a[164:167],v218,s[24:27],s76 offen offset:1024 sc1
s_and_b32 s64,s64,7
v_mfma_f32_16x16x32_bf16 v[124:127],v[188:191],a[132:135],v[124:127]
ds_read_b64_tr_b16 v[184:185],v215 offset:29696
ds_read_b64_tr_b16 v[186:187],v215 offset:33792
s_waitcnt lgkmcnt(6)
v_mfma_f32_16x16x32_bf16 v[128:131],v[160:163],a[128:131],v[128:131]
s_mul_i32 s64,s64,82944
v_lshrrev_b32 v248,5,v226
v_mfma_f32_16x16x32_bf16 v[132:135],v[160:163],a[132:135],v[132:135]
buffer_load_dwordx4 v223,s[20:23],s98 offen lds
s_add_u32 m0,s84,0
v_mfma_f32_16x16x32_bf16 v[136:139],v[164:167],a[128:131],v[136:139]
s_mul_i32 s98,s77,9
s_lshr_b32 s98,s98,1
v_mfma_f32_16x16x32_bf16 v[140:143],v[164:167],a[132:135],v[140:143]
ds_read_b64_tr_b16 v[188:189],v216 offset:29696
ds_read_b64_tr_b16 v[190:191],v216 offset:33792
v_mfma_f32_16x16x32_bf16 v[64:67],v[168:171],a[136:139],v[64:67]
ds_read_b64_tr_b16 v[160:161],v217 offset:29696
ds_read_b64_tr_b16 v[162:163],v217 offset:33792
v_mfma_f32_16x16x32_bf16 v[68:71],v[168:171],a[140:143],v[68:71]
ds_read_b64_tr_b16 v[164:165],v213 offset:29696
ds_read_b64_tr_b16 v[166:167],v213 offset:33792
v_mfma_f32_16x16x32_bf16 v[72:75],v[172:175],a[136:139],v[72:75]
s_cmp_eq_u32 s45,s42
s_cselect_b32 s16,-1,0
s_mov_b32 s17,s16
v_mfma_f32_16x16x32_bf16 v[76:79],v[172:175],a[140:143],v[76:79]
buffer_load_dwordx4 a[168:171],v218,s[24:27],s76 offen offset:2048 sc1
ds_read_b64_tr_b16 v[168:169],v214 offset:38912
s_waitcnt lgkmcnt(5)
v_mfma_f32_16x16x32_bf16 v[80:83],v[176:179],a[136:139],v[80:83]
ds_read_b64_tr_b16 v[170:171],v214 offset:39936
s_lshl_b32 s18,s16,31
v_mfma_f32_16x16x32_bf16 v[84:87],v[176:179],a[140:143],v[84:87]
ds_read_b64_tr_b16 v[172:173],v252 offset:38912
ds_read_b64_tr_b16 v[174:175],v252 offset:39936
v_mfma_f32_16x16x32_bf16 v[88:91],v[180:183],a[136:139],v[88:91]
v_or_b32 v239,s18,v212
v_mul_u32_u24 v248,78336,v248
v_mfma_f32_16x16x32_bf16 v[92:95],v[180:183],a[140:143],v[92:95]
s_waitcnt vmcnt(15)
s_barrier
v_mfma_f32_16x16x32_bf16 v[96:99],v[184:187],a[136:139],v[96:99]
ds_read_b64_tr_b16 v[176:177],v215 offset:40960
ds_read_b64_tr_b16 v[178:179],v215 offset:45056
v_mfma_f32_16x16x32_bf16 v[100:103],v[184:187],a[140:143],v[100:103]
buffer_load_dwordx4 a[172:175],v218,s[24:27],s76 offen offset:3072 sc1
ds_read_b64_tr_b16 v[180:181],v216 offset:40960
v_mfma_f32_16x16x32_bf16 v[104:107],v[188:191],a[136:139],v[104:107]
ds_read_b64_tr_b16 v[182:183],v216 offset:45056
s_lshl_b32 s91,s40,5
v_mfma_f32_16x16x32_bf16 v[108:111],v[188:191],a[140:143],v[108:111]
ds_read_b64_tr_b16 v[184:185],v217 offset:40960
ds_read_b64_tr_b16 v[186:187],v217 offset:45056
s_waitcnt lgkmcnt(6)
v_mfma_f32_16x16x32_bf16 v[112:115],v[160:163],a[136:139],v[112:115]
s_add_u32 s91,s91,20
s_lshl_b32 s91,s91,5
v_mfma_f32_16x16x32_bf16 v[116:119],v[160:163],a[140:143],v[116:119]
buffer_load_dwordx4 v219,s[20:23],s98 offen lds
ds_read_b64_tr_b16 v[188:189],v213 offset:40960
v_mfma_f32_16x16x32_bf16 v[120:123],v[164:167],a[136:139],v[120:123]
ds_read_b64_tr_b16 v[190:191],v213 offset:45056
s_add_u32 s91,s91,s41
v_mfma_f32_16x16x32_bf16 v[124:127],v[164:167],a[140:143],v[124:127]
ds_read_b64_tr_b16 v[160:161],v215 offset:41984
ds_read_b64_tr_b16 v[162:163],v215 offset:46080
v_mfma_f32_16x16x32_bf16 v[128:131],v[168:171],a[136:139],v[128:131]
s_lshl_b32 s91,s91,2
v_add_u32 v194,v248,v221
v_mfma_f32_16x16x32_bf16 v[132:135],v[168:171],a[140:143],v[132:135]
ds_read_b64_tr_b16 v[164:165],v216 offset:41984
ds_read_b64_tr_b16 v[166:167],v216 offset:46080
v_mfma_f32_16x16x32_bf16 v[136:139],v[172:175],a[136:139],v[136:139]
v_add_u32 v195,v248,v222
v_add_u32 v192,v248,v219
v_mfma_f32_16x16x32_bf16 v[140:143],v[172:175],a[140:143],v[140:143]
buffer_load_dwordx4 v220,s[20:23],s98 offen offset:1024 lds
s_add_u32 m0,s84,8192
s_waitcnt lgkmcnt(4)
s_waitcnt vmcnt(15)
v_mfma_f32_16x16x32_bf16 v[64:67],v[176:179],a[144:147],v[64:67]
ds_read_b64_tr_b16 v[168:169],v217 offset:41984
ds_read_b64_tr_b16 v[170:171],v217 offset:46080
v_mfma_f32_16x16x32_bf16 v[68:71],v[176:179],a[148:151],v[68:71]
ds_read_b64_tr_b16 v[172:173],v213 offset:41984
ds_read_b64_tr_b16 v[174:175],v213 offset:46080
v_mfma_f32_16x16x32_bf16 v[72:75],v[180:183],a[144:147],v[72:75]
s_waitcnt vmcnt(9)
v_add_u32 v193,v248,v220
v_mfma_f32_16x16x32_bf16 v[76:79],v[180:183],a[148:151],v[76:79]
buffer_load_dwordx4 v221,s[20:23],s98 offen lds
ds_read_b64_tr_b16 v[176:177],v214 offset:57344
v_cmp_ne_u32 vcc,1,v247
s_cbranch_vccnz L_slow_hc_4
L_back_hc_4:
v_mfma_f32_16x16x32_bf16 v[80:83],v[184:187],a[144:147],v[80:83]
ds_read_b64_tr_b16 v[178:179],v214 offset:58368
v_lshrrev_b32 v248,4,v226
v_mfma_f32_16x16x32_bf16 v[84:87],v[184:187],a[148:151],v[84:87]
ds_read_b64_tr_b16 v[180:181],v252 offset:57344
ds_read_b64_tr_b16 v[182:183],v252 offset:58368
v_mfma_f32_16x16x32_bf16 v[88:91],v[188:191],a[144:147],v[88:91]
v_mul_u32_u24 v248,78336,v248
v_add_u32 v196,v248,v223
v_mfma_f32_16x16x32_bf16 v[92:95],v[188:191],a[148:151],v[92:95]
buffer_load_dwordx4 a[176:179],v218,s[24:27],s77 offen sc1
ds_read_b64_tr_b16 v[184:185],v215 offset:49152
s_waitcnt lgkmcnt(5)
v_mfma_f32_16x16x32_bf16 v[96:99],v[160:163],a[144:147],v[96:99]
ds_read_b64_tr_b16 v[186:187],v215 offset:53248
v_add_u32 v240,143360,v212
v_mfma_f32_16x16x32_bf16 v[100:103],v[160:163],a[148:151],v[100:103]
ds_read_b64_tr_b16 v[188:189],v216 offset:49152
ds_read_b64_tr_b16 v[190:191],v216 offset:53248
v_mfma_f32_16x16x32_bf16 v[104:107],v[164:167],a[144:147],v[104:107]
v_add_u32 v194,294912,v194
v_add_u32 v195,294912,v195
v_mfma_f32_16x16x32_bf16 v[108:111],v[164:167],a[148:151],v[108:111]
buffer_load_dwordx4 v222,s[20:23],s98 offen offset:1024 lds
s_add_u32 m0,s99,16384
v_mfma_f32_16x16x32_bf16 v[112:115],v[168:171],a[144:147],v[112:115]
s_lshr_b32 s99,s84,1
ds_read_b64_tr_b16 v[160:161],v217 offset:49152
v_mfma_f32_16x16x32_bf16 v[116:119],v[168:171],a[148:151],v[116:119]
ds_read_b64_tr_b16 v[162:163],v217 offset:53248
ds_read_b64_tr_b16 v[164:165],v213 offset:49152
v_mfma_f32_16x16x32_bf16 v[120:123],v[172:175],a[144:147],v[120:123]
ds_read_b64_tr_b16 v[166:167],v213 offset:53248
v_mfma_f32_16x16x32_bf16 v[124:127],v[172:175],a[148:151],v[124:127]
buffer_load_dwordx4 a[180:183],v218,s[24:27],s77 offen offset:1024 sc1
ds_read_b64_tr_b16 v[168:169],v215 offset:50176
s_waitcnt lgkmcnt(5)
v_mfma_f32_16x16x32_bf16 v[128:131],v[176:179],a[144:147],v[128:131]
ds_read_b64_tr_b16 v[170:171],v215 offset:54272
v_mfma_f32_16x16x32_bf16 v[132:135],v[176:179],a[148:151],v[132:135]
buffer_load_dwordx4 v223,s[20:23],s98 offen lds
s_add_u32 m0,s84,102400
v_mfma_f32_16x16x32_bf16 v[136:139],v[180:183],a[144:147],v[136:139]
s_mul_i32 s98,s78,9
s_lshr_b32 s98,s98,1
v_mfma_f32_16x16x32_bf16 v[140:143],v[180:183],a[148:151],v[140:143]
ds_read_b64_tr_b16 v[172:173],v216 offset:50176
ds_read_b64_tr_b16 v[174:175],v216 offset:54272
v_mfma_f32_16x16x32_bf16 v[64:67],v[184:187],a[152:155],v[64:67]
ds_read_b64_tr_b16 v[176:177],v217 offset:50176
ds_read_b64_tr_b16 v[178:179],v217 offset:54272
v_mfma_f32_16x16x32_bf16 v[68:71],v[184:187],a[156:159],v[68:71]
ds_read_b64_tr_b16 v[180:181],v213 offset:50176
ds_read_b64_tr_b16 v[182:183],v213 offset:54272
v_mfma_f32_16x16x32_bf16 v[72:75],v[188:191],a[152:155],v[72:75]
v_mfma_f32_16x16x32_bf16 v[76:79],v[188:191],a[156:159],v[76:79]
buffer_load_dwordx4 a[184:187],v218,s[24:27],s77 offen offset:2048 sc1
ds_read_b64_tr_b16 v[184:185],v214 offset:59392
s_waitcnt lgkmcnt(5)
v_mfma_f32_16x16x32_bf16 v[80:83],v[160:163],a[152:155],v[80:83]
ds_read_b64_tr_b16 v[186:187],v214 offset:60416
v_mfma_f32_16x16x32_bf16 v[84:87],v[160:163],a[156:159],v[84:87]
ds_read_b64_tr_b16 v[188:189],v252 offset:59392
ds_read_b64_tr_b16 v[190:191],v252 offset:60416
v_mfma_f32_16x16x32_bf16 v[88:91],v[164:167],a[152:155],v[88:91]
v_mfma_f32_16x16x32_bf16 v[92:95],v[164:167],a[156:159],v[92:95]
v_add_u32 v215,61440,v215
s_waitcnt vmcnt(10)
v_mfma_f32_16x16x32_bf16 v[96:99],v[168:171],a[152:155],v[96:99]
s_barrier
ds_read_b64_tr_b16 v[160:161],v215 offset:0
v_mfma_f32_16x16x32_bf16 v[100:103],v[168:171],a[156:159],v[100:103]
buffer_load_dwordx4 a[188:191],v218,s[24:27],s77 offen offset:3072 sc1
v_add_u32 v216,61440,v216
buffer_store_dword v225,v224,s[24:27],s91 offen sc1
v_mfma_f32_16x16x32_bf16 v[104:107],v[172:175],a[152:155],v[104:107]
ds_read_b64_tr_b16 v[162:163],v215 offset:4096
ds_read_b64_tr_b16 v[164:165],v216 offset:0
v_mfma_f32_16x16x32_bf16 v[108:111],v[172:175],a[156:159],v[108:111]
v_add_u32 v217,61440,v217
ds_read_b64_tr_b16 v[166:167],v216 offset:4096
s_waitcnt lgkmcnt(4)
v_mfma_f32_16x16x32_bf16 v[112:115],v[176:179],a[152:155],v[112:115]
ds_read_b64_tr_b16 v[168:169],v217 offset:0
ds_read_b64_tr_b16 v[170:171],v217 offset:4096
v_mfma_f32_16x16x32_bf16 v[116:119],v[176:179],a[156:159],v[116:119]
buffer_load_dwordx4 v219,s[20:23],s98 offen lds
v_add_u32 v213,61440,v213
v_mfma_f32_16x16x32_bf16 v[120:123],v[180:183],a[152:155],v[120:123]
ds_read_b64_tr_b16 v[172:173],v213 offset:0
ds_read_b64_tr_b16 v[174:175],v213 offset:4096
v_mfma_f32_16x16x32_bf16 v[124:127],v[180:183],a[156:159],v[124:127]
ds_read_b64_tr_b16 v[176:177],v215 offset:1024
ds_read_b64_tr_b16 v[178:179],v215 offset:5120
v_mfma_f32_16x16x32_bf16 v[128:131],v[184:187],a[152:155],v[128:131]
v_mfma_f32_16x16x32_bf16 v[132:135],v[184:187],a[156:159],v[132:135]
ds_read_b64_tr_b16 v[180:181],v216 offset:1024
ds_read_b64_tr_b16 v[182:183],v216 offset:5120
v_mfma_f32_16x16x32_bf16 v[136:139],v[188:191],a[152:155],v[136:139]
v_mfma_f32_16x16x32_bf16 v[140:143],v[188:191],a[156:159],v[140:143]
buffer_load_dwordx4 v220,s[20:23],s98 offen offset:1024 lds
s_add_u32 m0,s84,110592
s_waitcnt lgkmcnt(4)
s_waitcnt vmcnt(12)
v_mfma_f32_16x16x32_bf16 v[64:67],v[160:163],a[160:163],v[64:67]
ds_read_b64_tr_b16 v[184:185],v217 offset:1024
ds_read_b64_tr_b16 v[186:187],v217 offset:5120
v_mfma_f32_16x16x32_bf16 v[68:71],v[160:163],a[164:167],v[68:71]
ds_read_b64_tr_b16 v[188:189],v213 offset:1024
ds_read_b64_tr_b16 v[190:191],v213 offset:5120
v_mfma_f32_16x16x32_bf16 v[72:75],v[164:167],a[160:163],v[72:75]
v_mfma_f32_16x16x32_bf16 v[76:79],v[164:167],a[164:167],v[76:79]
v_add_u32 v214,61440,v214
ds_read_b64_tr_b16 v[160:161],v214 offset:16384
v_mfma_f32_16x16x32_bf16 v[80:83],v[168:171],a[160:163],v[80:83]
ds_read_b64_tr_b16 v[162:163],v214 offset:17408
v_mfma_f32_16x16x32_bf16 v[84:87],v[168:171],a[164:167],v[84:87]
buffer_load_dwordx4 v221,s[20:23],s98 offen lds
v_add_u32 v252,61440,v252
v_mfma_f32_16x16x32_bf16 v[88:91],v[172:175],a[160:163],v[88:91]
ds_read_b64_tr_b16 v[164:165],v252 offset:16384
ds_read_b64_tr_b16 v[166:167],v252 offset:17408
v_mfma_f32_16x16x32_bf16 v[92:95],v[172:175],a[164:167],v[92:95]
ds_read_b64_tr_b16 v[168:169],v215 offset:8192
ds_read_b64_tr_b16 v[170:171],v215 offset:12288
s_waitcnt lgkmcnt(6)
v_mfma_f32_16x16x32_bf16 v[96:99],v[176:179],a[160:163],v[96:99]
v_mfma_f32_16x16x32_bf16 v[100:103],v[176:179],a[164:167],v[100:103]
buffer_load_dwordx4 v222,s[20:23],s98 offen offset:1024 lds
s_add_u32 m0,s99,118784
v_mfma_f32_16x16x32_bf16 v[104:107],v[180:183],a[160:163],v[104:107]
s_lshr_b32 s99,s84,1
ds_read_b64_tr_b16 v[172:173],v216 offset:8192
v_mfma_f32_16x16x32_bf16 v[108:111],v[180:183],a[164:167],v[108:111]
buffer_load_dwordx4 a[192:195],v218,s[24:27],s78 offen sc1
ds_read_b64_tr_b16 v[174:175],v216 offset:12288
v_mfma_f32_16x16x32_bf16 v[112:115],v[184:187],a[160:163],v[112:115]
ds_read_b64_tr_b16 v[176:177],v217 offset:8192
ds_read_b64_tr_b16 v[178:179],v217 offset:12288
v_mfma_f32_16x16x32_bf16 v[116:119],v[184:187],a[164:167],v[116:119]
ds_read_b64_tr_b16 v[180:181],v213 offset:8192
ds_read_b64_tr_b16 v[182:183],v213 offset:12288
v_mfma_f32_16x16x32_bf16 v[120:123],v[188:191],a[160:163],v[120:123]
v_mfma_f32_16x16x32_bf16 v[124:127],v[188:191],a[164:167],v[124:127]
ds_read_b64_tr_b16 v[184:185],v215 offset:9216
ds_read_b64_tr_b16 v[186:187],v215 offset:13312
s_waitcnt lgkmcnt(6)
v_mfma_f32_16x16x32_bf16 v[128:131],v[160:163],a[160:163],v[128:131]
v_mfma_f32_16x16x32_bf16 v[132:135],v[160:163],a[164:167],v[132:135]
buffer_load_dwordx4 v223,s[20:23],s98 offen lds
buffer_load_dwordx4 a[196:199],v218,s[24:27],s78 offen offset:1024 sc1
v_mfma_f32_16x16x32_bf16 v[136:139],v[164:167],a[160:163],v[136:139]
s_add_u32 m0,s84,122880
s_mul_i32 s98,s79,9
v_mfma_f32_16x16x32_bf16 v[140:143],v[164:167],a[164:167],v[140:143]
s_lshr_b32 s98,s98,1
ds_read_b64_tr_b16 v[188:189],v216 offset:9216
v_mfma_f32_16x16x32_bf16 v[64:67],v[168:171],a[168:171],v[64:67]
ds_read_b64_tr_b16 v[190:191],v216 offset:13312
ds_read_b64_tr_b16 v[160:161],v217 offset:9216
v_mfma_f32_16x16x32_bf16 v[68:71],v[168:171],a[172:175],v[68:71]
ds_read_b64_tr_b16 v[162:163],v217 offset:13312
ds_read_b64_tr_b16 v[164:165],v213 offset:9216
v_mfma_f32_16x16x32_bf16 v[72:75],v[172:175],a[168:171],v[72:75]
ds_read_b64_tr_b16 v[166:167],v213 offset:13312
v_mfma_f32_16x16x32_bf16 v[76:79],v[172:175],a[172:175],v[76:79]
buffer_load_dwordx4 a[200:203],v218,s[24:27],s78 offen offset:2048 sc1
ds_read_b64_tr_b16 v[168:169],v214 offset:18432
s_waitcnt lgkmcnt(5)
v_mfma_f32_16x16x32_bf16 v[80:83],v[176:179],a[168:171],v[80:83]
ds_read_b64_tr_b16 v[170:171],v214 offset:19456
v_mfma_f32_16x16x32_bf16 v[84:87],v[176:179],a[172:175],v[84:87]
ds_read_b64_tr_b16 v[172:173],v252 offset:18432
ds_read_b64_tr_b16 v[174:175],v252 offset:19456
v_mfma_f32_16x16x32_bf16 v[88:91],v[180:183],a[168:171],v[88:91]
v_mfma_f32_16x16x32_bf16 v[92:95],v[180:183],a[172:175],v[92:95]
v_subrev_u32 v215,81920,v215
s_waitcnt vmcnt(11)
v_mfma_f32_16x16x32_bf16 v[96:99],v[184:187],a[168:171],v[96:99]
s_barrier
ds_read_b64_tr_b16 v[176:177],v215 offset:0
v_mfma_f32_16x16x32_bf16 v[100:103],v[184:187],a[172:175],v[100:103]
buffer_load_dwordx4 a[204:207],v218,s[24:27],s78 offen offset:3072 sc1
v_subrev_u32 v216,81920,v216
v_mfma_f32_16x16x32_bf16 v[104:107],v[188:191],a[168:171],v[104:107]
ds_read_b64_tr_b16 v[178:179],v215 offset:4096
ds_read_b64_tr_b16 v[180:181],v216 offset:0
v_mfma_f32_16x16x32_bf16 v[108:111],v[188:191],a[172:175],v[108:111]
v_subrev_u32 v217,81920,v217
ds_read_b64_tr_b16 v[182:183],v216 offset:4096
s_waitcnt lgkmcnt(4)
v_mfma_f32_16x16x32_bf16 v[112:115],v[160:163],a[168:171],v[112:115]
ds_read_b64_tr_b16 v[184:185],v217 offset:0
ds_read_b64_tr_b16 v[186:187],v217 offset:4096
v_mfma_f32_16x16x32_bf16 v[116:119],v[160:163],a[172:175],v[116:119]
buffer_load_dwordx4 v219,s[20:23],s98 offen lds
v_subrev_u32 v213,81920,v213
v_mfma_f32_16x16x32_bf16 v[120:123],v[164:167],a[168:171],v[120:123]
ds_read_b64_tr_b16 v[188:189],v213 offset:0
ds_read_b64_tr_b16 v[190:191],v213 offset:4096
v_mfma_f32_16x16x32_bf16 v[124:127],v[164:167],a[172:175],v[124:127]
ds_read_b64_tr_b16 v[160:161],v215 offset:1024
ds_read_b64_tr_b16 v[162:163],v215 offset:5120
v_mfma_f32_16x16x32_bf16 v[128:131],v[168:171],a[168:171],v[128:131]
v_mfma_f32_16x16x32_bf16 v[132:135],v[168:171],a[172:175],v[132:135]
ds_read_b64_tr_b16 v[164:165],v216 offset:1024
ds_read_b64_tr_b16 v[166:167],v216 offset:5120
v_mfma_f32_16x16x32_bf16 v[136:139],v[172:175],a[168:171],v[136:139]
v_mfma_f32_16x16x32_bf16 v[140:143],v[172:175],a[172:175],v[140:143]
buffer_load_dwordx4 v220,s[20:23],s98 offen offset:1024 lds
s_add_u32 m0,s84,131072
s_waitcnt lgkmcnt(4)
s_waitcnt vmcnt(12)
v_mfma_f32_16x16x32_bf16 v[64:67],v[176:179],a[176:179],v[64:67]
ds_read_b64_tr_b16 v[168:169],v217 offset:1024
ds_read_b64_tr_b16 v[170:171],v217 offset:5120
v_mfma_f32_16x16x32_bf16 v[68:71],v[176:179],a[180:183],v[68:71]
ds_read_b64_tr_b16 v[172:173],v213 offset:1024
ds_read_b64_tr_b16 v[174:175],v213 offset:5120
v_mfma_f32_16x16x32_bf16 v[72:75],v[180:183],a[176:179],v[72:75]
v_mfma_f32_16x16x32_bf16 v[76:79],v[180:183],a[180:183],v[76:79]
v_subrev_u32 v214,81920,v214
ds_read_b64_tr_b16 v[176:177],v214 offset:16384
v_mfma_f32_16x16x32_bf16 v[80:83],v[184:187],a[176:179],v[80:83]
ds_read_b64_tr_b16 v[178:179],v214 offset:17408
v_mfma_f32_16x16x32_bf16 v[84:87],v[184:187],a[180:183],v[84:87]
buffer_load_dwordx4 v221,s[20:23],s98 offen lds
v_subrev_u32 v252,81920,v252
v_mfma_f32_16x16x32_bf16 v[88:91],v[188:191],a[176:179],v[88:91]
ds_read_b64_tr_b16 v[180:181],v252 offset:16384
ds_read_b64_tr_b16 v[182:183],v252 offset:17408
v_mfma_f32_16x16x32_bf16 v[92:95],v[188:191],a[180:183],v[92:95]
ds_read_b64_tr_b16 v[184:185],v215 offset:8192
ds_read_b64_tr_b16 v[186:187],v215 offset:12288
s_waitcnt lgkmcnt(6)
v_mfma_f32_16x16x32_bf16 v[96:99],v[160:163],a[176:179],v[96:99]
v_mfma_f32_16x16x32_bf16 v[100:103],v[160:163],a[180:183],v[100:103]
ds_read_b64_tr_b16 v[188:189],v216 offset:8192
ds_read_b64_tr_b16 v[190:191],v216 offset:12288
v_mfma_f32_16x16x32_bf16 v[104:107],v[164:167],a[176:179],v[104:107]
buffer_load_dwordx4 v222,s[20:23],s98 offen offset:1024 lds
s_add_u32 m0,s99,139264
v_mfma_f32_16x16x32_bf16 v[108:111],v[164:167],a[180:183],v[108:111]
buffer_load_dwordx4 a[208:211],v218,s[24:27],s79 offen sc1
s_lshr_b32 s99,s84,1
v_mfma_f32_16x16x32_bf16 v[112:115],v[168:171],a[176:179],v[112:115]
ds_read_b64_tr_b16 v[160:161],v217 offset:8192
ds_read_b64_tr_b16 v[162:163],v217 offset:12288
v_mfma_f32_16x16x32_bf16 v[116:119],v[168:171],a[180:183],v[116:119]
ds_read_b64_tr_b16 v[164:165],v213 offset:8192
ds_read_b64_tr_b16 v[166:167],v213 offset:12288
v_mfma_f32_16x16x32_bf16 v[120:123],v[172:175],a[176:179],v[120:123]
s_lshl_b32 s90,s40,5
s_add_u32 s90,s90,20
v_mfma_f32_16x16x32_bf16 v[124:127],v[172:175],a[180:183],v[124:127]
ds_read_b64_tr_b16 v[168:169],v215 offset:9216
ds_read_b64_tr_b16 v[170:171],v215 offset:13312
s_waitcnt lgkmcnt(6)
v_mfma_f32_16x16x32_bf16 v[128:131],v[176:179],a[176:179],v[128:131]
s_lshl_b32 s90,s90,7
v_and_b32 v227,15,v226
v_mfma_f32_16x16x32_bf16 v[132:135],v[176:179],a[180:183],v[132:135]
buffer_load_dwordx4 v223,s[20:23],s98 offen lds
buffer_load_dwordx4 a[212:215],v218,s[24:27],s79 offen offset:1024 sc1
v_mfma_f32_16x16x32_bf16 v[136:139],v[180:183],a[176:179],v[136:139]
s_add_u32 m0,s84,20480
s_mul_i32 s98,s80,9
v_mfma_f32_16x16x32_bf16 v[140:143],v[180:183],a[180:183],v[140:143]
s_lshr_b32 s98,s98,1
ds_read_b64_tr_b16 v[172:173],v216 offset:9216
v_mfma_f32_16x16x32_bf16 v[64:67],v[184:187],a[184:187],v[64:67]
ds_read_b64_tr_b16 v[174:175],v216 offset:13312
ds_read_b64_tr_b16 v[176:177],v217 offset:9216
ds_read_b64_tr_b16 v[178:179],v217 offset:13312
v_mfma_f32_16x16x32_bf16 v[68:71],v[184:187],a[188:191],v[68:71]
ds_read_b64_tr_b16 v[180:181],v213 offset:9216
ds_read_b64_tr_b16 v[182:183],v213 offset:13312
v_mfma_f32_16x16x32_bf16 v[72:75],v[188:191],a[184:187],v[72:75]
v_mul_u32_u24 v227,4,v227
v_mfma_f32_16x16x32_bf16 v[76:79],v[188:191],a[188:191],v[76:79]
buffer_load_dwordx4 a[216:219],v218,s[24:27],s79 offen offset:2048 sc1
ds_read_b64_tr_b16 v[184:185],v214 offset:18432
s_waitcnt lgkmcnt(5)
v_mfma_f32_16x16x32_bf16 v[80:83],v[160:163],a[184:187],v[80:83]
ds_read_b64_tr_b16 v[186:187],v214 offset:19456
v_mfma_f32_16x16x32_bf16 v[84:87],v[160:163],a[188:191],v[84:87]
ds_read_b64_tr_b16 v[188:189],v252 offset:18432
ds_read_b64_tr_b16 v[190:191],v252 offset:19456
v_mfma_f32_16x16x32_bf16 v[88:91],v[164:167],a[184:187],v[88:91]
v_mfma_f32_16x16x32_bf16 v[92:95],v[164:167],a[188:191],v[92:95]
v_add_u32 v215,102400,v215
s_waitcnt vmcnt(11)
v_mfma_f32_16x16x32_bf16 v[96:99],v[168:171],a[184:187],v[96:99]
s_barrier
ds_read_b64_tr_b16 v[160:161],v215 offset:0
v_mfma_f32_16x16x32_bf16 v[100:103],v[168:171],a[188:191],v[100:103]
buffer_load_dwordx4 a[220:223],v218,s[24:27],s79 offen offset:3072 sc1
s_lshl_b32 s49,s40,2
v_mfma_f32_16x16x32_bf16 v[104:107],v[172:175],a[184:187],v[104:107]
s_add_u32 s49,s49,s42
s_lshl_b32 s50,s49,15
v_mfma_f32_16x16x32_bf16 v[108:111],v[172:175],a[188:191],v[108:111]
s_add_u32 s50,s50,3145728
s_lshl_b32 s51,s45,1
s_waitcnt lgkmcnt(1)
v_mfma_f32_16x16x32_bf16 v[112:115],v[176:179],a[184:187],v[112:115]
s_add_u32 s51,s51,s44
s_add_u32 s51,s51,0
v_mfma_f32_16x16x32_bf16 v[116:119],v[176:179],a[188:191],v[116:119]
buffer_load_dwordx4 v219,s[20:23],s98 offen lds
s_and_b32 s51,s51,7
v_mfma_f32_16x16x32_bf16 v[120:123],v[180:183],a[184:187],v[120:123]
s_lshl_b32 s51,s51,12
s_add_u32 s51,s51,s50
v_mfma_f32_16x16x32_bf16 v[124:127],v[180:183],a[188:191],v[124:127]
s_lshl_b32 s52,s45,1
s_add_u32 s52,s52,s44
v_mfma_f32_16x16x32_bf16 v[128:131],v[184:187],a[184:187],v[128:131]
s_add_u32 s52,s52,1
s_and_b32 s52,s52,7
s_lshl_b32 s52,s52,12
v_add_u32 v216,102400,v216
v_add_u32 v217,102400,v217
v_add_u32 v213,102400,v213
ds_read_b64_tr_b16 v[162:163],v215 offset:4096
ds_read_b64_tr_b16 v[164:165],v216 offset:0
ds_read_b64_tr_b16 v[166:167],v216 offset:4096
ds_read_b64_tr_b16 v[168:169],v217 offset:0
ds_read_b64_tr_b16 v[170:171],v217 offset:4096
ds_read_b64_tr_b16 v[172:173],v213 offset:0
ds_read_b64_tr_b16 v[174:175],v213 offset:4096
v_mfma_f32_16x16x32_bf16 v[132:135],v[184:187],a[188:191],v[132:135]
s_add_u32 s52,s52,s50
s_lshl_b32 s49,s49,1
v_mfma_f32_16x16x32_bf16 v[136:139],v[188:191],a[184:187],v[136:139]
s_add_u32 s49,s49,s47
s_lshl_b32 s49,s49,1
v_mfma_f32_16x16x32_bf16 v[140:143],v[188:191],a[188:191],v[140:143]
buffer_load_dwordx4 v220,s[20:23],s98 offen offset:1024 lds
s_add_u32 m0,s84,28672
s_waitcnt lgkmcnt(0)
s_waitcnt vmcnt(11)
v_mfma_f32_16x16x32_bf16 v[64:67],v[160:163],a[192:195],v[64:67]
s_add_u32 s49,s49,s46
s_lshl_b32 s49,s49,10
v_mfma_f32_16x16x32_bf16 v[68:71],v[160:163],a[196:199],v[68:71]
s_add_u32 s49,s49,2097152
ds_read_b64_tr_b16 v[176:177],v215 offset:1024
v_mfma_f32_16x16x32_bf16 v[72:75],v[164:167],a[192:195],v[72:75]
ds_read_b64_tr_b16 v[178:179],v215 offset:5120
ds_read_b64_tr_b16 v[180:181],v216 offset:1024
v_mfma_f32_16x16x32_bf16 v[76:79],v[164:167],a[196:199],v[76:79]
buffer_load_dwordx4 v221,s[20:23],s98 offen lds
v_add_u32 v214,102400,v214
v_mfma_f32_16x16x32_bf16 v[80:83],v[168:171],a[192:195],v[80:83]
ds_read_b64_tr_b16 v[182:183],v216 offset:5120
ds_read_b64_tr_b16 v[184:185],v217 offset:1024
ds_read_b64_tr_b16 v[186:187],v217 offset:5120
ds_read_b64_tr_b16 v[188:189],v213 offset:1024
ds_read_b64_tr_b16 v[190:191],v213 offset:5120
v_mfma_f32_16x16x32_bf16 v[84:87],v[168:171],a[196:199],v[84:87]
v_add_u32 v252,102400,v252
ds_read_b64_tr_b16 v[160:161],v214 offset:16384
buffer_load_dword v247,v227,s[24:27],s90 offen sc1
v_mfma_f32_16x16x32_bf16 v[88:91],v[172:175],a[192:195],v[88:91]
ds_read_b64_tr_b16 v[162:163],v214 offset:17408
ds_read_b64_tr_b16 v[164:165],v252 offset:16384
v_mfma_f32_16x16x32_bf16 v[92:95],v[172:175],a[196:199],v[92:95]
buffer_load_dwordx4 a[224:227],v218,s[24:27],s80 offen sc1
ds_read_b64_tr_b16 v[166:167],v252 offset:17408
s_waitcnt lgkmcnt(4)
v_mfma_f32_16x16x32_bf16 v[96:99],v[176:179],a[192:195],v[96:99]
ds_read_b64_tr_b16 v[168:169],v215 offset:8192
ds_read_b64_tr_b16 v[170:171],v215 offset:12288
v_mfma_f32_16x16x32_bf16 v[100:103],v[176:179],a[196:199],v[100:103]
ds_read_b64_tr_b16 v[172:173],v216 offset:8192
ds_read_b64_tr_b16 v[174:175],v216 offset:12288
v_mfma_f32_16x16x32_bf16 v[104:107],v[180:183],a[192:195],v[104:107]
v_lshrrev_b32 v244,4,v226
v_lshlrev_b32 v244,8,v244
v_mfma_f32_16x16x32_bf16 v[108:111],v[180:183],a[196:199],v[108:111]
buffer_load_dwordx4 v222,s[20:23],s98 offen offset:1024 lds
s_add_u32 m0,s99,36864
v_mfma_f32_16x16x32_bf16 v[112:115],v[184:187],a[192:195],v[112:115]
s_lshr_b32 s99,s84,1
ds_read_b64_tr_b16 v[176:177],v217 offset:8192
v_mfma_f32_16x16x32_bf16 v[116:119],v[184:187],a[196:199],v[116:119]
ds_read_b64_tr_b16 v[178:179],v217 offset:12288
ds_read_b64_tr_b16 v[180:181],v213 offset:8192
v_mfma_f32_16x16x32_bf16 v[120:123],v[188:191],a[192:195],v[120:123]
ds_read_b64_tr_b16 v[182:183],v213 offset:12288
v_and_b32 v245,15,v226
v_mfma_f32_16x16x32_bf16 v[124:127],v[188:191],a[196:199],v[124:127]
buffer_load_dwordx4 a[228:231],v218,s[24:27],s80 offen offset:1024 sc1
ds_read_b64_tr_b16 v[184:185],v215 offset:9216
s_waitcnt lgkmcnt(5)
v_mfma_f32_16x16x32_bf16 v[128:131],v[160:163],a[192:195],v[128:131]
ds_read_b64_tr_b16 v[186:187],v215 offset:13312
v_lshl_add_u32 v244,v245,2,v244
v_mfma_f32_16x16x32_bf16 v[132:135],v[160:163],a[196:199],v[132:135]
buffer_load_dwordx4 v223,s[20:23],s98 offen lds
s_add_u32 m0,s84,40960
v_mfma_f32_16x16x32_bf16 v[136:139],v[164:167],a[192:195],v[136:139]
s_mul_i32 s98,s81,9
s_lshr_b32 s98,s98,1
v_mfma_f32_16x16x32_bf16 v[140:143],v[164:167],a[196:199],v[140:143]
ds_read_b64_tr_b16 v[188:189],v216 offset:9216
ds_read_b64_tr_b16 v[190:191],v216 offset:13312
v_mfma_f32_16x16x32_bf16 v[64:67],v[168:171],a[200:203],v[64:67]
ds_read_b64_tr_b16 v[160:161],v217 offset:9216
ds_read_b64_tr_b16 v[162:163],v217 offset:13312
v_mfma_f32_16x16x32_bf16 v[68:71],v[168:171],a[204:207],v[68:71]
ds_read_b64_tr_b16 v[164:165],v213 offset:9216
ds_read_b64_tr_b16 v[166:167],v213 offset:13312
v_mfma_f32_16x16x32_bf16 v[72:75],v[172:175],a[200:203],v[72:75]
v_mfma_f32_16x16x32_bf16 v[76:79],v[172:175],a[204:207],v[76:79]
buffer_load_dwordx4 a[232:235],v218,s[24:27],s80 offen offset:2048 sc1
ds_read_b64_tr_b16 v[168:169],v214 offset:18432
s_waitcnt lgkmcnt(5)
v_mfma_f32_16x16x32_bf16 v[80:83],v[176:179],a[200:203],v[80:83]
ds_read_b64_tr_b16 v[170:171],v214 offset:19456
v_mfma_f32_16x16x32_bf16 v[84:87],v[176:179],a[204:207],v[84:87]
ds_read_b64_tr_b16 v[172:173],v252 offset:18432
ds_read_b64_tr_b16 v[174:175],v252 offset:19456
v_mfma_f32_16x16x32_bf16 v[88:91],v[180:183],a[200:203],v[88:91]
v_mfma_f32_16x16x32_bf16 v[92:95],v[180:183],a[204:207],v[92:95]
s_waitcnt vmcnt(12)
s_barrier
v_mfma_f32_16x16x32_bf16 v[96:99],v[184:187],a[200:203],v[96:99]
ds_read_b64_tr_b16 v[176:177],v215 offset:20480
ds_read_b64_tr_b16 v[178:179],v215 offset:24576
v_mfma_f32_16x16x32_bf16 v[100:103],v[184:187],a[204:207],v[100:103]
buffer_load_dwordx4 a[236:239],v218,s[24:27],s80 offen offset:3072 sc1
ds_read_b64_tr_b16 v[180:181],v216 offset:20480
v_mfma_f32_16x16x32_bf16 v[104:107],v[188:191],a[200:203],v[104:107]
ds_read_b64_tr_b16 v[182:183],v216 offset:24576
s_waitcnt vmcnt(6)
v_mfma_f32_16x16x32_bf16 v[108:111],v[188:191],a[204:207],v[108:111]
ds_read_b64_tr_b16 v[184:185],v217 offset:20480
ds_read_b64_tr_b16 v[186:187],v217 offset:24576
s_waitcnt lgkmcnt(6)
v_mfma_f32_16x16x32_bf16 v[112:115],v[160:163],a[200:203],v[112:115]
v_cmp_ne_u32 vcc,1,v247
s_cbranch_vccnz L_slow_o_4
L_back_o_4:
v_mfma_f32_16x16x32_bf16 v[116:119],v[160:163],a[204:207],v[116:119]
buffer_load_dwordx4 v219,s[20:23],s98 offen lds
ds_read_b64_tr_b16 v[188:189],v213 offset:20480
v_mfma_f32_16x16x32_bf16 v[120:123],v[164:167],a[200:203],v[120:123]
ds_read_b64_tr_b16 v[190:191],v213 offset:24576
s_lshl_b32 s90,s40,5
v_mfma_f32_16x16x32_bf16 v[124:127],v[164:167],a[204:207],v[124:127]
ds_read_b64_tr_b16 v[160:161],v215 offset:21504
ds_read_b64_tr_b16 v[162:163],v215 offset:25600
v_mfma_f32_16x16x32_bf16 v[128:131],v[168:171],a[200:203],v[128:131]
s_add_u32 s90,s90,s42
s_add_u32 s90,s90,12
v_mfma_f32_16x16x32_bf16 v[132:135],v[168:171],a[204:207],v[132:135]
ds_read_b64_tr_b16 v[164:165],v216 offset:21504
ds_read_b64_tr_b16 v[166:167],v216 offset:25600
v_mfma_f32_16x16x32_bf16 v[136:139],v[172:175],a[200:203],v[136:139]
s_lshl_b32 s90,s90,7
v_and_b32 v227,1,v226
v_mfma_f32_16x16x32_bf16 v[140:143],v[172:175],a[204:207],v[140:143]
buffer_load_dwordx4 v220,s[20:23],s98 offen offset:1024 lds
s_add_u32 m0,s84,49152
s_waitcnt lgkmcnt(4)
v_mfma_f32_16x16x32_bf16 v[64:67],v[176:179],a[208:211],v[64:67]
ds_read_b64_tr_b16 v[168:169],v217 offset:21504
ds_read_b64_tr_b16 v[170:171],v217 offset:25600
v_mfma_f32_16x16x32_bf16 v[68:71],v[176:179],a[212:215],v[68:71]
ds_read_b64_tr_b16 v[172:173],v213 offset:21504
ds_read_b64_tr_b16 v[174:175],v213 offset:25600
v_mfma_f32_16x16x32_bf16 v[72:75],v[180:183],a[208:211],v[72:75]
v_mul_u32_u24 v227,12,v227
buffer_load_dword v247,v227,s[24:27],s90 offen sc1
v_mfma_f32_16x16x32_bf16 v[76:79],v[180:183],a[212:215],v[76:79]
ds_read_b64_tr_b16 v[176:177],v214 offset:36864
ds_read_b64_tr_b16 v[178:179],v214 offset:37888
v_mfma_f32_16x16x32_bf16 v[80:83],v[184:187],a[208:211],v[80:83]
v_mfma_f32_16x16x32_bf16 v[84:87],v[184:187],a[212:215],v[84:87]
buffer_load_dwordx4 v221,s[20:23],s98 offen lds
ds_read_b64_tr_b16 v[180:181],v252 offset:36864
v_mfma_f32_16x16x32_bf16 v[88:91],v[188:191],a[208:211],v[88:91]
ds_read_b64_tr_b16 v[182:183],v252 offset:37888
v_mfma_f32_16x16x32_bf16 v[92:95],v[188:191],a[212:215],v[92:95]
ds_read_b64_tr_b16 v[184:185],v215 offset:28672
ds_read_b64_tr_b16 v[186:187],v215 offset:32768
s_waitcnt lgkmcnt(6)
v_mfma_f32_16x16x32_bf16 v[96:99],v[160:163],a[208:211],v[96:99]
v_mfma_f32_16x16x32_bf16 v[100:103],v[160:163],a[212:215],v[100:103]
buffer_load_dwordx4 a[240:243],v218,s[24:27],s81 offen sc1
ds_read_b64_tr_b16 v[188:189],v216 offset:28672
v_mfma_f32_16x16x32_bf16 v[104:107],v[164:167],a[208:211],v[104:107]
ds_read_b64_tr_b16 v[190:191],v216 offset:32768
v_mfma_f32_16x16x32_bf16 v[108:111],v[164:167],a[212:215],v[108:111]
buffer_load_dwordx4 v222,s[20:23],s98 offen offset:1024 lds
s_add_u32 m0,s99,57344
v_mfma_f32_16x16x32_bf16 v[112:115],v[168:171],a[208:211],v[112:115]
s_lshr_b32 s99,s84,1
ds_read_b64_tr_b16 v[160:161],v217 offset:28672
v_mfma_f32_16x16x32_bf16 v[116:119],v[168:171],a[212:215],v[116:119]
ds_read_b64_tr_b16 v[162:163],v217 offset:32768
ds_read_b64_tr_b16 v[164:165],v213 offset:28672
v_mfma_f32_16x16x32_bf16 v[120:123],v[172:175],a[208:211],v[120:123]
ds_read_b64_tr_b16 v[166:167],v213 offset:32768
v_mfma_f32_16x16x32_bf16 v[124:127],v[172:175],a[212:215],v[124:127]
ds_read_b64_tr_b16 v[168:169],v215 offset:29696
ds_read_b64_tr_b16 v[170:171],v215 offset:33792
s_waitcnt lgkmcnt(6)
v_mfma_f32_16x16x32_bf16 v[128:131],v[176:179],a[208:211],v[128:131]
v_mfma_f32_16x16x32_bf16 v[132:135],v[176:179],a[212:215],v[132:135]
buffer_load_dwordx4 a[244:247],v218,s[24:27],s81 offen offset:1024 sc1
buffer_load_dwordx4 v223,s[20:23],s98 offen lds
v_mfma_f32_16x16x32_bf16 v[136:139],v[180:183],a[208:211],v[136:139]
s_add_u32 m0,s84,61440
s_mul_i32 s98,s82,9
v_mfma_f32_16x16x32_bf16 v[140:143],v[180:183],a[212:215],v[140:143]
s_lshr_b32 s98,s98,1
ds_read_b64_tr_b16 v[172:173],v216 offset:29696
v_mfma_f32_16x16x32_bf16 v[64:67],v[184:187],a[216:219],v[64:67]
ds_read_b64_tr_b16 v[174:175],v216 offset:33792
ds_read_b64_tr_b16 v[176:177],v217 offset:29696
ds_read_b64_tr_b16 v[178:179],v217 offset:33792
v_mfma_f32_16x16x32_bf16 v[68:71],v[184:187],a[220:223],v[68:71]
ds_read_b64_tr_b16 v[180:181],v213 offset:29696
ds_read_b64_tr_b16 v[182:183],v213 offset:33792
v_mfma_f32_16x16x32_bf16 v[72:75],v[188:191],a[216:219],v[72:75]
v_mfma_f32_16x16x32_bf16 v[76:79],v[188:191],a[220:223],v[76:79]
buffer_load_dwordx4 a[248:251],v218,s[24:27],s81 offen offset:2048 sc1
ds_read_b64_tr_b16 v[184:185],v214 offset:38912
ds_read_b64_tr_b16 v[186:187],v214 offset:39936
s_waitcnt lgkmcnt(6)
v_mfma_f32_16x16x32_bf16 v[80:83],v[160:163],a[216:219],v[80:83]
v_mfma_f32_16x16x32_bf16 v[84:87],v[160:163],a[220:223],v[84:87]
ds_read_b64_tr_b16 v[188:189],v252 offset:38912
ds_read_b64_tr_b16 v[190:191],v252 offset:39936
v_mfma_f32_16x16x32_bf16 v[88:91],v[164:167],a[216:219],v[88:91]
v_mfma_f32_16x16x32_bf16 v[92:95],v[164:167],a[220:223],v[92:95]
v_subrev_u32 v215,81920,v215
s_waitcnt vmcnt(11)
v_mfma_f32_16x16x32_bf16 v[96:99],v[168:171],a[216:219],v[96:99]
s_barrier
ds_read_b64_tr_b16 v[160:161],v215 offset:0
ds_read_b64_tr_b16 v[162:163],v215 offset:4096
v_mfma_f32_16x16x32_bf16 v[100:103],v[168:171],a[220:223],v[100:103]
buffer_load_dwordx4 a[252:255],v218,s[24:27],s81 offen offset:3072 sc1
v_subrev_u32 v216,81920,v216
ds_read_b64_tr_b16 v[164:165],v216 offset:0
v_mfma_f32_16x16x32_bf16 v[104:107],v[172:175],a[216:219],v[104:107]
ds_read_b64_tr_b16 v[166:167],v216 offset:4096
v_and_b32 v248,15,v226
v_lshrrev_b32 v200,4,v226
v_mfma_f32_16x16x32_bf16 v[108:111],v[172:175],a[220:223],v[108:111]
v_subrev_u32 v217,81920,v217
ds_read_b64_tr_b16 v[168:169],v217 offset:0
ds_read_b64_tr_b16 v[170:171],v217 offset:4096
s_waitcnt lgkmcnt(6)
v_mfma_f32_16x16x32_bf16 v[112:115],v[176:179],a[216:219],v[112:115]
v_lshlrev_b32 v200,2,v200
v_sub_u32 v248,v248,v200
v_and_b32 v200,1,v248
v_mfma_f32_16x16x32_bf16 v[116:119],v[176:179],a[220:223],v[116:119]
buffer_load_dwordx4 v219,s[20:23],s98 offen lds
v_subrev_u32 v213,81920,v213
ds_read_b64_tr_b16 v[172:173],v213 offset:0
v_mfma_f32_16x16x32_bf16 v[120:123],v[180:183],a[216:219],v[120:123]
buffer_load_dwordx4 v220,s[20:23],s98 offen offset:1024 lds
s_add_u32 m0,s84,69632
ds_read_b64_tr_b16 v[174:175],v213 offset:4096
v_mfma_f32_16x16x32_bf16 v[124:127],v[180:183],a[220:223],v[124:127]
buffer_load_dwordx4 v221,s[20:23],s98 offen lds
buffer_load_dwordx4 v222,s[20:23],s98 offen offset:1024 lds
s_add_u32 m0,s99,77824
v_mfma_f32_16x16x32_bf16 v[128:131],v[184:187],a[216:219],v[128:131]
buffer_load_dwordx4 v223,s[20:23],s98 offen lds
s_add_u32 m0,s84,81920
s_mul_i32 s98,s83,9
v_mfma_f32_16x16x32_bf16 v[132:135],v[184:187],a[220:223],v[132:135]
s_lshr_b32 s98,s98,1
buffer_load_dwordx4 v219,s[20:23],s98 offen lds
s_lshr_b32 s99,s84,1
s_waitcnt vmcnt(13)
v_cmp_ne_u32 vcc,1,v247
s_cbranch_vccnz L_slow_hd_4
L_back_hd_4:
v_mfma_f32_16x16x32_bf16 v[136:139],v[188:191],a[216:219],v[136:139]
ds_read_b64_tr_b16 v[176:177],v215 offset:1024
ds_read_b64_tr_b16 v[178:179],v215 offset:5120
ds_read_b64_tr_b16 v[180:181],v216 offset:1024
v_mfma_f32_16x16x32_bf16 v[140:143],v[188:191],a[220:223],v[140:143]
ds_read_b64_tr_b16 v[182:183],v216 offset:5120
ds_read_b64_tr_b16 v[184:185],v217 offset:1024
ds_read_b64_tr_b16 v[186:187],v217 offset:5120
s_waitcnt lgkmcnt(6)
v_mfma_f32_16x16x32_bf16 v[64:67],v[160:163],a[224:227],v[64:67]
v_lshrrev_b32 v248,1,v248
v_cmp_eq_u32 vcc,0,v248
v_lshlrev_b32 v200,4,v200
v_mfma_f32_16x16x32_bf16 v[68:71],v[160:163],a[228:231],v[68:71]
ds_read_b64_tr_b16 v[188:189],v213 offset:1024
ds_read_b64_tr_b16 v[190:191],v213 offset:5120
v_mov_b32 v201,0x3f80
v_mfma_f32_16x16x32_bf16 v[72:75],v[164:167],a[224:227],v[72:75]
v_lshlrev_b32 v201,v200,v201
v_cndmask_b32 v202,0,v201,vcc
v_cmp_eq_u32 vcc,1,v248
v_mfma_f32_16x16x32_bf16 v[76:79],v[164:167],a[228:231],v[76:79]
buffer_load_dwordx4 v220,s[20:23],s98 offen offset:1024 lds
s_add_u32 m0,s84,90112
v_subrev_u32 v214,81920,v214
v_mfma_f32_16x16x32_bf16 v[80:83],v[168:171],a[224:227],v[80:83]
ds_read_b64_tr_b16 v[160:161],v214 offset:16384
ds_read_b64_tr_b16 v[162:163],v214 offset:17408
v_cndmask_b32 v203,0,v201,vcc
v_mfma_f32_16x16x32_bf16 v[84:87],v[168:171],a[228:231],v[84:87]
v_subrev_u32 v252,81920,v252
ds_read_b64_tr_b16 v[164:165],v252 offset:16384
ds_read_b64_tr_b16 v[166:167],v252 offset:17408
v_mfma_f32_16x16x32_bf16 v[88:91],v[172:175],a[224:227],v[88:91]
v_mov_b32 v200,0
v_mov_b32 v201,0
v_mov_b32 v204,0
v_mfma_f32_16x16x32_bf16 v[92:95],v[172:175],a[228:231],v[92:95]
buffer_load_dwordx4 v[0:3],v212,s[24:27],s51 offen sc1
ds_read_b64_tr_b16 v[168:169],v215 offset:8192
ds_read_b64_tr_b16 v[170:171],v215 offset:12288
s_waitcnt lgkmcnt(6)
v_mfma_f32_16x16x32_bf16 v[96:99],v[176:179],a[224:227],v[96:99]
v_mov_b32 v205,0
v_mov_b32 v232,v202
v_mov_b32 v233,v203
v_mfma_f32_16x16x32_bf16 v[100:103],v[176:179],a[228:231],v[100:103]
buffer_load_dwordx4 v221,s[20:23],s98 offen lds
ds_read_b64_tr_b16 v[172:173],v216 offset:8192
ds_read_b64_tr_b16 v[174:175],v216 offset:12288
v_mfma_f32_16x16x32_bf16 v[104:107],v[180:183],a[224:227],v[104:107]
v_mov_b32 v234,v202
v_mov_b32 v235,v203
v_mfma_f32_16x16x32_bf16 v[108:111],v[180:183],a[228:231],v[108:111]
buffer_load_dwordx4 a[0:3],v218,s[24:27],s82 offen sc1
ds_read_b64_tr_b16 v[176:177],v217 offset:8192
ds_read_b64_tr_b16 v[178:179],v217 offset:12288
v_mfma_f32_16x16x32_bf16 v[112:115],v[184:187],a[224:227],v[112:115]
buffer_load_dwordx4 v[4:7],v212,s[24:27],s51 offen offset:1024 sc1
v_mfma_f32_16x16x32_bf16 v[116:119],v[184:187],a[228:231],v[116:119]
ds_read_b64_tr_b16 v[180:181],v213 offset:8192
ds_read_b64_tr_b16 v[182:183],v213 offset:12288
v_mfma_f32_16x16x32_bf16 v[120:123],v[188:191],a[224:227],v[120:123]
v_mfma_f32_16x16x32_bf16 v[124:127],v[188:191],a[228:231],v[124:127]
buffer_load_dwordx4 v222,s[20:23],s98 offen offset:1024 lds
buffer_load_dwordx4 a[16:19],v218,s[24:27],s83 offen sc1
s_add_u32 m0,s99,98304
s_waitcnt lgkmcnt(4)
v_mfma_f32_16x16x32_bf16 v[128:131],v[160:163],a[224:227],v[128:131]
ds_read_b64_tr_b16 v[184:185],v215 offset:9216
ds_read_b64_tr_b16 v[186:187],v215 offset:13312
v_mfma_f32_16x16x32_bf16 v[132:135],v[160:163],a[228:231],v[132:135]
buffer_load_dwordx4 v[8:11],v212,s[24:27],s51 offen offset:2048 sc1
buffer_load_dwordx4 a[4:7],v218,s[24:27],s82 offen offset:1024 sc1
ds_read_b64_tr_b16 v[188:189],v216 offset:9216
v_mfma_f32_16x16x32_bf16 v[136:139],v[164:167],a[224:227],v[136:139]
ds_read_b64_tr_b16 v[190:191],v216 offset:13312
v_mfma_f32_16x16x32_bf16 v[140:143],v[164:167],a[228:231],v[140:143]
s_lshr_b32 s99,s84,1
ds_read_b64_tr_b16 v[160:161],v217 offset:9216
ds_read_b64_tr_b16 v[162:163],v217 offset:13312
v_mfma_f32_16x16x32_bf16 v[64:67],v[168:171],a[232:235],v[64:67]
v_add_u32 v221,4608,v221
v_add_u32 v222,4608,v222
s_mul_i32 s100,s47,4608
v_mfma_f32_16x16x32_bf16 v[68:71],v[168:171],a[236:239],v[68:71]
buffer_load_dwordx4 v223,s[20:23],s98 offen lds
buffer_load_dwordx4 a[20:23],v218,s[24:27],s83 offen offset:1024 sc1
s_add_u32 m0,s84,122880
v_mfma_f32_16x16x32_bf16 v[72:75],v[172:175],a[232:235],v[72:75]
buffer_load_dwordx4 v[12:15],v212,s[24:27],s51 offen offset:3072 sc1
ds_read_b64_tr_b16 v[164:165],v213 offset:9216
ds_read_b64_tr_b16 v[166:167],v213 offset:13312
v_mfma_f32_16x16x32_bf16 v[76:79],v[172:175],a[236:239],v[76:79]
buffer_load_dwordx4 a[8:11],v218,s[24:27],s82 offen offset:2048 sc1
ds_read_b64_tr_b16 v[168:169],v214 offset:18432
ds_read_b64_tr_b16 v[170:171],v214 offset:19456
s_waitcnt lgkmcnt(6)
v_mfma_f32_16x16x32_bf16 v[80:83],v[176:179],a[232:235],v[80:83]
v_add_u32 v223,s100,v223
v_mfma_f32_16x16x32_bf16 v[84:87],v[176:179],a[236:239],v[84:87]
ds_read_b64_tr_b16 v[172:173],v252 offset:18432
ds_read_b64_tr_b16 v[174:175],v252 offset:19456
v_mfma_f32_16x16x32_bf16 v[88:91],v[180:183],a[232:235],v[88:91]
v_mfma_f32_16x16x32_bf16 v[92:95],v[180:183],a[236:239],v[92:95]
buffer_load_dwordx4 v[16:19],v212,s[24:27],s52 offen sc1
buffer_load_dwordx4 a[24:27],v218,s[24:27],s83 offen offset:2048 sc1
s_waitcnt vmcnt(23)
v_mfma_f32_16x16x32_bf16 v[96:99],v[184:187],a[232:235],v[96:99]
s_barrier
ds_read_b64_tr_b16 v[176:177],v215 offset:20480
ds_read_b64_tr_b16 v[178:179],v215 offset:24576
v_mfma_f32_16x16x32_bf16 v[100:103],v[184:187],a[236:239],v[100:103]
buffer_load_dwordx4 a[12:15],v218,s[24:27],s82 offen offset:3072 sc1
ds_read_b64_tr_b16 v[180:181],v216 offset:20480
ds_read_b64_tr_b16 v[182:183],v216 offset:24576
v_mfma_f32_16x16x32_bf16 v[104:107],v[188:191],a[232:235],v[104:107]
v_mfma_f32_16x16x32_bf16 v[108:111],v[188:191],a[236:239],v[108:111]
ds_read_b64_tr_b16 v[184:185],v217 offset:20480
ds_read_b64_tr_b16 v[186:187],v217 offset:24576
s_waitcnt lgkmcnt(6)
v_mfma_f32_16x16x32_bf16 v[112:115],v[160:163],a[232:235],v[112:115]
buffer_load_dwordx4 v[20:23],v212,s[24:27],s52 offen offset:1024 sc1
v_mfma_f32_16x16x32_bf16 v[116:119],v[160:163],a[236:239],v[116:119]
buffer_load_dwordx4 a[28:31],v218,s[24:27],s83 offen offset:3072 sc1
ds_read_b64_tr_b16 v[188:189],v213 offset:20480
ds_read_b64_tr_b16 v[190:191],v213 offset:24576
v_mfma_f32_16x16x32_bf16 v[120:123],v[164:167],a[232:235],v[120:123]
v_mfma_f32_16x16x32_bf16 v[124:127],v[164:167],a[236:239],v[124:127]
ds_read_b64_tr_b16 v[160:161],v215 offset:21504
ds_read_b64_tr_b16 v[162:163],v215 offset:25600
v_mfma_f32_16x16x32_bf16 v[128:131],v[168:171],a[232:235],v[128:131]
v_mfma_f32_16x16x32_bf16 v[132:135],v[168:171],a[236:239],v[132:135]
buffer_load_dwordx4 v[24:27],v212,s[24:27],s52 offen offset:2048 sc1
ds_read_b64_tr_b16 v[164:165],v216 offset:21504
ds_read_b64_tr_b16 v[166:167],v216 offset:25600
v_mfma_f32_16x16x32_bf16 v[136:139],v[172:175],a[232:235],v[136:139]
v_mfma_f32_16x16x32_bf16 v[140:143],v[172:175],a[236:239],v[140:143]
s_mul_i32 s54,s46,102400
s_add_u32 s54,s54,0
ds_read_b64_tr_b16 v[168:169],v217 offset:21504
s_waitcnt lgkmcnt(5)
s_waitcnt vmcnt(25)
v_mfma_f32_16x16x32_bf16 v[64:67],v[176:179],a[240:243],v[64:67]
ds_read_b64_tr_b16 v[170:171],v217 offset:25600
s_mov_b32 s55,18432
v_add_u32 v245,s54,v212
v_mfma_f32_16x16x32_bf16 v[68:71],v[176:179],a[244:247],v[68:71]
ds_read_b64_tr_b16 v[172:173],v213 offset:21504
ds_read_b64_tr_b16 v[174:175],v213 offset:25600
s_lshl_b32 s100,s47,13
v_mfma_f32_16x16x32_bf16 v[72:75],v[180:183],a[240:243],v[72:75]
buffer_load_dwordx4 v[28:31],v212,s[24:27],s52 offen offset:3072 sc1
v_and_b32 v251,15,v226
s_lshl_b32 s53,s40,2
v_mfma_f32_16x16x32_bf16 v[76:79],v[180:183],a[244:247],v[76:79]
ds_read_b64_tr_b16 v[176:177],v214 offset:36864
ds_read_b64_tr_b16 v[178:179],v214 offset:37888
s_add_u32 s53,s53,s42
v_mfma_f32_16x16x32_bf16 v[80:83],v[184:187],a[240:243],v[80:83]
s_lshl_b32 s53,s53,5
v_add_u32 v211,s53,v251
v_mul_u32_u24 v211,1152,v211
v_mfma_f32_16x16x32_bf16 v[84:87],v[184:187],a[244:247],v[84:87]
ds_read_b64_tr_b16 v[180:181],v252 offset:36864
ds_read_b64_tr_b16 v[182:183],v252 offset:37888
v_lshrrev_b32 v250,5,v226
v_mfma_f32_16x16x32_bf16 v[88:91],v[188:191],a[240:243],v[88:91]
v_lshl_add_u32 v211,v250,4,v211
s_lshl_b32 s53,s43,3
s_lshr_b32 s53,0x0e0a0400,s53
v_mfma_f32_16x16x32_bf16 v[92:95],v[188:191],a[244:247],v[92:95]
buffer_load_dword v144,v244,s[24:27],s49 offen sc1
ds_read_b64_tr_b16 v[184:185],v215 offset:28672
ds_read_b64_tr_b16 v[186:187],v215 offset:32768
s_waitcnt lgkmcnt(6)
v_mfma_f32_16x16x32_bf16 v[96:99],v[160:163],a[240:243],v[96:99]
s_and_b32 s53,s53,0xff
s_add_u32 s53,s53,s45
s_lshl_b32 s53,s53,6
v_mfma_f32_16x16x32_bf16 v[100:103],v[160:163],a[244:247],v[100:103]
ds_read_b64_tr_b16 v[188:189],v216 offset:28672
ds_read_b64_tr_b16 v[190:191],v216 offset:32768
v_bfe_u32 v250,v226,4,1
v_mfma_f32_16x16x32_bf16 v[104:107],v[164:167],a[240:243],v[104:107]
v_lshl_add_u32 v210,v250,5,v211
v_add_u32 v210,s53,v210
s_lshl_b32 s53,s42,7
v_mfma_f32_16x16x32_bf16 v[108:111],v[164:167],a[244:247],v[108:111]
ds_read_b64_tr_b16 v[160:161],v217 offset:28672
ds_read_b64_tr_b16 v[162:163],v217 offset:32768
s_add_u32 s53,s53,159744
v_mfma_f32_16x16x32_bf16 v[112:115],v[168:171],a[240:243],v[112:115]
buffer_load_dword v145,v244,s[24:27],s49 offen offset:64 sc1
v_lshl_add_u32 v251,v251,2,s53
v_lshlrev_b32 v250,3,v250
v_mfma_f32_16x16x32_bf16 v[116:119],v[168:171],a[244:247],v[116:119]
ds_read_b64_tr_b16 v[164:165],v213 offset:28672
ds_read_b64_tr_b16 v[166:167],v213 offset:32768
s_lshl_b32 s53,s43,1
v_mfma_f32_16x16x32_bf16 v[120:123],v[172:175],a[240:243],v[120:123]
buffer_load_dword v146,v244,s[24:27],s49 offen offset:128 sc1
s_add_u32 s53,s53,s47
s_lshl_b32 s53,s53,5
v_mfma_f32_16x16x32_bf16 v[124:127],v[172:175],a[244:247],v[124:127]
ds_read_b64_tr_b16 v[168:169],v215 offset:29696
ds_read_b64_tr_b16 v[170:171],v215 offset:33792
s_waitcnt lgkmcnt(6)
v_mfma_f32_16x16x32_bf16 v[128:131],v[176:179],a[240:243],v[128:131]
buffer_load_dword v147,v244,s[24:27],s49 offen offset:192 sc1
v_add_u32 v244,s100,v245
s_lshl_b32 s100,s47,10
v_mfma_f32_16x16x32_bf16 v[132:135],v[176:179],a[244:247],v[132:135]
buffer_load_dwordx4 v219,s[36:39],s57 offen lds
ds_read_b64_tr_b16 v[172:173],v216 offset:29696
ds_read_b64_tr_b16 v[174:175],v216 offset:33792
v_mfma_f32_16x16x32_bf16 v[136:139],v[180:183],a[240:243],v[136:139]
s_add_u32 s100,s100,16384
v_add_u32 v245,s100,v245
v_add_u32 v246,8,v244
v_mfma_f32_16x16x32_bf16 v[140:143],v[180:183],a[244:247],v[140:143]
ds_read_b64_tr_b16 v[176:177],v217 offset:29696
ds_read_b64_tr_b16 v[178:179],v217 offset:33792
v_add3_u32 v211,v250,v211,s53
v_mfma_f32_16x16x32_bf16 v[64:67],v[184:187],a[248:251],v[64:67]
s_lshl_b32 s53,s46,6
v_add_u32 v251,s53,v251
v_xor_b32 v250,64,v251
v_mfma_f32_16x16x32_bf16 v[68:71],v[184:187],a[252:255],v[68:71]
buffer_load_dwordx4 v220,s[36:39],s57 offen offset:1024 lds
s_add_u32 m0,s84,131072
ds_read_b64_tr_b16 v[180:181],v213 offset:29696
v_mfma_f32_16x16x32_bf16 v[72:75],v[188:191],a[248:251],v[72:75]
ds_read_b64_tr_b16 v[182:183],v213 offset:33792
v_mfma_f32_16x16x32_bf16 v[76:79],v[188:191],a[252:255],v[76:79]
ds_read_b64_tr_b16 v[184:185],v214 offset:38912
ds_read_b64_tr_b16 v[186:187],v214 offset:39936
s_waitcnt lgkmcnt(6)
v_mfma_f32_16x16x32_bf16 v[80:83],v[160:163],a[248:251],v[80:83]
v_mfma_f32_16x16x32_bf16 v[84:87],v[160:163],a[252:255],v[84:87]
buffer_load_dwordx4 v221,s[36:39],s57 offen lds
ds_read_b64_tr_b16 v[188:189],v252 offset:38912
ds_read_b64_tr_b16 v[190:191],v252 offset:39936
v_mfma_f32_16x16x32_bf16 v[88:91],v[164:167],a[248:251],v[88:91]
v_mfma_f32_16x16x32_bf16 v[92:95],v[164:167],a[252:255],v[92:95]
s_waitcnt vmcnt(28)
s_barrier
ds_read_b64_tr_b16 v[160:161],v215 offset:40960
v_mfma_f32_16x16x32_bf16 v[96:99],v[168:171],a[248:251],v[96:99]
ds_read_b64_tr_b16 v[162:163],v215 offset:45056
v_mfma_f32_16x16x32_bf16 v[100:103],v[168:171],a[252:255],v[100:103]
buffer_load_dwordx4 v222,s[36:39],s57 offen offset:1024 lds
s_add_u32 m0,s99,139264
s_lshr_b32 s99,s84,1
v_mfma_f32_16x16x32_bf16 v[104:107],v[172:175],a[248:251],v[104:107]
ds_read_b64_tr_b16 v[164:165],v215 offset:49152
ds_read_b64_tr_b16 v[166:167],v215 offset:53248
v_mfma_f32_16x16x32_bf16 v[108:111],v[172:175],a[252:255],v[108:111]
v_add_u32 v215,61440,v215
s_waitcnt vmcnt(18)
s_barrier
s_waitcnt lgkmcnt(4)
v_mfma_f32_16x16x32_bf16 v[112:115],v[176:179],a[248:251],v[112:115]
ds_read_b64_tr_b16 v[168:169],v215 offset:0
ds_read_b64_tr_b16 v[170:171],v215 offset:4096
v_mfma_f32_16x16x32_bf16 v[116:119],v[176:179],a[252:255],v[116:119]
buffer_load_dwordx4 v223,s[36:39],s57 offen lds
s_add_u32 m0,s84,20480
ds_read_b64_tr_b16 v[172:173],v215 offset:8192
v_mfma_f32_16x16x32_bf16 v[120:123],v[180:183],a[248:251],v[120:123]
ds_read_b64_tr_b16 v[174:175],v215 offset:12288
v_mfma_f32_16x16x32_bf16 v[124:127],v[180:183],a[252:255],v[124:127]
ds_read_b64_tr_b16 v[176:177],v216 offset:40960
ds_read_b64_tr_b16 v[178:179],v216 offset:45056
v_mfma_f32_16x16x32_bf16 v[128:131],v[184:187],a[248:251],v[128:131]
v_mfma_f32_16x16x32_bf16 v[132:135],v[184:187],a[252:255],v[132:135]
ds_read_b64_tr_b16 v[180:181],v216 offset:49152
ds_read_b64_tr_b16 v[182:183],v216 offset:53248
v_mfma_f32_16x16x32_bf16 v[136:139],v[188:191],a[248:251],v[136:139]
v_mfma_f32_16x16x32_bf16 v[140:143],v[188:191],a[252:255],v[140:143]
v_add_u32 v216,61440,v216
ds_read_b64_tr_b16 v[184:185],v216 offset:0
ds_read_b64_tr_b16 v[186:187],v216 offset:4096
s_waitcnt lgkmcnt(6)
s_waitcnt vmcnt(13)
v_mfma_f32_16x16x32_bf16 v[64:67],v[160:163],a[0:3],v[64:67]
v_mfma_f32_16x16x32_bf16 v[68:71],v[160:163],a[4:7],v[68:71]
s_getpc_b64 s[0:1]
L_cp7_4:
v_min_u32 v254,L_stop_4-L_cp7_4,v253
global_load_dword v255,v254,s[0:1]
v_mfma_f32_16x16x32_bf16 v[64:67],v[164:167],a[8:11],v[64:67]
ds_read_b64_tr_b16 v[188:189],v216 offset:8192
ds_read_b64_tr_b16 v[190:191],v216 offset:12288
v_mfma_f32_16x16x32_bf16 v[68:71],v[164:167],a[12:15],v[68:71]
buffer_load_dwordx4 v219,s[36:39],s58 offen lds
ds_read_b64_tr_b16 v[160:161],v217 offset:40960
ds_read_b64_tr_b16 v[162:163],v217 offset:45056
s_waitcnt vmcnt(13)
v_mfma_f32_16x16x32_bf16 v[64:67],v[168:171],a[16:19],v[64:67]
v_mfma_f32_16x16x32_bf16 v[68:71],v[168:171],a[20:23],v[68:71]
ds_read_b64_tr_b16 v[164:165],v217 offset:49152
ds_read_b64_tr_b16 v[166:167],v217 offset:53248
v_mfma_f32_16x16x32_bf16 v[64:67],v[172:175],a[24:27],v[64:67]
v_mfma_f32_16x16x32_bf16 v[68:71],v[172:175],a[28:31],v[68:71]
buffer_load_dwordx4 v220,s[36:39],s58 offen offset:1024 lds
s_add_u32 m0,s84,28672
v_add_u32 v217,61440,v217
s_waitcnt lgkmcnt(4)
v_mfma_f32_16x16x32_bf16 v[72:75],v[176:179],a[0:3],v[72:75]
ds_read_b64_tr_b16 v[168:169],v217 offset:0
ds_read_b64_tr_b16 v[170:171],v217 offset:4096
v_mfma_f32_16x16x32_bf16 v[76:79],v[176:179],a[4:7],v[76:79]
v_cvt_pk_bf16_f32 v64,v64,v65
v_cvt_pk_bf16_f32 v65,v66,v67
ds_read_b64_tr_b16 v[172:173],v217 offset:8192
v_mfma_f32_16x16x32_bf16 v[72:75],v[180:183],a[8:11],v[72:75]
v_cvt_pk_bf16_f32 v68,v68,v69
v_cvt_pk_bf16_f32 v69,v70,v71
ds_read_b64_tr_b16 v[174:175],v217 offset:12288
v_mfma_f32_16x16x32_bf16 v[76:79],v[180:183],a[12:15],v[76:79]
buffer_load_dwordx4 v221,s[36:39],s58 offen lds
ds_read_b64_tr_b16 v[176:177],v213 offset:40960
ds_read_b64_tr_b16 v[178:179],v213 offset:45056
v_mfma_f32_16x16x32_bf16 v[72:75],v[184:187],a[16:19],v[72:75]
ds_read_b32 v208,v251 offset:0
ds_read_b32 v209,v250 offset:0
v_mfma_f32_16x16x32_bf16 v[76:79],v[184:187],a[20:23],v[76:79]
ds_read_b64_tr_b16 v[180:181],v213 offset:49152
ds_read_b64_tr_b16 v[182:183],v213 offset:53248
v_mfma_f32_16x16x32_bf16 v[72:75],v[188:191],a[24:27],v[72:75]
v_mfma_f32_16x16x32_bf16 v[76:79],v[188:191],a[28:31],v[76:79]
buffer_load_dwordx4 v222,s[36:39],s58 offen offset:1024 lds
s_add_u32 m0,s99,36864
v_add_u32 v213,61440,v213
s_waitcnt lgkmcnt(6)
v_mfma_f32_16x16x32_bf16 v[80:83],v[160:163],a[0:3],v[80:83]
ds_read_b64_tr_b16 v[184:185],v213 offset:0
ds_read_b64_tr_b16 v[186:187],v213 offset:4096
v_mfma_f32_16x16x32_bf16 v[84:87],v[160:163],a[4:7],v[84:87]
v_cvt_pk_bf16_f32 v66,v72,v73
v_cvt_pk_bf16_f32 v67,v74,v75
buffer_store_dwordx4 v[64:67],v239,s[24:27],s86 offen sc1
v_mfma_f32_16x16x32_bf16 v[80:83],v[164:167],a[8:11],v[80:83]
v_cvt_pk_bf16_f32 v70,v76,v77
v_cvt_pk_bf16_f32 v71,v78,v79
buffer_store_dwordx4 v[68:71],v239,s[24:27],s87 offen sc1
ds_read_b64_tr_b16 v[188:189],v213 offset:8192
v_mfma_f32_16x16x32_bf16 v[84:87],v[164:167],a[12:15],v[84:87]
v_subrev_u32 v215,20480,v215
ds_read_b64_tr_b16 v[190:191],v213 offset:12288
ds_read_b64_tr_b16 v[160:161],v215 offset:1024
ds_read_b64_tr_b16 v[162:163],v215 offset:5120
v_mfma_f32_16x16x32_bf16 v[80:83],v[168:171],a[16:19],v[80:83]
s_mov_b64 exec,s[16:17]
ds_write_b128 v240,v[64:67] offset:0
s_mov_b64 exec,-1
s_nop 0
v_mfma_f32_16x16x32_bf16 v[84:87],v[168:171],a[20:23],v[84:87]
ds_read_b64_tr_b16 v[164:165],v215 offset:9216
ds_read_b64_tr_b16 v[166:167],v215 offset:13312
v_mfma_f32_16x16x32_bf16 v[80:83],v[172:175],a[24:27],v[80:83]
buffer_load_dwordx4 v223,s[36:39],s58 offen lds
s_mov_b64 exec,s[16:17]
ds_write_b128 v240,v[68:71] offset:4096
s_mov_b64 exec,-1
s_nop 0
v_mfma_f32_16x16x32_bf16 v[84:87],v[172:175],a[28:31],v[84:87]
ds_read_b64_tr_b16 v[168:169],v215 offset:21504
ds_read_b64_tr_b16 v[170:171],v215 offset:25600
s_waitcnt lgkmcnt(6)
v_mfma_f32_16x16x32_bf16 v[88:91],v[176:179],a[0:3],v[88:91]
v_mfma_f32_16x16x32_bf16 v[92:95],v[176:179],a[4:7],v[92:95]
v_cvt_pk_bf16_f32 v80,v80,v81
v_cvt_pk_bf16_f32 v81,v82,v83
ds_read_b64_tr_b16 v[172:173],v215 offset:29696
v_mfma_f32_16x16x32_bf16 v[88:91],v[180:183],a[8:11],v[88:91]
v_cvt_pk_bf16_f32 v84,v84,v85
v_cvt_pk_bf16_f32 v85,v86,v87
ds_read_b64_tr_b16 v[174:175],v215 offset:33792
v_mfma_f32_16x16x32_bf16 v[92:95],v[180:183],a[12:15],v[92:95]
v_subrev_u32 v216,20480,v216
ds_read_b64_tr_b16 v[176:177],v216 offset:1024
ds_read_b64_tr_b16 v[178:179],v216 offset:5120
v_mfma_f32_16x16x32_bf16 v[88:91],v[184:187],a[16:19],v[88:91]
v_mfma_f32_16x16x32_bf16 v[92:95],v[184:187],a[20:23],v[92:95]
ds_read_b64_tr_b16 v[180:181],v216 offset:9216
ds_read_b64_tr_b16 v[182:183],v216 offset:13312
v_mfma_f32_16x16x32_bf16 v[88:91],v[188:191],a[24:27],v[88:91]
v_mfma_f32_16x16x32_bf16 v[92:95],v[188:191],a[28:31],v[92:95]
ds_read_b64_tr_b16 v[184:185],v216 offset:21504
ds_read_b64_tr_b16 v[186:187],v216 offset:25600
s_waitcnt lgkmcnt(6)
v_mfma_f32_16x16x32_bf16 v[96:99],v[160:163],a[0:3],v[96:99]
v_mfma_f32_16x16x32_bf16 v[100:103],v[160:163],a[4:7],v[100:103]
s_nop 1
v_cvt_pk_bf16_f32 v82,v88,v89
v_cvt_pk_bf16_f32 v83,v90,v91
buffer_store_dwordx4 v[80:83],v239,s[24:27],s86 offen offset:1024 sc1
ds_read_b64_tr_b16 v[188:189],v216 offset:29696
v_mfma_f32_16x16x32_bf16 v[96:99],v[164:167],a[8:11],v[96:99]
v_cvt_pk_bf16_f32 v86,v92,v93
v_cvt_pk_bf16_f32 v87,v94,v95
buffer_store_dwordx4 v[84:87],v239,s[24:27],s87 offen offset:1024 sc1
ds_read_b64_tr_b16 v[190:191],v216 offset:33792
v_mfma_f32_16x16x32_bf16 v[100:103],v[164:167],a[12:15],v[100:103]
v_subrev_u32 v217,20480,v217
ds_read_b64_tr_b16 v[160:161],v217 offset:1024
ds_read_b64_tr_b16 v[162:163],v217 offset:5120
v_mfma_f32_16x16x32_bf16 v[96:99],v[168:171],a[16:19],v[96:99]
s_mov_b64 exec,s[16:17]
ds_write_b128 v240,v[80:83] offset:1024
s_mov_b64 exec,-1
s_nop 0
v_mfma_f32_16x16x32_bf16 v[100:103],v[168:171],a[20:23],v[100:103]
ds_read_b64_tr_b16 v[164:165],v217 offset:9216
ds_read_b64_tr_b16 v[166:167],v217 offset:13312
v_mfma_f32_16x16x32_bf16 v[96:99],v[172:175],a[24:27],v[96:99]
s_mov_b64 exec,s[16:17]
ds_write_b128 v240,v[84:87] offset:5120
s_mov_b64 exec,-1
s_nop 0
v_mfma_f32_16x16x32_bf16 v[100:103],v[172:175],a[28:31],v[100:103]
ds_read_b64_tr_b16 v[168:169],v217 offset:21504
ds_read_b64_tr_b16 v[170:171],v217 offset:25600
s_waitcnt lgkmcnt(6)
v_mfma_f32_16x16x32_bf16 v[104:107],v[176:179],a[0:3],v[104:107]
v_mfma_f32_16x16x32_bf16 v[108:111],v[176:179],a[4:7],v[108:111]
v_cvt_pk_bf16_f32 v96,v96,v97
v_cvt_pk_bf16_f32 v97,v98,v99
ds_read_b64_tr_b16 v[172:173],v217 offset:29696
ds_read_b64_tr_b16 v[174:175],v217 offset:33792
v_mfma_f32_16x16x32_bf16 v[104:107],v[180:183],a[8:11],v[104:107]
v_cvt_pk_bf16_f32 v100,v100,v101
v_cvt_pk_bf16_f32 v101,v102,v103
s_waitcnt vmcnt(15)
ds_write2st64_b64 v244,v[0:1],v[2:3] offset0:0 offset1:2
ds_write2st64_b64 v246,v[4:5],v[6:7] offset0:0 offset1:2
ds_write2st64_b64 v244,v[8:9],v[10:11] offset0:4 offset1:6
ds_write2st64_b64 v246,v[12:13],v[14:15] offset0:4 offset1:6
ds_write2st64_b64 v244,v[16:17],v[18:19] offset0:8 offset1:10
ds_write2st64_b64 v246,v[20:21],v[22:23] offset0:8 offset1:10
ds_write2st64_b64 v244,v[24:25],v[26:27] offset0:12 offset1:14
ds_write2st64_b64 v246,v[28:29],v[30:31] offset0:12 offset1:14
ds_write_b128 v245,v[144:147]
v_mfma_f32_16x16x32_bf16 v[108:111],v[180:183],a[12:15],v[108:111]
v_subrev_u32 v213,20480,v213
ds_read_b64_tr_b16 v[176:177],v213 offset:1024
ds_read_b64_tr_b16 v[178:179],v213 offset:5120
v_mfma_f32_16x16x32_bf16 v[104:107],v[184:187],a[16:19],v[104:107]
v_mfma_f32_16x16x32_bf16 v[108:111],v[184:187],a[20:23],v[108:111]
ds_read_b64_tr_b16 v[180:181],v213 offset:9216
ds_read_b64_tr_b16 v[182:183],v213 offset:13312
v_mfma_f32_16x16x32_bf16 v[104:107],v[188:191],a[24:27],v[104:107]
v_mfma_f32_16x16x32_bf16 v[108:111],v[188:191],a[28:31],v[108:111]
ds_read_b64_tr_b16 v[184:185],v213 offset:21504
ds_read_b64_tr_b16 v[186:187],v213 offset:25600
s_waitcnt lgkmcnt(15)
v_mfma_f32_16x16x32_bf16 v[112:115],v[160:163],a[0:3],v[112:115]
v_mfma_f32_16x16x32_bf16 v[116:119],v[160:163],a[4:7],v[116:119]
s_lshl_b32 s54,s46,10
s_add_u32 s54,s54,0
v_cvt_pk_bf16_f32 v98,v104,v105
v_cvt_pk_bf16_f32 v99,v106,v107
buffer_store_dwordx4 v[96:99],v239,s[24:27],s86 offen offset:2048 sc1
ds_read_b64_tr_b16 v[188:189],v213 offset:29696
ds_read_b64_tr_b16 v[190:191],v213 offset:33792
v_mfma_f32_16x16x32_bf16 v[112:115],v[164:167],a[8:11],v[112:115]
v_cvt_pk_bf16_f32 v102,v108,v109
v_cvt_pk_bf16_f32 v103,v110,v111
buffer_store_dwordx4 v[100:103],v239,s[24:27],s87 offen offset:2048 sc1
v_add_u32 v245,s54,v212
v_mfma_f32_16x16x32_bf16 v[116:119],v[164:167],a[12:15],v[116:119]
ds_read_b64_tr_b16 v[160:161],v214 offset:57344
ds_read_b64_tr_b16 v[162:163],v214 offset:58368
v_xor_b32 v246,1024,v245
v_mfma_f32_16x16x32_bf16 v[112:115],v[168:171],a[16:19],v[112:115]
s_mov_b64 exec,s[16:17]
ds_write_b128 v240,v[96:99] offset:2048
s_mov_b64 exec,-1
s_nop 0
v_mfma_f32_16x16x32_bf16 v[116:119],v[168:171],a[20:23],v[116:119]
ds_read_b64_tr_b16 v[164:165],v214 offset:59392
ds_read_b64_tr_b16 v[166:167],v214 offset:60416
v_mfma_f32_16x16x32_bf16 v[112:115],v[172:175],a[24:27],v[112:115]
s_mov_b64 exec,s[16:17]
ds_write_b128 v240,v[100:103] offset:6144
s_mov_b64 exec,-1
s_nop 0
v_mfma_f32_16x16x32_bf16 v[116:119],v[172:175],a[28:31],v[116:119]
v_add_u32 v214,61440,v214
ds_read_b64_tr_b16 v[168:169],v214 offset:16384
ds_read_b64_tr_b16 v[170:171],v214 offset:17408
s_waitcnt lgkmcnt(6)
v_mfma_f32_16x16x32_bf16 v[120:123],v[176:179],a[0:3],v[120:123]
s_lshl_b32 s88,s40,5
s_add_u32 s88,s88,s43
s_add_u32 s88,s88,16
s_lshl_b32 s88,s88,5
v_mfma_f32_16x16x32_bf16 v[124:127],v[176:179],a[4:7],v[124:127]
v_cvt_pk_bf16_f32 v112,v112,v113
v_cvt_pk_bf16_f32 v113,v114,v115
ds_read_b64_tr_b16 v[172:173],v214 offset:18432
ds_read_b64_tr_b16 v[174:175],v214 offset:19456
v_mfma_f32_16x16x32_bf16 v[120:123],v[180:183],a[8:11],v[120:123]
v_cvt_pk_bf16_f32 v116,v116,v117
v_cvt_pk_bf16_f32 v117,v118,v119
s_add_u32 s88,s88,s42
s_lshl_b32 s88,s88,2
v_mfma_f32_16x16x32_bf16 v[124:127],v[180:183],a[12:15],v[124:127]
ds_read_b64_tr_b16 v[176:177],v252 offset:57344
ds_read_b64_tr_b16 v[178:179],v252 offset:58368
v_mfma_f32_16x16x32_bf16 v[120:123],v[184:187],a[16:19],v[120:123]
v_mfma_f32_16x16x32_bf16 v[124:127],v[184:187],a[20:23],v[124:127]
ds_read_b64_tr_b16 v[180:181],v252 offset:59392
ds_read_b64_tr_b16 v[182:183],v252 offset:60416
v_mfma_f32_16x16x32_bf16 v[120:123],v[188:191],a[24:27],v[120:123]
v_mfma_f32_16x16x32_bf16 v[124:127],v[188:191],a[28:31],v[124:127]
v_add_u32 v252,61440,v252
ds_read_b64_tr_b16 v[184:185],v252 offset:16384
ds_read_b64_tr_b16 v[186:187],v252 offset:17408
s_waitcnt lgkmcnt(6)
v_mfma_f32_16x16x32_bf16 v[128:131],v[160:163],a[0:3],v[128:131]
v_mfma_f32_16x16x32_bf16 v[132:135],v[160:163],a[4:7],v[132:135]
s_nop 0
v_cvt_pk_bf16_f32 v114,v120,v121
v_cvt_pk_bf16_f32 v115,v122,v123
buffer_store_dwordx4 v[112:115],v239,s[24:27],s86 offen offset:3072 sc1
ds_read_b64_tr_b16 v[188:189],v252 offset:18432
ds_read_b64_tr_b16 v[190:191],v252 offset:19456
v_mfma_f32_16x16x32_bf16 v[128:131],v[164:167],a[8:11],v[128:131]
v_cvt_pk_bf16_f32 v118,v124,v125
v_cvt_pk_bf16_f32 v119,v126,v127
buffer_store_dwordx4 v[116:119],v239,s[24:27],s87 offen offset:3072 sc1
v_mfma_f32_16x16x32_bf16 v[132:135],v[164:167],a[12:15],v[132:135]
s_lshl_b32 s54,s47,6
v_xor_b32 v236,s54,v215
s_lshl_b32 s54,s46,10
v_add_u32 v236,s54,v236
v_mfma_f32_16x16x32_bf16 v[128:131],v[168:171],a[16:19],v[128:131]
s_add_u32 m0,s84,40960
s_lshr_b32 s99,s84,1
s_lshl_b32 s54,s47,5
s_waitcnt lgkmcnt(0)
v_mfma_f32_16x16x32_bf16 v[132:135],v[168:171],a[20:23],v[132:135]
v_xor_b32 v237,32,v236
v_xor_b32 v238,s54,v214
s_mul_i32 s54,s46,18432
s_sub_u32 s55,18432,s54
v_mfma_f32_16x16x32_bf16 v[128:131],v[172:175],a[24:27],v[128:131]
s_mov_b64 exec,s[16:17]
ds_write_b128 v240,v[112:115] offset:3072
s_mov_b64 exec,-1
s_nop 0
v_mfma_f32_16x16x32_bf16 v[132:135],v[172:175],a[28:31],v[132:135]
s_mov_b64 exec,s[16:17]
ds_write_b128 v240,v[116:119] offset:7168
s_mov_b64 exec,-1
s_nop 0
v_mfma_f32_16x16x32_bf16 v[136:139],v[176:179],a[0:3],v[136:139]
v_mfma_f32_16x16x32_bf16 v[140:143],v[176:179],a[4:7],v[140:143]
v_cvt_pk_bf16_f32 v128,v128,v129
v_cvt_pk_bf16_f32 v129,v130,v131
v_mfma_f32_16x16x32_bf16 v[136:139],v[180:183],a[8:11],v[136:139]
v_cvt_pk_bf16_f32 v130,v132,v133
v_cvt_pk_bf16_f32 v131,v134,v135
buffer_store_dwordx4 v[128:131],v239,s[24:27],s48 offen sc1
v_mfma_f32_16x16x32_bf16 v[140:143],v[180:183],a[12:15],v[140:143]
s_mov_b64 exec,s[16:17]
ds_write_b128 v240,v[128:131] offset:8192
s_mov_b64 exec,-1
s_nop 0
v_mfma_f32_16x16x32_bf16 v[136:139],v[184:187],a[16:19],v[136:139]
v_add_u32 v236,61440,v236
v_add_u32 v237,61440,v237
s_waitcnt vmcnt(7)
s_barrier
buffer_load_dwordx4 v219,s[36:39],s59 offen lds
buffer_load_dwordx4 v220,s[36:39],s59 offen offset:1024 lds
s_add_u32 m0,s84,49152
ds_read_b64_tr_b16 a[32:33],v236 offset:0
ds_read_b64_tr_b16 a[34:35],v236 offset:4096
ds_read_b64_tr_b16 a[36:37],v237 offset:0
ds_read_b64_tr_b16 a[38:39],v237 offset:4096
ds_read_b64_tr_b16 a[40:41],v238 offset:57344
ds_read_b64_tr_b16 a[42:43],v238 offset:58368
ds_read_b128 a[96:99],v245 offset:0
ds_read_b128 a[100:103],v246 offset:0
v_mfma_f32_16x16x32_bf16 v[140:143],v[184:187],a[20:23],v[140:143]
buffer_load_dwordx4 v221,s[36:39],s59 offen lds
buffer_load_dwordx4 v222,s[36:39],s59 offen offset:1024 lds
s_add_u32 m0,s99,57344
s_lshr_b32 s99,s84,1
v_mfma_f32_16x16x32_bf16 v[136:139],v[188:191],a[24:27],v[136:139]
buffer_load_dwordx4 v223,s[36:39],s59 offen lds
s_add_u32 m0,s84,61440
s_waitcnt lgkmcnt(0)
v_mfma_f32_16x16x32_bf16 v[140:143],v[188:191],a[28:31],v[140:143]
buffer_load_dwordx4 v219,s[36:39],s60 offen lds
buffer_load_dwordx4 v220,s[36:39],s60 offen offset:1024 lds
s_add_u32 m0,s84,69632
v_mfma_f32_16x16x32_bf16 v[144:147],a[32:35],a[96:99],0
buffer_load_dwordx4 v221,s[36:39],s60 offen lds
buffer_load_dwordx4 v222,s[36:39],s60 offen offset:1024 lds
s_add_u32 m0,s99,77824
s_lshr_b32 s99,s84,1
ds_read_b64_tr_b16 a[44:45],v236 offset:8192
ds_read_b64_tr_b16 a[46:47],v236 offset:12288
ds_read_b64_tr_b16 a[48:49],v237 offset:8192
ds_read_b64_tr_b16 a[50:51],v237 offset:12288
ds_read_b64_tr_b16 a[52:53],v238 offset:59392
ds_read_b64_tr_b16 a[54:55],v238 offset:60416
ds_read_b128 a[104:107],v245 offset:2048
ds_read_b128 a[108:111],v246 offset:2048
v_mfma_f32_16x16x32_bf16 v[152:155],a[32:35],a[100:103],0
buffer_load_dwordx4 v223,s[36:39],s60 offen lds
s_add_u32 m0,s84,81920
v_cvt_pk_bf16_f32 v136,v136,v137
v_cvt_pk_bf16_f32 v137,v138,v139
v_mfma_f32_16x16x32_bf16 v[148:151],a[36:39],a[96:99],0
buffer_load_dwordx4 v219,s[36:39],s61 offen lds
buffer_load_dwordx4 v220,s[36:39],s61 offen offset:1024 lds
s_add_u32 m0,s84,90112
v_cvt_pk_bf16_f32 v138,v140,v141
v_cvt_pk_bf16_f32 v139,v142,v143
buffer_store_dwordx4 v[136:139],v239,s[24:27],s48 offen offset:1024 sc1
s_mov_b64 exec,s[16:17]
ds_write_b128 v240,v[136:139] offset:9216
s_mov_b64 exec,-1
s_waitcnt lgkmcnt(0)
v_mfma_f32_16x16x32_bf16 v[156:159],a[36:39],a[100:103],0
buffer_load_dwordx4 v221,s[36:39],s61 offen lds
buffer_load_dwordx4 v222,s[36:39],s61 offen offset:1024 lds
s_add_u32 m0,s99,98304
v_mfma_f32_16x16x32_bf16 v[228:231],a[40:43],a[96:99],0
buffer_load_dwordx4 v223,s[36:39],s61 offen lds
v_mfma_f32_16x16x32_bf16 v[144:147],a[44:47],a[104:107],v[144:147]
v_subrev_u32 v236,102400,v236
v_subrev_u32 v237,102400,v237
v_subrev_u32 v238,61440,v238
ds_read_b64_tr_b16 a[32:33],v236 offset:0
ds_read_b64_tr_b16 a[34:35],v236 offset:4096
ds_read_b64_tr_b16 a[36:37],v237 offset:0
ds_read_b64_tr_b16 a[38:39],v237 offset:4096
ds_read_b64_tr_b16 a[40:41],v238 offset:16384
ds_read_b64_tr_b16 a[42:43],v238 offset:17408
ds_read_b128 a[96:99],v245 offset:4096
ds_read_b128 a[100:103],v246 offset:4096
v_mfma_f32_16x16x32_bf16 v[152:155],a[44:47],a[108:111],v[152:155]
v_mfma_f32_16x16x32_bf16 v[148:151],a[48:51],a[104:107],v[148:151]
s_add_u32 m0,s84,122880
s_lshr_b32 s99,s84,1
s_waitcnt lgkmcnt(0)
v_mfma_f32_16x16x32_bf16 v[156:159],a[48:51],a[108:111],v[156:159]
v_mfma_f32_16x16x32_bf16 v[228:231],a[52:55],a[104:107],v[228:231]
v_mfma_f32_16x16x32_bf16 v[144:147],a[32:35],a[96:99],v[144:147]
ds_read_b64_tr_b16 a[44:45],v236 offset:8192
ds_read_b64_tr_b16 a[46:47],v236 offset:12288
ds_read_b64_tr_b16 a[48:49],v237 offset:8192
ds_read_b64_tr_b16 a[50:51],v237 offset:12288
ds_read_b64_tr_b16 a[52:53],v238 offset:18432
ds_read_b64_tr_b16 a[54:55],v238 offset:19456
ds_read_b128 a[104:107],v245 offset:6144
ds_read_b128 a[108:111],v246 offset:6144
v_mfma_f32_16x16x32_bf16 v[152:155],a[32:35],a[100:103],v[152:155]
v_mfma_f32_16x16x32_bf16 v[148:151],a[36:39],a[96:99],v[148:151]
s_waitcnt lgkmcnt(0)
v_mfma_f32_16x16x32_bf16 v[156:159],a[36:39],a[100:103],v[156:159]
v_mfma_f32_16x16x32_bf16 v[228:231],a[40:43],a[96:99],v[228:231]
v_mfma_f32_16x16x32_bf16 v[144:147],a[44:47],a[104:107],v[144:147]
s_waitcnt vmcnt(3)
s_barrier
buffer_load_dwordx4 v219,s[36:39],s62 offen lds
buffer_load_dwordx4 v220,s[36:39],s62 offen offset:1024 lds
s_add_u32 m0,s84,131072
ds_read_b64_tr_b16 a[32:33],v236 offset:20480
v_mfma_f32_16x16x32_bf16 v[152:155],a[44:47],a[108:111],v[152:155]
buffer_load_dwordx4 v221,s[36:39],s62 offen lds
buffer_load_dwordx4 v222,s[36:39],s62 offen offset:1024 lds
s_add_u32 m0,s99,139264
s_lshr_b32 s99,s84,1
ds_read_b64_tr_b16 a[34:35],v236 offset:24576
ds_read_b64_tr_b16 a[36:37],v237 offset:20480
v_mfma_f32_16x16x32_bf16 v[148:151],a[48:51],a[104:107],v[148:151]
buffer_load_dwordx4 v223,s[36:39],s62 offen lds
s_add_u32 m0,s84,20480
ds_read_b64_tr_b16 a[38:39],v237 offset:24576
ds_read_b64_tr_b16 a[40:41],v238 offset:36864
ds_read_b64_tr_b16 a[42:43],v238 offset:37888
ds_read_b128 a[96:99],v245 offset:8192
ds_read_b128 a[100:103],v246 offset:8192
buffer_store_dword v225,v224,s[24:27],s88 offen sc1
v_mfma_f32_16x16x32_bf16 v[156:159],a[48:51],a[108:111],v[156:159]
v_mfma_f32_16x16x32_bf16 v[228:231],a[52:55],a[104:107],v[228:231]
s_waitcnt lgkmcnt(0)
s_lshl_b32 s56,s40,2
s_add_u32 s56,s56,s43
s_lshl_b32 s56,s56,2
v_mfma_f32_16x16x32_bf16 v[144:147],a[32:35],a[96:99],v[144:147]
ds_read_b64_tr_b16 a[44:45],v236 offset:28672
ds_read_b64_tr_b16 a[46:47],v236 offset:32768
ds_read_b64_tr_b16 a[48:49],v237 offset:28672
ds_read_b64_tr_b16 a[50:51],v237 offset:32768
v_mfma_f32_16x16x32_bf16 v[152:155],a[32:35],a[100:103],v[152:155]
ds_read_b64_tr_b16 a[52:53],v238 offset:38912
ds_read_b64_tr_b16 a[54:55],v238 offset:39936
ds_read_b128 a[104:107],v245 offset:10240
ds_read_b128 a[108:111],v246 offset:10240
v_mfma_f32_16x16x32_bf16 v[148:151],a[36:39],a[96:99],v[148:151]
buffer_load_dwordx4 v219,s[36:39],s63 offen lds
s_add_u32 s56,s56,s42
s_mul_i32 s56,s56,40960
s_add_u32 s56,s56,5242880
v_mfma_f32_16x16x32_bf16 v[156:159],a[36:39],a[100:103],v[156:159]
buffer_load_dwordx4 v220,s[36:39],s63 offen offset:1024 lds
s_add_u32 m0,s84,28672
s_waitcnt lgkmcnt(0)
v_mfma_f32_16x16x32_bf16 v[228:231],a[40:43],a[96:99],v[228:231]
buffer_load_dwordx4 v221,s[36:39],s63 offen lds
s_lshl_b32 s100,s45,10
v_add_u32 v213,s100,v212
v_mfma_f32_16x16x32_bf16 v[144:147],a[44:47],a[104:107],v[144:147]
buffer_load_dwordx4 v222,s[36:39],s63 offen offset:1024 lds
s_add_u32 m0,s99,36864
ds_read_b64_tr_b16 a[32:33],v236 offset:40960
ds_read_b64_tr_b16 a[34:35],v236 offset:45056
ds_read_b64_tr_b16 a[36:37],v237 offset:40960
ds_read_b64_tr_b16 a[38:39],v237 offset:45056
ds_read_b64_tr_b16 a[40:41],v238 offset:57344
ds_read_b64_tr_b16 a[42:43],v238 offset:58368
ds_read_b128 a[96:99],v245 offset:12288
ds_read_b128 a[100:103],v246 offset:12288
v_mfma_f32_16x16x32_bf16 v[152:155],a[44:47],a[108:111],v[152:155]
buffer_load_dwordx4 v223,s[36:39],s63 offen lds
s_lshl_b32 s100,s46,12
v_add_u32 v213,s100,v213
v_mfma_f32_16x16x32_bf16 v[148:151],a[48:51],a[104:107],v[148:151]
s_add_u32 m0,s84,40960
s_lshr_b32 s99,s84,1
s_waitcnt lgkmcnt(0)
v_mfma_f32_16x16x32_bf16 v[156:159],a[48:51],a[108:111],v[156:159]
s_add_u32 s49,s42,1
s_and_b32 s49,s49,3
s_mul_i32 s49,s49,10240
v_mfma_f32_16x16x32_bf16 v[228:231],a[52:55],a[104:107],v[228:231]
s_lshl_b32 s90,s40,5
s_add_u32 s90,s90,s43
s_add_u32 s90,s90,16
s_lshl_b32 s90,s90,7
v_mfma_f32_16x16x32_bf16 v[144:147],a[32:35],a[96:99],v[144:147]
ds_read_b64_tr_b16 a[44:45],v236 offset:49152
ds_read_b64_tr_b16 a[46:47],v236 offset:53248
ds_read_b64_tr_b16 a[48:49],v237 offset:49152
ds_read_b64_tr_b16 a[50:51],v237 offset:53248
ds_read_b64_tr_b16 a[52:53],v238 offset:59392
ds_read_b64_tr_b16 a[54:55],v238 offset:60416
ds_read_b128 a[104:107],v245 offset:14336
ds_read_b128 a[108:111],v246 offset:14336
v_mfma_f32_16x16x32_bf16 v[152:155],a[32:35],a[100:103],v[152:155]
v_and_b32 v227,3,v226
v_mul_u32_u24 v227,4,v227
s_add_u32 s49,s49,s56
v_mfma_f32_16x16x32_bf16 v[148:151],a[36:39],a[96:99],v[148:151]
s_waitcnt lgkmcnt(0)
s_add_u32 s50,s42,2
s_and_b32 s50,s50,3
v_mfma_f32_16x16x32_bf16 v[156:159],a[36:39],a[100:103],v[156:159]
s_mul_i32 s50,s50,10240
s_add_u32 s50,s50,s56
s_add_u32 s51,s42,3
v_mfma_f32_16x16x32_bf16 v[228:231],a[40:43],a[96:99],v[228:231]
s_and_b32 s51,s51,3
s_mul_i32 s51,s51,10240
s_add_u32 s51,s51,s56
v_xor_b32 v214,4096,v213
v_mfma_f32_16x16x32_bf16 v[144:147],a[44:47],a[104:107],v[144:147]
v_add_u32 v236,61440,v236
v_add_u32 v237,61440,v237
v_add_u32 v238,61440,v238
v_add_u32 v245,102400,v245
s_waitcnt vmcnt(6)
s_barrier
buffer_load_dwordx4 v219,s[36:39],s64 offen lds
buffer_load_dwordx4 v220,s[36:39],s64 offen offset:1024 lds
s_add_u32 m0,s84,49152
ds_read_b64_tr_b16 a[32:33],v236 offset:0
v_mfma_f32_16x16x32_bf16 v[152:155],a[44:47],a[108:111],v[152:155]
buffer_load_dwordx4 v221,s[36:39],s64 offen lds
buffer_load_dwordx4 v222,s[36:39],s64 offen offset:1024 lds
s_add_u32 m0,s99,57344
ds_read_b64_tr_b16 a[34:35],v236 offset:4096
ds_read_b64_tr_b16 a[36:37],v237 offset:0
v_mfma_f32_16x16x32_bf16 v[148:151],a[48:51],a[104:107],v[148:151]
buffer_load_dwordx4 v223,s[36:39],s64 offen lds
s_add_u32 m0,s84,61440
s_lshr_b32 s99,s84,1
v_add_u32 v246,102400,v246
ds_read_b64_tr_b16 a[38:39],v237 offset:4096
ds_read_b64_tr_b16 a[40:41],v238 offset:16384
ds_read_b64_tr_b16 a[42:43],v238 offset:17408
ds_read_b128 a[96:99],v245 offset:0
ds_read_b128 a[100:103],v246 offset:0
v_mfma_f32_16x16x32_bf16 v[156:159],a[48:51],a[108:111],v[156:159]
s_lshl_b32 s100,s47,7
s_add_u32 s100,s100,s46
s_lshl_b32 s100,s100,3
v_mfma_f32_16x16x32_bf16 v[228:231],a[52:55],a[104:107],v[228:231]
s_waitcnt lgkmcnt(0)
s_add_u32 s100,s100,8192
v_add_u32 v218,s100,v212
v_mfma_f32_16x16x32_bf16 v[144:147],a[32:35],a[96:99],v[144:147]
ds_read_b64_tr_b16 a[44:45],v236 offset:8192
ds_read_b64_tr_b16 a[46:47],v236 offset:12288
ds_read_b64_tr_b16 a[48:49],v237 offset:8192
v_mfma_f32_16x16x32_bf16 v[152:155],a[32:35],a[100:103],v[152:155]
ds_read_b64_tr_b16 a[50:51],v237 offset:12288
ds_read_b64_tr_b16 a[52:53],v238 offset:18432
ds_read_b64_tr_b16 a[54:55],v238 offset:19456
v_mfma_f32_16x16x32_bf16 v[148:151],a[36:39],a[96:99],v[148:151]
ds_read_b128 a[104:107],v245 offset:2048
ds_read_b128 a[108:111],v246 offset:2048
v_add_u32 v240,143360,v213
v_mfma_f32_16x16x32_bf16 v[156:159],a[36:39],a[100:103],v[156:159]
ds_read_b128 v[64:67],v240
v_add_u32 v241,143360,v214
ds_read_b128 v[80:83],v241
v_mfma_f32_16x16x32_bf16 v[228:231],a[40:43],a[96:99],v[228:231]
s_waitcnt lgkmcnt(2)
v_add_u32 v242,143360,v218
ds_read_b64 v[96:97],v242
v_mfma_f32_16x16x32_bf16 v[144:147],a[44:47],a[104:107],v[144:147]
ds_read_b64_tr_b16 a[32:33],v236 offset:40960
ds_read_b64_tr_b16 a[34:35],v236 offset:45056
ds_read_b64_tr_b16 a[36:37],v237 offset:40960
v_mfma_f32_16x16x32_bf16 v[152:155],a[44:47],a[108:111],v[152:155]
ds_read_b64_tr_b16 a[38:39],v237 offset:45056
ds_read_b64_tr_b16 a[40:41],v238 offset:57344
ds_read_b64_tr_b16 a[42:43],v238 offset:58368
v_mfma_f32_16x16x32_bf16 v[148:151],a[48:51],a[104:107],v[148:151]
buffer_load_dwordx4 v192,s[36:39],s65 offen lds
ds_read_b128 a[96:99],v245 offset:4096
ds_read_b128 a[100:103],v246 offset:4096
v_mfma_f32_16x16x32_bf16 v[156:159],a[48:51],a[108:111],v[156:159]
buffer_load_dwordx4 v193,s[36:39],s65 offen offset:1024 lds
s_add_u32 m0,s84,69632
v_mfma_f32_16x16x32_bf16 v[228:231],a[52:55],a[104:107],v[228:231]
buffer_load_dwordx4 v194,s[36:39],s65 offen lds
s_waitcnt lgkmcnt(0)
v_mfma_f32_16x16x32_bf16 v[144:147],a[32:35],a[96:99],v[144:147]
buffer_load_dwordx4 v195,s[36:39],s65 offen offset:1024 lds
s_add_u32 m0,s99,77824
ds_read_b64_tr_b16 a[44:45],v236 offset:49152
v_mfma_f32_16x16x32_bf16 v[152:155],a[32:35],a[100:103],v[152:155]
buffer_load_dwordx4 v196,s[36:39],s85 offen lds
ds_read_b64_tr_b16 a[46:47],v236 offset:53248
ds_read_b64_tr_b16 a[48:49],v237 offset:49152
v_mfma_f32_16x16x32_bf16 v[148:151],a[36:39],a[96:99],v[148:151]
ds_read_b64_tr_b16 a[50:51],v237 offset:53248
ds_read_b64_tr_b16 a[52:53],v238 offset:59392
ds_read_b64_tr_b16 a[54:55],v238 offset:60416
ds_read_b128 a[104:107],v245 offset:6144
ds_read_b128 a[108:111],v246 offset:6144
v_mfma_f32_16x16x32_bf16 v[156:159],a[36:39],a[100:103],v[156:159]
v_mfma_f32_16x16x32_bf16 v[228:231],a[40:43],a[96:99],v[228:231]
s_waitcnt lgkmcnt(0)
v_mfma_f32_16x16x32_bf16 v[144:147],a[44:47],a[104:107],v[144:147]
v_subrev_u32 v236,61440,v236
v_subrev_u32 v237,61440,v237
v_subrev_u32 v238,61440,v238
s_waitcnt vmcnt(5)
s_barrier
ds_read_b64_tr_b16 a[32:33],v236 offset:0
v_mfma_f32_16x16x32_bf16 v[152:155],a[44:47],a[108:111],v[152:155]
ds_read_b64_tr_b16 a[34:35],v236 offset:4096
ds_read_b64_tr_b16 a[36:37],v237 offset:0
ds_read_b64_tr_b16 a[38:39],v237 offset:4096
v_mfma_f32_16x16x32_bf16 v[148:151],a[48:51],a[104:107],v[148:151]
ds_read_b64_tr_b16 a[40:41],v238 offset:16384
ds_read_b64_tr_b16 a[42:43],v238 offset:17408
ds_read_b128 a[96:99],v245 offset:8192
ds_read_b128 a[100:103],v246 offset:8192
v_mfma_f32_16x16x32_bf16 v[156:159],a[48:51],a[108:111],v[156:159]
v_mfma_f32_16x16x32_bf16 v[228:231],a[52:55],a[104:107],v[228:231]
s_waitcnt lgkmcnt(0)
buffer_load_dword v247,v227,s[24:27],s90 offen sc1
v_mfma_f32_16x16x32_bf16 v[144:147],a[32:35],a[96:99],v[144:147]
ds_read_b64_tr_b16 a[44:45],v236 offset:8192
ds_read_b64_tr_b16 a[46:47],v236 offset:12288
ds_read_b64_tr_b16 a[48:49],v237 offset:8192
v_mfma_f32_16x16x32_bf16 v[152:155],a[32:35],a[100:103],v[152:155]
ds_read_b64_tr_b16 a[50:51],v237 offset:12288
ds_read_b64_tr_b16 a[52:53],v238 offset:18432
ds_read_b64_tr_b16 a[54:55],v238 offset:19456
v_mfma_f32_16x16x32_bf16 v[148:151],a[36:39],a[96:99],v[148:151]
ds_read_b128 a[104:107],v245 offset:10240
ds_read_b128 a[108:111],v246 offset:10240
v_mfma_f32_16x16x32_bf16 v[156:159],a[36:39],a[100:103],v[156:159]
v_mfma_f32_16x16x32_bf16 v[228:231],a[40:43],a[96:99],v[228:231]
s_waitcnt lgkmcnt(0)
v_mfma_f32_16x16x32_bf16 v[144:147],a[44:47],a[104:107],v[144:147]
ds_read_b64_tr_b16 a[32:33],v236 offset:20480
ds_read_b64_tr_b16 a[34:35],v236 offset:24576
ds_read_b64_tr_b16 a[36:37],v237 offset:20480
v_mfma_f32_16x16x32_bf16 v[152:155],a[44:47],a[108:111],v[152:155]
buffer_load_dwordx4 v[36:39],v210,s[4:7],s54 offen offset:0
ds_read_b64_tr_b16 a[38:39],v237 offset:24576
ds_read_b64_tr_b16 a[40:41],v238 offset:36864
v_mfma_f32_16x16x32_bf16 v[148:151],a[48:51],a[104:107],v[148:151]
ds_read_b64_tr_b16 a[42:43],v238 offset:37888
ds_read_b128 a[96:99],v245 offset:12288
ds_read_b128 a[100:103],v246 offset:12288
v_mfma_f32_16x16x32_bf16 v[156:159],a[48:51],a[108:111],v[156:159]
v_mfma_f32_16x16x32_bf16 v[228:231],a[52:55],a[104:107],v[228:231]
s_waitcnt lgkmcnt(0)
v_mfma_f32_16x16x32_bf16 v[144:147],a[32:35],a[96:99],v[144:147]
ds_read_b64_tr_b16 a[44:45],v236 offset:28672
ds_read_b64_tr_b16 a[46:47],v236 offset:32768
ds_read_b64_tr_b16 a[48:49],v237 offset:28672
v_mfma_f32_16x16x32_bf16 v[152:155],a[32:35],a[100:103],v[152:155]
ds_read_b64_tr_b16 a[50:51],v237 offset:32768
ds_read_b64_tr_b16 a[52:53],v238 offset:38912
ds_read_b64_tr_b16 a[54:55],v238 offset:39936
ds_read_b128 a[104:107],v245 offset:14336
v_mfma_f32_16x16x32_bf16 v[148:151],a[36:39],a[96:99],v[148:151]
ds_read_b128 a[108:111],v246 offset:14336
v_mfma_f32_16x16x32_bf16 v[156:159],a[36:39],a[100:103],v[156:159]
v_mfma_f32_16x16x32_bf16 v[228:231],a[40:43],a[96:99],v[228:231]
buffer_load_dwordx4 v[40:43],v210,s[4:7],s55 offen offset:0
s_waitcnt lgkmcnt(0)
v_mfma_f32_16x16x32_bf16 v[144:147],a[44:47],a[104:107],v[144:147]
v_subrev_u32 v245,102400,v245
v_subrev_u32 v246,102400,v246
s_waitcnt vmcnt(3)
s_barrier
ds_read_b64_tr_b16 a[32:33],v236 offset:40960
v_mfma_f32_16x16x32_bf16 v[152:155],a[44:47],a[108:111],v[152:155]
ds_read_b64_tr_b16 a[34:35],v236 offset:45056
ds_read_b64_tr_b16 a[36:37],v237 offset:40960
ds_read_b64_tr_b16 a[38:39],v237 offset:45056
ds_read_b64_tr_b16 a[40:41],v238 offset:57344
v_mfma_f32_16x16x32_bf16 v[148:151],a[48:51],a[104:107],v[148:151]
ds_read_b64_tr_b16 a[42:43],v238 offset:58368
ds_read_b128 a[96:99],v245 offset:16384
ds_read_b128 a[100:103],v246 offset:16384
v_mfma_f32_16x16x32_bf16 v[156:159],a[48:51],a[108:111],v[156:159]
v_mfma_f32_16x16x32_bf16 v[228:231],a[52:55],a[104:107],v[228:231]
s_waitcnt vmcnt(2)
v_cmp_ne_u32 vcc,1,v247
s_cbranch_vccnz L_slow_p_4
L_back_p_4:
buffer_load_dwordx4 v[68:71],v213,s[24:27],s49 offen sc1
buffer_load_dwordx4 v[72:75],v213,s[24:27],s50 offen sc1
buffer_load_dwordx4 v[76:79],v213,s[24:27],s51 offen sc1
buffer_load_dwordx4 v[84:87],v214,s[24:27],s49 offen sc1
buffer_load_dwordx4 v[88:91],v214,s[24:27],s50 offen sc1
buffer_load_dwordx4 v[92:95],v214,s[24:27],s51 offen sc1
buffer_load_dwordx2 v[98:99],v218,s[24:27],s49 offen sc1
buffer_load_dwordx2 v[100:101],v218,s[24:27],s50 offen sc1
buffer_load_dwordx2 v[102:103],v218,s[24:27],s51 offen sc1
s_waitcnt lgkmcnt(0)
v_mfma_f32_16x16x32_bf16 v[144:147],a[32:35],a[96:99],v[144:147]
buffer_load_dwordx2 v[44:45],v211,s[4:7],s54 offen offset:448
v_add_u32 v245,102400,v245
v_add_u32 v246,102400,v246
ds_read_b64_tr_b16 a[44:45],v236 offset:49152
v_mfma_f32_16x16x32_bf16 v[152:155],a[32:35],a[100:103],v[152:155]
ds_read_b64_tr_b16 a[46:47],v236 offset:53248
ds_read_b64_tr_b16 a[48:49],v237 offset:49152
ds_read_b64_tr_b16 a[50:51],v237 offset:53248
v_mfma_f32_16x16x32_bf16 v[148:151],a[36:39],a[96:99],v[148:151]
ds_read_b64_tr_b16 a[52:53],v238 offset:59392
ds_read_b64_tr_b16 a[54:55],v238 offset:60416
ds_read_b128 a[104:107],v245 offset:16384
ds_read_b128 a[108:111],v246 offset:16384
v_mfma_f32_16x16x32_bf16 v[156:159],a[36:39],a[100:103],v[156:159]
v_mfma_f32_16x16x32_bf16 v[228:231],a[40:43],a[96:99],v[228:231]
s_waitcnt lgkmcnt(0)
v_mfma_f32_16x16x32_bf16 v[144:147],a[44:47],a[104:107],v[144:147]
v_mfma_f32_16x16x32_bf16 v[152:155],a[44:47],a[108:111],v[152:155]
v_mfma_f32_16x16x32_bf16 v[148:151],a[48:51],a[104:107],v[148:151]
v_mfma_f32_16x16x32_bf16 v[156:159],a[48:51],a[108:111],v[156:159]
v_mfma_f32_16x16x32_bf16 v[228:231],a[52:55],a[104:107],v[228:231]
s_waitcnt vmcnt(11)
v_permlane16_swap_b32 v36,v38
v_permlane16_swap_b32 v37,v39
s_waitcnt vmcnt(10)
v_permlane16_swap_b32 v40,v42
v_permlane16_swap_b32 v41,v43
v_mfma_f32_16x16x32_bf16 v[0:3],v[202:205],v[64:67],0
v_mfma_f32_16x16x32_bf16 v[4:7],v[200:203],v[64:67],0
s_waitcnt vmcnt(9)
v_mfma_f32_16x16x32_bf16 v[0:3],v[202:205],v[68:71],v[0:3]
v_mfma_f32_16x16x32_bf16 v[4:7],v[200:203],v[68:71],v[4:7]
s_waitcnt vmcnt(8)
v_mfma_f32_16x16x32_bf16 v[0:3],v[202:205],v[72:75],v[0:3]
v_mfma_f32_16x16x32_bf16 v[4:7],v[200:203],v[72:75],v[4:7]
s_waitcnt vmcnt(7)
v_mfma_f32_16x16x32_bf16 v[0:3],v[202:205],v[76:79],v[0:3]
v_mfma_f32_16x16x32_bf16 v[4:7],v[200:203],v[76:79],v[4:7]
s_nop 6
v_mul_f32 v0,v208,v0
v_mul_f32 v1,v208,v1
v_mul_f32 v2,v208,v2
v_mul_f32 v3,v208,v3
v_mfma_f32_16x16x32_bf16 v[8:11],v[202:205],v[80:83],0
v_mul_f32 v160,0xbfb8aa3b,v0
v_mul_f32 v162,0xbfb8aa3b,v1
v_mul_f32 v164,0xbfb8aa3b,v2
v_mul_f32 v166,0xbfb8aa3b,v3
v_exp_f32 v160,v160
v_exp_f32 v162,v162
v_mfma_f32_16x16x32_bf16 v[12:15],v[200:203],v[80:83],0
v_exp_f32 v164,v164
v_exp_f32 v166,v166
v_mul_f32 v0,v0,v144
v_mul_f32 v1,v1,v145
v_mul_f32 v2,v2,v146
v_mul_f32 v3,v3,v147
s_waitcnt vmcnt(6)
v_mfma_f32_16x16x32_bf16 v[8:11],v[202:205],v[84:87],v[8:11]
v_add_f32 v160,1.0,v160
v_add_f32 v162,1.0,v162
v_add_f32 v164,1.0,v164
v_add_f32 v166,1.0,v166
v_rcp_f32 v160,v160
v_rcp_f32 v162,v162
v_mfma_f32_16x16x32_bf16 v[12:15],v[200:203],v[84:87],v[12:15]
v_rcp_f32 v164,v164
v_rcp_f32 v166,v166
v_lshlrev_b32 v161,16,v36
v_and_b32 v163,0xffff0000,v36
v_lshlrev_b32 v165,16,v37
v_and_b32 v167,0xffff0000,v37
v_fma_f32 v0,v0,v160,v161
v_fma_f32 v1,v1,v162,v163
v_fma_f32 v2,v2,v164,v165
v_fma_f32 v3,v3,v166,v167
v_cvt_pk_bf16_f32 v0,v0,v1
v_cvt_pk_bf16_f32 v1,v2,v3
v_mul_f32 v4,v208,v4
v_mul_f32 v5,v208,v5
v_mul_f32 v6,v208,v6
v_mul_f32 v7,v208,v7
s_waitcnt vmcnt(5)
v_mfma_f32_16x16x32_bf16 v[8:11],v[202:205],v[88:91],v[8:11]
v_mul_f32 v168,0xbfb8aa3b,v4
v_mul_f32 v170,0xbfb8aa3b,v5
v_mul_f32 v172,0xbfb8aa3b,v6
v_mul_f32 v174,0xbfb8aa3b,v7
v_exp_f32 v168,v168
v_exp_f32 v170,v170
v_mfma_f32_16x16x32_bf16 v[12:15],v[200:203],v[88:91],v[12:15]
v_exp_f32 v172,v172
v_exp_f32 v174,v174
v_mul_f32 v4,v4,v148
v_mul_f32 v5,v5,v149
v_mul_f32 v6,v6,v150
v_mul_f32 v7,v7,v151
s_waitcnt vmcnt(4)
v_mfma_f32_16x16x32_bf16 v[8:11],v[202:205],v[92:95],v[8:11]
v_add_f32 v168,1.0,v168
v_add_f32 v170,1.0,v170
v_add_f32 v172,1.0,v172
v_add_f32 v174,1.0,v174
v_rcp_f32 v168,v168
v_rcp_f32 v170,v170
v_mfma_f32_16x16x32_bf16 v[12:15],v[200:203],v[92:95],v[12:15]
v_rcp_f32 v172,v172
v_rcp_f32 v174,v174
v_lshlrev_b32 v169,16,v38
v_and_b32 v171,0xffff0000,v38
v_lshlrev_b32 v173,16,v39
v_and_b32 v175,0xffff0000,v39
v_fma_f32 v4,v4,v168,v169
v_fma_f32 v5,v5,v170,v171
v_fma_f32 v6,v6,v172,v173
v_fma_f32 v7,v7,v174,v175
v_cvt_pk_bf16_f32 v2,v4,v5
v_cvt_pk_bf16_f32 v3,v6,v7
s_nop 0
v_permlane16_swap_b32 v0,v2
v_permlane16_swap_b32 v1,v3
buffer_store_dwordx4 v[0:3],v210,s[28:31],s54 offen offset:0
v_mul_f32 v8,v209,v8
v_mul_f32 v9,v209,v9
v_mul_f32 v10,v209,v10
v_mul_f32 v11,v209,v11
s_waitcnt vmcnt(4)
v_mfma_f32_16x16x32_bf16 v[16:19],v[232:235],v[96:99],0
v_mul_f32 v160,0xbfb8aa3b,v8
v_mul_f32 v162,0xbfb8aa3b,v9
v_mul_f32 v164,0xbfb8aa3b,v10
v_mul_f32 v166,0xbfb8aa3b,v11
v_exp_f32 v160,v160
v_exp_f32 v162,v162
s_waitcnt vmcnt(2)
v_mfma_f32_16x16x32_bf16 v[16:19],v[232:235],v[100:103],v[16:19]
v_exp_f32 v164,v164
v_exp_f32 v166,v166
v_mul_f32 v8,v8,v152
v_mul_f32 v9,v9,v153
v_mul_f32 v10,v10,v154
v_mul_f32 v11,v11,v155
v_add_f32 v160,1.0,v160
v_add_f32 v162,1.0,v162
v_add_f32 v164,1.0,v164
v_add_f32 v166,1.0,v166
v_rcp_f32 v160,v160
v_rcp_f32 v162,v162
v_rcp_f32 v164,v164
v_rcp_f32 v166,v166
v_lshlrev_b32 v161,16,v40
v_and_b32 v163,0xffff0000,v40
v_lshlrev_b32 v165,16,v41
v_and_b32 v167,0xffff0000,v41
v_fma_f32 v8,v8,v160,v161
v_fma_f32 v9,v9,v162,v163
v_fma_f32 v10,v10,v164,v165
v_fma_f32 v11,v11,v166,v167
v_cvt_pk_bf16_f32 v8,v8,v9
v_cvt_pk_bf16_f32 v9,v10,v11
v_mul_f32 v12,v209,v12
v_mul_f32 v13,v209,v13
v_mul_f32 v14,v209,v14
v_mul_f32 v15,v209,v15
v_mul_f32 v168,0xbfb8aa3b,v12
v_mul_f32 v170,0xbfb8aa3b,v13
v_mul_f32 v172,0xbfb8aa3b,v14
v_mul_f32 v174,0xbfb8aa3b,v15
v_exp_f32 v168,v168
v_exp_f32 v170,v170
v_exp_f32 v172,v172
v_exp_f32 v174,v174
v_mul_f32 v12,v12,v156
v_mul_f32 v13,v13,v157
v_mul_f32 v14,v14,v158
v_mul_f32 v15,v15,v159
v_add_f32 v168,1.0,v168
v_add_f32 v170,1.0,v170
v_add_f32 v172,1.0,v172
v_add_f32 v174,1.0,v174
v_rcp_f32 v168,v168
v_rcp_f32 v170,v170
v_rcp_f32 v172,v172
v_rcp_f32 v174,v174
v_lshlrev_b32 v169,16,v42
v_and_b32 v171,0xffff0000,v42
v_lshlrev_b32 v173,16,v43
v_and_b32 v175,0xffff0000,v43
v_fma_f32 v12,v12,v168,v169
v_fma_f32 v13,v13,v170,v171
v_fma_f32 v14,v14,v172,v173
v_fma_f32 v15,v15,v174,v175
v_cvt_pk_bf16_f32 v10,v12,v13
v_cvt_pk_bf16_f32 v11,v14,v15
s_nop 0
v_permlane16_swap_b32 v8,v10
v_permlane16_swap_b32 v9,v11
buffer_store_dwordx4 v[8:11],v210,s[28:31],s55 offen offset:0
v_mul_f32 v16,v208,v16
v_mul_f32 v17,v208,v17
v_mul_f32 v18,v208,v18
v_mul_f32 v19,v208,v19
v_mul_f32 v160,0xbfb8aa3b,v16
v_mul_f32 v162,0xbfb8aa3b,v17
v_mul_f32 v164,0xbfb8aa3b,v18
v_mul_f32 v166,0xbfb8aa3b,v19
v_exp_f32 v160,v160
v_exp_f32 v162,v162
v_exp_f32 v164,v164
v_exp_f32 v166,v166
v_mul_f32 v16,v16,v228
v_mul_f32 v17,v17,v229
v_mul_f32 v18,v18,v230
v_mul_f32 v19,v19,v231
v_add_f32 v160,1.0,v160
v_add_f32 v162,1.0,v162
v_add_f32 v164,1.0,v164
v_add_f32 v166,1.0,v166
v_rcp_f32 v160,v160
v_rcp_f32 v162,v162
v_rcp_f32 v164,v164
v_rcp_f32 v166,v166
s_waitcnt vmcnt(2)
v_lshlrev_b32 v161,16,v44
v_and_b32 v163,0xffff0000,v44
v_lshlrev_b32 v165,16,v45
v_and_b32 v167,0xffff0000,v45
v_fma_f32 v16,v16,v160,v161
v_fma_f32 v17,v17,v162,v163
v_fma_f32 v18,v18,v164,v165
v_fma_f32 v19,v19,v166,v167
v_cvt_pk_bf16_f32 v16,v16,v17
v_cvt_pk_bf16_f32 v17,v18,v19
buffer_store_dwordx2 v[16:17],v211,s[28:31],s54 offen offset:448
s_endpgm
L_slow_clr_4:
s_mov_b32 s97,0
L_spin_clr_4:
buffer_load_dword v247,v227,s[32:35],0 offen sc1
s_waitcnt vmcnt(0)
v_cmp_ne_u32 vcc,1,v247
s_add_u32 s97,s97,1
s_cbranch_vccz L_exit_clr_4
s_cmp_lt_u32 s97,200000
s_cbranch_scc1 L_spin_clr_4
L_exit_clr_4:

s_branch L_back_clr_4
L_slow_ha_4:
s_mov_b32 s97,0
L_spin_ha_4:
buffer_load_dword v247,v227,s[24:27],s90 offen sc1
s_waitcnt vmcnt(0)
v_cmp_ne_u32 vcc,1,v247
s_add_u32 s97,s97,1
s_cbranch_vccz L_exit_ha_4
s_cmp_lt_u32 s97,200000
s_cbranch_scc1 L_spin_ha_4
L_exit_ha_4:

s_branch L_back_ha_4
L_slow_kv_4:
s_mov_b32 s97,0
L_spin_kv_4:
buffer_load_dword v247,v227,s[24:27],s90 offen sc1
s_waitcnt vmcnt(0)
v_cmp_ne_u32 vcc,1,v247
s_add_u32 s97,s97,1
s_cbranch_vccz L_exit_kv_4
s_cmp_lt_u32 s97,200000
s_cbranch_scc1 L_spin_kv_4
L_exit_kv_4:

s_branch L_back_kv_4
L_slow_hb_4:
s_mov_b32 s97,0
L_spin_hb_4:
buffer_load_dword v247,v227,s[24:27],s90 offen sc1
s_waitcnt vmcnt(0)
v_cmp_ne_u32 vcc,1,v247
s_add_u32 s97,s97,1
s_cbranch_vccz L_exit_hb_4
s_cmp_lt_u32 s97,200000
s_cbranch_scc1 L_spin_hb_4
L_exit_hb_4:

s_branch L_back_hb_4
L_slow_hc_4:
s_mov_b32 s97,0
L_spin_hc_4:
buffer_load_dword v247,v227,s[24:27],s90 offen sc1
s_waitcnt vmcnt(0)
v_cmp_ne_u32 vcc,1,v247
s_add_u32 s97,s97,1
s_cbranch_vccz L_exit_hc_4
s_cmp_lt_u32 s97,200000
s_cbranch_scc1 L_spin_hc_4
L_exit_hc_4:

s_branch L_back_hc_4
L_slow_o_4:
s_mov_b32 s97,0
L_spin_o_4:
buffer_load_dword v247,v227,s[24:27],s90 offen sc1
s_waitcnt vmcnt(0)
v_cmp_ne_u32 vcc,1,v247
s_add_u32 s97,s97,1
s_cbranch_vccz L_exit_o_4
s_cmp_lt_u32 s97,200000
s_cbranch_scc1 L_spin_o_4
L_exit_o_4:

s_branch L_back_o_4
L_slow_hd_4:
s_mov_b32 s97,0
L_spin_hd_4:
buffer_load_dword v247,v227,s[24:27],s90 offen sc1
s_waitcnt vmcnt(0)
v_cmp_ne_u32 vcc,1,v247
s_add_u32 s97,s97,1
s_cbranch_vccz L_exit_hd_4
s_cmp_lt_u32 s97,200000
s_cbranch_scc1 L_spin_hd_4
L_exit_hd_4:

s_branch L_back_hd_4
L_slow_p_4:
s_mov_b32 s97,0
L_spin_p_4:
buffer_load_dword v247,v227,s[24:27],s90 offen sc1
s_waitcnt vmcnt(0)
v_cmp_ne_u32 vcc,1,v247
s_add_u32 s97,s97,1
s_cbranch_vccz L_exit_p_4
s_cmp_lt_u32 s97,200000
s_cbranch_scc1 L_spin_p_4
L_exit_p_4:

s_branch L_back_p_4
L_stop_4:
s_endpgm
.section .rodata,"a"
.p2align 6
.amdhsa_kernel recurrent_scan__linear_attn_block__glu_gated_glu__prompt_kernel
  .amdhsa_next_free_vgpr 512
  .amdhsa_next_free_sgpr 102
  .amdhsa_accum_offset 256
  .amdhsa_group_segment_fixed_size 0
  .amdhsa_kernarg_size 80
  .amdhsa_float_denorm_mode_32 3
  .amdhsa_user_sgpr_count 2
  .amdhsa_user_sgpr_kernarg_segment_ptr 1
  .amdhsa_system_sgpr_workgroup_id_x 1
.end_amdhsa_kernel
```
